```python
import torch

def _softmax(x, axis=-1):
    return torch.softmax(x, dim=axis)
def _gelu(x):
    return torch.nn.functional.gelu(x, approximate="tanh")
def _silu(x):
    return torch.nn.functional.silu(x)
def _sigmoid(x):
    return torch.sigmoid(x)
def _layernorm(x, axis=-1, eps=1e-5):
    m = x.mean(dim=axis, keepdim=True)
    v = x.var(dim=axis, keepdim=True, unbiased=False)
    return (x - m) / torch.sqrt(v + eps)
def _scatter_add(tgt, idx, src, axis=0):
    return tgt.clone().index_add_(axis, idx, src)
def _segment_sum(src, seg, n):
    out = torch.zeros((n,) + src.shape[1:], dtype=src.dtype)
    return out.index_add_(0, seg, src)
def _pad(x, pw):
    flat = tuple(v for pair in reversed(pw) for v in pair)
    return torch.nn.functional.pad(x, flat)

kernel_name = 'interleave_layers__spectral_gfnet__glu_gated_swiglu__prompt'

def setup_inputs():

    _w = (lambda a: (lambda t: t.to(torch.bfloat16) if t.is_floating_point() else t)(torch.as_tensor(a)))
    def _A_setup():
        B, S, D = 1, 2048, 512
        Df = D // 2 + 1
        return {
            "x": _w((lambda *s: torch.randn(*s, dtype=torch.bfloat16) * 0.05)(B, S, D)),
            "w_r": _w((lambda *s: torch.randn(*s, dtype=torch.bfloat16) * 0.4)(S, Df) * 0.02),
            "w_i": _w((lambda *s: torch.randn(*s, dtype=torch.bfloat16) * 0.4)(S, Df) * 0.02),
        }
    _A_in = _A_setup()

    def _B_setup():
        B, S, D, F = 1, 2048, 512, 1792
        return {
            "x": _w((lambda *s: torch.randn(*s, dtype=torch.bfloat16) * 0.05)(B, S, D)),
            "w1": _w((lambda *s: torch.randn(*s, dtype=torch.bfloat16) * 0.2)(D, F) * (2.0 / D) ** 0.5),
            "w3": _w((lambda *s: torch.randn(*s, dtype=torch.bfloat16) * 0.2)(D, F) * (2.0 / D) ** 0.5),
            "w2": _w((lambda *s: torch.randn(*s, dtype=torch.bfloat16) * 0.2)(F, D) * (2.0 / F) ** 0.5),
        }
    _B_in = _B_setup()

    return {
        "A_x": _A_in["x"],
        "A_w_r": _A_in["w_r"],
        "A_w_i": _A_in["w_i"],
        "B_x": _B_in["x"],
        "B_w1": _B_in["w1"],
        "B_w3": _B_in["w3"],
        "B_w2": _B_in["w2"],
    }

def reference(A_x, A_w_r, A_w_i, B_x, B_w1, B_w3, B_w2):
    def _A_ref(x, w_r, w_i):
        B, S, D = x.shape
        X = (lambda x, axes=(-2,-1): torch.fft.rfft2(x.float(), dim=axes))(x, axes=(-2, -1))
        W = w_r + 1j * w_i
        X = X * W
        y = (lambda x, s, axes=(-2,-1): torch.fft.irfft2(x, s=s, dim=axes).to(torch.bfloat16))(X, (S, D), axes=(-2, -1))
        return y

    def _B_ref(x, w1, w3, w2):
        gate = torch.einsum("bsd,df->bsf", x, w1)
        up = torch.einsum("bsd,df->bsf", x, w3)
        h = _silu(gate) * up
        out = torch.einsum("bsf,fd->bsd", h, w2)
        return out

    x = A_x
    x = x + _A_ref(_layernorm(x, axis=-1), A_w_r, A_w_i)
    x = x + _B_ref(_layernorm(x, axis=-1), B_w1, B_w3, B_w2)
    x = x + _A_ref(_layernorm(x, axis=-1), A_w_r, A_w_i)
    x = x + _B_ref(_layernorm(x, axis=-1), B_w1, B_w3, B_w2)
    return x
```

```asm
; @launch kernel=q0_kernel grid=(240,1,1) block=(256,1,1) lds=131072
; @launch kernel=q1_kernel grid=(256,1,1) block=(256,1,1) lds=24576
; @launch kernel=q2_kernel grid=(252,1,1) block=(256,1,1) lds=131584
; @launch kernel=q3_kernel grid=(256,1,1) block=(256,1,1) lds=49152
; @launch kernel=q4_kernel grid=(368,1,1) block=(256,1,1) lds=24576
; @launch kernel=q5_kernel grid=(256,1,1) block=(256,1,1) lds=131584
.amdgcn_target "amdgcn-amd-amdhsa--gfx950"
.text
.globl q0_kernel
.p2align 8
.type q0_kernel,@function
q0_kernel:
L_q0_kernel:
  s_cmp_ge_u32 s2, 240
  s_cbranch_scc1 q0e4
  s_load_dwordx2 s[4:5], s[0:1], 72
  v_lshrrev_b32 v1, 6, v0
  s_nop 0
  v_readfirstlane_b32 s3, v1
  s_cmp_ge_u32 s2, 176
  s_cbranch_scc1 q0p3
  s_getpc_b64 s[6:7]
  s_add_u32 s6, s6, RF@rel32@lo+4
  s_addc_u32 s7, s7, RF@rel32@hi+12
  s_mov_b32 s8, s6
  s_mov_b32 s9, s7
  s_mov_b32 s10, 0x80000
  s_mov_b32 s11, 0x20000
  s_cmp_ge_u32 s2, 64
  s_cbranch_scc1 q0b2
  s_load_dwordx2 s[6:7], s[0:1], 0
  s_getpc_b64 s[96:97]
pf6:
  s_mov_b32 s98, text_end-pf6
  s_mov_b32 s99, 0x20000
  v_lshlrev_b32 v2, 6, v0
  buffer_load_dword v3, v2, s[96:99], 0 offen
  s_lshr_b32 s30, s2, 3
  s_lshl_b32 s30, s30, 2
  s_add_u32 s30, s30, s3
  s_mul_i32 s30, s30, 8192
  v_and_b32 v2, 63, v0
  v_mul_u32_u24 v2, 128, v2
  v_add_u32 v2, s30, v2
  buffer_load_dword v3, v2, s[8:11], 0 offen
  s_and_b32 s20, s2, 7
  s_lshl_b32 s20, s20, 1
  s_bfe_u32 s21, s2, 0x10003
  s_or_b32 s20, s20, s21
  s_lshr_b32 s21, s2, 4
  s_waitcnt lgkmcnt(0)
  s_mov_b32 s12, s6
  s_mov_b32 s13, s7
  s_mov_b32 s14, 0x200000
  s_mov_b32 s15, 0x20000
  s_mov_b32 s16, s4
  s_mov_b32 s17, s5
  s_mov_b32 s18, 0x200000
  s_mov_b32 s19, 0x20000
  s_add_u32 s22, s3, s21
  s_and_b32 s22, s22, 3
  s_lshl_b32 s22, s22, 5
  s_lshl_b32 s23, s20, 7
  s_add_u32 s22, s22, s23
  s_lshl_b32 s22, s22, 10
  s_lshl_b32 s24, s21, 2
  s_add_u32 s24, s24, s3
  s_lshl_b32 s25, s24, 15
  s_lshl_b32 s30, s20, 2
  s_add_u32 s30, s30, s21
  s_lshl_b32 s30, s30, 2
  s_add_u32 s30, s30, s3
  s_lshl_b32 s30, s30, 13
  v_and_b32 v2, 63, v0
  v_mul_u32_u24 v2, 128, v2
  buffer_load_dword v3, v2, s[12:15], s30 offen
  s_lshl_b32 s50, s21, 1
  s_and_b32 s51, s20, 1
  s_add_u32 s50, s50, s51
  s_and_b32 s50, s50, 7
  v_and_b32 v71, 63, v0
  v_lshlrev_b32 v68, 4, v71
  v_and_b32 v69, 31, v71
  v_lshrrev_b32 v70, 5, v71
  v_lshrrev_b32 v104, 4, v71
  v_xor_b32 v104, v104, v71
  v_and_b32 v104, 7, v104
  v_lshlrev_b32 v104, 4, v104
  v_lshrrev_b32 v105, 3, v71
  v_lshl_or_b32 v106, v105, 10, v104
  v_lshrrev_b32 v104, 4, v71
  v_add_u32 v104, 4, v104
  v_xor_b32 v104, v104, v71
  v_and_b32 v104, 7, v104
  v_lshlrev_b32 v104, 4, v104
  v_lshrrev_b32 v105, 3, v71
  v_lshl_or_b32 v107, v105, 10, v104
  s_lshl_b32 s28, s3, 12
  s_add_u32 m0, s28, 0
  s_add_u32 s29, s22, 0
  buffer_load_dwordx4 v106, s[12:15], s29 offen lds
  s_add_u32 m0, s28, 1024
  s_add_u32 s29, s22, 8192
  buffer_load_dwordx4 v107, s[12:15], s29 offen lds
  s_add_u32 m0, s28, 2048
  s_add_u32 s29, s22, 16384
  buffer_load_dwordx4 v106, s[12:15], s29 offen lds
  s_add_u32 m0, s28, 3072
  s_add_u32 s29, s22, 24576
  buffer_load_dwordx4 v107, s[12:15], s29 offen lds
  buffer_load_dwordx4 a[0:3], v68, s[8:11], s25 offen offset:0
  buffer_load_dwordx4 a[4:7], v68, s[8:11], s25 offen offset:1024
  buffer_load_dwordx4 a[8:11], v68, s[8:11], s25 offen offset:2048
  s_add_u32 m0, s28, 16384
  s_add_u32 s29, s22, 128
  buffer_load_dwordx4 v106, s[12:15], s29 offen lds
  s_add_u32 m0, s28, 17408
  s_add_u32 s29, s22, 8320
  buffer_load_dwordx4 v107, s[12:15], s29 offen lds
  s_add_u32 m0, s28, 18432
  s_add_u32 s29, s22, 16512
  buffer_load_dwordx4 v106, s[12:15], s29 offen lds
  s_add_u32 m0, s28, 19456
  s_add_u32 s29, s22, 24704
  buffer_load_dwordx4 v107, s[12:15], s29 offen lds
  buffer_load_dwordx4 a[12:15], v68, s[8:11], s25 offen offset:3072
  v_lshrrev_b32 v104, 1, v69
  v_and_b32 v104, 7, v104
  v_xor_b32 v104, v104, v70
  v_xor_b32 v105, 0, v104
  v_lshlrev_b32 v105, 4, v105
  v_lshl_or_b32 v108, v69, 7, v105
  v_add_u32 v112, 0x10000, v108
  v_xor_b32 v105, 2, v104
  v_lshlrev_b32 v105, 4, v105
  v_lshl_or_b32 v109, v69, 7, v105
  v_add_u32 v113, 0x10000, v109
  v_xor_b32 v105, 4, v104
  v_lshlrev_b32 v105, 4, v105
  v_lshl_or_b32 v110, v69, 7, v105
  v_add_u32 v114, 0x10000, v110
  v_xor_b32 v105, 6, v104
  v_lshlrev_b32 v105, 4, v105
  v_lshl_or_b32 v111, v69, 7, v105
  v_add_u32 v115, 0x10000, v111
  s_waitcnt vmcnt(8)
  s_barrier
  ds_read_b128 v[72:75], v108 offset:0
  ds_read_b128 v[76:79], v108 offset:4096
  ds_read_b128 v[80:83], v108 offset:8192
  ds_read_b128 v[84:87], v108 offset:12288
  s_waitcnt vmcnt(7) lgkmcnt(3)
  v_mfma_f32_32x32x16_bf16 v[4:19], a[0:3], v[72:75], 0
  ds_read_b128 v[88:91], v109 offset:0
  ds_read_b128 v[92:95], v109 offset:4096
  s_add_u32 s25, s25, 4096
  buffer_load_dwordx4 a[16:19], v68, s[8:11], s25 offen offset:0
  s_waitcnt lgkmcnt(4)
  v_mfma_f32_32x32x16_bf16 v[20:35], a[0:3], v[76:79], 0
  ds_read_b128 v[96:99], v109 offset:8192
  s_waitcnt lgkmcnt(4)
  v_mfma_f32_32x32x16_bf16 v[36:51], a[0:3], v[80:83], 0
  ds_read_b128 v[100:103], v109 offset:12288
  buffer_load_dwordx4 a[20:23], v68, s[8:11], s25 offen offset:1024
  s_waitcnt lgkmcnt(4)
  v_mfma_f32_32x32x16_bf16 v[52:67], a[0:3], v[84:87], 0
  s_waitcnt vmcnt(8) lgkmcnt(3)
  v_mfma_f32_32x32x16_bf16 v[4:19], a[4:7], v[88:91], v[4:19]
  ds_read_b128 v[72:75], v110 offset:0
  ds_read_b128 v[76:79], v110 offset:4096
  buffer_load_dwordx4 a[24:27], v68, s[8:11], s25 offen offset:2048
  s_waitcnt lgkmcnt(4)
  v_mfma_f32_32x32x16_bf16 v[20:35], a[4:7], v[92:95], v[20:35]
  ds_read_b128 v[80:83], v110 offset:8192
  s_waitcnt lgkmcnt(4)
  v_mfma_f32_32x32x16_bf16 v[36:51], a[4:7], v[96:99], v[36:51]
  ds_read_b128 v[84:87], v110 offset:12288
  s_add_u32 m0, s28, 32768
  s_add_u32 s29, s22, 256
  buffer_load_dwordx4 v106, s[12:15], s29 offen lds
  s_waitcnt lgkmcnt(4)
  v_mfma_f32_32x32x16_bf16 v[52:67], a[4:7], v[100:103], v[52:67]
  s_waitcnt vmcnt(9) lgkmcnt(3)
  v_mfma_f32_32x32x16_bf16 v[4:19], a[8:11], v[72:75], v[4:19]
  ds_read_b128 v[88:91], v111 offset:0
  ds_read_b128 v[92:95], v111 offset:4096
  s_add_u32 m0, s28, 33792
  s_add_u32 s29, s22, 8448
  buffer_load_dwordx4 v107, s[12:15], s29 offen lds
  s_waitcnt lgkmcnt(4)
  v_mfma_f32_32x32x16_bf16 v[20:35], a[8:11], v[76:79], v[20:35]
  ds_read_b128 v[96:99], v111 offset:8192
  s_waitcnt lgkmcnt(4)
  v_mfma_f32_32x32x16_bf16 v[36:51], a[8:11], v[80:83], v[36:51]
  ds_read_b128 v[100:103], v111 offset:12288
  s_add_u32 m0, s28, 34816
  s_add_u32 s29, s22, 16640
  buffer_load_dwordx4 v106, s[12:15], s29 offen lds
  s_waitcnt lgkmcnt(4)
  v_mfma_f32_32x32x16_bf16 v[52:67], a[8:11], v[84:87], v[52:67]
  s_waitcnt vmcnt(7)
  s_barrier
  s_waitcnt vmcnt(6) lgkmcnt(3)
  v_mfma_f32_32x32x16_bf16 v[4:19], a[12:15], v[88:91], v[4:19]
  ds_read_b128 v[72:75], v108 offset:16384
  ds_read_b128 v[76:79], v108 offset:20480
  s_add_u32 m0, s28, 35840
  s_add_u32 s29, s22, 24832
  buffer_load_dwordx4 v107, s[12:15], s29 offen lds
  s_waitcnt lgkmcnt(4)
  v_mfma_f32_32x32x16_bf16 v[20:35], a[12:15], v[92:95], v[20:35]
  ds_read_b128 v[80:83], v108 offset:24576
  s_waitcnt lgkmcnt(4)
  v_mfma_f32_32x32x16_bf16 v[36:51], a[12:15], v[96:99], v[36:51]
  ds_read_b128 v[84:87], v108 offset:28672
  buffer_load_dwordx4 a[28:31], v68, s[8:11], s25 offen offset:3072
  s_waitcnt lgkmcnt(4)
  v_mfma_f32_32x32x16_bf16 v[52:67], a[12:15], v[100:103], v[52:67]
  s_waitcnt vmcnt(7) lgkmcnt(3)
  v_mfma_f32_32x32x16_bf16 v[4:19], a[16:19], v[72:75], v[4:19]
  ds_read_b128 v[88:91], v109 offset:16384
  ds_read_b128 v[92:95], v109 offset:20480
  s_add_u32 s25, s25, 4096
  buffer_load_dwordx4 a[32:35], v68, s[8:11], s25 offen offset:0
  s_waitcnt lgkmcnt(4)
  v_mfma_f32_32x32x16_bf16 v[20:35], a[16:19], v[76:79], v[20:35]
  ds_read_b128 v[96:99], v109 offset:24576
  s_waitcnt lgkmcnt(4)
  v_mfma_f32_32x32x16_bf16 v[36:51], a[16:19], v[80:83], v[36:51]
  ds_read_b128 v[100:103], v109 offset:28672
  buffer_load_dwordx4 a[36:39], v68, s[8:11], s25 offen offset:1024
  s_waitcnt lgkmcnt(4)
  v_mfma_f32_32x32x16_bf16 v[52:67], a[16:19], v[84:87], v[52:67]
  s_waitcnt vmcnt(8) lgkmcnt(3)
  v_mfma_f32_32x32x16_bf16 v[4:19], a[20:23], v[88:91], v[4:19]
  ds_read_b128 v[72:75], v110 offset:16384
  ds_read_b128 v[76:79], v110 offset:20480
  buffer_load_dwordx4 a[40:43], v68, s[8:11], s25 offen offset:2048
  s_waitcnt lgkmcnt(4)
  v_mfma_f32_32x32x16_bf16 v[20:35], a[20:23], v[92:95], v[20:35]
  ds_read_b128 v[80:83], v110 offset:24576
  s_waitcnt lgkmcnt(4)
  v_mfma_f32_32x32x16_bf16 v[36:51], a[20:23], v[96:99], v[36:51]
  ds_read_b128 v[84:87], v110 offset:28672
  s_add_u32 m0, s28, 49152
  s_add_u32 s29, s22, 384
  buffer_load_dwordx4 v106, s[12:15], s29 offen lds
  s_waitcnt lgkmcnt(4)
  v_mfma_f32_32x32x16_bf16 v[52:67], a[20:23], v[100:103], v[52:67]
  s_waitcnt vmcnt(9) lgkmcnt(3)
  v_mfma_f32_32x32x16_bf16 v[4:19], a[24:27], v[72:75], v[4:19]
  ds_read_b128 v[88:91], v111 offset:16384
  ds_read_b128 v[92:95], v111 offset:20480
  s_add_u32 m0, s28, 50176
  s_add_u32 s29, s22, 8576
  buffer_load_dwordx4 v107, s[12:15], s29 offen lds
  s_waitcnt lgkmcnt(4)
  v_mfma_f32_32x32x16_bf16 v[20:35], a[24:27], v[76:79], v[20:35]
  ds_read_b128 v[96:99], v111 offset:24576
  s_waitcnt lgkmcnt(4)
  v_mfma_f32_32x32x16_bf16 v[36:51], a[24:27], v[80:83], v[36:51]
  ds_read_b128 v[100:103], v111 offset:28672
  s_add_u32 m0, s28, 51200
  s_add_u32 s29, s22, 16768
  buffer_load_dwordx4 v106, s[12:15], s29 offen lds
  s_waitcnt lgkmcnt(4)
  v_mfma_f32_32x32x16_bf16 v[52:67], a[24:27], v[84:87], v[52:67]
  s_waitcnt vmcnt(7)
  s_barrier
  s_waitcnt vmcnt(6) lgkmcnt(3)
  v_mfma_f32_32x32x16_bf16 v[4:19], a[28:31], v[88:91], v[4:19]
  ds_read_b128 v[72:75], v108 offset:32768
  ds_read_b128 v[76:79], v108 offset:36864
  s_add_u32 m0, s28, 52224
  s_add_u32 s29, s22, 24960
  buffer_load_dwordx4 v107, s[12:15], s29 offen lds
  s_waitcnt lgkmcnt(4)
  v_mfma_f32_32x32x16_bf16 v[20:35], a[28:31], v[92:95], v[20:35]
  ds_read_b128 v[80:83], v108 offset:40960
  s_waitcnt lgkmcnt(4)
  v_mfma_f32_32x32x16_bf16 v[36:51], a[28:31], v[96:99], v[36:51]
  ds_read_b128 v[84:87], v108 offset:45056
  buffer_load_dwordx4 a[44:47], v68, s[8:11], s25 offen offset:3072
  s_waitcnt lgkmcnt(4)
  v_mfma_f32_32x32x16_bf16 v[52:67], a[28:31], v[100:103], v[52:67]
  s_waitcnt vmcnt(7) lgkmcnt(3)
  v_mfma_f32_32x32x16_bf16 v[4:19], a[32:35], v[72:75], v[4:19]
  ds_read_b128 v[88:91], v109 offset:32768
  ds_read_b128 v[92:95], v109 offset:36864
  s_add_u32 s25, s25, 4096
  buffer_load_dwordx4 a[48:51], v68, s[8:11], s25 offen offset:0
  s_waitcnt lgkmcnt(4)
  v_mfma_f32_32x32x16_bf16 v[20:35], a[32:35], v[76:79], v[20:35]
  ds_read_b128 v[96:99], v109 offset:40960
  s_waitcnt lgkmcnt(4)
  v_mfma_f32_32x32x16_bf16 v[36:51], a[32:35], v[80:83], v[36:51]
  ds_read_b128 v[100:103], v109 offset:45056
  buffer_load_dwordx4 a[52:55], v68, s[8:11], s25 offen offset:1024
  s_waitcnt lgkmcnt(4)
  v_mfma_f32_32x32x16_bf16 v[52:67], a[32:35], v[84:87], v[52:67]
  s_waitcnt vmcnt(8) lgkmcnt(3)
  v_mfma_f32_32x32x16_bf16 v[4:19], a[36:39], v[88:91], v[4:19]
  ds_read_b128 v[72:75], v110 offset:32768
  ds_read_b128 v[76:79], v110 offset:36864
  buffer_load_dwordx4 a[56:59], v68, s[8:11], s25 offen offset:2048
  s_waitcnt lgkmcnt(4)
  v_mfma_f32_32x32x16_bf16 v[20:35], a[36:39], v[92:95], v[20:35]
  ds_read_b128 v[80:83], v110 offset:40960
  s_waitcnt lgkmcnt(4)
  v_mfma_f32_32x32x16_bf16 v[36:51], a[36:39], v[96:99], v[36:51]
  ds_read_b128 v[84:87], v110 offset:45056
  s_add_u32 m0, s28, 65536
  s_add_u32 s29, s22, 512
  buffer_load_dwordx4 v106, s[12:15], s29 offen lds
  s_waitcnt lgkmcnt(4)
  v_mfma_f32_32x32x16_bf16 v[52:67], a[36:39], v[100:103], v[52:67]
  s_waitcnt vmcnt(9) lgkmcnt(3)
  v_mfma_f32_32x32x16_bf16 v[4:19], a[40:43], v[72:75], v[4:19]
  ds_read_b128 v[88:91], v111 offset:32768
  ds_read_b128 v[92:95], v111 offset:36864
  s_add_u32 m0, s28, 66560
  s_add_u32 s29, s22, 8704
  buffer_load_dwordx4 v107, s[12:15], s29 offen lds
  s_waitcnt lgkmcnt(4)
  v_mfma_f32_32x32x16_bf16 v[20:35], a[40:43], v[76:79], v[20:35]
  ds_read_b128 v[96:99], v111 offset:40960
  s_waitcnt lgkmcnt(4)
  v_mfma_f32_32x32x16_bf16 v[36:51], a[40:43], v[80:83], v[36:51]
  ds_read_b128 v[100:103], v111 offset:45056
  s_add_u32 m0, s28, 67584
  s_add_u32 s29, s22, 16896
  buffer_load_dwordx4 v106, s[12:15], s29 offen lds
  s_waitcnt lgkmcnt(4)
  v_mfma_f32_32x32x16_bf16 v[52:67], a[40:43], v[84:87], v[52:67]
  s_waitcnt vmcnt(7)
  s_barrier
  s_waitcnt vmcnt(6) lgkmcnt(3)
  v_mfma_f32_32x32x16_bf16 v[4:19], a[44:47], v[88:91], v[4:19]
  ds_read_b128 v[72:75], v108 offset:49152
  ds_read_b128 v[76:79], v108 offset:53248
  s_add_u32 m0, s28, 68608
  s_add_u32 s29, s22, 25088
  buffer_load_dwordx4 v107, s[12:15], s29 offen lds
  s_waitcnt lgkmcnt(4)
  v_mfma_f32_32x32x16_bf16 v[20:35], a[44:47], v[92:95], v[20:35]
  ds_read_b128 v[80:83], v108 offset:57344
  s_waitcnt lgkmcnt(4)
  v_mfma_f32_32x32x16_bf16 v[36:51], a[44:47], v[96:99], v[36:51]
  ds_read_b128 v[84:87], v108 offset:61440
  buffer_load_dwordx4 a[60:63], v68, s[8:11], s25 offen offset:3072
  s_waitcnt lgkmcnt(4)
  v_mfma_f32_32x32x16_bf16 v[52:67], a[44:47], v[100:103], v[52:67]
  s_waitcnt vmcnt(7) lgkmcnt(3)
  v_mfma_f32_32x32x16_bf16 v[4:19], a[48:51], v[72:75], v[4:19]
  ds_read_b128 v[88:91], v109 offset:49152
  ds_read_b128 v[92:95], v109 offset:53248
  s_add_u32 s25, s25, 4096
  buffer_load_dwordx4 a[64:67], v68, s[8:11], s25 offen offset:0
  s_waitcnt lgkmcnt(4)
  v_mfma_f32_32x32x16_bf16 v[20:35], a[48:51], v[76:79], v[20:35]
  ds_read_b128 v[96:99], v109 offset:57344
  s_waitcnt lgkmcnt(4)
  v_mfma_f32_32x32x16_bf16 v[36:51], a[48:51], v[80:83], v[36:51]
  ds_read_b128 v[100:103], v109 offset:61440
  buffer_load_dwordx4 a[68:71], v68, s[8:11], s25 offen offset:1024
  s_waitcnt lgkmcnt(4)
  v_mfma_f32_32x32x16_bf16 v[52:67], a[48:51], v[84:87], v[52:67]
  s_waitcnt vmcnt(8) lgkmcnt(3)
  v_mfma_f32_32x32x16_bf16 v[4:19], a[52:55], v[88:91], v[4:19]
  ds_read_b128 v[72:75], v110 offset:49152
  ds_read_b128 v[76:79], v110 offset:53248
  buffer_load_dwordx4 a[72:75], v68, s[8:11], s25 offen offset:2048
  s_waitcnt lgkmcnt(4)
  v_mfma_f32_32x32x16_bf16 v[20:35], a[52:55], v[92:95], v[20:35]
  ds_read_b128 v[80:83], v110 offset:57344
  s_waitcnt lgkmcnt(4)
  v_mfma_f32_32x32x16_bf16 v[36:51], a[52:55], v[96:99], v[36:51]
  ds_read_b128 v[84:87], v110 offset:61440
  s_add_u32 m0, s28, 81920
  s_add_u32 s29, s22, 640
  buffer_load_dwordx4 v106, s[12:15], s29 offen lds
  s_waitcnt lgkmcnt(4)
  v_mfma_f32_32x32x16_bf16 v[52:67], a[52:55], v[100:103], v[52:67]
  s_waitcnt vmcnt(9) lgkmcnt(3)
  v_mfma_f32_32x32x16_bf16 v[4:19], a[56:59], v[72:75], v[4:19]
  ds_read_b128 v[88:91], v111 offset:49152
  ds_read_b128 v[92:95], v111 offset:53248
  s_add_u32 m0, s28, 82944
  s_add_u32 s29, s22, 8832
  buffer_load_dwordx4 v107, s[12:15], s29 offen lds
  s_waitcnt lgkmcnt(4)
  v_mfma_f32_32x32x16_bf16 v[20:35], a[56:59], v[76:79], v[20:35]
  ds_read_b128 v[96:99], v111 offset:57344
  s_waitcnt lgkmcnt(4)
  v_mfma_f32_32x32x16_bf16 v[36:51], a[56:59], v[80:83], v[36:51]
  ds_read_b128 v[100:103], v111 offset:61440
  s_add_u32 m0, s28, 83968
  s_add_u32 s29, s22, 17024
  buffer_load_dwordx4 v106, s[12:15], s29 offen lds
  s_waitcnt lgkmcnt(4)
  v_mfma_f32_32x32x16_bf16 v[52:67], a[56:59], v[84:87], v[52:67]
  s_waitcnt vmcnt(7)
  s_barrier
  s_waitcnt vmcnt(6) lgkmcnt(3)
  v_mfma_f32_32x32x16_bf16 v[4:19], a[60:63], v[88:91], v[4:19]
  ds_read_b128 v[72:75], v112 offset:0
  ds_read_b128 v[76:79], v112 offset:4096
  s_add_u32 m0, s28, 84992
  s_add_u32 s29, s22, 25216
  buffer_load_dwordx4 v107, s[12:15], s29 offen lds
  s_waitcnt lgkmcnt(4)
  v_mfma_f32_32x32x16_bf16 v[20:35], a[60:63], v[92:95], v[20:35]
  ds_read_b128 v[80:83], v112 offset:8192
  s_waitcnt lgkmcnt(4)
  v_mfma_f32_32x32x16_bf16 v[36:51], a[60:63], v[96:99], v[36:51]
  ds_read_b128 v[84:87], v112 offset:12288
  buffer_load_dwordx4 a[76:79], v68, s[8:11], s25 offen offset:3072
  s_waitcnt lgkmcnt(4)
  v_mfma_f32_32x32x16_bf16 v[52:67], a[60:63], v[100:103], v[52:67]
  s_waitcnt vmcnt(7) lgkmcnt(3)
  v_mfma_f32_32x32x16_bf16 v[4:19], a[64:67], v[72:75], v[4:19]
  ds_read_b128 v[88:91], v113 offset:0
  ds_read_b128 v[92:95], v113 offset:4096
  s_add_u32 s25, s25, 4096
  buffer_load_dwordx4 a[80:83], v68, s[8:11], s25 offen offset:0
  s_waitcnt lgkmcnt(4)
  v_mfma_f32_32x32x16_bf16 v[20:35], a[64:67], v[76:79], v[20:35]
  ds_read_b128 v[96:99], v113 offset:8192
  s_waitcnt lgkmcnt(4)
  v_mfma_f32_32x32x16_bf16 v[36:51], a[64:67], v[80:83], v[36:51]
  ds_read_b128 v[100:103], v113 offset:12288
  buffer_load_dwordx4 a[84:87], v68, s[8:11], s25 offen offset:1024
  s_waitcnt lgkmcnt(4)
  v_mfma_f32_32x32x16_bf16 v[52:67], a[64:67], v[84:87], v[52:67]
  s_waitcnt vmcnt(8) lgkmcnt(3)
  v_mfma_f32_32x32x16_bf16 v[4:19], a[68:71], v[88:91], v[4:19]
  ds_read_b128 v[72:75], v114 offset:0
  ds_read_b128 v[76:79], v114 offset:4096
  buffer_load_dwordx4 a[88:91], v68, s[8:11], s25 offen offset:2048
  s_waitcnt lgkmcnt(4)
  v_mfma_f32_32x32x16_bf16 v[20:35], a[68:71], v[92:95], v[20:35]
  ds_read_b128 v[80:83], v114 offset:8192
  s_waitcnt lgkmcnt(4)
  v_mfma_f32_32x32x16_bf16 v[36:51], a[68:71], v[96:99], v[36:51]
  ds_read_b128 v[84:87], v114 offset:12288
  s_add_u32 m0, s28, 98304
  s_add_u32 s29, s22, 768
  buffer_load_dwordx4 v106, s[12:15], s29 offen lds
  s_waitcnt lgkmcnt(4)
  v_mfma_f32_32x32x16_bf16 v[52:67], a[68:71], v[100:103], v[52:67]
  s_waitcnt vmcnt(9) lgkmcnt(3)
  v_mfma_f32_32x32x16_bf16 v[4:19], a[72:75], v[72:75], v[4:19]
  ds_read_b128 v[88:91], v115 offset:0
  ds_read_b128 v[92:95], v115 offset:4096
  s_add_u32 m0, s28, 99328
  s_add_u32 s29, s22, 8960
  buffer_load_dwordx4 v107, s[12:15], s29 offen lds
  s_waitcnt lgkmcnt(4)
  v_mfma_f32_32x32x16_bf16 v[20:35], a[72:75], v[76:79], v[20:35]
  ds_read_b128 v[96:99], v115 offset:8192
  s_waitcnt lgkmcnt(4)
  v_mfma_f32_32x32x16_bf16 v[36:51], a[72:75], v[80:83], v[36:51]
  ds_read_b128 v[100:103], v115 offset:12288
  s_add_u32 m0, s28, 100352
  s_add_u32 s29, s22, 17152
  buffer_load_dwordx4 v106, s[12:15], s29 offen lds
  s_waitcnt lgkmcnt(4)
  v_mfma_f32_32x32x16_bf16 v[52:67], a[72:75], v[84:87], v[52:67]
  s_waitcnt vmcnt(7)
  s_barrier
  s_waitcnt vmcnt(6) lgkmcnt(3)
  v_mfma_f32_32x32x16_bf16 v[4:19], a[76:79], v[88:91], v[4:19]
  ds_read_b128 v[72:75], v112 offset:16384
  ds_read_b128 v[76:79], v112 offset:20480
  s_add_u32 m0, s28, 101376
  s_add_u32 s29, s22, 25344
  buffer_load_dwordx4 v107, s[12:15], s29 offen lds
  s_waitcnt lgkmcnt(4)
  v_mfma_f32_32x32x16_bf16 v[20:35], a[76:79], v[92:95], v[20:35]
  ds_read_b128 v[80:83], v112 offset:24576
  s_waitcnt lgkmcnt(4)
  v_mfma_f32_32x32x16_bf16 v[36:51], a[76:79], v[96:99], v[36:51]
  ds_read_b128 v[84:87], v112 offset:28672
  buffer_load_dwordx4 a[92:95], v68, s[8:11], s25 offen offset:3072
  s_waitcnt lgkmcnt(4)
  v_mfma_f32_32x32x16_bf16 v[52:67], a[76:79], v[100:103], v[52:67]
  s_waitcnt vmcnt(7) lgkmcnt(3)
  v_mfma_f32_32x32x16_bf16 v[4:19], a[80:83], v[72:75], v[4:19]
  ds_read_b128 v[88:91], v113 offset:16384
  ds_read_b128 v[92:95], v113 offset:20480
  s_add_u32 s25, s25, 4096
  buffer_load_dwordx4 a[96:99], v68, s[8:11], s25 offen offset:0
  s_waitcnt lgkmcnt(4)
  v_mfma_f32_32x32x16_bf16 v[20:35], a[80:83], v[76:79], v[20:35]
  ds_read_b128 v[96:99], v113 offset:24576
  s_waitcnt lgkmcnt(4)
  v_mfma_f32_32x32x16_bf16 v[36:51], a[80:83], v[80:83], v[36:51]
  ds_read_b128 v[100:103], v113 offset:28672
  buffer_load_dwordx4 a[100:103], v68, s[8:11], s25 offen offset:1024
  s_waitcnt lgkmcnt(4)
  v_mfma_f32_32x32x16_bf16 v[52:67], a[80:83], v[84:87], v[52:67]
  s_waitcnt vmcnt(8) lgkmcnt(3)
  v_mfma_f32_32x32x16_bf16 v[4:19], a[84:87], v[88:91], v[4:19]
  ds_read_b128 v[72:75], v114 offset:16384
  ds_read_b128 v[76:79], v114 offset:20480
  buffer_load_dwordx4 a[104:107], v68, s[8:11], s25 offen offset:2048
  s_waitcnt lgkmcnt(4)
  v_mfma_f32_32x32x16_bf16 v[20:35], a[84:87], v[92:95], v[20:35]
  ds_read_b128 v[80:83], v114 offset:24576
  s_waitcnt lgkmcnt(4)
  v_mfma_f32_32x32x16_bf16 v[36:51], a[84:87], v[96:99], v[36:51]
  ds_read_b128 v[84:87], v114 offset:28672
  s_add_u32 m0, s28, 114688
  s_add_u32 s29, s22, 896
  buffer_load_dwordx4 v106, s[12:15], s29 offen lds
  s_waitcnt lgkmcnt(4)
  v_mfma_f32_32x32x16_bf16 v[52:67], a[84:87], v[100:103], v[52:67]
  s_waitcnt vmcnt(9) lgkmcnt(3)
  v_mfma_f32_32x32x16_bf16 v[4:19], a[88:91], v[72:75], v[4:19]
  ds_read_b128 v[88:91], v115 offset:16384
  ds_read_b128 v[92:95], v115 offset:20480
  s_add_u32 m0, s28, 115712
  s_add_u32 s29, s22, 9088
  buffer_load_dwordx4 v107, s[12:15], s29 offen lds
  s_waitcnt lgkmcnt(4)
  v_mfma_f32_32x32x16_bf16 v[20:35], a[88:91], v[76:79], v[20:35]
  ds_read_b128 v[96:99], v115 offset:24576
  s_waitcnt lgkmcnt(4)
  v_mfma_f32_32x32x16_bf16 v[36:51], a[88:91], v[80:83], v[36:51]
  ds_read_b128 v[100:103], v115 offset:28672
  s_add_u32 m0, s28, 116736
  s_add_u32 s29, s22, 17280
  buffer_load_dwordx4 v106, s[12:15], s29 offen lds
  s_waitcnt lgkmcnt(4)
  v_mfma_f32_32x32x16_bf16 v[52:67], a[88:91], v[84:87], v[52:67]
  s_waitcnt vmcnt(7)
  s_barrier
  s_waitcnt vmcnt(6) lgkmcnt(3)
  v_mfma_f32_32x32x16_bf16 v[4:19], a[92:95], v[88:91], v[4:19]
  ds_read_b128 v[72:75], v112 offset:32768
  ds_read_b128 v[76:79], v112 offset:36864
  s_add_u32 m0, s28, 117760
  s_add_u32 s29, s22, 25472
  buffer_load_dwordx4 v107, s[12:15], s29 offen lds
  s_waitcnt lgkmcnt(4)
  v_mfma_f32_32x32x16_bf16 v[20:35], a[92:95], v[92:95], v[20:35]
  ds_read_b128 v[80:83], v112 offset:40960
  s_waitcnt lgkmcnt(4)
  v_mfma_f32_32x32x16_bf16 v[36:51], a[92:95], v[96:99], v[36:51]
  ds_read_b128 v[84:87], v112 offset:45056
  buffer_load_dwordx4 a[108:111], v68, s[8:11], s25 offen offset:3072
  s_waitcnt lgkmcnt(4)
  v_mfma_f32_32x32x16_bf16 v[52:67], a[92:95], v[100:103], v[52:67]
  s_waitcnt vmcnt(7) lgkmcnt(3)
  v_mfma_f32_32x32x16_bf16 v[4:19], a[96:99], v[72:75], v[4:19]
  ds_read_b128 v[88:91], v113 offset:32768
  ds_read_b128 v[92:95], v113 offset:36864
  s_add_u32 s25, s25, 4096
  buffer_load_dwordx4 a[112:115], v68, s[8:11], s25 offen offset:0
  s_waitcnt lgkmcnt(4)
  v_mfma_f32_32x32x16_bf16 v[20:35], a[96:99], v[76:79], v[20:35]
  ds_read_b128 v[96:99], v113 offset:40960
  s_waitcnt lgkmcnt(4)
  v_mfma_f32_32x32x16_bf16 v[36:51], a[96:99], v[80:83], v[36:51]
  ds_read_b128 v[100:103], v113 offset:45056
  buffer_load_dwordx4 a[116:119], v68, s[8:11], s25 offen offset:1024
  s_waitcnt lgkmcnt(4)
  v_mfma_f32_32x32x16_bf16 v[52:67], a[96:99], v[84:87], v[52:67]
  s_waitcnt vmcnt(8) lgkmcnt(3)
  v_mfma_f32_32x32x16_bf16 v[4:19], a[100:103], v[88:91], v[4:19]
  ds_read_b128 v[72:75], v114 offset:32768
  ds_read_b128 v[76:79], v114 offset:36864
  buffer_load_dwordx4 a[120:123], v68, s[8:11], s25 offen offset:2048
  s_waitcnt lgkmcnt(4)
  v_mfma_f32_32x32x16_bf16 v[20:35], a[100:103], v[92:95], v[20:35]
  ds_read_b128 v[80:83], v114 offset:40960
  s_waitcnt lgkmcnt(4)
  v_mfma_f32_32x32x16_bf16 v[36:51], a[100:103], v[96:99], v[36:51]
  ds_read_b128 v[84:87], v114 offset:45056
  buffer_load_dwordx4 a[124:127], v68, s[8:11], s25 offen offset:3072
  s_waitcnt lgkmcnt(4)
  v_mfma_f32_32x32x16_bf16 v[52:67], a[100:103], v[100:103], v[52:67]
  s_waitcnt vmcnt(9) lgkmcnt(3)
  v_mfma_f32_32x32x16_bf16 v[4:19], a[104:107], v[72:75], v[4:19]
  ds_read_b128 v[88:91], v115 offset:32768
  ds_read_b128 v[92:95], v115 offset:36864
  s_waitcnt lgkmcnt(4)
  v_mfma_f32_32x32x16_bf16 v[20:35], a[104:107], v[76:79], v[20:35]
  ds_read_b128 v[96:99], v115 offset:40960
  s_waitcnt lgkmcnt(4)
  v_mfma_f32_32x32x16_bf16 v[36:51], a[104:107], v[80:83], v[36:51]
  ds_read_b128 v[100:103], v115 offset:45056
  s_waitcnt lgkmcnt(4)
  v_mfma_f32_32x32x16_bf16 v[52:67], a[104:107], v[84:87], v[52:67]
  s_waitcnt vmcnt(5)
  s_barrier
  s_waitcnt vmcnt(4) lgkmcnt(3)
  v_mfma_f32_32x32x16_bf16 v[4:19], a[108:111], v[88:91], v[4:19]
  ds_read_b128 v[72:75], v112 offset:49152
  ds_read_b128 v[76:79], v112 offset:53248
  s_waitcnt lgkmcnt(4)
  v_mfma_f32_32x32x16_bf16 v[20:35], a[108:111], v[92:95], v[20:35]
  ds_read_b128 v[80:83], v112 offset:57344
  s_waitcnt lgkmcnt(4)
  v_mfma_f32_32x32x16_bf16 v[36:51], a[108:111], v[96:99], v[36:51]
  ds_read_b128 v[84:87], v112 offset:61440
  s_waitcnt lgkmcnt(4)
  v_mfma_f32_32x32x16_bf16 v[52:67], a[108:111], v[100:103], v[52:67]
  s_waitcnt vmcnt(3) lgkmcnt(3)
  v_mfma_f32_32x32x16_bf16 v[4:19], a[112:115], v[72:75], v[4:19]
  ds_read_b128 v[88:91], v113 offset:49152
  ds_read_b128 v[92:95], v113 offset:53248
  s_waitcnt lgkmcnt(4)
  v_mfma_f32_32x32x16_bf16 v[20:35], a[112:115], v[76:79], v[20:35]
  ds_read_b128 v[96:99], v113 offset:57344
  s_waitcnt lgkmcnt(4)
  v_mfma_f32_32x32x16_bf16 v[36:51], a[112:115], v[80:83], v[36:51]
  ds_read_b128 v[100:103], v113 offset:61440
  s_waitcnt lgkmcnt(4)
  v_mfma_f32_32x32x16_bf16 v[52:67], a[112:115], v[84:87], v[52:67]
  s_waitcnt vmcnt(2) lgkmcnt(3)
  v_mfma_f32_32x32x16_bf16 v[4:19], a[116:119], v[88:91], v[4:19]
  ds_read_b128 v[72:75], v114 offset:49152
  ds_read_b128 v[76:79], v114 offset:53248
  s_waitcnt lgkmcnt(4)
  v_mfma_f32_32x32x16_bf16 v[20:35], a[116:119], v[92:95], v[20:35]
  ds_read_b128 v[80:83], v114 offset:57344
  s_waitcnt lgkmcnt(4)
  v_mfma_f32_32x32x16_bf16 v[36:51], a[116:119], v[96:99], v[36:51]
  ds_read_b128 v[84:87], v114 offset:61440
  s_waitcnt lgkmcnt(4)
  v_mfma_f32_32x32x16_bf16 v[52:67], a[116:119], v[100:103], v[52:67]
  s_waitcnt vmcnt(1) lgkmcnt(3)
  v_mfma_f32_32x32x16_bf16 v[4:19], a[120:123], v[72:75], v[4:19]
  ds_read_b128 v[88:91], v115 offset:49152
  ds_read_b128 v[92:95], v115 offset:53248
  s_waitcnt lgkmcnt(4)
  v_mfma_f32_32x32x16_bf16 v[20:35], a[120:123], v[76:79], v[20:35]
  ds_read_b128 v[96:99], v115 offset:57344
  s_waitcnt lgkmcnt(4)
  v_mfma_f32_32x32x16_bf16 v[36:51], a[120:123], v[80:83], v[36:51]
  ds_read_b128 v[100:103], v115 offset:61440
  s_waitcnt lgkmcnt(4)
  v_mfma_f32_32x32x16_bf16 v[52:67], a[120:123], v[84:87], v[52:67]
  s_waitcnt vmcnt(0) lgkmcnt(3)
  v_mfma_f32_32x32x16_bf16 v[4:19], a[124:127], v[88:91], v[4:19]
  s_waitcnt lgkmcnt(2)
  v_mfma_f32_32x32x16_bf16 v[20:35], a[124:127], v[92:95], v[20:35]
  s_waitcnt lgkmcnt(1)
  v_mfma_f32_32x32x16_bf16 v[36:51], a[124:127], v[96:99], v[36:51]
  s_waitcnt lgkmcnt(0)
  v_mfma_f32_32x32x16_bf16 v[52:67], a[124:127], v[100:103], v[52:67]
  v_lshlrev_b32 v104, 2, v69
  v_lshl_or_b32 v104, v70, 14, v104
  s_add_u32 s30, s21, 0
  s_and_b32 s30, s30, 3
  s_lshl_b32 s30, s30, 7
  v_add_u32 v116, s30, v104
  s_add_u32 s30, s21, 1
  s_and_b32 s30, s30, 3
  s_lshl_b32 s30, s30, 7
  v_add_u32 v117, s30, v104
  s_add_u32 s30, s21, 2
  s_and_b32 s30, s30, 3
  s_lshl_b32 s30, s30, 7
  v_add_u32 v118, s30, v104
  s_add_u32 s30, s21, 3
  s_and_b32 s30, s30, 3
  s_lshl_b32 s30, s30, 7
  v_add_u32 v119, s30, v104
  s_lshl_b32 s30, s24, 17
  s_lshl_b32 s31, s20, 9
  s_add_u32 s30, s30, s31
  s_add_u32 s32, s30, 0
  s_add_u32 s33, s30, 8192
  s_add_u32 s34, s30, 32768
  s_add_u32 s35, s30, 40960
  s_add_u32 s36, s30, 65536
  s_add_u32 s37, s30, 73728
  s_add_u32 s38, s30, 98304
  s_add_u32 s39, s30, 106496
  v_cvt_pk_bf16_f32 v120, v4, v5
  v_cvt_pk_bf16_f32 v121, v6, v7
  v_cvt_pk_bf16_f32 v122, v8, v9
  v_cvt_pk_bf16_f32 v123, v10, v11
  v_cvt_pk_bf16_f32 v124, v12, v13
  v_cvt_pk_bf16_f32 v125, v14, v15
  v_cvt_pk_bf16_f32 v126, v16, v17
  v_cvt_pk_bf16_f32 v127, v18, v19
  buffer_store_dword v120, v116, s[16:19], s32 offen sc0 sc1
  buffer_store_dword v121, v116, s[16:19], s33 offen sc0 sc1
  buffer_store_dword v122, v116, s[16:19], s34 offen sc0 sc1
  buffer_store_dword v123, v116, s[16:19], s35 offen sc0 sc1
  buffer_store_dword v124, v116, s[16:19], s36 offen sc0 sc1
  buffer_store_dword v125, v116, s[16:19], s37 offen sc0 sc1
  buffer_store_dword v126, v116, s[16:19], s38 offen sc0 sc1
  buffer_store_dword v127, v116, s[16:19], s39 offen sc0 sc1
  v_cvt_pk_bf16_f32 v120, v20, v21
  v_cvt_pk_bf16_f32 v121, v22, v23
  v_cvt_pk_bf16_f32 v122, v24, v25
  v_cvt_pk_bf16_f32 v123, v26, v27
  v_cvt_pk_bf16_f32 v124, v28, v29
  v_cvt_pk_bf16_f32 v125, v30, v31
  v_cvt_pk_bf16_f32 v126, v32, v33
  v_cvt_pk_bf16_f32 v127, v34, v35
  buffer_store_dword v120, v117, s[16:19], s32 offen sc0 sc1
  buffer_store_dword v121, v117, s[16:19], s33 offen sc0 sc1
  buffer_store_dword v122, v117, s[16:19], s34 offen sc0 sc1
  buffer_store_dword v123, v117, s[16:19], s35 offen sc0 sc1
  buffer_store_dword v124, v117, s[16:19], s36 offen sc0 sc1
  buffer_store_dword v125, v117, s[16:19], s37 offen sc0 sc1
  buffer_store_dword v126, v117, s[16:19], s38 offen sc0 sc1
  buffer_store_dword v127, v117, s[16:19], s39 offen sc0 sc1
  v_cvt_pk_bf16_f32 v120, v36, v37
  v_cvt_pk_bf16_f32 v121, v38, v39
  v_cvt_pk_bf16_f32 v122, v40, v41
  v_cvt_pk_bf16_f32 v123, v42, v43
  v_cvt_pk_bf16_f32 v124, v44, v45
  v_cvt_pk_bf16_f32 v125, v46, v47
  v_cvt_pk_bf16_f32 v126, v48, v49
  v_cvt_pk_bf16_f32 v127, v50, v51
  buffer_store_dword v120, v118, s[16:19], s32 offen sc0 sc1
  buffer_store_dword v121, v118, s[16:19], s33 offen sc0 sc1
  buffer_store_dword v122, v118, s[16:19], s34 offen sc0 sc1
  buffer_store_dword v123, v118, s[16:19], s35 offen sc0 sc1
  buffer_store_dword v124, v118, s[16:19], s36 offen sc0 sc1
  buffer_store_dword v125, v118, s[16:19], s37 offen sc0 sc1
  buffer_store_dword v126, v118, s[16:19], s38 offen sc0 sc1
  buffer_store_dword v127, v118, s[16:19], s39 offen sc0 sc1
  v_cvt_pk_bf16_f32 v120, v52, v53
  v_cvt_pk_bf16_f32 v121, v54, v55
  v_cvt_pk_bf16_f32 v122, v56, v57
  v_cvt_pk_bf16_f32 v123, v58, v59
  v_cvt_pk_bf16_f32 v124, v60, v61
  v_cvt_pk_bf16_f32 v125, v62, v63
  v_cvt_pk_bf16_f32 v126, v64, v65
  v_cvt_pk_bf16_f32 v127, v66, v67
  buffer_store_dword v120, v119, s[16:19], s32 offen sc0 sc1
  buffer_store_dword v121, v119, s[16:19], s33 offen sc0 sc1
  buffer_store_dword v122, v119, s[16:19], s34 offen sc0 sc1
  buffer_store_dword v123, v119, s[16:19], s35 offen sc0 sc1
  buffer_store_dword v124, v119, s[16:19], s36 offen sc0 sc1
  buffer_store_dword v125, v119, s[16:19], s37 offen sc0 sc1
  buffer_store_dword v126, v119, s[16:19], s38 offen sc0 sc1
  buffer_store_dword v127, v119, s[16:19], s39 offen sc0 sc1
  s_endpgm
q0b2:
  s_load_dwordx2 s[6:7], s[0:1], 32
  s_load_dwordx2 s[12:13], s[0:1], 40
  s_getpc_b64 s[96:97]
pf7:
  s_mov_b32 s98, text_end-pf7
  s_mov_b32 s99, 0x20000
  v_lshlrev_b32 v2, 6, v0
  buffer_load_dword v3, v2, s[96:99], 0 offen
  s_lshr_b32 s30, s2, 3
  s_lshl_b32 s30, s30, 2
  s_add_u32 s30, s30, s3
  s_mul_i32 s30, s30, 8192
  v_and_b32 v2, 63, v0
  v_mul_u32_u24 v2, 128, v2
  v_add_u32 v2, s30, v2
  buffer_load_dword v3, v2, s[8:11], 0 offen
  s_sub_u32 s20, s2, 64
  s_and_b32 s21, s20, 7
  s_lshr_b32 s22, s20, 3
  s_lshr_b32 s23, s22, 2
  s_lshl_b32 s23, s23, 3
  s_add_u32 s23, s23, s21
  s_and_b32 s24, s22, 3
  s_lshr_b32 s26, s21, 1
  s_add_u32 s26, s26, 24
  s_and_b32 s27, s21, 1
  s_lshl_b32 s27, s27, 1
  s_and_b32 s30, s22, 1
  s_or_b32 s27, s27, s30
  s_cmp_ge_u32 s22, 12
  s_cselect_b32 s23, s26, s23
  s_cselect_b32 s24, s27, s24
  s_cmp_ge_u32 s23, 14
  s_cselect_b32 s26, 1, 0
  s_cselect_b32 s27, 14, 0
  s_sub_u32 s23, s23, s27
  s_lshl_b32 s27, s26, 3
  s_add_u32 s27, s27, 32
  s_waitcnt lgkmcnt(0)
  s_cmp_eq_u32 s26, 0
  s_cselect_b32 s6, s6, s12
  s_cselect_b32 s7, s7, s13
  s_mov_b32 s12, s6
  s_mov_b32 s13, s7
  s_mov_b32 s14, 0x1c0000
  s_mov_b32 s15, 0x20000
  s_add_u32 s16, s4, 0x800000
  s_addc_u32 s17, s5, 0
  s_mov_b32 s18, 0x380000
  s_mov_b32 s19, 0x20000
  s_mul_i32 s22, s3, 14336
  s_lshl_b32 s21, s23, 8
  s_add_u32 s22, s22, s21
  s_lshl_b32 s27, s24, 2
  s_add_u32 s27, s27, s3
  s_lshl_b32 s25, s27, 15
  s_lshl_b32 s30, s24, 2
  s_add_u32 s30, s30, s3
  s_mul_i32 s30, s30, 114688
  s_lshl_b32 s31, s23, 8
  s_add_u32 s30, s30, s31
  v_and_b32 v2, 63, v0
  v_lshrrev_b32 v1, 1, v2
  v_mul_u32_u24 v1, 3584, v1
  v_and_b32 v2, 1, v2
  v_mul_u32_u24 v2, 128, v2
  v_add_u32 v2, v1, v2
  buffer_load_dword v3, v2, s[12:15], s30 offen
  s_sub_u32 s50, s2, 64
  s_lshr_b32 s50, s50, 5
  s_add_u32 s50, s50, 2
  s_and_b32 s51, s2, 8
  s_lshr_b32 s51, s51, 3
  s_cmp_ge_u32 s2, 160
  s_cselect_b32 s51, s51, 0
  s_add_u32 s50, s50, s51
  s_lshl_b32 s51, s24, 1
  s_add_u32 s50, s50, s51
  s_and_b32 s50, s50, 7
  v_and_b32 v71, 63, v0
  v_lshlrev_b32 v68, 4, v71
  v_and_b32 v69, 31, v71
  v_lshrrev_b32 v70, 5, v71
  v_lshrrev_b32 v105, 4, v71
  v_lshlrev_b32 v104, 2, v105
  v_xor_b32 v104, v104, v71
  v_and_b32 v104, 15, v104
  v_lshlrev_b32 v104, 4, v104
  v_mul_u32_u24 v105, 3584, v105
  v_add_u32 v106, v104, v105
  s_lshl_b32 s28, s3, 10
  s_add_u32 m0, s28, 0
  s_add_u32 s29, s22, 0
  buffer_load_dwordx4 v106, s[12:15], s29 offen lds
  s_add_u32 m0, s28, 4096
  s_add_u32 s29, s22, 57344
  buffer_load_dwordx4 v106, s[12:15], s29 offen lds
  buffer_load_dwordx4 a[0:3], v68, s[8:11], s25 offen offset:0
  s_add_u32 m0, s28, 8192
  s_add_u32 s29, s22, 114688
  buffer_load_dwordx4 v106, s[12:15], s29 offen lds
  s_add_u32 m0, s28, 12288
  s_add_u32 s29, s22, 172032
  buffer_load_dwordx4 v106, s[12:15], s29 offen lds
  buffer_load_dwordx4 a[4:7], v68, s[8:11], s25 offen offset:1024
  buffer_load_dwordx4 a[8:11], v68, s[8:11], s25 offen offset:2048
  s_add_u32 m0, s28, 16384
  s_add_u32 s29, s22, 229376
  buffer_load_dwordx4 v106, s[12:15], s29 offen lds
  s_add_u32 m0, s28, 20480
  s_add_u32 s29, s22, 286720
  buffer_load_dwordx4 v106, s[12:15], s29 offen lds
  s_add_u32 m0, s28, 24576
  s_add_u32 s29, s22, 344064
  buffer_load_dwordx4 v106, s[12:15], s29 offen lds
  s_add_u32 m0, s28, 28672
  s_add_u32 s29, s22, 401408
  buffer_load_dwordx4 v106, s[12:15], s29 offen lds
  buffer_load_dwordx4 a[12:15], v68, s[8:11], s25 offen offset:3072
  v_bfe_u32 v104, v71, 2, 2
  v_lshl_add_u32 v105, v70, 3, v104
  v_lshlrev_b32 v105, 8, v105
  v_bfe_u32 v115, v71, 4, 1
  v_lshl_or_b32 v105, v115, 5, v105
  v_and_b32 v115, 3, v71
  v_lshl_or_b32 v105, v115, 3, v105
  v_xor_b32 v116, 0, v104
  v_lshl_or_b32 v107, v116, 6, v105
  v_add_u32 v111, 0x10000, v107
  v_xor_b32 v116, 1, v104
  v_lshl_or_b32 v108, v116, 6, v105
  v_add_u32 v112, 0x10000, v108
  v_xor_b32 v116, 2, v104
  v_lshl_or_b32 v109, v116, 6, v105
  v_add_u32 v113, 0x10000, v109
  v_xor_b32 v116, 3, v104
  v_lshl_or_b32 v110, v116, 6, v105
  v_add_u32 v114, 0x10000, v110
  s_waitcnt vmcnt(11)
  s_barrier
  ds_read_b64_tr_b16 v[72:73], v107 offset:0
  ds_read_b64_tr_b16 v[74:75], v107 offset:1024
  ds_read_b64_tr_b16 v[76:77], v108 offset:0
  ds_read_b64_tr_b16 v[78:79], v108 offset:1024
  ds_read_b64_tr_b16 v[80:81], v109 offset:0
  ds_read_b64_tr_b16 v[82:83], v109 offset:1024
  ds_read_b64_tr_b16 v[84:85], v110 offset:0
  ds_read_b64_tr_b16 v[86:87], v110 offset:1024
  s_waitcnt vmcnt(10)
  s_barrier
  s_waitcnt vmcnt(9) lgkmcnt(6)
  v_mfma_f32_32x32x16_bf16 v[4:19], a[0:3], v[72:75], 0
  ds_read_b64_tr_b16 v[88:89], v107 offset:4096
  ds_read_b64_tr_b16 v[90:91], v107 offset:5120
  ds_read_b64_tr_b16 v[92:93], v108 offset:4096
  s_add_u32 s25, s25, 4096
  buffer_load_dwordx4 a[16:19], v68, s[8:11], s25 offen offset:0
  s_waitcnt lgkmcnt(7)
  v_mfma_f32_32x32x16_bf16 v[20:35], a[0:3], v[76:79], 0
  ds_read_b64_tr_b16 v[94:95], v108 offset:5120
  ds_read_b64_tr_b16 v[96:97], v109 offset:4096
  ds_read_b64_tr_b16 v[98:99], v109 offset:5120
  s_waitcnt lgkmcnt(8)
  v_mfma_f32_32x32x16_bf16 v[36:51], a[0:3], v[80:83], 0
  ds_read_b64_tr_b16 v[100:101], v110 offset:4096
  ds_read_b64_tr_b16 v[102:103], v110 offset:5120
  buffer_load_dwordx4 a[20:23], v68, s[8:11], s25 offen offset:1024
  s_waitcnt lgkmcnt(8)
  v_mfma_f32_32x32x16_bf16 v[52:67], a[0:3], v[84:87], 0
  s_waitcnt vmcnt(9)
  s_barrier
  s_waitcnt vmcnt(8) lgkmcnt(6)
  v_mfma_f32_32x32x16_bf16 v[4:19], a[4:7], v[88:91], v[4:19]
  ds_read_b64_tr_b16 v[72:73], v107 offset:8192
  ds_read_b64_tr_b16 v[74:75], v107 offset:9216
  ds_read_b64_tr_b16 v[76:77], v108 offset:8192
  buffer_load_dwordx4 a[24:27], v68, s[8:11], s25 offen offset:2048
  s_waitcnt lgkmcnt(7)
  v_mfma_f32_32x32x16_bf16 v[20:35], a[4:7], v[92:95], v[20:35]
  ds_read_b64_tr_b16 v[78:79], v108 offset:9216
  ds_read_b64_tr_b16 v[80:81], v109 offset:8192
  ds_read_b64_tr_b16 v[82:83], v109 offset:9216
  s_waitcnt lgkmcnt(8)
  v_mfma_f32_32x32x16_bf16 v[36:51], a[4:7], v[96:99], v[36:51]
  ds_read_b64_tr_b16 v[84:85], v110 offset:8192
  ds_read_b64_tr_b16 v[86:87], v110 offset:9216
  s_add_u32 m0, s28, 32768
  s_add_u32 s29, s22, 458752
  buffer_load_dwordx4 v106, s[12:15], s29 offen lds
  s_waitcnt lgkmcnt(8)
  v_mfma_f32_32x32x16_bf16 v[52:67], a[4:7], v[100:103], v[52:67]
  s_waitcnt vmcnt(9) lgkmcnt(6)
  v_mfma_f32_32x32x16_bf16 v[4:19], a[8:11], v[72:75], v[4:19]
  ds_read_b64_tr_b16 v[88:89], v107 offset:12288
  ds_read_b64_tr_b16 v[90:91], v107 offset:13312
  ds_read_b64_tr_b16 v[92:93], v108 offset:12288
  s_add_u32 m0, s28, 36864
  s_add_u32 s29, s22, 516096
  buffer_load_dwordx4 v106, s[12:15], s29 offen lds
  s_waitcnt lgkmcnt(7)
  v_mfma_f32_32x32x16_bf16 v[20:35], a[8:11], v[76:79], v[20:35]
  ds_read_b64_tr_b16 v[94:95], v108 offset:13312
  ds_read_b64_tr_b16 v[96:97], v109 offset:12288
  ds_read_b64_tr_b16 v[98:99], v109 offset:13312
  s_waitcnt lgkmcnt(8)
  v_mfma_f32_32x32x16_bf16 v[36:51], a[8:11], v[80:83], v[36:51]
  ds_read_b64_tr_b16 v[100:101], v110 offset:12288
  ds_read_b64_tr_b16 v[102:103], v110 offset:13312
  s_add_u32 m0, s28, 40960
  s_add_u32 s29, s22, 573440
  buffer_load_dwordx4 v106, s[12:15], s29 offen lds
  s_waitcnt lgkmcnt(8)
  v_mfma_f32_32x32x16_bf16 v[52:67], a[8:11], v[84:87], v[52:67]
  s_waitcnt vmcnt(7)
  s_barrier
  s_waitcnt vmcnt(6) lgkmcnt(6)
  v_mfma_f32_32x32x16_bf16 v[4:19], a[12:15], v[88:91], v[4:19]
  ds_read_b64_tr_b16 v[72:73], v107 offset:16384
  ds_read_b64_tr_b16 v[74:75], v107 offset:17408
  ds_read_b64_tr_b16 v[76:77], v108 offset:16384
  s_add_u32 m0, s28, 45056
  s_add_u32 s29, s22, 630784
  buffer_load_dwordx4 v106, s[12:15], s29 offen lds
  s_waitcnt lgkmcnt(7)
  v_mfma_f32_32x32x16_bf16 v[20:35], a[12:15], v[92:95], v[20:35]
  ds_read_b64_tr_b16 v[78:79], v108 offset:17408
  ds_read_b64_tr_b16 v[80:81], v109 offset:16384
  ds_read_b64_tr_b16 v[82:83], v109 offset:17408
  s_waitcnt lgkmcnt(8)
  v_mfma_f32_32x32x16_bf16 v[36:51], a[12:15], v[96:99], v[36:51]
  ds_read_b64_tr_b16 v[84:85], v110 offset:16384
  ds_read_b64_tr_b16 v[86:87], v110 offset:17408
  buffer_load_dwordx4 a[28:31], v68, s[8:11], s25 offen offset:3072
  s_waitcnt lgkmcnt(8)
  v_mfma_f32_32x32x16_bf16 v[52:67], a[12:15], v[100:103], v[52:67]
  s_waitcnt vmcnt(7) lgkmcnt(6)
  v_mfma_f32_32x32x16_bf16 v[4:19], a[16:19], v[72:75], v[4:19]
  ds_read_b64_tr_b16 v[88:89], v107 offset:20480
  ds_read_b64_tr_b16 v[90:91], v107 offset:21504
  ds_read_b64_tr_b16 v[92:93], v108 offset:20480
  s_add_u32 s25, s25, 4096
  buffer_load_dwordx4 a[32:35], v68, s[8:11], s25 offen offset:0
  s_waitcnt lgkmcnt(7)
  v_mfma_f32_32x32x16_bf16 v[20:35], a[16:19], v[76:79], v[20:35]
  ds_read_b64_tr_b16 v[94:95], v108 offset:21504
  ds_read_b64_tr_b16 v[96:97], v109 offset:20480
  ds_read_b64_tr_b16 v[98:99], v109 offset:21504
  s_waitcnt lgkmcnt(8)
  v_mfma_f32_32x32x16_bf16 v[36:51], a[16:19], v[80:83], v[36:51]
  ds_read_b64_tr_b16 v[100:101], v110 offset:20480
  ds_read_b64_tr_b16 v[102:103], v110 offset:21504
  buffer_load_dwordx4 a[36:39], v68, s[8:11], s25 offen offset:1024
  s_waitcnt lgkmcnt(8)
  v_mfma_f32_32x32x16_bf16 v[52:67], a[16:19], v[84:87], v[52:67]
  s_waitcnt vmcnt(8) lgkmcnt(6)
  v_mfma_f32_32x32x16_bf16 v[4:19], a[20:23], v[88:91], v[4:19]
  ds_read_b64_tr_b16 v[72:73], v107 offset:24576
  ds_read_b64_tr_b16 v[74:75], v107 offset:25600
  ds_read_b64_tr_b16 v[76:77], v108 offset:24576
  buffer_load_dwordx4 a[40:43], v68, s[8:11], s25 offen offset:2048
  s_waitcnt lgkmcnt(7)
  v_mfma_f32_32x32x16_bf16 v[20:35], a[20:23], v[92:95], v[20:35]
  ds_read_b64_tr_b16 v[78:79], v108 offset:25600
  ds_read_b64_tr_b16 v[80:81], v109 offset:24576
  ds_read_b64_tr_b16 v[82:83], v109 offset:25600
  s_waitcnt lgkmcnt(8)
  v_mfma_f32_32x32x16_bf16 v[36:51], a[20:23], v[96:99], v[36:51]
  ds_read_b64_tr_b16 v[84:85], v110 offset:24576
  ds_read_b64_tr_b16 v[86:87], v110 offset:25600
  s_add_u32 m0, s28, 49152
  s_add_u32 s29, s22, 688128
  buffer_load_dwordx4 v106, s[12:15], s29 offen lds
  s_waitcnt lgkmcnt(8)
  v_mfma_f32_32x32x16_bf16 v[52:67], a[20:23], v[100:103], v[52:67]
  s_waitcnt vmcnt(9) lgkmcnt(6)
  v_mfma_f32_32x32x16_bf16 v[4:19], a[24:27], v[72:75], v[4:19]
  ds_read_b64_tr_b16 v[88:89], v107 offset:28672
  ds_read_b64_tr_b16 v[90:91], v107 offset:29696
  ds_read_b64_tr_b16 v[92:93], v108 offset:28672
  s_add_u32 m0, s28, 53248
  s_add_u32 s29, s22, 745472
  buffer_load_dwordx4 v106, s[12:15], s29 offen lds
  s_waitcnt lgkmcnt(7)
  v_mfma_f32_32x32x16_bf16 v[20:35], a[24:27], v[76:79], v[20:35]
  ds_read_b64_tr_b16 v[94:95], v108 offset:29696
  ds_read_b64_tr_b16 v[96:97], v109 offset:28672
  ds_read_b64_tr_b16 v[98:99], v109 offset:29696
  s_waitcnt lgkmcnt(8)
  v_mfma_f32_32x32x16_bf16 v[36:51], a[24:27], v[80:83], v[36:51]
  ds_read_b64_tr_b16 v[100:101], v110 offset:28672
  ds_read_b64_tr_b16 v[102:103], v110 offset:29696
  s_add_u32 m0, s28, 57344
  s_add_u32 s29, s22, 802816
  buffer_load_dwordx4 v106, s[12:15], s29 offen lds
  s_waitcnt lgkmcnt(8)
  v_mfma_f32_32x32x16_bf16 v[52:67], a[24:27], v[84:87], v[52:67]
  s_waitcnt vmcnt(7)
  s_barrier
  s_waitcnt vmcnt(6) lgkmcnt(6)
  v_mfma_f32_32x32x16_bf16 v[4:19], a[28:31], v[88:91], v[4:19]
  ds_read_b64_tr_b16 v[72:73], v107 offset:32768
  ds_read_b64_tr_b16 v[74:75], v107 offset:33792
  ds_read_b64_tr_b16 v[76:77], v108 offset:32768
  s_add_u32 m0, s28, 61440
  s_add_u32 s29, s22, 860160
  buffer_load_dwordx4 v106, s[12:15], s29 offen lds
  s_waitcnt lgkmcnt(7)
  v_mfma_f32_32x32x16_bf16 v[20:35], a[28:31], v[92:95], v[20:35]
  ds_read_b64_tr_b16 v[78:79], v108 offset:33792
  ds_read_b64_tr_b16 v[80:81], v109 offset:32768
  ds_read_b64_tr_b16 v[82:83], v109 offset:33792
  s_waitcnt lgkmcnt(8)
  v_mfma_f32_32x32x16_bf16 v[36:51], a[28:31], v[96:99], v[36:51]
  ds_read_b64_tr_b16 v[84:85], v110 offset:32768
  ds_read_b64_tr_b16 v[86:87], v110 offset:33792
  buffer_load_dwordx4 a[44:47], v68, s[8:11], s25 offen offset:3072
  s_waitcnt lgkmcnt(8)
  v_mfma_f32_32x32x16_bf16 v[52:67], a[28:31], v[100:103], v[52:67]
  s_waitcnt vmcnt(7) lgkmcnt(6)
  v_mfma_f32_32x32x16_bf16 v[4:19], a[32:35], v[72:75], v[4:19]
  ds_read_b64_tr_b16 v[88:89], v107 offset:36864
  ds_read_b64_tr_b16 v[90:91], v107 offset:37888
  ds_read_b64_tr_b16 v[92:93], v108 offset:36864
  s_add_u32 s25, s25, 4096
  buffer_load_dwordx4 a[48:51], v68, s[8:11], s25 offen offset:0
  s_waitcnt lgkmcnt(7)
  v_mfma_f32_32x32x16_bf16 v[20:35], a[32:35], v[76:79], v[20:35]
  ds_read_b64_tr_b16 v[94:95], v108 offset:37888
  ds_read_b64_tr_b16 v[96:97], v109 offset:36864
  ds_read_b64_tr_b16 v[98:99], v109 offset:37888
  s_waitcnt lgkmcnt(8)
  v_mfma_f32_32x32x16_bf16 v[36:51], a[32:35], v[80:83], v[36:51]
  ds_read_b64_tr_b16 v[100:101], v110 offset:36864
  ds_read_b64_tr_b16 v[102:103], v110 offset:37888
  buffer_load_dwordx4 a[52:55], v68, s[8:11], s25 offen offset:1024
  s_waitcnt lgkmcnt(8)
  v_mfma_f32_32x32x16_bf16 v[52:67], a[32:35], v[84:87], v[52:67]
  s_waitcnt vmcnt(8) lgkmcnt(6)
  v_mfma_f32_32x32x16_bf16 v[4:19], a[36:39], v[88:91], v[4:19]
  ds_read_b64_tr_b16 v[72:73], v107 offset:40960
  ds_read_b64_tr_b16 v[74:75], v107 offset:41984
  ds_read_b64_tr_b16 v[76:77], v108 offset:40960
  buffer_load_dwordx4 a[56:59], v68, s[8:11], s25 offen offset:2048
  s_waitcnt lgkmcnt(7)
  v_mfma_f32_32x32x16_bf16 v[20:35], a[36:39], v[92:95], v[20:35]
  ds_read_b64_tr_b16 v[78:79], v108 offset:41984
  ds_read_b64_tr_b16 v[80:81], v109 offset:40960
  ds_read_b64_tr_b16 v[82:83], v109 offset:41984
  s_waitcnt lgkmcnt(8)
  v_mfma_f32_32x32x16_bf16 v[36:51], a[36:39], v[96:99], v[36:51]
  ds_read_b64_tr_b16 v[84:85], v110 offset:40960
  ds_read_b64_tr_b16 v[86:87], v110 offset:41984
  s_add_u32 m0, s28, 65536
  s_add_u32 s29, s22, 917504
  buffer_load_dwordx4 v106, s[12:15], s29 offen lds
  s_waitcnt lgkmcnt(8)
  v_mfma_f32_32x32x16_bf16 v[52:67], a[36:39], v[100:103], v[52:67]
  s_waitcnt vmcnt(9) lgkmcnt(6)
  v_mfma_f32_32x32x16_bf16 v[4:19], a[40:43], v[72:75], v[4:19]
  ds_read_b64_tr_b16 v[88:89], v107 offset:45056
  ds_read_b64_tr_b16 v[90:91], v107 offset:46080
  ds_read_b64_tr_b16 v[92:93], v108 offset:45056
  s_add_u32 m0, s28, 69632
  s_add_u32 s29, s22, 974848
  buffer_load_dwordx4 v106, s[12:15], s29 offen lds
  s_waitcnt lgkmcnt(7)
  v_mfma_f32_32x32x16_bf16 v[20:35], a[40:43], v[76:79], v[20:35]
  ds_read_b64_tr_b16 v[94:95], v108 offset:46080
  ds_read_b64_tr_b16 v[96:97], v109 offset:45056
  ds_read_b64_tr_b16 v[98:99], v109 offset:46080
  s_waitcnt lgkmcnt(8)
  v_mfma_f32_32x32x16_bf16 v[36:51], a[40:43], v[80:83], v[36:51]
  ds_read_b64_tr_b16 v[100:101], v110 offset:45056
  ds_read_b64_tr_b16 v[102:103], v110 offset:46080
  s_add_u32 m0, s28, 73728
  s_add_u32 s29, s22, 1032192
  buffer_load_dwordx4 v106, s[12:15], s29 offen lds
  s_waitcnt lgkmcnt(8)
  v_mfma_f32_32x32x16_bf16 v[52:67], a[40:43], v[84:87], v[52:67]
  s_waitcnt vmcnt(7)
  s_barrier
  s_waitcnt vmcnt(6) lgkmcnt(6)
  v_mfma_f32_32x32x16_bf16 v[4:19], a[44:47], v[88:91], v[4:19]
  ds_read_b64_tr_b16 v[72:73], v107 offset:49152
  ds_read_b64_tr_b16 v[74:75], v107 offset:50176
  ds_read_b64_tr_b16 v[76:77], v108 offset:49152
  s_add_u32 m0, s28, 77824
  s_add_u32 s29, s22, 1089536
  buffer_load_dwordx4 v106, s[12:15], s29 offen lds
  s_waitcnt lgkmcnt(7)
  v_mfma_f32_32x32x16_bf16 v[20:35], a[44:47], v[92:95], v[20:35]
  ds_read_b64_tr_b16 v[78:79], v108 offset:50176
  ds_read_b64_tr_b16 v[80:81], v109 offset:49152
  ds_read_b64_tr_b16 v[82:83], v109 offset:50176
  s_waitcnt lgkmcnt(8)
  v_mfma_f32_32x32x16_bf16 v[36:51], a[44:47], v[96:99], v[36:51]
  ds_read_b64_tr_b16 v[84:85], v110 offset:49152
  ds_read_b64_tr_b16 v[86:87], v110 offset:50176
  buffer_load_dwordx4 a[60:63], v68, s[8:11], s25 offen offset:3072
  s_waitcnt lgkmcnt(8)
  v_mfma_f32_32x32x16_bf16 v[52:67], a[44:47], v[100:103], v[52:67]
  s_waitcnt vmcnt(7) lgkmcnt(6)
  v_mfma_f32_32x32x16_bf16 v[4:19], a[48:51], v[72:75], v[4:19]
  ds_read_b64_tr_b16 v[88:89], v107 offset:53248
  ds_read_b64_tr_b16 v[90:91], v107 offset:54272
  ds_read_b64_tr_b16 v[92:93], v108 offset:53248
  s_add_u32 s25, s25, 4096
  buffer_load_dwordx4 a[64:67], v68, s[8:11], s25 offen offset:0
  s_waitcnt lgkmcnt(7)
  v_mfma_f32_32x32x16_bf16 v[20:35], a[48:51], v[76:79], v[20:35]
  ds_read_b64_tr_b16 v[94:95], v108 offset:54272
  ds_read_b64_tr_b16 v[96:97], v109 offset:53248
  ds_read_b64_tr_b16 v[98:99], v109 offset:54272
  s_waitcnt lgkmcnt(8)
  v_mfma_f32_32x32x16_bf16 v[36:51], a[48:51], v[80:83], v[36:51]
  ds_read_b64_tr_b16 v[100:101], v110 offset:53248
  ds_read_b64_tr_b16 v[102:103], v110 offset:54272
  buffer_load_dwordx4 a[68:71], v68, s[8:11], s25 offen offset:1024
  s_waitcnt lgkmcnt(8)
  v_mfma_f32_32x32x16_bf16 v[52:67], a[48:51], v[84:87], v[52:67]
  s_waitcnt vmcnt(8) lgkmcnt(6)
  v_mfma_f32_32x32x16_bf16 v[4:19], a[52:55], v[88:91], v[4:19]
  ds_read_b64_tr_b16 v[72:73], v107 offset:57344
  ds_read_b64_tr_b16 v[74:75], v107 offset:58368
  ds_read_b64_tr_b16 v[76:77], v108 offset:57344
  buffer_load_dwordx4 a[72:75], v68, s[8:11], s25 offen offset:2048
  s_waitcnt lgkmcnt(7)
  v_mfma_f32_32x32x16_bf16 v[20:35], a[52:55], v[92:95], v[20:35]
  ds_read_b64_tr_b16 v[78:79], v108 offset:58368
  ds_read_b64_tr_b16 v[80:81], v109 offset:57344
  ds_read_b64_tr_b16 v[82:83], v109 offset:58368
  s_waitcnt lgkmcnt(8)
  v_mfma_f32_32x32x16_bf16 v[36:51], a[52:55], v[96:99], v[36:51]
  ds_read_b64_tr_b16 v[84:85], v110 offset:57344
  ds_read_b64_tr_b16 v[86:87], v110 offset:58368
  s_add_u32 m0, s28, 81920
  s_add_u32 s29, s22, 1146880
  buffer_load_dwordx4 v106, s[12:15], s29 offen lds
  s_waitcnt lgkmcnt(8)
  v_mfma_f32_32x32x16_bf16 v[52:67], a[52:55], v[100:103], v[52:67]
  s_waitcnt vmcnt(9) lgkmcnt(6)
  v_mfma_f32_32x32x16_bf16 v[4:19], a[56:59], v[72:75], v[4:19]
  ds_read_b64_tr_b16 v[88:89], v107 offset:61440
  ds_read_b64_tr_b16 v[90:91], v107 offset:62464
  ds_read_b64_tr_b16 v[92:93], v108 offset:61440
  s_add_u32 m0, s28, 86016
  s_add_u32 s29, s22, 1204224
  buffer_load_dwordx4 v106, s[12:15], s29 offen lds
  s_waitcnt lgkmcnt(7)
  v_mfma_f32_32x32x16_bf16 v[20:35], a[56:59], v[76:79], v[20:35]
  ds_read_b64_tr_b16 v[94:95], v108 offset:62464
  ds_read_b64_tr_b16 v[96:97], v109 offset:61440
  ds_read_b64_tr_b16 v[98:99], v109 offset:62464
  s_waitcnt lgkmcnt(8)
  v_mfma_f32_32x32x16_bf16 v[36:51], a[56:59], v[80:83], v[36:51]
  ds_read_b64_tr_b16 v[100:101], v110 offset:61440
  ds_read_b64_tr_b16 v[102:103], v110 offset:62464
  s_add_u32 m0, s28, 90112
  s_add_u32 s29, s22, 1261568
  buffer_load_dwordx4 v106, s[12:15], s29 offen lds
  s_waitcnt lgkmcnt(8)
  v_mfma_f32_32x32x16_bf16 v[52:67], a[56:59], v[84:87], v[52:67]
  s_waitcnt vmcnt(7)
  s_barrier
  s_waitcnt vmcnt(6) lgkmcnt(6)
  v_mfma_f32_32x32x16_bf16 v[4:19], a[60:63], v[88:91], v[4:19]
  ds_read_b64_tr_b16 v[72:73], v111 offset:0
  ds_read_b64_tr_b16 v[74:75], v111 offset:1024
  ds_read_b64_tr_b16 v[76:77], v112 offset:0
  s_add_u32 m0, s28, 94208
  s_add_u32 s29, s22, 1318912
  buffer_load_dwordx4 v106, s[12:15], s29 offen lds
  s_waitcnt lgkmcnt(7)
  v_mfma_f32_32x32x16_bf16 v[20:35], a[60:63], v[92:95], v[20:35]
  ds_read_b64_tr_b16 v[78:79], v112 offset:1024
  ds_read_b64_tr_b16 v[80:81], v113 offset:0
  ds_read_b64_tr_b16 v[82:83], v113 offset:1024
  s_waitcnt lgkmcnt(8)
  v_mfma_f32_32x32x16_bf16 v[36:51], a[60:63], v[96:99], v[36:51]
  ds_read_b64_tr_b16 v[84:85], v114 offset:0
  ds_read_b64_tr_b16 v[86:87], v114 offset:1024
  buffer_load_dwordx4 a[76:79], v68, s[8:11], s25 offen offset:3072
  s_waitcnt lgkmcnt(8)
  v_mfma_f32_32x32x16_bf16 v[52:67], a[60:63], v[100:103], v[52:67]
  s_waitcnt vmcnt(7) lgkmcnt(6)
  v_mfma_f32_32x32x16_bf16 v[4:19], a[64:67], v[72:75], v[4:19]
  ds_read_b64_tr_b16 v[88:89], v111 offset:4096
  ds_read_b64_tr_b16 v[90:91], v111 offset:5120
  ds_read_b64_tr_b16 v[92:93], v112 offset:4096
  s_add_u32 s25, s25, 4096
  buffer_load_dwordx4 a[80:83], v68, s[8:11], s25 offen offset:0
  s_waitcnt lgkmcnt(7)
  v_mfma_f32_32x32x16_bf16 v[20:35], a[64:67], v[76:79], v[20:35]
  ds_read_b64_tr_b16 v[94:95], v112 offset:5120
  ds_read_b64_tr_b16 v[96:97], v113 offset:4096
  ds_read_b64_tr_b16 v[98:99], v113 offset:5120
  s_waitcnt lgkmcnt(8)
  v_mfma_f32_32x32x16_bf16 v[36:51], a[64:67], v[80:83], v[36:51]
  ds_read_b64_tr_b16 v[100:101], v114 offset:4096
  ds_read_b64_tr_b16 v[102:103], v114 offset:5120
  buffer_load_dwordx4 a[84:87], v68, s[8:11], s25 offen offset:1024
  s_waitcnt lgkmcnt(8)
  v_mfma_f32_32x32x16_bf16 v[52:67], a[64:67], v[84:87], v[52:67]
  s_waitcnt vmcnt(8) lgkmcnt(6)
  v_mfma_f32_32x32x16_bf16 v[4:19], a[68:71], v[88:91], v[4:19]
  ds_read_b64_tr_b16 v[72:73], v111 offset:8192
  ds_read_b64_tr_b16 v[74:75], v111 offset:9216
  ds_read_b64_tr_b16 v[76:77], v112 offset:8192
  buffer_load_dwordx4 a[88:91], v68, s[8:11], s25 offen offset:2048
  s_waitcnt lgkmcnt(7)
  v_mfma_f32_32x32x16_bf16 v[20:35], a[68:71], v[92:95], v[20:35]
  ds_read_b64_tr_b16 v[78:79], v112 offset:9216
  ds_read_b64_tr_b16 v[80:81], v113 offset:8192
  ds_read_b64_tr_b16 v[82:83], v113 offset:9216
  s_waitcnt lgkmcnt(8)
  v_mfma_f32_32x32x16_bf16 v[36:51], a[68:71], v[96:99], v[36:51]
  ds_read_b64_tr_b16 v[84:85], v114 offset:8192
  ds_read_b64_tr_b16 v[86:87], v114 offset:9216
  s_add_u32 m0, s28, 98304
  s_add_u32 s29, s22, 1376256
  buffer_load_dwordx4 v106, s[12:15], s29 offen lds
  s_waitcnt lgkmcnt(8)
  v_mfma_f32_32x32x16_bf16 v[52:67], a[68:71], v[100:103], v[52:67]
  s_waitcnt vmcnt(9) lgkmcnt(6)
  v_mfma_f32_32x32x16_bf16 v[4:19], a[72:75], v[72:75], v[4:19]
  ds_read_b64_tr_b16 v[88:89], v111 offset:12288
  ds_read_b64_tr_b16 v[90:91], v111 offset:13312
  ds_read_b64_tr_b16 v[92:93], v112 offset:12288
  s_add_u32 m0, s28, 102400
  s_add_u32 s29, s22, 1433600
  buffer_load_dwordx4 v106, s[12:15], s29 offen lds
  s_waitcnt lgkmcnt(7)
  v_mfma_f32_32x32x16_bf16 v[20:35], a[72:75], v[76:79], v[20:35]
  ds_read_b64_tr_b16 v[94:95], v112 offset:13312
  ds_read_b64_tr_b16 v[96:97], v113 offset:12288
  ds_read_b64_tr_b16 v[98:99], v113 offset:13312
  s_waitcnt lgkmcnt(8)
  v_mfma_f32_32x32x16_bf16 v[36:51], a[72:75], v[80:83], v[36:51]
  ds_read_b64_tr_b16 v[100:101], v114 offset:12288
  ds_read_b64_tr_b16 v[102:103], v114 offset:13312
  s_add_u32 m0, s28, 106496
  s_add_u32 s29, s22, 1490944
  buffer_load_dwordx4 v106, s[12:15], s29 offen lds
  s_waitcnt lgkmcnt(8)
  v_mfma_f32_32x32x16_bf16 v[52:67], a[72:75], v[84:87], v[52:67]
  s_waitcnt vmcnt(7)
  s_barrier
  s_waitcnt vmcnt(6) lgkmcnt(6)
  v_mfma_f32_32x32x16_bf16 v[4:19], a[76:79], v[88:91], v[4:19]
  ds_read_b64_tr_b16 v[72:73], v111 offset:16384
  ds_read_b64_tr_b16 v[74:75], v111 offset:17408
  ds_read_b64_tr_b16 v[76:77], v112 offset:16384
  s_add_u32 m0, s28, 110592
  s_add_u32 s29, s22, 1548288
  buffer_load_dwordx4 v106, s[12:15], s29 offen lds
  s_waitcnt lgkmcnt(7)
  v_mfma_f32_32x32x16_bf16 v[20:35], a[76:79], v[92:95], v[20:35]
  ds_read_b64_tr_b16 v[78:79], v112 offset:17408
  ds_read_b64_tr_b16 v[80:81], v113 offset:16384
  ds_read_b64_tr_b16 v[82:83], v113 offset:17408
  s_waitcnt lgkmcnt(8)
  v_mfma_f32_32x32x16_bf16 v[36:51], a[76:79], v[96:99], v[36:51]
  ds_read_b64_tr_b16 v[84:85], v114 offset:16384
  ds_read_b64_tr_b16 v[86:87], v114 offset:17408
  buffer_load_dwordx4 a[92:95], v68, s[8:11], s25 offen offset:3072
  s_waitcnt lgkmcnt(8)
  v_mfma_f32_32x32x16_bf16 v[52:67], a[76:79], v[100:103], v[52:67]
  s_waitcnt vmcnt(7) lgkmcnt(6)
  v_mfma_f32_32x32x16_bf16 v[4:19], a[80:83], v[72:75], v[4:19]
  ds_read_b64_tr_b16 v[88:89], v111 offset:20480
  ds_read_b64_tr_b16 v[90:91], v111 offset:21504
  ds_read_b64_tr_b16 v[92:93], v112 offset:20480
  s_add_u32 s25, s25, 4096
  buffer_load_dwordx4 a[96:99], v68, s[8:11], s25 offen offset:0
  s_waitcnt lgkmcnt(7)
  v_mfma_f32_32x32x16_bf16 v[20:35], a[80:83], v[76:79], v[20:35]
  ds_read_b64_tr_b16 v[94:95], v112 offset:21504
  ds_read_b64_tr_b16 v[96:97], v113 offset:20480
  ds_read_b64_tr_b16 v[98:99], v113 offset:21504
  s_waitcnt lgkmcnt(8)
  v_mfma_f32_32x32x16_bf16 v[36:51], a[80:83], v[80:83], v[36:51]
  ds_read_b64_tr_b16 v[100:101], v114 offset:20480
  ds_read_b64_tr_b16 v[102:103], v114 offset:21504
  buffer_load_dwordx4 a[100:103], v68, s[8:11], s25 offen offset:1024
  s_waitcnt lgkmcnt(8)
  v_mfma_f32_32x32x16_bf16 v[52:67], a[80:83], v[84:87], v[52:67]
  s_waitcnt vmcnt(8) lgkmcnt(6)
  v_mfma_f32_32x32x16_bf16 v[4:19], a[84:87], v[88:91], v[4:19]
  ds_read_b64_tr_b16 v[72:73], v111 offset:24576
  ds_read_b64_tr_b16 v[74:75], v111 offset:25600
  ds_read_b64_tr_b16 v[76:77], v112 offset:24576
  buffer_load_dwordx4 a[104:107], v68, s[8:11], s25 offen offset:2048
  s_waitcnt lgkmcnt(7)
  v_mfma_f32_32x32x16_bf16 v[20:35], a[84:87], v[92:95], v[20:35]
  ds_read_b64_tr_b16 v[78:79], v112 offset:25600
  ds_read_b64_tr_b16 v[80:81], v113 offset:24576
  ds_read_b64_tr_b16 v[82:83], v113 offset:25600
  s_waitcnt lgkmcnt(8)
  v_mfma_f32_32x32x16_bf16 v[36:51], a[84:87], v[96:99], v[36:51]
  ds_read_b64_tr_b16 v[84:85], v114 offset:24576
  ds_read_b64_tr_b16 v[86:87], v114 offset:25600
  s_add_u32 m0, s28, 114688
  s_add_u32 s29, s22, 1605632
  buffer_load_dwordx4 v106, s[12:15], s29 offen lds
  s_waitcnt lgkmcnt(8)
  v_mfma_f32_32x32x16_bf16 v[52:67], a[84:87], v[100:103], v[52:67]
  s_waitcnt vmcnt(9) lgkmcnt(6)
  v_mfma_f32_32x32x16_bf16 v[4:19], a[88:91], v[72:75], v[4:19]
  ds_read_b64_tr_b16 v[88:89], v111 offset:28672
  ds_read_b64_tr_b16 v[90:91], v111 offset:29696
  ds_read_b64_tr_b16 v[92:93], v112 offset:28672
  s_add_u32 m0, s28, 118784
  s_add_u32 s29, s22, 1662976
  buffer_load_dwordx4 v106, s[12:15], s29 offen lds
  s_waitcnt lgkmcnt(7)
  v_mfma_f32_32x32x16_bf16 v[20:35], a[88:91], v[76:79], v[20:35]
  ds_read_b64_tr_b16 v[94:95], v112 offset:29696
  ds_read_b64_tr_b16 v[96:97], v113 offset:28672
  ds_read_b64_tr_b16 v[98:99], v113 offset:29696
  s_waitcnt lgkmcnt(8)
  v_mfma_f32_32x32x16_bf16 v[36:51], a[88:91], v[80:83], v[36:51]
  ds_read_b64_tr_b16 v[100:101], v114 offset:28672
  ds_read_b64_tr_b16 v[102:103], v114 offset:29696
  s_add_u32 m0, s28, 122880
  s_add_u32 s29, s22, 1720320
  buffer_load_dwordx4 v106, s[12:15], s29 offen lds
  s_waitcnt lgkmcnt(8)
  v_mfma_f32_32x32x16_bf16 v[52:67], a[88:91], v[84:87], v[52:67]
  s_waitcnt vmcnt(7)
  s_barrier
  s_waitcnt vmcnt(6) lgkmcnt(6)
  v_mfma_f32_32x32x16_bf16 v[4:19], a[92:95], v[88:91], v[4:19]
  ds_read_b64_tr_b16 v[72:73], v111 offset:32768
  ds_read_b64_tr_b16 v[74:75], v111 offset:33792
  ds_read_b64_tr_b16 v[76:77], v112 offset:32768
  s_add_u32 m0, s28, 126976
  s_add_u32 s29, s22, 1777664
  buffer_load_dwordx4 v106, s[12:15], s29 offen lds
  s_waitcnt lgkmcnt(7)
  v_mfma_f32_32x32x16_bf16 v[20:35], a[92:95], v[92:95], v[20:35]
  ds_read_b64_tr_b16 v[78:79], v112 offset:33792
  ds_read_b64_tr_b16 v[80:81], v113 offset:32768
  ds_read_b64_tr_b16 v[82:83], v113 offset:33792
  s_waitcnt lgkmcnt(8)
  v_mfma_f32_32x32x16_bf16 v[36:51], a[92:95], v[96:99], v[36:51]
  ds_read_b64_tr_b16 v[84:85], v114 offset:32768
  ds_read_b64_tr_b16 v[86:87], v114 offset:33792
  buffer_load_dwordx4 a[108:111], v68, s[8:11], s25 offen offset:3072
  s_waitcnt lgkmcnt(8)
  v_mfma_f32_32x32x16_bf16 v[52:67], a[92:95], v[100:103], v[52:67]
  s_waitcnt vmcnt(7) lgkmcnt(6)
  v_mfma_f32_32x32x16_bf16 v[4:19], a[96:99], v[72:75], v[4:19]
  ds_read_b64_tr_b16 v[88:89], v111 offset:36864
  ds_read_b64_tr_b16 v[90:91], v111 offset:37888
  ds_read_b64_tr_b16 v[92:93], v112 offset:36864
  s_add_u32 s25, s25, 4096
  buffer_load_dwordx4 a[112:115], v68, s[8:11], s25 offen offset:0
  s_waitcnt lgkmcnt(7)
  v_mfma_f32_32x32x16_bf16 v[20:35], a[96:99], v[76:79], v[20:35]
  ds_read_b64_tr_b16 v[94:95], v112 offset:37888
  ds_read_b64_tr_b16 v[96:97], v113 offset:36864
  ds_read_b64_tr_b16 v[98:99], v113 offset:37888
  s_waitcnt lgkmcnt(8)
  v_mfma_f32_32x32x16_bf16 v[36:51], a[96:99], v[80:83], v[36:51]
  ds_read_b64_tr_b16 v[100:101], v114 offset:36864
  ds_read_b64_tr_b16 v[102:103], v114 offset:37888
  buffer_load_dwordx4 a[116:119], v68, s[8:11], s25 offen offset:1024
  s_waitcnt lgkmcnt(8)
  v_mfma_f32_32x32x16_bf16 v[52:67], a[96:99], v[84:87], v[52:67]
  s_waitcnt vmcnt(8) lgkmcnt(6)
  v_mfma_f32_32x32x16_bf16 v[4:19], a[100:103], v[88:91], v[4:19]
  ds_read_b64_tr_b16 v[72:73], v111 offset:40960
  ds_read_b64_tr_b16 v[74:75], v111 offset:41984
  ds_read_b64_tr_b16 v[76:77], v112 offset:40960
  buffer_load_dwordx4 a[120:123], v68, s[8:11], s25 offen offset:2048
  s_waitcnt lgkmcnt(7)
  v_mfma_f32_32x32x16_bf16 v[20:35], a[100:103], v[92:95], v[20:35]
  ds_read_b64_tr_b16 v[78:79], v112 offset:41984
  ds_read_b64_tr_b16 v[80:81], v113 offset:40960
  ds_read_b64_tr_b16 v[82:83], v113 offset:41984
  s_waitcnt lgkmcnt(8)
  v_mfma_f32_32x32x16_bf16 v[36:51], a[100:103], v[96:99], v[36:51]
  ds_read_b64_tr_b16 v[84:85], v114 offset:40960
  ds_read_b64_tr_b16 v[86:87], v114 offset:41984
  buffer_load_dwordx4 a[124:127], v68, s[8:11], s25 offen offset:3072
  s_waitcnt lgkmcnt(8)
  v_mfma_f32_32x32x16_bf16 v[52:67], a[100:103], v[100:103], v[52:67]
  s_waitcnt vmcnt(9) lgkmcnt(6)
  v_mfma_f32_32x32x16_bf16 v[4:19], a[104:107], v[72:75], v[4:19]
  ds_read_b64_tr_b16 v[88:89], v111 offset:45056
  ds_read_b64_tr_b16 v[90:91], v111 offset:46080
  ds_read_b64_tr_b16 v[92:93], v112 offset:45056
  s_waitcnt lgkmcnt(7)
  v_mfma_f32_32x32x16_bf16 v[20:35], a[104:107], v[76:79], v[20:35]
  ds_read_b64_tr_b16 v[94:95], v112 offset:46080
  ds_read_b64_tr_b16 v[96:97], v113 offset:45056
  ds_read_b64_tr_b16 v[98:99], v113 offset:46080
  s_waitcnt lgkmcnt(8)
  v_mfma_f32_32x32x16_bf16 v[36:51], a[104:107], v[80:83], v[36:51]
  ds_read_b64_tr_b16 v[100:101], v114 offset:45056
  ds_read_b64_tr_b16 v[102:103], v114 offset:46080
  s_waitcnt lgkmcnt(8)
  v_mfma_f32_32x32x16_bf16 v[52:67], a[104:107], v[84:87], v[52:67]
  s_waitcnt vmcnt(5)
  s_barrier
  s_waitcnt vmcnt(4) lgkmcnt(6)
  v_mfma_f32_32x32x16_bf16 v[4:19], a[108:111], v[88:91], v[4:19]
  ds_read_b64_tr_b16 v[72:73], v111 offset:49152
  ds_read_b64_tr_b16 v[74:75], v111 offset:50176
  ds_read_b64_tr_b16 v[76:77], v112 offset:49152
  s_waitcnt lgkmcnt(7)
  v_mfma_f32_32x32x16_bf16 v[20:35], a[108:111], v[92:95], v[20:35]
  ds_read_b64_tr_b16 v[78:79], v112 offset:50176
  ds_read_b64_tr_b16 v[80:81], v113 offset:49152
  ds_read_b64_tr_b16 v[82:83], v113 offset:50176
  s_waitcnt lgkmcnt(8)
  v_mfma_f32_32x32x16_bf16 v[36:51], a[108:111], v[96:99], v[36:51]
  ds_read_b64_tr_b16 v[84:85], v114 offset:49152
  ds_read_b64_tr_b16 v[86:87], v114 offset:50176
  s_waitcnt lgkmcnt(8)
  v_mfma_f32_32x32x16_bf16 v[52:67], a[108:111], v[100:103], v[52:67]
  s_waitcnt vmcnt(3) lgkmcnt(6)
  v_mfma_f32_32x32x16_bf16 v[4:19], a[112:115], v[72:75], v[4:19]
  ds_read_b64_tr_b16 v[88:89], v111 offset:53248
  ds_read_b64_tr_b16 v[90:91], v111 offset:54272
  ds_read_b64_tr_b16 v[92:93], v112 offset:53248
  s_waitcnt lgkmcnt(7)
  v_mfma_f32_32x32x16_bf16 v[20:35], a[112:115], v[76:79], v[20:35]
  ds_read_b64_tr_b16 v[94:95], v112 offset:54272
  ds_read_b64_tr_b16 v[96:97], v113 offset:53248
  ds_read_b64_tr_b16 v[98:99], v113 offset:54272
  s_waitcnt lgkmcnt(8)
  v_mfma_f32_32x32x16_bf16 v[36:51], a[112:115], v[80:83], v[36:51]
  ds_read_b64_tr_b16 v[100:101], v114 offset:53248
  ds_read_b64_tr_b16 v[102:103], v114 offset:54272
  s_waitcnt lgkmcnt(8)
  v_mfma_f32_32x32x16_bf16 v[52:67], a[112:115], v[84:87], v[52:67]
  s_waitcnt vmcnt(2) lgkmcnt(6)
  v_mfma_f32_32x32x16_bf16 v[4:19], a[116:119], v[88:91], v[4:19]
  ds_read_b64_tr_b16 v[72:73], v111 offset:57344
  ds_read_b64_tr_b16 v[74:75], v111 offset:58368
  ds_read_b64_tr_b16 v[76:77], v112 offset:57344
  s_waitcnt lgkmcnt(7)
  v_mfma_f32_32x32x16_bf16 v[20:35], a[116:119], v[92:95], v[20:35]
  ds_read_b64_tr_b16 v[78:79], v112 offset:58368
  ds_read_b64_tr_b16 v[80:81], v113 offset:57344
  ds_read_b64_tr_b16 v[82:83], v113 offset:58368
  s_waitcnt lgkmcnt(8)
  v_mfma_f32_32x32x16_bf16 v[36:51], a[116:119], v[96:99], v[36:51]
  ds_read_b64_tr_b16 v[84:85], v114 offset:57344
  ds_read_b64_tr_b16 v[86:87], v114 offset:58368
  s_waitcnt lgkmcnt(8)
  v_mfma_f32_32x32x16_bf16 v[52:67], a[116:119], v[100:103], v[52:67]
  s_waitcnt vmcnt(1) lgkmcnt(6)
  v_mfma_f32_32x32x16_bf16 v[4:19], a[120:123], v[72:75], v[4:19]
  ds_read_b64_tr_b16 v[88:89], v111 offset:61440
  ds_read_b64_tr_b16 v[90:91], v111 offset:62464
  ds_read_b64_tr_b16 v[92:93], v112 offset:61440
  s_waitcnt lgkmcnt(7)
  v_mfma_f32_32x32x16_bf16 v[20:35], a[120:123], v[76:79], v[20:35]
  ds_read_b64_tr_b16 v[94:95], v112 offset:62464
  ds_read_b64_tr_b16 v[96:97], v113 offset:61440
  ds_read_b64_tr_b16 v[98:99], v113 offset:62464
  s_waitcnt lgkmcnt(8)
  v_mfma_f32_32x32x16_bf16 v[36:51], a[120:123], v[80:83], v[36:51]
  ds_read_b64_tr_b16 v[100:101], v114 offset:61440
  ds_read_b64_tr_b16 v[102:103], v114 offset:62464
  s_waitcnt lgkmcnt(8)
  v_mfma_f32_32x32x16_bf16 v[52:67], a[120:123], v[84:87], v[52:67]
  s_waitcnt vmcnt(0) lgkmcnt(6)
  v_mfma_f32_32x32x16_bf16 v[4:19], a[124:127], v[88:91], v[4:19]
  s_waitcnt lgkmcnt(4)
  v_mfma_f32_32x32x16_bf16 v[20:35], a[124:127], v[92:95], v[20:35]
  s_waitcnt lgkmcnt(2)
  v_mfma_f32_32x32x16_bf16 v[36:51], a[124:127], v[96:99], v[36:51]
  s_waitcnt lgkmcnt(0)
  v_mfma_f32_32x32x16_bf16 v[52:67], a[124:127], v[100:103], v[52:67]
  s_cmp_eq_u32 s27, 0
  s_cselect_b32 s30, -1, 0
  s_mov_b32 s31, 0
  s_mov_b64 exec, s[30:31]
  s_nop 1
  v_mov_b32 v5, 0
  s_nop 0
  v_mov_b32 v21, 0
  s_nop 0
  v_mov_b32 v37, 0
  s_nop 0
  v_mov_b32 v53, 0
  s_mov_b64 exec, -1
  s_lshl_b32 s30, s23, 18
  s_lshl_b32 s31, s26, 15
  s_add_u32 s30, s30, s31
  s_lshl_b32 s31, s27, 11
  s_add_u32 s30, s30, s31
  s_add_u32 s31, s30, 0
  v_cvt_pk_bf16_f32 v120, v4, v5
  v_cvt_pk_bf16_f32 v121, v6, v7
  v_cvt_pk_bf16_f32 v122, v8, v9
  v_cvt_pk_bf16_f32 v123, v10, v11
  v_cvt_pk_bf16_f32 v124, v12, v13
  v_cvt_pk_bf16_f32 v125, v14, v15
  v_cvt_pk_bf16_f32 v126, v16, v17
  v_cvt_pk_bf16_f32 v127, v18, v19
  buffer_store_dwordx4 v[120:123], v68, s[16:19], s31 offen sc0 sc1
  buffer_store_dwordx4 v[124:127], v68, s[16:19], s31 offen offset:1024 sc0 sc1
  s_add_u32 s31, s30, 65536
  v_cvt_pk_bf16_f32 v120, v20, v21
  v_cvt_pk_bf16_f32 v121, v22, v23
  v_cvt_pk_bf16_f32 v122, v24, v25
  v_cvt_pk_bf16_f32 v123, v26, v27
  v_cvt_pk_bf16_f32 v124, v28, v29
  v_cvt_pk_bf16_f32 v125, v30, v31
  v_cvt_pk_bf16_f32 v126, v32, v33
  v_cvt_pk_bf16_f32 v127, v34, v35
  buffer_store_dwordx4 v[120:123], v68, s[16:19], s31 offen sc0 sc1
  buffer_store_dwordx4 v[124:127], v68, s[16:19], s31 offen offset:1024 sc0 sc1
  s_add_u32 s31, s30, 131072
  v_cvt_pk_bf16_f32 v120, v36, v37
  v_cvt_pk_bf16_f32 v121, v38, v39
  v_cvt_pk_bf16_f32 v122, v40, v41
  v_cvt_pk_bf16_f32 v123, v42, v43
  v_cvt_pk_bf16_f32 v124, v44, v45
  v_cvt_pk_bf16_f32 v125, v46, v47
  v_cvt_pk_bf16_f32 v126, v48, v49
  v_cvt_pk_bf16_f32 v127, v50, v51
  buffer_store_dwordx4 v[120:123], v68, s[16:19], s31 offen sc0 sc1
  buffer_store_dwordx4 v[124:127], v68, s[16:19], s31 offen offset:1024 sc0 sc1
  s_add_u32 s31, s30, 196608
  v_cvt_pk_bf16_f32 v120, v52, v53
  v_cvt_pk_bf16_f32 v121, v54, v55
  v_cvt_pk_bf16_f32 v122, v56, v57
  v_cvt_pk_bf16_f32 v123, v58, v59
  v_cvt_pk_bf16_f32 v124, v60, v61
  v_cvt_pk_bf16_f32 v125, v62, v63
  v_cvt_pk_bf16_f32 v126, v64, v65
  v_cvt_pk_bf16_f32 v127, v66, v67
  buffer_store_dwordx4 v[120:123], v68, s[16:19], s31 offen sc0 sc1
  buffer_store_dwordx4 v[124:127], v68, s[16:19], s31 offen offset:1024 sc0 sc1
  s_endpgm
q0p3:
  s_load_dwordx2 s[6:7], s[0:1], 8
  s_load_dwordx2 s[12:13], s[0:1], 16
  s_load_dwordx2 s[62:63], s[0:1], 48
  s_sub_u32 s20, s2, 176
  s_and_b32 s21, s20, 3
  s_lshr_b32 s20, s20, 2
  s_and_b32 s22, s20, 3
  s_bfe_u32 s23, s20, 0x10002
  s_lshr_b32 s24, s20, 3
  s_waitcnt lgkmcnt(0)
  s_mov_b32 s8, s6
  s_mov_b32 s9, s7
  s_mov_b32 s10, 0x101000
  s_mov_b32 s11, 0x20000
  s_mov_b32 s16, s12
  s_mov_b32 s17, s13
  s_mov_b32 s18, 0x101000
  s_mov_b32 s19, 0x20000
  s_add_u32 s12, s4, 0x1800000
  s_addc_u32 s13, s5, 0
  s_mov_b32 s14, 0x200000
  s_mov_b32 s15, 0x20000
  s_sub_u32 s30, s2, 176
  s_lshl_b32 s30, s30, 2
  s_add_u32 s30, s30, s3
  s_getpc_b64 s[52:53]
  s_add_u32 s52, s52, CT@rel32@lo+4
  s_addc_u32 s53, s53, CT@rel32@hi+12
  s_mov_b32 s54, 53248
  s_mov_b32 s55, 0x20000
  s_getpc_b64 s[56:57]
  s_add_u32 s56, s56, L_q1_kernel@rel32@lo+4
  s_addc_u32 s57, s57, L_q1_kernel@rel32@hi+12
  s_mov_b32 s58, text_end-L_q1_kernel
  s_mov_b32 s59, 0x20000
  v_and_b32 v5, 63, v0
  v_lshlrev_b32 v5, 6, v5
  s_add_u32 s60, s30, 16
  s_and_b32 s60, s60, 255
  s_lshl_b32 s60, s60, 12
  v_add_u32 v6, s60, v5
  buffer_load_dword v7, v6, s[52:55], 0 offen
  s_add_u32 s60, s30, 48
  s_and_b32 s60, s60, 255
  s_lshl_b32 s60, s60, 12
  v_add_u32 v6, s60, v5
  buffer_load_dword v8, v6, s[56:59], 0 offen
  v_and_b32 v1, 63, v0
  s_lshl_b32 s25, s21, 6
  v_add_u32 v1, s25, v1
  v_mov_b32 v4, 256
  v_cmp_eq_u32 vcc, 0, v1
  s_nop 1
  v_cndmask_b32 v2, v1, v4, vcc
  v_lshlrev_b32 v2, 1, v2
  v_lshlrev_b32 v3, 13, v1
  s_lshl_b32 s25, s22, 4
  s_lshl_b32 s26, s3, 2
  s_add_u32 s25, s25, s26
  s_lshl_b32 s26, s23, 10
  s_add_u32 s25, s25, s26
  s_lshl_b32 s26, s24, 9
  s_add_u32 s25, s25, s26
  s_mul_i32 s25, s25, 514
  s_lshl_b32 s26, s22, 6
  s_lshl_b32 s27, s24, 5
  s_add_u32 s26, s26, s27
  s_lshl_b32 s27, s3, 2
  s_add_u32 s26, s26, s27
  s_lshl_b32 s26, s26, 4
  s_lshl_b32 s27, s23, 12
  s_add_u32 s26, s26, s27
  s_load_dwordx2 s[34:35], s[0:1], 0
  s_sub_u32 s30, s2, 176
  s_lshr_b32 s31, s30, 3
  s_and_b32 s30, s30, 7
  s_lshl_b32 s30, s30, 3
  s_add_u32 s30, s30, s31
  s_lshl_b32 s30, s30, 5
  s_lshl_b32 s31, s3, 3
  s_add_u32 s30, s30, s31
  s_waitcnt lgkmcnt(0)
  s_mov_b32 s36, s34
  s_mov_b32 s37, s35
  s_mov_b32 s38, 0x200000
  s_mov_b32 s39, 0x20000
  s_add_u32 s40, s4, 0x1a00000
  s_addc_u32 s41, s5, 0
  s_mov_b32 s42, 0x4000
  s_mov_b32 s43, 0x20000
  v_and_b32 v46, 63, v0
  v_lshrrev_b32 v45, 3, v46
  v_and_b32 v44, 7, v46
  v_lshlrev_b32 v44, 4, v44
  v_lshl_or_b32 v44, v45, 10, v44
  s_lshl_b32 s31, s30, 10
  buffer_load_dwordx4 v[12:15], v44, s[36:39], s31 offen offset:0
  buffer_load_dwordx4 v[16:19], v44, s[36:39], s31 offen offset:128
  buffer_load_dwordx4 v[20:23], v44, s[36:39], s31 offen offset:256
  buffer_load_dwordx4 v[24:27], v44, s[36:39], s31 offen offset:384
  buffer_load_dwordx4 v[28:31], v44, s[36:39], s31 offen offset:512
  buffer_load_dwordx4 v[32:35], v44, s[36:39], s31 offen offset:640
  buffer_load_dwordx4 v[36:39], v44, s[36:39], s31 offen offset:768
  buffer_load_dwordx4 v[40:43], v44, s[36:39], s31 offen offset:896
  s_add_u32 s28, s25, 0
  buffer_load_ushort v48, v2, s[8:11], s28 offen
  buffer_load_ushort v80, v2, s[16:19], s28 offen
  s_add_u32 s28, s25, 32896
  buffer_load_ushort v49, v2, s[8:11], s28 offen
  buffer_load_ushort v81, v2, s[16:19], s28 offen
  s_add_u32 s28, s25, 65792
  buffer_load_ushort v50, v2, s[8:11], s28 offen
  buffer_load_ushort v82, v2, s[16:19], s28 offen
  s_add_u32 s28, s25, 98688
  buffer_load_ushort v51, v2, s[8:11], s28 offen
  buffer_load_ushort v83, v2, s[16:19], s28 offen
  s_add_u32 s28, s25, 514
  buffer_load_ushort v52, v2, s[8:11], s28 offen
  buffer_load_ushort v84, v2, s[16:19], s28 offen
  s_add_u32 s28, s25, 33410
  buffer_load_ushort v53, v2, s[8:11], s28 offen
  buffer_load_ushort v85, v2, s[16:19], s28 offen
  s_add_u32 s28, s25, 66306
  buffer_load_ushort v54, v2, s[8:11], s28 offen
  buffer_load_ushort v86, v2, s[16:19], s28 offen
  s_add_u32 s28, s25, 99202
  buffer_load_ushort v55, v2, s[8:11], s28 offen
  buffer_load_ushort v87, v2, s[16:19], s28 offen
  s_add_u32 s28, s25, 1028
  buffer_load_ushort v56, v2, s[8:11], s28 offen
  buffer_load_ushort v88, v2, s[16:19], s28 offen
  s_add_u32 s28, s25, 33924
  buffer_load_ushort v57, v2, s[8:11], s28 offen
  buffer_load_ushort v89, v2, s[16:19], s28 offen
  s_add_u32 s28, s25, 66820
  buffer_load_ushort v58, v2, s[8:11], s28 offen
  buffer_load_ushort v90, v2, s[16:19], s28 offen
  s_add_u32 s28, s25, 99716
  buffer_load_ushort v59, v2, s[8:11], s28 offen
  buffer_load_ushort v91, v2, s[16:19], s28 offen
  s_add_u32 s28, s25, 1542
  buffer_load_ushort v60, v2, s[8:11], s28 offen
  buffer_load_ushort v92, v2, s[16:19], s28 offen
  s_add_u32 s28, s25, 34438
  buffer_load_ushort v61, v2, s[8:11], s28 offen
  buffer_load_ushort v93, v2, s[16:19], s28 offen
  s_add_u32 s28, s25, 67334
  buffer_load_ushort v62, v2, s[8:11], s28 offen
  buffer_load_ushort v94, v2, s[16:19], s28 offen
  s_add_u32 s28, s25, 100230
  buffer_load_ushort v63, v2, s[8:11], s28 offen
  buffer_load_ushort v95, v2, s[16:19], s28 offen
  s_add_u32 s28, s25, 131584
  buffer_load_ushort v64, v2, s[8:11], s28 offen
  buffer_load_ushort v96, v2, s[16:19], s28 offen
  s_add_u32 s28, s25, 164480
  buffer_load_ushort v65, v2, s[8:11], s28 offen
  buffer_load_ushort v97, v2, s[16:19], s28 offen
  s_add_u32 s28, s25, 197376
  buffer_load_ushort v66, v2, s[8:11], s28 offen
  buffer_load_ushort v98, v2, s[16:19], s28 offen
  s_add_u32 s28, s25, 230272
  buffer_load_ushort v67, v2, s[8:11], s28 offen
  buffer_load_ushort v99, v2, s[16:19], s28 offen
  s_add_u32 s28, s25, 132098
  buffer_load_ushort v68, v2, s[8:11], s28 offen
  buffer_load_ushort v100, v2, s[16:19], s28 offen
  s_add_u32 s28, s25, 164994
  buffer_load_ushort v69, v2, s[8:11], s28 offen
  buffer_load_ushort v101, v2, s[16:19], s28 offen
  s_add_u32 s28, s25, 197890
  buffer_load_ushort v70, v2, s[8:11], s28 offen
  buffer_load_ushort v102, v2, s[16:19], s28 offen
  s_add_u32 s28, s25, 230786
  buffer_load_ushort v71, v2, s[8:11], s28 offen
  buffer_load_ushort v103, v2, s[16:19], s28 offen
  s_add_u32 s28, s25, 132612
  buffer_load_ushort v72, v2, s[8:11], s28 offen
  buffer_load_ushort v104, v2, s[16:19], s28 offen
  s_add_u32 s28, s25, 165508
  buffer_load_ushort v73, v2, s[8:11], s28 offen
  buffer_load_ushort v105, v2, s[16:19], s28 offen
  s_add_u32 s28, s25, 198404
  buffer_load_ushort v74, v2, s[8:11], s28 offen
  buffer_load_ushort v106, v2, s[16:19], s28 offen
  s_add_u32 s28, s25, 231300
  buffer_load_ushort v75, v2, s[8:11], s28 offen
  buffer_load_ushort v107, v2, s[16:19], s28 offen
  s_add_u32 s28, s25, 133126
  buffer_load_ushort v76, v2, s[8:11], s28 offen
  buffer_load_ushort v108, v2, s[16:19], s28 offen
  s_add_u32 s28, s25, 166022
  buffer_load_ushort v77, v2, s[8:11], s28 offen
  buffer_load_ushort v109, v2, s[16:19], s28 offen
  s_add_u32 s28, s25, 198918
  buffer_load_ushort v78, v2, s[8:11], s28 offen
  buffer_load_ushort v110, v2, s[16:19], s28 offen
  s_add_u32 s28, s25, 231814
  buffer_load_ushort v79, v2, s[8:11], s28 offen
  buffer_load_ushort v111, v2, s[16:19], s28 offen
  v_mov_b32 v112, 0
  v_mov_b32 v113, 0
  v_mov_b32 v114, 0
  v_mov_b32 v115, 0
  s_waitcnt vmcnt(63)
  v_lshlrev_b32 v116, 16, v12
  v_and_b32 v117, 0xffff0000, v12
  v_lshlrev_b32 v118, 16, v13
  v_and_b32 v119, 0xffff0000, v13
  v_lshlrev_b32 v120, 16, v14
  v_and_b32 v121, 0xffff0000, v14
  v_lshlrev_b32 v122, 16, v15
  v_and_b32 v123, 0xffff0000, v15
  v_pk_add_f32 v[112:113], v[112:113], v[116:117]
  v_pk_fma_f32 v[114:115], v[116:117], v[116:117], v[114:115]
  v_pk_add_f32 v[112:113], v[112:113], v[118:119]
  v_pk_fma_f32 v[114:115], v[118:119], v[118:119], v[114:115]
  v_pk_add_f32 v[112:113], v[112:113], v[120:121]
  v_pk_fma_f32 v[114:115], v[120:121], v[120:121], v[114:115]
  v_pk_add_f32 v[112:113], v[112:113], v[122:123]
  v_pk_fma_f32 v[114:115], v[122:123], v[122:123], v[114:115]
  v_lshlrev_b32 v116, 16, v16
  v_and_b32 v117, 0xffff0000, v16
  v_lshlrev_b32 v118, 16, v17
  v_and_b32 v119, 0xffff0000, v17
  v_lshlrev_b32 v120, 16, v18
  v_and_b32 v121, 0xffff0000, v18
  v_lshlrev_b32 v122, 16, v19
  v_and_b32 v123, 0xffff0000, v19
  v_pk_add_f32 v[112:113], v[112:113], v[116:117]
  v_pk_fma_f32 v[114:115], v[116:117], v[116:117], v[114:115]
  v_pk_add_f32 v[112:113], v[112:113], v[118:119]
  v_pk_fma_f32 v[114:115], v[118:119], v[118:119], v[114:115]
  v_pk_add_f32 v[112:113], v[112:113], v[120:121]
  v_pk_fma_f32 v[114:115], v[120:121], v[120:121], v[114:115]
  v_pk_add_f32 v[112:113], v[112:113], v[122:123]
  v_pk_fma_f32 v[114:115], v[122:123], v[122:123], v[114:115]
  v_lshlrev_b32 v116, 16, v20
  v_and_b32 v117, 0xffff0000, v20
  v_lshlrev_b32 v118, 16, v21
  v_and_b32 v119, 0xffff0000, v21
  v_lshlrev_b32 v120, 16, v22
  v_and_b32 v121, 0xffff0000, v22
  v_lshlrev_b32 v122, 16, v23
  v_and_b32 v123, 0xffff0000, v23
  v_pk_add_f32 v[112:113], v[112:113], v[116:117]
  v_pk_fma_f32 v[114:115], v[116:117], v[116:117], v[114:115]
  v_pk_add_f32 v[112:113], v[112:113], v[118:119]
  v_pk_fma_f32 v[114:115], v[118:119], v[118:119], v[114:115]
  v_pk_add_f32 v[112:113], v[112:113], v[120:121]
  v_pk_fma_f32 v[114:115], v[120:121], v[120:121], v[114:115]
  v_pk_add_f32 v[112:113], v[112:113], v[122:123]
  v_pk_fma_f32 v[114:115], v[122:123], v[122:123], v[114:115]
  v_lshlrev_b32 v116, 16, v24
  v_and_b32 v117, 0xffff0000, v24
  v_lshlrev_b32 v118, 16, v25
  v_and_b32 v119, 0xffff0000, v25
  v_lshlrev_b32 v120, 16, v26
  v_and_b32 v121, 0xffff0000, v26
  v_lshlrev_b32 v122, 16, v27
  v_and_b32 v123, 0xffff0000, v27
  v_pk_add_f32 v[112:113], v[112:113], v[116:117]
  v_pk_fma_f32 v[114:115], v[116:117], v[116:117], v[114:115]
  v_pk_add_f32 v[112:113], v[112:113], v[118:119]
  v_pk_fma_f32 v[114:115], v[118:119], v[118:119], v[114:115]
  v_pk_add_f32 v[112:113], v[112:113], v[120:121]
  v_pk_fma_f32 v[114:115], v[120:121], v[120:121], v[114:115]
  v_pk_add_f32 v[112:113], v[112:113], v[122:123]
  v_pk_fma_f32 v[114:115], v[122:123], v[122:123], v[114:115]
  v_lshlrev_b32 v116, 16, v28
  v_and_b32 v117, 0xffff0000, v28
  v_lshlrev_b32 v118, 16, v29
  v_and_b32 v119, 0xffff0000, v29
  v_lshlrev_b32 v120, 16, v30
  v_and_b32 v121, 0xffff0000, v30
  v_lshlrev_b32 v122, 16, v31
  v_and_b32 v123, 0xffff0000, v31
  v_pk_add_f32 v[112:113], v[112:113], v[116:117]
  v_pk_fma_f32 v[114:115], v[116:117], v[116:117], v[114:115]
  v_pk_add_f32 v[112:113], v[112:113], v[118:119]
  v_pk_fma_f32 v[114:115], v[118:119], v[118:119], v[114:115]
  v_pk_add_f32 v[112:113], v[112:113], v[120:121]
  v_pk_fma_f32 v[114:115], v[120:121], v[120:121], v[114:115]
  v_pk_add_f32 v[112:113], v[112:113], v[122:123]
  v_pk_fma_f32 v[114:115], v[122:123], v[122:123], v[114:115]
  v_lshlrev_b32 v116, 16, v32
  v_and_b32 v117, 0xffff0000, v32
  v_lshlrev_b32 v118, 16, v33
  v_and_b32 v119, 0xffff0000, v33
  v_lshlrev_b32 v120, 16, v34
  v_and_b32 v121, 0xffff0000, v34
  v_lshlrev_b32 v122, 16, v35
  v_and_b32 v123, 0xffff0000, v35
  v_pk_add_f32 v[112:113], v[112:113], v[116:117]
  v_pk_fma_f32 v[114:115], v[116:117], v[116:117], v[114:115]
  v_pk_add_f32 v[112:113], v[112:113], v[118:119]
  v_pk_fma_f32 v[114:115], v[118:119], v[118:119], v[114:115]
  v_pk_add_f32 v[112:113], v[112:113], v[120:121]
  v_pk_fma_f32 v[114:115], v[120:121], v[120:121], v[114:115]
  v_pk_add_f32 v[112:113], v[112:113], v[122:123]
  v_pk_fma_f32 v[114:115], v[122:123], v[122:123], v[114:115]
  v_lshlrev_b32 v116, 16, v36
  v_and_b32 v117, 0xffff0000, v36
  v_lshlrev_b32 v118, 16, v37
  v_and_b32 v119, 0xffff0000, v37
  v_lshlrev_b32 v120, 16, v38
  v_and_b32 v121, 0xffff0000, v38
  v_lshlrev_b32 v122, 16, v39
  v_and_b32 v123, 0xffff0000, v39
  v_pk_add_f32 v[112:113], v[112:113], v[116:117]
  v_pk_fma_f32 v[114:115], v[116:117], v[116:117], v[114:115]
  v_pk_add_f32 v[112:113], v[112:113], v[118:119]
  v_pk_fma_f32 v[114:115], v[118:119], v[118:119], v[114:115]
  v_pk_add_f32 v[112:113], v[112:113], v[120:121]
  v_pk_fma_f32 v[114:115], v[120:121], v[120:121], v[114:115]
  v_pk_add_f32 v[112:113], v[112:113], v[122:123]
  v_pk_fma_f32 v[114:115], v[122:123], v[122:123], v[114:115]
  v_lshlrev_b32 v116, 16, v40
  v_and_b32 v117, 0xffff0000, v40
  v_lshlrev_b32 v118, 16, v41
  v_and_b32 v119, 0xffff0000, v41
  v_lshlrev_b32 v120, 16, v42
  v_and_b32 v121, 0xffff0000, v42
  v_lshlrev_b32 v122, 16, v43
  v_and_b32 v123, 0xffff0000, v43
  v_pk_add_f32 v[112:113], v[112:113], v[116:117]
  v_pk_fma_f32 v[114:115], v[116:117], v[116:117], v[114:115]
  v_pk_add_f32 v[112:113], v[112:113], v[118:119]
  v_pk_fma_f32 v[114:115], v[118:119], v[118:119], v[114:115]
  v_pk_add_f32 v[112:113], v[112:113], v[120:121]
  v_pk_fma_f32 v[114:115], v[120:121], v[120:121], v[114:115]
  v_pk_add_f32 v[112:113], v[112:113], v[122:123]
  v_pk_fma_f32 v[114:115], v[122:123], v[122:123], v[114:115]
  v_add_f32 v112, v112, v113
  v_add_f32 v114, v114, v115
  s_nop 0
  v_add_f32_dpp v112, v112, v112 quad_perm:[1,0,3,2] row_mask:0xf bank_mask:0xf
  v_add_f32_dpp v114, v114, v114 quad_perm:[1,0,3,2] row_mask:0xf bank_mask:0xf
  s_nop 0
  v_add_f32_dpp v112, v112, v112 quad_perm:[2,3,0,1] row_mask:0xf bank_mask:0xf
  v_add_f32_dpp v114, v114, v114 quad_perm:[2,3,0,1] row_mask:0xf bank_mask:0xf
  s_nop 0
  v_add_f32_dpp v112, v112, v112 row_half_mirror row_mask:0xf bank_mask:0xf
  v_add_f32_dpp v114, v114, v114 row_half_mirror row_mask:0xf bank_mask:0xf
  v_mul_f32 v112, v112, v112
  s_mov_b32 s33, 0xbb000000
  v_fma_f32 v114, v112, s33, v114
  v_lshlrev_b32 v45, 2, v45
  v_mov_b32 v112, 0
  s_lshl_b32 s31, s30, 2
  s_add_u32 s33, s31, 0x2000
  s_mov_b32 exec_lo, 0x01010101
  s_mov_b32 exec_hi, 0x01010101
  buffer_store_dword v114, v45, s[40:43], s31 offen
  buffer_store_dword v112, v45, s[40:43], s33 offen
  s_add_u32 s44, s4, 0x1a10000
  s_addc_u32 s45, s5, 0
  s_mov_b32 s46, 0x10000
  s_mov_b32 s47, 0x20000
  s_sub_u32 s31, s2, 176
  s_mul_i32 s33, s31, 4352
  s_lshl_b32 s31, s31, 2
  s_add_u32 s31, s31, s3
  s_cmp_lt_u32 s31, 64
  s_cselect_b32 s31, 1, 0
  s_cmp_eq_u32 s3, 0
  s_cselect_b32 exec_lo, s31, 0
  s_mov_b32 exec_hi, 0
  buffer_store_dword v112, v45, s[44:47], s33 offen
  s_mov_b64 exec, -1
  s_waitcnt vmcnt(63)
  v_lshl_or_b32 v48, v80, 16, v48
  v_lshl_or_b32 v49, v81, 16, v49
  s_waitcnt vmcnt(61)
  v_lshl_or_b32 v50, v82, 16, v50
  s_waitcnt vmcnt(59)
  v_lshl_or_b32 v51, v83, 16, v51
  buffer_store_dwordx4 v[48:51], v3, s[12:15], s26 offen offset:0
  s_waitcnt vmcnt(58)
  v_lshl_or_b32 v52, v84, 16, v52
  s_waitcnt vmcnt(56)
  v_lshl_or_b32 v53, v85, 16, v53
  s_waitcnt vmcnt(54)
  v_lshl_or_b32 v54, v86, 16, v54
  s_waitcnt vmcnt(52)
  v_lshl_or_b32 v55, v87, 16, v55
  buffer_store_dwordx4 v[52:55], v3, s[12:15], s26 offen offset:16
  s_waitcnt vmcnt(51)
  v_lshl_or_b32 v56, v88, 16, v56
  s_waitcnt vmcnt(49)
  v_lshl_or_b32 v57, v89, 16, v57
  s_waitcnt vmcnt(47)
  v_lshl_or_b32 v58, v90, 16, v58
  s_waitcnt vmcnt(45)
  v_lshl_or_b32 v59, v91, 16, v59
  buffer_store_dwordx4 v[56:59], v3, s[12:15], s26 offen offset:32
  s_waitcnt vmcnt(44)
  v_lshl_or_b32 v60, v92, 16, v60
  s_waitcnt vmcnt(42)
  v_lshl_or_b32 v61, v93, 16, v61
  s_waitcnt vmcnt(40)
  v_lshl_or_b32 v62, v94, 16, v62
  s_waitcnt vmcnt(38)
  v_lshl_or_b32 v63, v95, 16, v63
  buffer_store_dwordx4 v[60:63], v3, s[12:15], s26 offen offset:48
  s_waitcnt vmcnt(37)
  v_lshl_or_b32 v64, v96, 16, v64
  s_waitcnt vmcnt(35)
  v_lshl_or_b32 v65, v97, 16, v65
  s_waitcnt vmcnt(33)
  v_lshl_or_b32 v66, v98, 16, v66
  s_waitcnt vmcnt(31)
  v_lshl_or_b32 v67, v99, 16, v67
  buffer_store_dwordx4 v[64:67], v3, s[12:15], s26 offen offset:256
  s_waitcnt vmcnt(30)
  v_lshl_or_b32 v68, v100, 16, v68
  s_waitcnt vmcnt(28)
  v_lshl_or_b32 v69, v101, 16, v69
  s_waitcnt vmcnt(26)
  v_lshl_or_b32 v70, v102, 16, v70
  s_waitcnt vmcnt(24)
  v_lshl_or_b32 v71, v103, 16, v71
  buffer_store_dwordx4 v[68:71], v3, s[12:15], s26 offen offset:272
  s_waitcnt vmcnt(23)
  v_lshl_or_b32 v72, v104, 16, v72
  s_waitcnt vmcnt(21)
  v_lshl_or_b32 v73, v105, 16, v73
  s_waitcnt vmcnt(19)
  v_lshl_or_b32 v74, v106, 16, v74
  s_waitcnt vmcnt(17)
  v_lshl_or_b32 v75, v107, 16, v75
  buffer_store_dwordx4 v[72:75], v3, s[12:15], s26 offen offset:288
  s_waitcnt vmcnt(16)
  v_lshl_or_b32 v76, v108, 16, v76
  s_waitcnt vmcnt(14)
  v_lshl_or_b32 v77, v109, 16, v77
  s_waitcnt vmcnt(12)
  v_lshl_or_b32 v78, v110, 16, v78
  s_waitcnt vmcnt(10)
  v_lshl_or_b32 v79, v111, 16, v79
  buffer_store_dwordx4 v[76:79], v3, s[12:15], s26 offen offset:304
  s_endpgm
q0e4:
  s_endpgm
.section .rodata,"a"
.p2align 6
.amdhsa_kernel q0_kernel
  .amdhsa_next_free_vgpr 256
  .amdhsa_next_free_sgpr 102
  .amdhsa_accum_offset 128
  .amdhsa_group_segment_fixed_size 0
  .amdhsa_kernarg_size 80
  .amdhsa_user_sgpr_count 2
  .amdhsa_user_sgpr_kernarg_segment_ptr 1
  .amdhsa_system_sgpr_workgroup_id_x 1
.end_amdhsa_kernel
.text
.globl q1_kernel
.p2align 8
.type q1_kernel,@function
q1_kernel:
L_q1_kernel:
  s_cmp_ge_u32 s2, 256
  s_cbranch_scc1 ce8
  s_load_dwordx2 s[4:5], s[0:1], 72
  v_lshrrev_b32 v1, 6, v0
  s_nop 0
  v_readfirstlane_b32 s3, v1
  s_load_dwordx2 s[48:49], s[0:1], 48
  s_getpc_b64 s[96:97]
pf10:
  s_mov_b32 s98, text_end-pf10
  s_mov_b32 s99, 0x20000
  v_lshlrev_b32 v2, 6, v0
  buffer_load_dword v3, v2, s[96:99], 0 offen
  s_getpc_b64 s[6:7]
  s_add_u32 s6, s6, CT@rel32@lo+4
  s_addc_u32 s7, s7, CT@rel32@hi+12
  s_lshl_b32 s28, s2, 13
  s_add_u32 s29, s28, 0x0
  s_waitcnt lgkmcnt(0)
  s_add_u32 s12, s4, s29
  s_addc_u32 s13, s5, 0
  s_mov_b32 s14, 0x2000
  s_mov_b32 s15, 0x20000
  s_add_u32 s16, s4, 0x1a00000
  s_addc_u32 s17, s5, 0
  s_mov_b32 s18, 0x2000
  s_mov_b32 s19, 0x20000
  v_lshlrev_b32 v20, 5, v0
  buffer_load_dwordx4 v[4:7], v20, s[12:15], 0 offen
  buffer_load_dwordx4 v[8:11], v20, s[12:15], 0 offen offset:16
  buffer_load_dwordx4 v[12:15], v20, s[16:19], 0 offen
  buffer_load_dwordx4 v[16:19], v20, s[16:19], 0 offen offset:16
  s_add_u32 s29, s28, 0x1800000
  s_add_u32 s20, s4, s29
  s_addc_u32 s21, s5, 0
  s_mov_b32 s22, 0x2000
  s_mov_b32 s23, 0x20000
  v_lshlrev_b32 v32, 4, v0
  s_movk_i32 s37, 0x1000
  s_mov_b32 s8, s6
  s_mov_b32 s9, s7
  s_mov_b32 s10, 0xd000
  s_mov_b32 s11, 0x20000
  s_add_u32 s29, s28, 0x200000
  s_add_u32 s24, s4, s29
  s_addc_u32 s25, s5, 0
  s_mov_b32 s26, 0x2000
  s_mov_b32 s27, 0x20000
  v_and_b32 v22, 63, v0
  v_lshlrev_b32 v21, 4, v22
  s_and_b32 s30, s3, 1
  s_lshr_b32 s31, s3, 1
  s_lshl_b32 s32, s31, 12
  s_add_u32 s33, s32, 8192
  buffer_load_dwordx4 v[36:39], v21, s[8:11], s32 offen offset:0
  buffer_load_dwordx4 v[52:55], v21, s[8:11], s33 offen offset:0
  buffer_load_dwordx4 v[40:43], v21, s[8:11], s32 offen offset:1024
  buffer_load_dwordx4 v[56:59], v21, s[8:11], s33 offen offset:1024
  buffer_load_dwordx4 v[44:47], v21, s[8:11], s32 offen offset:2048
  buffer_load_dwordx4 v[60:63], v21, s[8:11], s33 offen offset:2048
  buffer_load_dwordx4 v[48:51], v21, s[8:11], s32 offen offset:3072
  buffer_load_dwordx4 v[64:67], v21, s[8:11], s33 offen offset:3072
  s_lshl_b32 s34, s3, 12
  s_add_u32 s35, s34, 36864
  s_add_u32 s34, s34, 20480
  buffer_load_dwordx4 v[84:87], v21, s[8:11], s34 offen offset:0
  buffer_load_dwordx4 v[88:91], v21, s[8:11], s34 offen offset:1024
  buffer_load_dwordx4 v[92:95], v21, s[8:11], s34 offen offset:2048
  buffer_load_dwordx4 v[96:99], v21, s[8:11], s34 offen offset:3072
  s_mov_b32 s36, 16384
  buffer_load_dwordx4 v[100:103], v21, s[8:11], s36 offen offset:0
  buffer_load_dwordx4 v[108:111], v21, s[8:11], s36 offen offset:2048
  buffer_load_dwordx4 v[104:107], v21, s[8:11], s36 offen offset:1024
  buffer_load_dwordx4 v[112:115], v21, s[8:11], s36 offen offset:3072
  buffer_load_dwordx4 v[24:27], v32, s[20:23], 0 offen
  buffer_load_dwordx4 v[28:31], v32, s[20:23], s37 offen
  buffer_load_dwordx4 v[124:127], v21, s[8:11], s35 offen offset:0
  buffer_load_dwordx4 v[128:131], v21, s[8:11], s35 offen offset:1024
  buffer_load_dwordx4 v[132:135], v21, s[8:11], s35 offen offset:2048
  buffer_load_dwordx4 v[136:139], v21, s[8:11], s35 offen offset:3072
  v_and_b32 v140, 15, v22
  v_lshrrev_b32 v141, 4, v22
  v_lshlrev_b32 v142, 7, v140
  v_lshl_or_b32 v142, v141, 4, v142
  s_lshl_b32 s38, s31, 12
  s_lshl_b32 s39, s30, 6
  s_add_u32 s38, s38, s39
  buffer_load_dwordx4 v[148:151], v142, s[12:15], s38 offen offset:0
  buffer_load_dwordx4 v[152:155], v142, s[12:15], s38 offen offset:2048
  s_mov_b32 s52, s48
  s_mov_b32 s53, s49
  s_mov_b32 s54, 0x1c0000
  s_mov_b32 s55, 0x20000
  s_getpc_b64 s[56:57]
  s_add_u32 s56, s56, RT@rel32@lo+4
  s_addc_u32 s57, s57, RT@rel32@hi+12
  s_mov_b32 s58, 0x80000
  s_mov_b32 s59, 0x20000
  s_lshl_b32 s50, s3, 8
  s_add_u32 s50, s50, s2
  s_lshl_b32 s50, s50, 13
  v_mul_u32_u24 v156, 128, v22
  v_add_u32 v156, s50, v156
  buffer_load_dword v3, v156, s[52:55], 0 offen
  v_subrev_u32 v157, 2097152, v156
  buffer_load_dword v3, v157, s[56:59], 0 offen
  s_mov_b32 s40, 0x3b000000
  s_cmp_eq_u32 s2, 0
  s_cselect_b32 s41, 0, 0xffff0000
  s_cselect_b32 s43, 0, 0x3a000000
  s_mov_b32 s42, 0x3a000000
  s_mov_b32 s44, 0x80008000
  v_mov_b32 v158, 0x3727c5ac
  v_bfe_u32 v143, v0, 5, 1
  v_lshlrev_b32 v143, 1, v143
  v_xor_b32 v143, v143, v0
  v_and_b32 v143, 3, v143
  v_lshlrev_b32 v143, 4, v143
  v_lshrrev_b32 v144, 2, v0
  v_lshl_or_b32 v159, v144, 6, v143
  v_bfe_u32 v143, v22, 2, 2
  v_lshl_add_u32 v143, v141, 3, v143
  v_lshlrev_b32 v143, 6, v143
  v_xor_b32 v144, s30, v141
  v_and_b32 v144, 1, v144
  v_lshl_or_b32 v143, v144, 5, v143
  v_and_b32 v144, 3, v22
  v_lshl_or_b32 v160, v144, 3, v143
  v_lshrrev_b32 v143, 2, v140
  v_sub_u32 v143, 0, v143
  v_xor_b32 v143, v143, v141
  v_and_b32 v143, 3, v143
  v_lshlrev_b32 v166, 4, v143
  v_lshl_or_b32 v166, v140, 6, v166
  s_lshl_b32 s45, s31, 11
  s_lshl_b32 s46, s30, 3
  s_add_u32 s45, s45, s46
  s_add_u32 s45, s45, 8192
  v_add_u32 v161, s45, v166
  s_lshl_b32 s45, s3, 10
  s_add_u32 s45, s45, 8192
  v_add_u32 v162, s45, v166
  v_lshrrev_b32 v143, 1, v141
  s_lshl_b32 s45, s3, 1
  v_add_u32 v143, s45, v143
  v_xor_b32 v143, v143, v140
  v_and_b32 v143, 7, v143
  v_lshlrev_b32 v143, 4, v143
  v_and_b32 v144, 1, v141
  v_lshl_or_b32 v143, v144, 3, v143
  v_lshl_or_b32 v143, v140, 7, v143
  v_add_u32 v163, 16384, v143
  v_add_u32 v143, 0, v141
  v_xor_b32 v143, v143, v140
  v_and_b32 v143, 7, v143
  v_lshlrev_b32 v143, 4, v143
  v_lshl_or_b32 v143, v140, 7, v143
  s_lshl_b32 s45, s30, 11
  s_add_u32 s45, s45, 16384
  v_add_u32 v164, s45, v143
  v_add_u32 v143, 4, v141
  v_xor_b32 v143, v143, v140
  v_and_b32 v143, 7, v143
  v_lshlrev_b32 v143, 4, v143
  v_lshl_or_b32 v143, v140, 7, v143
  s_lshl_b32 s45, s30, 11
  s_add_u32 s45, s45, 16384
  v_add_u32 v165, s45, v143
  s_waitcnt vmcnt(27)
  v_fma_f32 v12, v12, s40, v158
  v_fma_f32 v13, v13, s40, v158
  v_fma_f32 v14, v14, s40, v158
  v_fma_f32 v15, v15, s40, v158
  s_waitcnt vmcnt(26)
  v_fma_f32 v16, v16, s40, v158
  v_fma_f32 v17, v17, s40, v158
  v_fma_f32 v18, v18, s40, v158
  v_fma_f32 v19, v19, s40, v158
  v_rsq_f32 v12, v12
  v_rsq_f32 v13, v13
  v_rsq_f32 v14, v14
  v_rsq_f32 v15, v15
  v_rsq_f32 v16, v16
  v_rsq_f32 v17, v17
  v_rsq_f32 v18, v18
  v_rsq_f32 v19, v19
  v_lshlrev_b32 v168, 16, v4
  v_and_b32 v176, s41, v4
  v_lshlrev_b32 v169, 16, v5
  v_and_b32 v177, s41, v5
  v_lshlrev_b32 v170, 16, v6
  v_and_b32 v178, s41, v6
  v_lshlrev_b32 v171, 16, v7
  v_and_b32 v179, s41, v7
  v_lshlrev_b32 v172, 16, v8
  v_and_b32 v180, s41, v8
  v_lshlrev_b32 v173, 16, v9
  v_and_b32 v181, s41, v9
  v_lshlrev_b32 v174, 16, v10
  v_and_b32 v182, s41, v10
  v_lshlrev_b32 v175, 16, v11
  v_and_b32 v183, s41, v11
  v_mul_f32 v168, v168, v12
  v_mul_f32 v176, v176, v12
  v_mul_f32 v169, v169, v13
  v_mul_f32 v177, v177, v13
  v_mul_f32 v170, v170, v14
  v_mul_f32 v178, v178, v14
  v_mul_f32 v171, v171, v15
  v_mul_f32 v179, v179, v15
  v_mul_f32 v172, v172, v16
  v_mul_f32 v180, v180, v16
  v_mul_f32 v173, v173, v17
  v_mul_f32 v181, v181, v17
  v_mul_f32 v174, v174, v18
  v_mul_f32 v182, v182, v18
  v_mul_f32 v175, v175, v19
  v_mul_f32 v183, v183, v19
  v_cvt_pk_bf16_f32 v184, v168, v169
  v_cvt_pk_bf16_f32 v185, v170, v171
  v_cvt_pk_bf16_f32 v186, v172, v173
  v_cvt_pk_bf16_f32 v187, v174, v175
  ds_write_b128 v159, v[184:187] offset:0
  v_cvt_pk_bf16_f32 v188, v176, v177
  v_cvt_pk_bf16_f32 v189, v178, v179
  v_cvt_pk_bf16_f32 v190, v180, v181
  v_cvt_pk_bf16_f32 v191, v182, v183
  ds_write_b128 v159, v[188:191] offset:4096
  s_waitcnt vmcnt(24)
  v_xor_b32 v68, s44, v52
  v_xor_b32 v69, s44, v53
  v_xor_b32 v70, s44, v54
  v_xor_b32 v71, s44, v55
  s_waitcnt vmcnt(22)
  v_xor_b32 v72, s44, v56
  v_xor_b32 v73, s44, v57
  v_xor_b32 v74, s44, v58
  v_xor_b32 v75, s44, v59
  s_waitcnt vmcnt(20)
  v_xor_b32 v76, s44, v60
  v_xor_b32 v77, s44, v61
  v_xor_b32 v78, s44, v62
  v_xor_b32 v79, s44, v63
  s_waitcnt vmcnt(18)
  v_xor_b32 v80, s44, v64
  v_xor_b32 v81, s44, v65
  v_xor_b32 v82, s44, v66
  v_xor_b32 v83, s44, v67
  s_waitcnt lgkmcnt(0)
  s_barrier
  ds_read_b64_tr_b16 v[168:169], v160 offset:0
  ds_read_b64_tr_b16 v[170:171], v160 offset:256
  ds_read_b64_tr_b16 v[172:173], v160 offset:4096
  ds_read_b64_tr_b16 v[174:175], v160 offset:4352
  ds_read_b64_tr_b16 v[176:177], v160 offset:2048
  ds_read_b64_tr_b16 v[178:179], v160 offset:2304
  ds_read_b64_tr_b16 v[180:181], v160 offset:6144
  ds_read_b64_tr_b16 v[182:183], v160 offset:6400
  s_waitcnt lgkmcnt(6)
  v_mfma_f32_16x16x32_bf16 v[200:203], v[168:171], v[36:39], 0
  v_mfma_f32_16x16x32_bf16 v[204:207], v[168:171], v[44:47], 0
  s_waitcnt lgkmcnt(4)
  v_mfma_f32_16x16x32_bf16 v[208:211], v[172:175], v[36:39], 0
  v_mfma_f32_16x16x32_bf16 v[212:215], v[172:175], v[44:47], 0
  v_mfma_f32_16x16x32_bf16 v[200:203], v[172:175], v[52:55], v[200:203]
  v_mfma_f32_16x16x32_bf16 v[204:207], v[172:175], v[60:63], v[204:207]
  v_mfma_f32_16x16x32_bf16 v[208:211], v[168:171], v[68:71], v[208:211]
  v_mfma_f32_16x16x32_bf16 v[212:215], v[168:171], v[76:79], v[212:215]
  s_waitcnt lgkmcnt(2)
  v_mfma_f32_16x16x32_bf16 v[200:203], v[176:179], v[40:43], v[200:203]
  v_mfma_f32_16x16x32_bf16 v[204:207], v[176:179], v[48:51], v[204:207]
  s_waitcnt lgkmcnt(0)
  v_mfma_f32_16x16x32_bf16 v[208:211], v[180:183], v[40:43], v[208:211]
  v_mfma_f32_16x16x32_bf16 v[212:215], v[180:183], v[48:51], v[212:215]
  v_mfma_f32_16x16x32_bf16 v[200:203], v[180:183], v[56:59], v[200:203]
  v_mfma_f32_16x16x32_bf16 v[204:207], v[180:183], v[64:67], v[204:207]
  v_mfma_f32_16x16x32_bf16 v[208:211], v[176:179], v[72:75], v[208:211]
  v_mfma_f32_16x16x32_bf16 v[212:215], v[176:179], v[80:83], v[212:215]
  s_waitcnt vmcnt(12)
  v_xor_b32 v116, s44, v108
  v_xor_b32 v117, s44, v109
  v_xor_b32 v118, s44, v110
  v_xor_b32 v119, s44, v111
  s_waitcnt vmcnt(10)
  v_xor_b32 v120, s44, v112
  v_xor_b32 v121, s44, v113
  v_xor_b32 v122, s44, v114
  v_xor_b32 v123, s44, v115
  v_mul_f32 v168, v208, v88
  v_mul_f32 v172, v200, v88
  v_mul_f32 v169, v209, v89
  v_mul_f32 v173, v201, v89
  v_mul_f32 v170, v210, v90
  v_mul_f32 v174, v202, v90
  v_mul_f32 v171, v211, v91
  v_mul_f32 v175, v203, v91
  v_fma_f32 v168, v200, v84, v168
  v_fma_f32 v172, v208, v84, -v172
  v_fma_f32 v169, v201, v85, v169
  v_fma_f32 v173, v209, v85, -v173
  v_fma_f32 v170, v202, v86, v170
  v_fma_f32 v174, v210, v86, -v174
  v_fma_f32 v171, v203, v87, v171
  v_fma_f32 v175, v211, v87, -v175
  v_cvt_pk_bf16_f32 v216, v168, v169
  v_cvt_pk_bf16_f32 v218, v172, v173
  v_cvt_pk_bf16_f32 v217, v170, v171
  v_cvt_pk_bf16_f32 v219, v174, v175
  ds_write_b64 v161, v[216:217] offset:0
  ds_write_b64 v161, v[218:219] offset:4096
  v_mul_f32 v176, v212, v96
  v_mul_f32 v180, v204, v96
  v_mul_f32 v177, v213, v97
  v_mul_f32 v181, v205, v97
  v_mul_f32 v178, v214, v98
  v_mul_f32 v182, v206, v98
  v_mul_f32 v179, v215, v99
  v_mul_f32 v183, v207, v99
  v_fma_f32 v176, v204, v92, v176
  v_fma_f32 v180, v212, v92, -v180
  v_fma_f32 v177, v205, v93, v177
  v_fma_f32 v181, v213, v93, -v181
  v_fma_f32 v178, v206, v94, v178
  v_fma_f32 v182, v214, v94, -v182
  v_fma_f32 v179, v207, v95, v179
  v_fma_f32 v183, v215, v95, -v183
  v_cvt_pk_bf16_f32 v220, v176, v177
  v_cvt_pk_bf16_f32 v222, v180, v181
  v_cvt_pk_bf16_f32 v221, v178, v179
  v_cvt_pk_bf16_f32 v223, v182, v183
  ds_write_b64 v161, v[220:221] offset:1024
  ds_write_b64 v161, v[222:223] offset:5120
  s_waitcnt vmcnt(9)
  v_lshlrev_b32 v232, 16, v24
  v_and_b32 v24, 0xffff0000, v24
  v_lshlrev_b32 v233, 16, v25
  v_and_b32 v25, 0xffff0000, v25
  v_lshlrev_b32 v234, 16, v26
  v_and_b32 v26, 0xffff0000, v26
  v_lshlrev_b32 v235, 16, v27
  v_and_b32 v27, 0xffff0000, v27
  s_waitcnt vmcnt(8)
  v_lshlrev_b32 v236, 16, v28
  v_and_b32 v28, 0xffff0000, v28
  v_lshlrev_b32 v237, 16, v29
  v_and_b32 v29, 0xffff0000, v29
  v_lshlrev_b32 v238, 16, v30
  v_and_b32 v30, 0xffff0000, v30
  v_lshlrev_b32 v239, 16, v31
  v_and_b32 v31, 0xffff0000, v31
  s_waitcnt lgkmcnt(0)
  s_barrier
  ds_read_b128 v[168:171], v162
  ds_read_b128 v[172:175], v162 offset:4096
  s_waitcnt lgkmcnt(1)
  v_mfma_f32_16x16x32_bf16 v[200:203], v[100:103], v[168:171], 0
  v_mfma_f32_16x16x32_bf16 v[204:207], v[104:107], v[168:171], 0
  v_mfma_f32_16x16x32_bf16 v[208:211], v[116:119], v[168:171], 0
  v_mfma_f32_16x16x32_bf16 v[212:215], v[120:123], v[168:171], 0
  s_waitcnt lgkmcnt(0)
  v_mfma_f32_16x16x32_bf16 v[200:203], v[108:111], v[172:175], v[200:203]
  v_mfma_f32_16x16x32_bf16 v[204:207], v[112:115], v[172:175], v[204:207]
  v_mfma_f32_16x16x32_bf16 v[208:211], v[100:103], v[172:175], v[208:211]
  v_mfma_f32_16x16x32_bf16 v[212:215], v[104:107], v[172:175], v[212:215]
  s_nop 6
  v_mul_f32 v176, v208, v24
  v_mul_f32 v180, v208, v232
  v_mul_f32 v177, v209, v25
  v_mul_f32 v181, v209, v233
  v_mul_f32 v178, v210, v26
  v_mul_f32 v182, v210, v234
  v_mul_f32 v179, v211, v27
  v_mul_f32 v183, v211, v235
  v_fma_f32 v176, v200, v232, -v176
  v_fma_f32 v180, v200, v24, v180
  v_fma_f32 v177, v201, v233, -v177
  v_fma_f32 v181, v201, v25, v181
  v_fma_f32 v178, v202, v234, -v178
  v_fma_f32 v182, v202, v26, v182
  v_fma_f32 v179, v203, v235, -v179
  v_fma_f32 v183, v203, v27, v183
  v_cvt_pk_bf16_f32 v216, v176, v177
  v_cvt_pk_bf16_f32 v220, v180, v181
  v_cvt_pk_bf16_f32 v217, v178, v179
  v_cvt_pk_bf16_f32 v221, v182, v183
  v_mul_f32 v184, v212, v28
  v_mul_f32 v188, v212, v236
  v_mul_f32 v185, v213, v29
  v_mul_f32 v189, v213, v237
  v_mul_f32 v186, v214, v30
  v_mul_f32 v190, v214, v238
  v_mul_f32 v187, v215, v31
  v_mul_f32 v191, v215, v239
  v_fma_f32 v184, v204, v236, -v184
  v_fma_f32 v188, v204, v28, v188
  v_fma_f32 v185, v205, v237, -v185
  v_fma_f32 v189, v205, v29, v189
  v_fma_f32 v186, v206, v238, -v186
  v_fma_f32 v190, v206, v30, v190
  v_fma_f32 v187, v207, v239, -v187
  v_fma_f32 v191, v207, v31, v191
  v_cvt_pk_bf16_f32 v218, v184, v185
  v_cvt_pk_bf16_f32 v222, v188, v189
  v_cvt_pk_bf16_f32 v219, v186, v187
  v_cvt_pk_bf16_f32 v223, v190, v191
  s_nop 0
  v_mfma_f32_16x16x32_bf16 v[4:7], v[216:219], v[100:103], 0
  v_mfma_f32_16x16x32_bf16 v[8:11], v[216:219], v[104:107], 0
  v_mfma_f32_16x16x32_bf16 v[12:15], v[216:219], v[108:111], 0
  v_mfma_f32_16x16x32_bf16 v[16:19], v[216:219], v[112:115], 0
  v_mfma_f32_16x16x32_bf16 v[4:7], v[220:223], v[116:119], v[4:7]
  v_mfma_f32_16x16x32_bf16 v[8:11], v[220:223], v[120:123], v[8:11]
  v_mfma_f32_16x16x32_bf16 v[12:15], v[220:223], v[100:103], v[12:15]
  v_mfma_f32_16x16x32_bf16 v[16:19], v[220:223], v[104:107], v[16:19]
  s_waitcnt vmcnt(3)
  v_lshlrev_b32 v240, 16, v148
  v_and_b32 v148, 0xffff0000, v148
  v_lshlrev_b32 v241, 16, v149
  v_and_b32 v149, 0xffff0000, v149
  v_lshlrev_b32 v242, 16, v150
  v_and_b32 v150, 0xffff0000, v150
  v_lshlrev_b32 v243, 16, v151
  v_and_b32 v151, 0xffff0000, v151
  s_waitcnt vmcnt(2)
  v_lshlrev_b32 v244, 16, v152
  v_and_b32 v152, 0xffff0000, v152
  v_lshlrev_b32 v245, 16, v153
  v_and_b32 v153, 0xffff0000, v153
  v_lshlrev_b32 v246, 16, v154
  v_and_b32 v154, 0xffff0000, v154
  v_lshlrev_b32 v247, 16, v155
  v_and_b32 v155, 0xffff0000, v155
  v_mul_f32 v168, v12, v128
  v_mul_f32 v172, v4, v128
  v_mul_f32 v169, v13, v129
  v_mul_f32 v173, v5, v129
  v_mul_f32 v170, v14, v130
  v_mul_f32 v174, v6, v130
  v_mul_f32 v171, v15, v131
  v_mul_f32 v175, v7, v131
  v_fma_f32 v168, v4, v124, -v168
  v_fma_f32 v172, v12, v124, v172
  v_fma_f32 v169, v5, v125, -v169
  v_fma_f32 v173, v13, v125, v173
  v_fma_f32 v170, v6, v126, -v170
  v_fma_f32 v174, v14, v126, v174
  v_fma_f32 v171, v7, v127, -v171
  v_fma_f32 v175, v15, v127, v175
  v_cvt_pk_bf16_f32 v224, v168, v169
  v_cvt_pk_bf16_f32 v226, v172, v173
  v_cvt_pk_bf16_f32 v225, v170, v171
  v_cvt_pk_bf16_f32 v227, v174, v175
  ds_write_b64 v163, v[224:225] offset:0
  ds_write_b64 v163, v[226:227] offset:4096
  v_mul_f32 v176, v16, v136
  v_mul_f32 v180, v8, v136
  v_mul_f32 v177, v17, v137
  v_mul_f32 v181, v9, v137
  v_mul_f32 v178, v18, v138
  v_mul_f32 v182, v10, v138
  v_mul_f32 v179, v19, v139
  v_mul_f32 v183, v11, v139
  v_fma_f32 v176, v8, v132, -v176
  v_fma_f32 v180, v16, v132, v180
  v_fma_f32 v177, v9, v133, -v177
  v_fma_f32 v181, v17, v133, v181
  v_fma_f32 v178, v10, v134, -v178
  v_fma_f32 v182, v18, v134, v182
  v_fma_f32 v179, v11, v135, -v179
  v_fma_f32 v183, v19, v135, v183
  v_cvt_pk_bf16_f32 v228, v176, v177
  v_cvt_pk_bf16_f32 v230, v180, v181
  v_cvt_pk_bf16_f32 v229, v178, v179
  v_cvt_pk_bf16_f32 v231, v182, v183
  ds_write_b64 v163, v[228:229] offset:2048
  ds_write_b64 v163, v[230:231] offset:6144
  s_waitcnt lgkmcnt(0)
  s_barrier
  ds_read_b128 v[168:171], v164 offset:0
  ds_read_b128 v[172:175], v164 offset:4096
  ds_read_b128 v[176:179], v165 offset:0
  ds_read_b128 v[180:183], v165 offset:4096
  s_waitcnt lgkmcnt(3)
  v_mfma_f32_16x16x32_bf16 v[200:203], v[168:171], v[36:39], 0
  v_mfma_f32_16x16x32_bf16 v[204:207], v[168:171], v[44:47], 0
  v_mfma_f32_16x16x32_bf16 v[208:211], v[168:171], v[52:55], 0
  v_mfma_f32_16x16x32_bf16 v[212:215], v[168:171], v[60:63], 0
  s_waitcnt lgkmcnt(2)
  v_mfma_f32_16x16x32_bf16 v[200:203], v[172:175], v[68:71], v[200:203]
  v_mfma_f32_16x16x32_bf16 v[204:207], v[172:175], v[76:79], v[204:207]
  v_mfma_f32_16x16x32_bf16 v[208:211], v[172:175], v[36:39], v[208:211]
  v_mfma_f32_16x16x32_bf16 v[212:215], v[172:175], v[44:47], v[212:215]
  s_waitcnt lgkmcnt(1)
  v_mfma_f32_16x16x32_bf16 v[200:203], v[176:179], v[40:43], v[200:203]
  v_mfma_f32_16x16x32_bf16 v[204:207], v[176:179], v[48:51], v[204:207]
  v_mfma_f32_16x16x32_bf16 v[208:211], v[176:179], v[56:59], v[208:211]
  v_mfma_f32_16x16x32_bf16 v[212:215], v[176:179], v[64:67], v[212:215]
  s_waitcnt lgkmcnt(0)
  v_mfma_f32_16x16x32_bf16 v[200:203], v[180:183], v[72:75], v[200:203]
  v_mfma_f32_16x16x32_bf16 v[204:207], v[180:183], v[80:83], v[204:207]
  v_mfma_f32_16x16x32_bf16 v[208:211], v[180:183], v[40:43], v[208:211]
  v_mfma_f32_16x16x32_bf16 v[212:215], v[180:183], v[48:51], v[212:215]
  s_nop 4
  v_fma_f32 v240, v200, s42, v240
  s_nop 0
  v_fma_f32 v148, v208, s43, v148
  v_fma_f32 v241, v201, s42, v241
  v_fma_f32 v149, v209, s43, v149
  v_fma_f32 v242, v202, s42, v242
  v_fma_f32 v150, v210, s43, v150
  v_fma_f32 v243, v203, s42, v243
  v_fma_f32 v151, v211, s43, v151
  v_cvt_pk_bf16_f32 v216, v240, v148
  v_cvt_pk_bf16_f32 v217, v241, v149
  v_cvt_pk_bf16_f32 v218, v242, v150
  v_cvt_pk_bf16_f32 v219, v243, v151
  buffer_store_dwordx4 v[216:219], v142, s[24:27], s38 offen offset:0 sc0 sc1
  v_fma_f32 v244, v204, s42, v244
  v_fma_f32 v152, v212, s43, v152
  v_fma_f32 v245, v205, s42, v245
  v_fma_f32 v153, v213, s43, v153
  v_fma_f32 v246, v206, s42, v246
  v_fma_f32 v154, v214, s43, v154
  v_fma_f32 v247, v207, s42, v247
  v_fma_f32 v155, v215, s43, v155
  v_cvt_pk_bf16_f32 v220, v244, v152
  v_cvt_pk_bf16_f32 v221, v245, v153
  v_cvt_pk_bf16_f32 v222, v246, v154
  v_cvt_pk_bf16_f32 v223, v247, v155
  buffer_store_dwordx4 v[220:223], v142, s[24:27], s38 offen offset:2048 sc0 sc1
  s_endpgm
ce8:
  s_endpgm
.section .rodata,"a"
.p2align 6
.amdhsa_kernel q1_kernel
  .amdhsa_next_free_vgpr 248
  .amdhsa_next_free_sgpr 102
  .amdhsa_accum_offset 248
  .amdhsa_group_segment_fixed_size 0
  .amdhsa_kernarg_size 80
  .amdhsa_user_sgpr_count 2
  .amdhsa_user_sgpr_kernarg_segment_ptr 1
  .amdhsa_system_sgpr_workgroup_id_x 1
.end_amdhsa_kernel
.text
.globl q2_kernel
.p2align 8
.type q2_kernel,@function
q2_kernel:
L_q2_kernel:
  s_cmp_ge_u32 s2, 252
  s_cbranch_scc1 ge11
  s_load_dwordx2 s[4:5], s[0:1], 72
  v_lshrrev_b32 v1, 6, v0
  s_nop 0
  v_readfirstlane_b32 s3, v1
  s_cmp_ge_u32 s2, 224
  s_cbranch_scc1 gs12
  s_getpc_b64 s[96:97]
pf13:
  s_mov_b32 s98, text_end-pf13
  s_mov_b32 s99, 0x20000
  v_lshlrev_b32 v2, 6, v0
  buffer_load_dword v3, v2, s[96:99], 0 offen
  s_and_b32 s20, s2, 7
  s_lshr_b32 s21, s2, 3
  s_and_b32 s22, s20, 3
  s_lshl_b32 s22, s22, 2
  s_and_b32 s23, s21, 3
  s_add_u32 s22, s22, s23
  s_lshr_b32 s23, s20, 2
  s_mul_i32 s23, s23, 7
  s_lshr_b32 s24, s21, 2
  s_add_u32 s23, s23, s24
  s_waitcnt lgkmcnt(0)
  s_add_u32 s12, s4, 0x200000
  s_addc_u32 s13, s5, 0
  s_mov_b32 s14, 0x200000
  s_mov_b32 s15, 0x20000
  s_add_u32 s8, s4, 0x800000
  s_addc_u32 s9, s5, 0
  s_mov_b32 s10, 0x380000
  s_mov_b32 s11, 0x20000
  s_add_u32 s16, s4, 0x1000000
  s_addc_u32 s17, s5, 0
  s_mov_b32 s18, 0x700000
  s_mov_b32 s19, 0x20000
  s_lshl_b32 s24, s3, 14
  s_lshl_b32 s25, s22, 9
  s_add_u32 s24, s24, s25
  s_lshl_b32 s25, s23, 2
  s_add_u32 s25, s25, s3
  s_lshl_b32 s26, s25, 16
  s_add_u32 s27, s26, 32768
  s_lshl_b32 s31, s25, 11
  s_lshl_b32 s34, s22, 2
  s_add_u32 s30, s3, 0
  s_and_b32 s30, s30, 3
  s_add_u32 s30, s30, s34
  s_mul_i32 s30, s30, 114688
  s_add_u32 s36, s30, s31
  s_add_u32 s30, s3, 1
  s_and_b32 s30, s30, 3
  s_add_u32 s30, s30, s34
  s_mul_i32 s30, s30, 114688
  s_add_u32 s37, s30, s31
  s_add_u32 s30, s3, 2
  s_and_b32 s30, s30, 3
  s_add_u32 s30, s30, s34
  s_mul_i32 s30, s30, 114688
  s_add_u32 s38, s30, s31
  s_add_u32 s30, s3, 3
  s_and_b32 s30, s30, 3
  s_add_u32 s30, s30, s34
  s_mul_i32 s30, s30, 114688
  s_add_u32 s39, s30, s31
  s_and_b32 s50, s21, 3
  s_lshl_b32 s50, s50, 1
  s_lshr_b32 s51, s21, 2
  s_add_u32 s50, s50, s51
  s_and_b32 s50, s50, 7
  v_and_b32 v135, 63, v0
  v_lshlrev_b32 v132, 4, v135
  v_and_b32 v133, 31, v135
  v_lshrrev_b32 v134, 5, v135
  v_lshlrev_b32 v168, 4, v133
  v_lshl_or_b32 v170, v134, 13, v168
  s_lshl_b32 s28, s3, 10
  s_add_u32 m0, s28, 0
  s_add_u32 s29, s24, 0
  buffer_load_dwordx4 v170, s[12:15], s29 offen lds
  s_add_u32 m0, s28, 4096
  s_add_u32 s29, s24, 65536
  buffer_load_dwordx4 v170, s[12:15], s29 offen lds
  buffer_load_dwordx4 a[0:3], v132, s[8:11], s26 offen offset:0
  buffer_load_dwordx4 a[4:7], v132, s[8:11], s27 offen offset:0
  s_add_u32 m0, s28, 8192
  s_add_u32 s29, s24, 131072
  buffer_load_dwordx4 v170, s[12:15], s29 offen lds
  s_add_u32 m0, s28, 12288
  s_add_u32 s29, s24, 196608
  buffer_load_dwordx4 v170, s[12:15], s29 offen lds
  buffer_load_dwordx4 a[8:11], v132, s[8:11], s26 offen offset:1024
  buffer_load_dwordx4 a[12:15], v132, s[8:11], s27 offen offset:1024
  buffer_load_dwordx4 a[16:19], v132, s[8:11], s26 offen offset:2048
  buffer_load_dwordx4 a[20:23], v132, s[8:11], s27 offen offset:2048
  s_add_u32 m0, s28, 16384
  s_add_u32 s29, s24, 262144
  buffer_load_dwordx4 v170, s[12:15], s29 offen lds
  s_add_u32 m0, s28, 20480
  s_add_u32 s29, s24, 327680
  buffer_load_dwordx4 v170, s[12:15], s29 offen lds
  v_lshlrev_b32 v168, 2, v133
  v_lshl_or_b32 v168, v134, 10, v168
  s_add_u32 s29, s3, 0
  s_and_b32 s29, s29, 3
  s_lshl_b32 s29, s29, 7
  v_add_u32 v171, s29, v168
  v_add_u32 v175, 0x10000, v171
  s_add_u32 s29, s3, 1
  s_and_b32 s29, s29, 3
  s_lshl_b32 s29, s29, 7
  v_add_u32 v172, s29, v168
  v_add_u32 v176, 0x10000, v172
  s_add_u32 s29, s3, 2
  s_and_b32 s29, s29, 3
  s_lshl_b32 s29, s29, 7
  v_add_u32 v173, s29, v168
  v_add_u32 v177, 0x10000, v173
  s_add_u32 s29, s3, 3
  s_and_b32 s29, s29, 3
  s_lshl_b32 s29, s29, 7
  v_add_u32 v174, s29, v168
  v_add_u32 v178, 0x10000, v174
  v_mov_b32 v180, 0
  v_mov_b32 v181, 0
  s_mov_b32 s33, 0xffff0000
  v_mov_b32 v192, s33
  v_cmp_gt_u32 vcc, 32, v135
  v_mov_b32 v184, 0
  s_nop 0
  v_cndmask_b32 v192, v192, v184, vcc
  s_waitcnt vmcnt(11)
  s_barrier
  ds_read2st64_b32 v[136:137], v171 offset0:0 offset1:2
  ds_read2st64_b32 v[138:139], v171 offset0:8 offset1:10
  ds_read2st64_b32 v[140:141], v172 offset0:0 offset1:2
  ds_read2st64_b32 v[142:143], v172 offset0:8 offset1:10
  ds_read2st64_b32 v[144:145], v173 offset0:0 offset1:2
  ds_read2st64_b32 v[146:147], v173 offset0:8 offset1:10
  ds_read2st64_b32 v[148:149], v174 offset0:0 offset1:2
  ds_read2st64_b32 v[150:151], v174 offset0:8 offset1:10
  s_waitcnt vmcnt(10)
  s_barrier
  s_waitcnt vmcnt(9) lgkmcnt(6)
  v_mfma_f32_32x32x16_bf16 v[4:19], a[0:3], v[136:139], 0
  ds_read2st64_b32 v[152:153], v171 offset0:16 offset1:18
  ds_read2st64_b32 v[154:155], v171 offset0:24 offset1:26
  v_lshlrev_b32 v184, 16, v136
  v_and_b32 v185, v192, v136
  s_waitcnt vmcnt(8)
  v_mfma_f32_32x32x16_bf16 v[68:83], a[4:7], v[136:139], 0
  ds_read2st64_b32 v[156:157], v172 offset0:16 offset1:18
  s_add_u32 m0, s28, 24576
  s_add_u32 s29, s24, 393216
  buffer_load_dwordx4 v170, s[12:15], s29 offen lds
  v_lshlrev_b32 v186, 16, v137
  v_and_b32 v187, s33, v137
  s_waitcnt lgkmcnt(7)
  v_mfma_f32_32x32x16_bf16 v[20:35], a[0:3], v[140:143], 0
  ds_read2st64_b32 v[158:159], v172 offset0:24 offset1:26
  v_lshlrev_b32 v188, 16, v138
  v_and_b32 v189, s33, v138
  v_mfma_f32_32x32x16_bf16 v[84:99], a[4:7], v[140:143], 0
  ds_read2st64_b32 v[160:161], v173 offset0:16 offset1:18
  s_add_u32 m0, s28, 28672
  s_add_u32 s29, s24, 458752
  buffer_load_dwordx4 v170, s[12:15], s29 offen lds
  v_lshlrev_b32 v190, 16, v139
  v_and_b32 v191, s33, v139
  s_waitcnt lgkmcnt(7)
  v_mfma_f32_32x32x16_bf16 v[36:51], a[0:3], v[144:147], 0
  ds_read2st64_b32 v[162:163], v173 offset0:24 offset1:26
  v_fmac_f32 v180, v184, v184
  v_fmac_f32 v181, v185, v185
  v_mfma_f32_32x32x16_bf16 v[100:115], a[4:7], v[144:147], 0
  ds_read2st64_b32 v[164:165], v174 offset0:16 offset1:18
  buffer_load_dwordx4 a[24:27], v132, s[8:11], s26 offen offset:3072
  v_fmac_f32 v180, v186, v186
  v_fmac_f32 v181, v187, v187
  s_waitcnt lgkmcnt(7)
  v_mfma_f32_32x32x16_bf16 v[52:67], a[0:3], v[148:151], 0
  ds_read2st64_b32 v[166:167], v174 offset0:24 offset1:26
  v_fmac_f32 v180, v188, v188
  v_fmac_f32 v181, v189, v189
  v_mfma_f32_32x32x16_bf16 v[116:131], a[4:7], v[148:151], 0
  buffer_load_dwordx4 a[28:31], v132, s[8:11], s27 offen offset:3072
  v_fmac_f32 v180, v190, v190
  v_fmac_f32 v181, v191, v191
  s_waitcnt vmcnt(10)
  s_barrier
  s_waitcnt vmcnt(9) lgkmcnt(6)
  v_mfma_f32_32x32x16_bf16 v[4:19], a[8:11], v[152:155], v[4:19]
  ds_read2st64_b32 v[136:137], v171 offset0:32 offset1:34
  ds_read2st64_b32 v[138:139], v171 offset0:40 offset1:42
  v_lshlrev_b32 v184, 16, v152
  v_and_b32 v185, s33, v152
  s_waitcnt vmcnt(8)
  v_mfma_f32_32x32x16_bf16 v[68:83], a[12:15], v[152:155], v[68:83]
  ds_read2st64_b32 v[140:141], v172 offset0:32 offset1:34
  s_add_u32 s26, s26, 4096
  buffer_load_dwordx4 a[32:35], v132, s[8:11], s26 offen offset:0
  v_lshlrev_b32 v186, 16, v153
  v_and_b32 v187, s33, v153
  s_waitcnt lgkmcnt(7)
  v_mfma_f32_32x32x16_bf16 v[20:35], a[8:11], v[156:159], v[20:35]
  ds_read2st64_b32 v[142:143], v172 offset0:40 offset1:42
  v_lshlrev_b32 v188, 16, v154
  v_and_b32 v189, s33, v154
  v_mfma_f32_32x32x16_bf16 v[84:99], a[12:15], v[156:159], v[84:99]
  ds_read2st64_b32 v[144:145], v173 offset0:32 offset1:34
  s_add_u32 s27, s27, 4096
  buffer_load_dwordx4 a[36:39], v132, s[8:11], s27 offen offset:0
  v_lshlrev_b32 v190, 16, v155
  v_and_b32 v191, s33, v155
  s_waitcnt lgkmcnt(7)
  v_mfma_f32_32x32x16_bf16 v[36:51], a[8:11], v[160:163], v[36:51]
  ds_read2st64_b32 v[146:147], v173 offset0:40 offset1:42
  v_fmac_f32 v180, v184, v184
  v_fmac_f32 v181, v185, v185
  v_mfma_f32_32x32x16_bf16 v[100:115], a[12:15], v[160:163], v[100:115]
  ds_read2st64_b32 v[148:149], v174 offset0:32 offset1:34
  buffer_load_dwordx4 a[40:43], v132, s[8:11], s26 offen offset:1024
  v_fmac_f32 v180, v186, v186
  v_fmac_f32 v181, v187, v187
  s_waitcnt lgkmcnt(7)
  v_mfma_f32_32x32x16_bf16 v[52:67], a[8:11], v[164:167], v[52:67]
  ds_read2st64_b32 v[150:151], v174 offset0:40 offset1:42
  v_fmac_f32 v180, v188, v188
  v_fmac_f32 v181, v189, v189
  v_mfma_f32_32x32x16_bf16 v[116:131], a[12:15], v[164:167], v[116:131]
  buffer_load_dwordx4 a[44:47], v132, s[8:11], s27 offen offset:1024
  v_fmac_f32 v180, v190, v190
  v_fmac_f32 v181, v191, v191
  s_waitcnt vmcnt(11) lgkmcnt(6)
  v_mfma_f32_32x32x16_bf16 v[4:19], a[16:19], v[136:139], v[4:19]
  ds_read2st64_b32 v[152:153], v171 offset0:48 offset1:50
  ds_read2st64_b32 v[154:155], v171 offset0:56 offset1:58
  v_lshlrev_b32 v184, 16, v136
  v_and_b32 v185, s33, v136
  s_waitcnt vmcnt(10)
  v_mfma_f32_32x32x16_bf16 v[68:83], a[20:23], v[136:139], v[68:83]
  ds_read2st64_b32 v[156:157], v172 offset0:48 offset1:50
  buffer_load_dwordx4 a[48:51], v132, s[8:11], s26 offen offset:2048
  v_lshlrev_b32 v186, 16, v137
  v_and_b32 v187, s33, v137
  s_waitcnt lgkmcnt(7)
  v_mfma_f32_32x32x16_bf16 v[20:35], a[16:19], v[140:143], v[20:35]
  ds_read2st64_b32 v[158:159], v172 offset0:56 offset1:58
  v_lshlrev_b32 v188, 16, v138
  v_and_b32 v189, s33, v138
  v_mfma_f32_32x32x16_bf16 v[84:99], a[20:23], v[140:143], v[84:99]
  ds_read2st64_b32 v[160:161], v173 offset0:48 offset1:50
  buffer_load_dwordx4 a[52:55], v132, s[8:11], s27 offen offset:2048
  v_lshlrev_b32 v190, 16, v139
  v_and_b32 v191, s33, v139
  s_waitcnt lgkmcnt(7)
  v_mfma_f32_32x32x16_bf16 v[36:51], a[16:19], v[144:147], v[36:51]
  ds_read2st64_b32 v[162:163], v173 offset0:56 offset1:58
  v_fmac_f32 v180, v184, v184
  v_fmac_f32 v181, v185, v185
  v_mfma_f32_32x32x16_bf16 v[100:115], a[20:23], v[144:147], v[100:115]
  ds_read2st64_b32 v[164:165], v174 offset0:48 offset1:50
  s_add_u32 m0, s28, 32768
  s_add_u32 s29, s24, 524288
  buffer_load_dwordx4 v170, s[12:15], s29 offen lds
  v_fmac_f32 v180, v186, v186
  v_fmac_f32 v181, v187, v187
  s_waitcnt lgkmcnt(7)
  v_mfma_f32_32x32x16_bf16 v[52:67], a[16:19], v[148:151], v[52:67]
  ds_read2st64_b32 v[166:167], v174 offset0:56 offset1:58
  v_fmac_f32 v180, v188, v188
  v_fmac_f32 v181, v189, v189
  v_mfma_f32_32x32x16_bf16 v[116:131], a[20:23], v[148:151], v[116:131]
  s_add_u32 m0, s28, 36864
  s_add_u32 s29, s24, 589824
  buffer_load_dwordx4 v170, s[12:15], s29 offen lds
  v_fmac_f32 v180, v190, v190
  v_fmac_f32 v181, v191, v191
  s_waitcnt vmcnt(10)
  s_barrier
  s_waitcnt vmcnt(9) lgkmcnt(6)
  v_mfma_f32_32x32x16_bf16 v[4:19], a[24:27], v[152:155], v[4:19]
  ds_read2st64_b32 v[136:137], v171 offset0:64 offset1:66
  ds_read2st64_b32 v[138:139], v171 offset0:72 offset1:74
  v_lshlrev_b32 v184, 16, v152
  v_and_b32 v185, s33, v152
  s_waitcnt vmcnt(8)
  v_mfma_f32_32x32x16_bf16 v[68:83], a[28:31], v[152:155], v[68:83]
  ds_read2st64_b32 v[140:141], v172 offset0:64 offset1:66
  s_add_u32 m0, s28, 40960
  s_add_u32 s29, s24, 655360
  buffer_load_dwordx4 v170, s[12:15], s29 offen lds
  v_lshlrev_b32 v186, 16, v153
  v_and_b32 v187, s33, v153
  s_waitcnt lgkmcnt(7)
  v_mfma_f32_32x32x16_bf16 v[20:35], a[24:27], v[156:159], v[20:35]
  ds_read2st64_b32 v[142:143], v172 offset0:72 offset1:74
  v_lshlrev_b32 v188, 16, v154
  v_and_b32 v189, s33, v154
  v_mfma_f32_32x32x16_bf16 v[84:99], a[28:31], v[156:159], v[84:99]
  ds_read2st64_b32 v[144:145], v173 offset0:64 offset1:66
  s_add_u32 m0, s28, 45056
  s_add_u32 s29, s24, 720896
  buffer_load_dwordx4 v170, s[12:15], s29 offen lds
  v_lshlrev_b32 v190, 16, v155
  v_and_b32 v191, s33, v155
  s_waitcnt lgkmcnt(7)
  v_mfma_f32_32x32x16_bf16 v[36:51], a[24:27], v[160:163], v[36:51]
  ds_read2st64_b32 v[146:147], v173 offset0:72 offset1:74
  v_fmac_f32 v180, v184, v184
  v_fmac_f32 v181, v185, v185
  v_mfma_f32_32x32x16_bf16 v[100:115], a[28:31], v[160:163], v[100:115]
  ds_read2st64_b32 v[148:149], v174 offset0:64 offset1:66
  buffer_load_dwordx4 a[56:59], v132, s[8:11], s26 offen offset:3072
  v_fmac_f32 v180, v186, v186
  v_fmac_f32 v181, v187, v187
  s_waitcnt lgkmcnt(7)
  v_mfma_f32_32x32x16_bf16 v[52:67], a[24:27], v[164:167], v[52:67]
  ds_read2st64_b32 v[150:151], v174 offset0:72 offset1:74
  v_fmac_f32 v180, v188, v188
  v_fmac_f32 v181, v189, v189
  v_mfma_f32_32x32x16_bf16 v[116:131], a[28:31], v[164:167], v[116:131]
  buffer_load_dwordx4 a[60:63], v132, s[8:11], s27 offen offset:3072
  v_fmac_f32 v180, v190, v190
  v_fmac_f32 v181, v191, v191
  s_waitcnt vmcnt(11) lgkmcnt(6)
  v_mfma_f32_32x32x16_bf16 v[4:19], a[32:35], v[136:139], v[4:19]
  ds_read2st64_b32 v[152:153], v171 offset0:80 offset1:82
  ds_read2st64_b32 v[154:155], v171 offset0:88 offset1:90
  v_lshlrev_b32 v184, 16, v136
  v_and_b32 v185, s33, v136
  s_waitcnt vmcnt(10)
  v_mfma_f32_32x32x16_bf16 v[68:83], a[36:39], v[136:139], v[68:83]
  ds_read2st64_b32 v[156:157], v172 offset0:80 offset1:82
  s_add_u32 s26, s26, 4096
  buffer_load_dwordx4 a[64:67], v132, s[8:11], s26 offen offset:0
  v_lshlrev_b32 v186, 16, v137
  v_and_b32 v187, s33, v137
  s_waitcnt lgkmcnt(7)
  v_mfma_f32_32x32x16_bf16 v[20:35], a[32:35], v[140:143], v[20:35]
  ds_read2st64_b32 v[158:159], v172 offset0:88 offset1:90
  v_lshlrev_b32 v188, 16, v138
  v_and_b32 v189, s33, v138
  v_mfma_f32_32x32x16_bf16 v[84:99], a[36:39], v[140:143], v[84:99]
  ds_read2st64_b32 v[160:161], v173 offset0:80 offset1:82
  s_add_u32 s27, s27, 4096
  buffer_load_dwordx4 a[68:71], v132, s[8:11], s27 offen offset:0
  v_lshlrev_b32 v190, 16, v139
  v_and_b32 v191, s33, v139
  s_waitcnt lgkmcnt(7)
  v_mfma_f32_32x32x16_bf16 v[36:51], a[32:35], v[144:147], v[36:51]
  ds_read2st64_b32 v[162:163], v173 offset0:88 offset1:90
  v_fmac_f32 v180, v184, v184
  v_fmac_f32 v181, v185, v185
  v_mfma_f32_32x32x16_bf16 v[100:115], a[36:39], v[144:147], v[100:115]
  ds_read2st64_b32 v[164:165], v174 offset0:80 offset1:82
  buffer_load_dwordx4 a[72:75], v132, s[8:11], s26 offen offset:1024
  v_fmac_f32 v180, v186, v186
  v_fmac_f32 v181, v187, v187
  s_waitcnt lgkmcnt(7)
  v_mfma_f32_32x32x16_bf16 v[52:67], a[32:35], v[148:151], v[52:67]
  ds_read2st64_b32 v[166:167], v174 offset0:88 offset1:90
  v_fmac_f32 v180, v188, v188
  v_fmac_f32 v181, v189, v189
  v_mfma_f32_32x32x16_bf16 v[116:131], a[36:39], v[148:151], v[116:131]
  buffer_load_dwordx4 a[76:79], v132, s[8:11], s27 offen offset:1024
  v_fmac_f32 v180, v190, v190
  v_fmac_f32 v181, v191, v191
  s_waitcnt vmcnt(13) lgkmcnt(6)
  v_mfma_f32_32x32x16_bf16 v[4:19], a[40:43], v[152:155], v[4:19]
  ds_read2st64_b32 v[136:137], v171 offset0:96 offset1:98
  ds_read2st64_b32 v[138:139], v171 offset0:104 offset1:106
  v_lshlrev_b32 v184, 16, v152
  v_and_b32 v185, s33, v152
  s_waitcnt vmcnt(12)
  v_mfma_f32_32x32x16_bf16 v[68:83], a[44:47], v[152:155], v[68:83]
  ds_read2st64_b32 v[140:141], v172 offset0:96 offset1:98
  buffer_load_dwordx4 a[80:83], v132, s[8:11], s26 offen offset:2048
  v_lshlrev_b32 v186, 16, v153
  v_and_b32 v187, s33, v153
  s_waitcnt lgkmcnt(7)
  v_mfma_f32_32x32x16_bf16 v[20:35], a[40:43], v[156:159], v[20:35]
  ds_read2st64_b32 v[142:143], v172 offset0:104 offset1:106
  v_lshlrev_b32 v188, 16, v154
  v_and_b32 v189, s33, v154
  v_mfma_f32_32x32x16_bf16 v[84:99], a[44:47], v[156:159], v[84:99]
  ds_read2st64_b32 v[144:145], v173 offset0:96 offset1:98
  buffer_load_dwordx4 a[84:87], v132, s[8:11], s27 offen offset:2048
  v_lshlrev_b32 v190, 16, v155
  v_and_b32 v191, s33, v155
  s_waitcnt lgkmcnt(7)
  v_mfma_f32_32x32x16_bf16 v[36:51], a[40:43], v[160:163], v[36:51]
  ds_read2st64_b32 v[146:147], v173 offset0:104 offset1:106
  v_fmac_f32 v180, v184, v184
  v_fmac_f32 v181, v185, v185
  v_mfma_f32_32x32x16_bf16 v[100:115], a[44:47], v[160:163], v[100:115]
  ds_read2st64_b32 v[148:149], v174 offset0:96 offset1:98
  s_add_u32 m0, s28, 49152
  s_add_u32 s29, s24, 786432
  buffer_load_dwordx4 v170, s[12:15], s29 offen lds
  v_fmac_f32 v180, v186, v186
  v_fmac_f32 v181, v187, v187
  s_waitcnt lgkmcnt(7)
  v_mfma_f32_32x32x16_bf16 v[52:67], a[40:43], v[164:167], v[52:67]
  ds_read2st64_b32 v[150:151], v174 offset0:104 offset1:106
  v_fmac_f32 v180, v188, v188
  v_fmac_f32 v181, v189, v189
  v_mfma_f32_32x32x16_bf16 v[116:131], a[44:47], v[164:167], v[116:131]
  s_add_u32 m0, s28, 53248
  s_add_u32 s29, s24, 851968
  buffer_load_dwordx4 v170, s[12:15], s29 offen lds
  v_fmac_f32 v180, v190, v190
  v_fmac_f32 v181, v191, v191
  s_waitcnt vmcnt(15) lgkmcnt(6)
  v_mfma_f32_32x32x16_bf16 v[4:19], a[48:51], v[136:139], v[4:19]
  ds_read2st64_b32 v[152:153], v171 offset0:112 offset1:114
  ds_read2st64_b32 v[154:155], v171 offset0:120 offset1:122
  v_lshlrev_b32 v184, 16, v136
  v_and_b32 v185, s33, v136
  s_waitcnt vmcnt(14)
  v_mfma_f32_32x32x16_bf16 v[68:83], a[52:55], v[136:139], v[68:83]
  ds_read2st64_b32 v[156:157], v172 offset0:112 offset1:114
  s_add_u32 m0, s28, 57344
  s_add_u32 s29, s24, 917504
  buffer_load_dwordx4 v170, s[12:15], s29 offen lds
  v_lshlrev_b32 v186, 16, v137
  v_and_b32 v187, s33, v137
  s_waitcnt lgkmcnt(7)
  v_mfma_f32_32x32x16_bf16 v[20:35], a[48:51], v[140:143], v[20:35]
  ds_read2st64_b32 v[158:159], v172 offset0:120 offset1:122
  v_lshlrev_b32 v188, 16, v138
  v_and_b32 v189, s33, v138
  v_mfma_f32_32x32x16_bf16 v[84:99], a[52:55], v[140:143], v[84:99]
  ds_read2st64_b32 v[160:161], v173 offset0:112 offset1:114
  s_add_u32 m0, s28, 61440
  s_add_u32 s29, s24, 983040
  buffer_load_dwordx4 v170, s[12:15], s29 offen lds
  v_lshlrev_b32 v190, 16, v139
  v_and_b32 v191, s33, v139
  s_waitcnt lgkmcnt(7)
  v_mfma_f32_32x32x16_bf16 v[36:51], a[48:51], v[144:147], v[36:51]
  ds_read2st64_b32 v[162:163], v173 offset0:120 offset1:122
  v_fmac_f32 v180, v184, v184
  v_fmac_f32 v181, v185, v185
  v_mfma_f32_32x32x16_bf16 v[100:115], a[52:55], v[144:147], v[100:115]
  ds_read2st64_b32 v[164:165], v174 offset0:112 offset1:114
  buffer_load_dwordx4 a[88:91], v132, s[8:11], s26 offen offset:3072
  v_fmac_f32 v180, v186, v186
  v_fmac_f32 v181, v187, v187
  s_waitcnt lgkmcnt(7)
  v_mfma_f32_32x32x16_bf16 v[52:67], a[48:51], v[148:151], v[52:67]
  ds_read2st64_b32 v[166:167], v174 offset0:120 offset1:122
  v_fmac_f32 v180, v188, v188
  v_fmac_f32 v181, v189, v189
  v_mfma_f32_32x32x16_bf16 v[116:131], a[52:55], v[148:151], v[116:131]
  buffer_load_dwordx4 a[92:95], v132, s[8:11], s27 offen offset:3072
  v_fmac_f32 v180, v190, v190
  v_fmac_f32 v181, v191, v191
  s_waitcnt vmcnt(14)
  s_barrier
  s_waitcnt vmcnt(13) lgkmcnt(6)
  v_mfma_f32_32x32x16_bf16 v[4:19], a[56:59], v[152:155], v[4:19]
  ds_read2st64_b32 v[136:137], v171 offset0:128 offset1:130
  ds_read2st64_b32 v[138:139], v171 offset0:136 offset1:138
  v_lshlrev_b32 v184, 16, v152
  v_and_b32 v185, s33, v152
  s_waitcnt vmcnt(12)
  v_mfma_f32_32x32x16_bf16 v[68:83], a[60:63], v[152:155], v[68:83]
  ds_read2st64_b32 v[140:141], v172 offset0:128 offset1:130
  s_add_u32 s26, s26, 4096
  buffer_load_dwordx4 a[96:99], v132, s[8:11], s26 offen offset:0
  v_lshlrev_b32 v186, 16, v153
  v_and_b32 v187, s33, v153
  s_waitcnt lgkmcnt(7)
  v_mfma_f32_32x32x16_bf16 v[20:35], a[56:59], v[156:159], v[20:35]
  ds_read2st64_b32 v[142:143], v172 offset0:136 offset1:138
  v_lshlrev_b32 v188, 16, v154
  v_and_b32 v189, s33, v154
  v_mfma_f32_32x32x16_bf16 v[84:99], a[60:63], v[156:159], v[84:99]
  ds_read2st64_b32 v[144:145], v173 offset0:128 offset1:130
  s_add_u32 s27, s27, 4096
  buffer_load_dwordx4 a[100:103], v132, s[8:11], s27 offen offset:0
  v_lshlrev_b32 v190, 16, v155
  v_and_b32 v191, s33, v155
  s_waitcnt lgkmcnt(7)
  v_mfma_f32_32x32x16_bf16 v[36:51], a[56:59], v[160:163], v[36:51]
  ds_read2st64_b32 v[146:147], v173 offset0:136 offset1:138
  v_fmac_f32 v180, v184, v184
  v_fmac_f32 v181, v185, v185
  v_mfma_f32_32x32x16_bf16 v[100:115], a[60:63], v[160:163], v[100:115]
  ds_read2st64_b32 v[148:149], v174 offset0:128 offset1:130
  buffer_load_dwordx4 a[104:107], v132, s[8:11], s26 offen offset:1024
  v_fmac_f32 v180, v186, v186
  v_fmac_f32 v181, v187, v187
  s_waitcnt lgkmcnt(7)
  v_mfma_f32_32x32x16_bf16 v[52:67], a[56:59], v[164:167], v[52:67]
  ds_read2st64_b32 v[150:151], v174 offset0:136 offset1:138
  v_fmac_f32 v180, v188, v188
  v_fmac_f32 v181, v189, v189
  v_mfma_f32_32x32x16_bf16 v[116:131], a[60:63], v[164:167], v[116:131]
  buffer_load_dwordx4 a[108:111], v132, s[8:11], s27 offen offset:1024
  v_fmac_f32 v180, v190, v190
  v_fmac_f32 v181, v191, v191
  s_waitcnt vmcnt(15) lgkmcnt(6)
  v_mfma_f32_32x32x16_bf16 v[4:19], a[64:67], v[136:139], v[4:19]
  ds_read2st64_b32 v[152:153], v171 offset0:144 offset1:146
  ds_read2st64_b32 v[154:155], v171 offset0:152 offset1:154
  v_lshlrev_b32 v184, 16, v136
  v_and_b32 v185, s33, v136
  s_waitcnt vmcnt(14)
  v_mfma_f32_32x32x16_bf16 v[68:83], a[68:71], v[136:139], v[68:83]
  ds_read2st64_b32 v[156:157], v172 offset0:144 offset1:146
  buffer_load_dwordx4 a[112:115], v132, s[8:11], s26 offen offset:2048
  v_lshlrev_b32 v186, 16, v137
  v_and_b32 v187, s33, v137
  s_waitcnt lgkmcnt(7)
  v_mfma_f32_32x32x16_bf16 v[20:35], a[64:67], v[140:143], v[20:35]
  ds_read2st64_b32 v[158:159], v172 offset0:152 offset1:154
  v_lshlrev_b32 v188, 16, v138
  v_and_b32 v189, s33, v138
  v_mfma_f32_32x32x16_bf16 v[84:99], a[68:71], v[140:143], v[84:99]
  ds_read2st64_b32 v[160:161], v173 offset0:144 offset1:146
  buffer_load_dwordx4 a[116:119], v132, s[8:11], s27 offen offset:2048
  v_lshlrev_b32 v190, 16, v139
  v_and_b32 v191, s33, v139
  s_waitcnt lgkmcnt(7)
  v_mfma_f32_32x32x16_bf16 v[36:51], a[64:67], v[144:147], v[36:51]
  ds_read2st64_b32 v[162:163], v173 offset0:152 offset1:154
  v_fmac_f32 v180, v184, v184
  v_fmac_f32 v181, v185, v185
  v_mfma_f32_32x32x16_bf16 v[100:115], a[68:71], v[144:147], v[100:115]
  ds_read2st64_b32 v[164:165], v174 offset0:144 offset1:146
  s_add_u32 m0, s28, 65536
  s_add_u32 s29, s24, 1048576
  buffer_load_dwordx4 v170, s[12:15], s29 offen lds
  v_fmac_f32 v180, v186, v186
  v_fmac_f32 v181, v187, v187
  s_waitcnt lgkmcnt(7)
  v_mfma_f32_32x32x16_bf16 v[52:67], a[64:67], v[148:151], v[52:67]
  ds_read2st64_b32 v[166:167], v174 offset0:152 offset1:154
  v_fmac_f32 v180, v188, v188
  v_fmac_f32 v181, v189, v189
  v_mfma_f32_32x32x16_bf16 v[116:131], a[68:71], v[148:151], v[116:131]
  s_add_u32 m0, s28, 69632
  s_add_u32 s29, s24, 1114112
  buffer_load_dwordx4 v170, s[12:15], s29 offen lds
  v_fmac_f32 v180, v190, v190
  v_fmac_f32 v181, v191, v191
  s_waitcnt vmcnt(17) lgkmcnt(6)
  v_mfma_f32_32x32x16_bf16 v[4:19], a[72:75], v[152:155], v[4:19]
  ds_read2st64_b32 v[136:137], v171 offset0:160 offset1:162
  ds_read2st64_b32 v[138:139], v171 offset0:168 offset1:170
  v_lshlrev_b32 v184, 16, v152
  v_and_b32 v185, s33, v152
  s_waitcnt vmcnt(16)
  v_mfma_f32_32x32x16_bf16 v[68:83], a[76:79], v[152:155], v[68:83]
  ds_read2st64_b32 v[140:141], v172 offset0:160 offset1:162
  s_add_u32 m0, s28, 73728
  s_add_u32 s29, s24, 1179648
  buffer_load_dwordx4 v170, s[12:15], s29 offen lds
  v_lshlrev_b32 v186, 16, v153
  v_and_b32 v187, s33, v153
  s_waitcnt lgkmcnt(7)
  v_mfma_f32_32x32x16_bf16 v[20:35], a[72:75], v[156:159], v[20:35]
  ds_read2st64_b32 v[142:143], v172 offset0:168 offset1:170
  v_lshlrev_b32 v188, 16, v154
  v_and_b32 v189, s33, v154
  v_mfma_f32_32x32x16_bf16 v[84:99], a[76:79], v[156:159], v[84:99]
  ds_read2st64_b32 v[144:145], v173 offset0:160 offset1:162
  s_add_u32 m0, s28, 77824
  s_add_u32 s29, s24, 1245184
  buffer_load_dwordx4 v170, s[12:15], s29 offen lds
  v_lshlrev_b32 v190, 16, v155
  v_and_b32 v191, s33, v155
  s_waitcnt lgkmcnt(7)
  v_mfma_f32_32x32x16_bf16 v[36:51], a[72:75], v[160:163], v[36:51]
  ds_read2st64_b32 v[146:147], v173 offset0:168 offset1:170
  v_fmac_f32 v180, v184, v184
  v_fmac_f32 v181, v185, v185
  v_mfma_f32_32x32x16_bf16 v[100:115], a[76:79], v[160:163], v[100:115]
  ds_read2st64_b32 v[148:149], v174 offset0:160 offset1:162
  buffer_load_dwordx4 a[120:123], v132, s[8:11], s26 offen offset:3072
  v_fmac_f32 v180, v186, v186
  v_fmac_f32 v181, v187, v187
  s_waitcnt lgkmcnt(7)
  v_mfma_f32_32x32x16_bf16 v[52:67], a[72:75], v[164:167], v[52:67]
  ds_read2st64_b32 v[150:151], v174 offset0:168 offset1:170
  v_fmac_f32 v180, v188, v188
  v_fmac_f32 v181, v189, v189
  v_mfma_f32_32x32x16_bf16 v[116:131], a[76:79], v[164:167], v[116:131]
  buffer_load_dwordx4 a[124:127], v132, s[8:11], s27 offen offset:3072
  v_fmac_f32 v180, v190, v190
  v_fmac_f32 v181, v191, v191
  s_waitcnt vmcnt(19) lgkmcnt(6)
  v_mfma_f32_32x32x16_bf16 v[4:19], a[80:83], v[136:139], v[4:19]
  ds_read2st64_b32 v[152:153], v171 offset0:176 offset1:178
  ds_read2st64_b32 v[154:155], v171 offset0:184 offset1:186
  v_lshlrev_b32 v184, 16, v136
  v_and_b32 v185, s33, v136
  s_waitcnt vmcnt(18)
  v_mfma_f32_32x32x16_bf16 v[68:83], a[84:87], v[136:139], v[68:83]
  ds_read2st64_b32 v[156:157], v172 offset0:176 offset1:178
  s_add_u32 s26, s26, 4096
  buffer_load_dwordx4 a[128:131], v132, s[8:11], s26 offen offset:0
  v_lshlrev_b32 v186, 16, v137
  v_and_b32 v187, s33, v137
  s_waitcnt lgkmcnt(7)
  v_mfma_f32_32x32x16_bf16 v[20:35], a[80:83], v[140:143], v[20:35]
  ds_read2st64_b32 v[158:159], v172 offset0:184 offset1:186
  v_lshlrev_b32 v188, 16, v138
  v_and_b32 v189, s33, v138
  v_mfma_f32_32x32x16_bf16 v[84:99], a[84:87], v[140:143], v[84:99]
  ds_read2st64_b32 v[160:161], v173 offset0:176 offset1:178
  s_add_u32 s27, s27, 4096
  buffer_load_dwordx4 a[132:135], v132, s[8:11], s27 offen offset:0
  v_lshlrev_b32 v190, 16, v139
  v_and_b32 v191, s33, v139
  s_waitcnt lgkmcnt(7)
  v_mfma_f32_32x32x16_bf16 v[36:51], a[80:83], v[144:147], v[36:51]
  ds_read2st64_b32 v[162:163], v173 offset0:184 offset1:186
  v_fmac_f32 v180, v184, v184
  v_fmac_f32 v181, v185, v185
  v_mfma_f32_32x32x16_bf16 v[100:115], a[84:87], v[144:147], v[100:115]
  ds_read2st64_b32 v[164:165], v174 offset0:176 offset1:178
  buffer_load_dwordx4 a[136:139], v132, s[8:11], s26 offen offset:1024
  v_fmac_f32 v180, v186, v186
  v_fmac_f32 v181, v187, v187
  s_waitcnt lgkmcnt(7)
  v_mfma_f32_32x32x16_bf16 v[52:67], a[80:83], v[148:151], v[52:67]
  ds_read2st64_b32 v[166:167], v174 offset0:184 offset1:186
  v_fmac_f32 v180, v188, v188
  v_fmac_f32 v181, v189, v189
  v_mfma_f32_32x32x16_bf16 v[116:131], a[84:87], v[148:151], v[116:131]
  buffer_load_dwordx4 a[140:143], v132, s[8:11], s27 offen offset:1024
  v_fmac_f32 v180, v190, v190
  v_fmac_f32 v181, v191, v191
  s_waitcnt vmcnt(18)
  s_barrier
  s_waitcnt vmcnt(17) lgkmcnt(6)
  v_mfma_f32_32x32x16_bf16 v[4:19], a[88:91], v[152:155], v[4:19]
  ds_read2st64_b32 v[136:137], v171 offset0:192 offset1:194
  ds_read2st64_b32 v[138:139], v171 offset0:200 offset1:202
  v_lshlrev_b32 v184, 16, v152
  v_and_b32 v185, s33, v152
  s_waitcnt vmcnt(16)
  v_mfma_f32_32x32x16_bf16 v[68:83], a[92:95], v[152:155], v[68:83]
  ds_read2st64_b32 v[140:141], v172 offset0:192 offset1:194
  buffer_load_dwordx4 a[144:147], v132, s[8:11], s26 offen offset:2048
  v_lshlrev_b32 v186, 16, v153
  v_and_b32 v187, s33, v153
  s_waitcnt lgkmcnt(7)
  v_mfma_f32_32x32x16_bf16 v[20:35], a[88:91], v[156:159], v[20:35]
  ds_read2st64_b32 v[142:143], v172 offset0:200 offset1:202
  v_lshlrev_b32 v188, 16, v154
  v_and_b32 v189, s33, v154
  v_mfma_f32_32x32x16_bf16 v[84:99], a[92:95], v[156:159], v[84:99]
  ds_read2st64_b32 v[144:145], v173 offset0:192 offset1:194
  buffer_load_dwordx4 a[148:151], v132, s[8:11], s27 offen offset:2048
  v_lshlrev_b32 v190, 16, v155
  v_and_b32 v191, s33, v155
  s_waitcnt lgkmcnt(7)
  v_mfma_f32_32x32x16_bf16 v[36:51], a[88:91], v[160:163], v[36:51]
  ds_read2st64_b32 v[146:147], v173 offset0:200 offset1:202
  v_fmac_f32 v180, v184, v184
  v_fmac_f32 v181, v185, v185
  v_mfma_f32_32x32x16_bf16 v[100:115], a[92:95], v[160:163], v[100:115]
  ds_read2st64_b32 v[148:149], v174 offset0:192 offset1:194
  s_add_u32 m0, s28, 81920
  s_add_u32 s29, s24, 1310720
  buffer_load_dwordx4 v170, s[12:15], s29 offen lds
  v_fmac_f32 v180, v186, v186
  v_fmac_f32 v181, v187, v187
  s_waitcnt lgkmcnt(7)
  v_mfma_f32_32x32x16_bf16 v[52:67], a[88:91], v[164:167], v[52:67]
  ds_read2st64_b32 v[150:151], v174 offset0:200 offset1:202
  v_fmac_f32 v180, v188, v188
  v_fmac_f32 v181, v189, v189
  v_mfma_f32_32x32x16_bf16 v[116:131], a[92:95], v[164:167], v[116:131]
  s_add_u32 m0, s28, 86016
  s_add_u32 s29, s24, 1376256
  buffer_load_dwordx4 v170, s[12:15], s29 offen lds
  v_fmac_f32 v180, v190, v190
  v_fmac_f32 v181, v191, v191
  s_waitcnt vmcnt(19) lgkmcnt(6)
  v_mfma_f32_32x32x16_bf16 v[4:19], a[96:99], v[136:139], v[4:19]
  ds_read2st64_b32 v[152:153], v171 offset0:208 offset1:210
  ds_read2st64_b32 v[154:155], v171 offset0:216 offset1:218
  v_lshlrev_b32 v184, 16, v136
  v_and_b32 v185, s33, v136
  s_waitcnt vmcnt(18)
  v_mfma_f32_32x32x16_bf16 v[68:83], a[100:103], v[136:139], v[68:83]
  ds_read2st64_b32 v[156:157], v172 offset0:208 offset1:210
  s_add_u32 m0, s28, 90112
  s_add_u32 s29, s24, 1441792
  buffer_load_dwordx4 v170, s[12:15], s29 offen lds
  v_lshlrev_b32 v186, 16, v137
  v_and_b32 v187, s33, v137
  s_waitcnt lgkmcnt(7)
  v_mfma_f32_32x32x16_bf16 v[20:35], a[96:99], v[140:143], v[20:35]
  ds_read2st64_b32 v[158:159], v172 offset0:216 offset1:218
  v_lshlrev_b32 v188, 16, v138
  v_and_b32 v189, s33, v138
  v_mfma_f32_32x32x16_bf16 v[84:99], a[100:103], v[140:143], v[84:99]
  ds_read2st64_b32 v[160:161], v173 offset0:208 offset1:210
  s_add_u32 m0, s28, 94208
  s_add_u32 s29, s24, 1507328
  buffer_load_dwordx4 v170, s[12:15], s29 offen lds
  v_lshlrev_b32 v190, 16, v139
  v_and_b32 v191, s33, v139
  s_waitcnt lgkmcnt(7)
  v_mfma_f32_32x32x16_bf16 v[36:51], a[96:99], v[144:147], v[36:51]
  ds_read2st64_b32 v[162:163], v173 offset0:216 offset1:218
  v_fmac_f32 v180, v184, v184
  v_fmac_f32 v181, v185, v185
  v_mfma_f32_32x32x16_bf16 v[100:115], a[100:103], v[144:147], v[100:115]
  ds_read2st64_b32 v[164:165], v174 offset0:208 offset1:210
  buffer_load_dwordx4 a[152:155], v132, s[8:11], s26 offen offset:3072
  v_fmac_f32 v180, v186, v186
  v_fmac_f32 v181, v187, v187
  s_waitcnt lgkmcnt(7)
  v_mfma_f32_32x32x16_bf16 v[52:67], a[96:99], v[148:151], v[52:67]
  ds_read2st64_b32 v[166:167], v174 offset0:216 offset1:218
  v_fmac_f32 v180, v188, v188
  v_fmac_f32 v181, v189, v189
  v_mfma_f32_32x32x16_bf16 v[116:131], a[100:103], v[148:151], v[116:131]
  buffer_load_dwordx4 a[156:159], v132, s[8:11], s27 offen offset:3072
  v_fmac_f32 v180, v190, v190
  v_fmac_f32 v181, v191, v191
  s_waitcnt vmcnt(21) lgkmcnt(6)
  v_mfma_f32_32x32x16_bf16 v[4:19], a[104:107], v[152:155], v[4:19]
  ds_read2st64_b32 v[136:137], v171 offset0:224 offset1:226
  ds_read2st64_b32 v[138:139], v171 offset0:232 offset1:234
  v_lshlrev_b32 v184, 16, v152
  v_and_b32 v185, s33, v152
  s_waitcnt vmcnt(20)
  v_mfma_f32_32x32x16_bf16 v[68:83], a[108:111], v[152:155], v[68:83]
  ds_read2st64_b32 v[140:141], v172 offset0:224 offset1:226
  s_add_u32 m0, s28, 98304
  s_add_u32 s29, s24, 1572864
  buffer_load_dwordx4 v170, s[12:15], s29 offen lds
  v_lshlrev_b32 v186, 16, v153
  v_and_b32 v187, s33, v153
  s_waitcnt lgkmcnt(7)
  v_mfma_f32_32x32x16_bf16 v[20:35], a[104:107], v[156:159], v[20:35]
  ds_read2st64_b32 v[142:143], v172 offset0:232 offset1:234
  v_lshlrev_b32 v188, 16, v154
  v_and_b32 v189, s33, v154
  v_mfma_f32_32x32x16_bf16 v[84:99], a[108:111], v[156:159], v[84:99]
  ds_read2st64_b32 v[144:145], v173 offset0:224 offset1:226
  s_add_u32 m0, s28, 102400
  s_add_u32 s29, s24, 1638400
  buffer_load_dwordx4 v170, s[12:15], s29 offen lds
  v_lshlrev_b32 v190, 16, v155
  v_and_b32 v191, s33, v155
  s_waitcnt lgkmcnt(7)
  v_mfma_f32_32x32x16_bf16 v[36:51], a[104:107], v[160:163], v[36:51]
  ds_read2st64_b32 v[146:147], v173 offset0:232 offset1:234
  v_fmac_f32 v180, v184, v184
  v_fmac_f32 v181, v185, v185
  v_mfma_f32_32x32x16_bf16 v[100:115], a[108:111], v[160:163], v[100:115]
  ds_read2st64_b32 v[148:149], v174 offset0:224 offset1:226
  s_add_u32 m0, s28, 106496
  s_add_u32 s29, s24, 1703936
  buffer_load_dwordx4 v170, s[12:15], s29 offen lds
  v_fmac_f32 v180, v186, v186
  v_fmac_f32 v181, v187, v187
  s_waitcnt lgkmcnt(7)
  v_mfma_f32_32x32x16_bf16 v[52:67], a[104:107], v[164:167], v[52:67]
  ds_read2st64_b32 v[150:151], v174 offset0:232 offset1:234
  v_fmac_f32 v180, v188, v188
  v_fmac_f32 v181, v189, v189
  v_mfma_f32_32x32x16_bf16 v[116:131], a[108:111], v[164:167], v[116:131]
  s_add_u32 m0, s28, 110592
  s_add_u32 s29, s24, 1769472
  buffer_load_dwordx4 v170, s[12:15], s29 offen lds
  v_fmac_f32 v180, v190, v190
  v_fmac_f32 v181, v191, v191
  s_waitcnt vmcnt(23) lgkmcnt(6)
  v_mfma_f32_32x32x16_bf16 v[4:19], a[112:115], v[136:139], v[4:19]
  ds_read2st64_b32 v[152:153], v171 offset0:240 offset1:242
  ds_read2st64_b32 v[154:155], v171 offset0:248 offset1:250
  v_lshlrev_b32 v184, 16, v136
  v_and_b32 v185, s33, v136
  s_waitcnt vmcnt(22)
  v_mfma_f32_32x32x16_bf16 v[68:83], a[116:119], v[136:139], v[68:83]
  ds_read2st64_b32 v[156:157], v172 offset0:240 offset1:242
  s_add_u32 s26, s26, 4096
  buffer_load_dwordx4 a[160:163], v132, s[8:11], s26 offen offset:0
  v_lshlrev_b32 v186, 16, v137
  v_and_b32 v187, s33, v137
  s_waitcnt lgkmcnt(7)
  v_mfma_f32_32x32x16_bf16 v[20:35], a[112:115], v[140:143], v[20:35]
  ds_read2st64_b32 v[158:159], v172 offset0:248 offset1:250
  v_lshlrev_b32 v188, 16, v138
  v_and_b32 v189, s33, v138
  v_mfma_f32_32x32x16_bf16 v[84:99], a[116:119], v[140:143], v[84:99]
  ds_read2st64_b32 v[160:161], v173 offset0:240 offset1:242
  s_add_u32 s27, s27, 4096
  buffer_load_dwordx4 a[164:167], v132, s[8:11], s27 offen offset:0
  v_lshlrev_b32 v190, 16, v139
  v_and_b32 v191, s33, v139
  s_waitcnt lgkmcnt(7)
  v_mfma_f32_32x32x16_bf16 v[36:51], a[112:115], v[144:147], v[36:51]
  ds_read2st64_b32 v[162:163], v173 offset0:248 offset1:250
  v_fmac_f32 v180, v184, v184
  v_fmac_f32 v181, v185, v185
  v_mfma_f32_32x32x16_bf16 v[100:115], a[116:119], v[144:147], v[100:115]
  ds_read2st64_b32 v[164:165], v174 offset0:240 offset1:242
  buffer_load_dwordx4 a[168:171], v132, s[8:11], s26 offen offset:1024
  v_fmac_f32 v180, v186, v186
  v_fmac_f32 v181, v187, v187
  s_waitcnt lgkmcnt(7)
  v_mfma_f32_32x32x16_bf16 v[52:67], a[112:115], v[148:151], v[52:67]
  ds_read2st64_b32 v[166:167], v174 offset0:248 offset1:250
  v_fmac_f32 v180, v188, v188
  v_fmac_f32 v181, v189, v189
  v_mfma_f32_32x32x16_bf16 v[116:131], a[116:119], v[148:151], v[116:131]
  buffer_load_dwordx4 a[172:175], v132, s[8:11], s27 offen offset:1024
  v_fmac_f32 v180, v190, v190
  v_fmac_f32 v181, v191, v191
  s_waitcnt vmcnt(22)
  s_barrier
  s_waitcnt vmcnt(21) lgkmcnt(6)
  v_mfma_f32_32x32x16_bf16 v[4:19], a[120:123], v[152:155], v[4:19]
  ds_read2st64_b32 v[136:137], v175 offset0:0 offset1:2
  ds_read2st64_b32 v[138:139], v175 offset0:8 offset1:10
  v_lshlrev_b32 v184, 16, v152
  v_and_b32 v185, s33, v152
  s_waitcnt vmcnt(20)
  v_mfma_f32_32x32x16_bf16 v[68:83], a[124:127], v[152:155], v[68:83]
  ds_read2st64_b32 v[140:141], v176 offset0:0 offset1:2
  buffer_load_dwordx4 a[176:179], v132, s[8:11], s26 offen offset:2048
  v_lshlrev_b32 v186, 16, v153
  v_and_b32 v187, s33, v153
  s_waitcnt lgkmcnt(7)
  v_mfma_f32_32x32x16_bf16 v[20:35], a[120:123], v[156:159], v[20:35]
  ds_read2st64_b32 v[142:143], v176 offset0:8 offset1:10
  v_lshlrev_b32 v188, 16, v154
  v_and_b32 v189, s33, v154
  v_mfma_f32_32x32x16_bf16 v[84:99], a[124:127], v[156:159], v[84:99]
  ds_read2st64_b32 v[144:145], v177 offset0:0 offset1:2
  buffer_load_dwordx4 a[180:183], v132, s[8:11], s27 offen offset:2048
  v_lshlrev_b32 v190, 16, v155
  v_and_b32 v191, s33, v155
  s_waitcnt lgkmcnt(7)
  v_mfma_f32_32x32x16_bf16 v[36:51], a[120:123], v[160:163], v[36:51]
  ds_read2st64_b32 v[146:147], v177 offset0:8 offset1:10
  v_fmac_f32 v180, v184, v184
  v_fmac_f32 v181, v185, v185
  v_mfma_f32_32x32x16_bf16 v[100:115], a[124:127], v[160:163], v[100:115]
  ds_read2st64_b32 v[148:149], v178 offset0:0 offset1:2
  buffer_load_dwordx4 a[184:187], v132, s[8:11], s26 offen offset:3072
  v_fmac_f32 v180, v186, v186
  v_fmac_f32 v181, v187, v187
  s_waitcnt lgkmcnt(7)
  v_mfma_f32_32x32x16_bf16 v[52:67], a[120:123], v[164:167], v[52:67]
  ds_read2st64_b32 v[150:151], v178 offset0:8 offset1:10
  v_fmac_f32 v180, v188, v188
  v_fmac_f32 v181, v189, v189
  v_mfma_f32_32x32x16_bf16 v[116:131], a[124:127], v[164:167], v[116:131]
  buffer_load_dwordx4 a[188:191], v132, s[8:11], s27 offen offset:3072
  v_fmac_f32 v180, v190, v190
  v_fmac_f32 v181, v191, v191
  s_waitcnt vmcnt(23) lgkmcnt(6)
  v_mfma_f32_32x32x16_bf16 v[4:19], a[128:131], v[136:139], v[4:19]
  ds_read2st64_b32 v[152:153], v175 offset0:16 offset1:18
  ds_read2st64_b32 v[154:155], v175 offset0:24 offset1:26
  v_lshlrev_b32 v184, 16, v136
  v_and_b32 v185, s33, v136
  s_waitcnt vmcnt(22)
  v_mfma_f32_32x32x16_bf16 v[68:83], a[132:135], v[136:139], v[68:83]
  ds_read2st64_b32 v[156:157], v176 offset0:16 offset1:18
  s_add_u32 m0, s28, 114688
  s_add_u32 s29, s24, 1835008
  buffer_load_dwordx4 v170, s[12:15], s29 offen lds
  v_lshlrev_b32 v186, 16, v137
  v_and_b32 v187, s33, v137
  s_waitcnt lgkmcnt(7)
  v_mfma_f32_32x32x16_bf16 v[20:35], a[128:131], v[140:143], v[20:35]
  ds_read2st64_b32 v[158:159], v176 offset0:24 offset1:26
  v_lshlrev_b32 v188, 16, v138
  v_and_b32 v189, s33, v138
  v_mfma_f32_32x32x16_bf16 v[84:99], a[132:135], v[140:143], v[84:99]
  ds_read2st64_b32 v[160:161], v177 offset0:16 offset1:18
  s_add_u32 m0, s28, 118784
  s_add_u32 s29, s24, 1900544
  buffer_load_dwordx4 v170, s[12:15], s29 offen lds
  v_lshlrev_b32 v190, 16, v139
  v_and_b32 v191, s33, v139
  s_waitcnt lgkmcnt(7)
  v_mfma_f32_32x32x16_bf16 v[36:51], a[128:131], v[144:147], v[36:51]
  ds_read2st64_b32 v[162:163], v177 offset0:24 offset1:26
  v_fmac_f32 v180, v184, v184
  v_fmac_f32 v181, v185, v185
  v_mfma_f32_32x32x16_bf16 v[100:115], a[132:135], v[144:147], v[100:115]
  ds_read2st64_b32 v[164:165], v178 offset0:16 offset1:18
  s_add_u32 m0, s28, 122880
  s_add_u32 s29, s24, 1966080
  buffer_load_dwordx4 v170, s[12:15], s29 offen lds
  v_fmac_f32 v180, v186, v186
  v_fmac_f32 v181, v187, v187
  s_waitcnt lgkmcnt(7)
  v_mfma_f32_32x32x16_bf16 v[52:67], a[128:131], v[148:151], v[52:67]
  ds_read2st64_b32 v[166:167], v178 offset0:24 offset1:26
  v_fmac_f32 v180, v188, v188
  v_fmac_f32 v181, v189, v189
  v_mfma_f32_32x32x16_bf16 v[116:131], a[132:135], v[148:151], v[116:131]
  s_add_u32 m0, s28, 126976
  s_add_u32 s29, s24, 2031616
  buffer_load_dwordx4 v170, s[12:15], s29 offen lds
  v_fmac_f32 v180, v190, v190
  v_fmac_f32 v181, v191, v191
  s_waitcnt vmcnt(25) lgkmcnt(6)
  v_mfma_f32_32x32x16_bf16 v[4:19], a[136:139], v[152:155], v[4:19]
  ds_read2st64_b32 v[136:137], v175 offset0:32 offset1:34
  ds_read2st64_b32 v[138:139], v175 offset0:40 offset1:42
  v_lshlrev_b32 v184, 16, v152
  v_and_b32 v185, s33, v152
  s_waitcnt vmcnt(24)
  v_mfma_f32_32x32x16_bf16 v[68:83], a[140:143], v[152:155], v[68:83]
  ds_read2st64_b32 v[140:141], v176 offset0:32 offset1:34
  s_add_u32 s26, s26, 4096
  buffer_load_dwordx4 a[192:195], v132, s[8:11], s26 offen offset:0
  v_lshlrev_b32 v186, 16, v153
  v_and_b32 v187, s33, v153
  s_waitcnt lgkmcnt(7)
  v_mfma_f32_32x32x16_bf16 v[20:35], a[136:139], v[156:159], v[20:35]
  ds_read2st64_b32 v[142:143], v176 offset0:40 offset1:42
  v_lshlrev_b32 v188, 16, v154
  v_and_b32 v189, s33, v154
  v_mfma_f32_32x32x16_bf16 v[84:99], a[140:143], v[156:159], v[84:99]
  ds_read2st64_b32 v[144:145], v177 offset0:32 offset1:34
  s_add_u32 s27, s27, 4096
  buffer_load_dwordx4 a[196:199], v132, s[8:11], s27 offen offset:0
  v_lshlrev_b32 v190, 16, v155
  v_and_b32 v191, s33, v155
  s_waitcnt lgkmcnt(7)
  v_mfma_f32_32x32x16_bf16 v[36:51], a[136:139], v[160:163], v[36:51]
  ds_read2st64_b32 v[146:147], v177 offset0:40 offset1:42
  v_fmac_f32 v180, v184, v184
  v_fmac_f32 v181, v185, v185
  v_mfma_f32_32x32x16_bf16 v[100:115], a[140:143], v[160:163], v[100:115]
  ds_read2st64_b32 v[148:149], v178 offset0:32 offset1:34
  buffer_load_dwordx4 a[200:203], v132, s[8:11], s26 offen offset:1024
  v_fmac_f32 v180, v186, v186
  v_fmac_f32 v181, v187, v187
  s_waitcnt lgkmcnt(7)
  v_mfma_f32_32x32x16_bf16 v[52:67], a[136:139], v[164:167], v[52:67]
  ds_read2st64_b32 v[150:151], v178 offset0:40 offset1:42
  v_fmac_f32 v180, v188, v188
  v_fmac_f32 v181, v189, v189
  v_mfma_f32_32x32x16_bf16 v[116:131], a[140:143], v[164:167], v[116:131]
  buffer_load_dwordx4 a[204:207], v132, s[8:11], s27 offen offset:1024
  v_fmac_f32 v180, v190, v190
  v_fmac_f32 v181, v191, v191
  s_waitcnt vmcnt(27) lgkmcnt(6)
  v_mfma_f32_32x32x16_bf16 v[4:19], a[144:147], v[136:139], v[4:19]
  ds_read2st64_b32 v[152:153], v175 offset0:48 offset1:50
  ds_read2st64_b32 v[154:155], v175 offset0:56 offset1:58
  v_lshlrev_b32 v184, 16, v136
  v_and_b32 v185, s33, v136
  s_waitcnt vmcnt(26)
  v_mfma_f32_32x32x16_bf16 v[68:83], a[148:151], v[136:139], v[68:83]
  ds_read2st64_b32 v[156:157], v176 offset0:48 offset1:50
  buffer_load_dwordx4 a[208:211], v132, s[8:11], s26 offen offset:2048
  v_lshlrev_b32 v186, 16, v137
  v_and_b32 v187, s33, v137
  s_waitcnt lgkmcnt(7)
  v_mfma_f32_32x32x16_bf16 v[20:35], a[144:147], v[140:143], v[20:35]
  ds_read2st64_b32 v[158:159], v176 offset0:56 offset1:58
  v_lshlrev_b32 v188, 16, v138
  v_and_b32 v189, s33, v138
  v_mfma_f32_32x32x16_bf16 v[84:99], a[148:151], v[140:143], v[84:99]
  ds_read2st64_b32 v[160:161], v177 offset0:48 offset1:50
  buffer_load_dwordx4 a[212:215], v132, s[8:11], s27 offen offset:2048
  v_lshlrev_b32 v190, 16, v139
  v_and_b32 v191, s33, v139
  s_waitcnt lgkmcnt(7)
  v_mfma_f32_32x32x16_bf16 v[36:51], a[144:147], v[144:147], v[36:51]
  ds_read2st64_b32 v[162:163], v177 offset0:56 offset1:58
  v_fmac_f32 v180, v184, v184
  v_fmac_f32 v181, v185, v185
  v_mfma_f32_32x32x16_bf16 v[100:115], a[148:151], v[144:147], v[100:115]
  ds_read2st64_b32 v[164:165], v178 offset0:48 offset1:50
  buffer_load_dwordx4 a[216:219], v132, s[8:11], s26 offen offset:3072
  v_fmac_f32 v180, v186, v186
  v_fmac_f32 v181, v187, v187
  s_waitcnt lgkmcnt(7)
  v_mfma_f32_32x32x16_bf16 v[52:67], a[144:147], v[148:151], v[52:67]
  ds_read2st64_b32 v[166:167], v178 offset0:56 offset1:58
  v_fmac_f32 v180, v188, v188
  v_fmac_f32 v181, v189, v189
  v_mfma_f32_32x32x16_bf16 v[116:131], a[148:151], v[148:151], v[116:131]
  buffer_load_dwordx4 a[220:223], v132, s[8:11], s27 offen offset:3072
  v_fmac_f32 v180, v190, v190
  v_fmac_f32 v181, v191, v191
  s_waitcnt vmcnt(26)
  s_barrier
  s_waitcnt vmcnt(25) lgkmcnt(6)
  v_mfma_f32_32x32x16_bf16 v[4:19], a[152:155], v[152:155], v[4:19]
  ds_read2st64_b32 v[136:137], v175 offset0:64 offset1:66
  ds_read2st64_b32 v[138:139], v175 offset0:72 offset1:74
  v_lshlrev_b32 v184, 16, v152
  v_and_b32 v185, s33, v152
  s_waitcnt vmcnt(24)
  v_mfma_f32_32x32x16_bf16 v[68:83], a[156:159], v[152:155], v[68:83]
  ds_read2st64_b32 v[140:141], v175 offset0:80 offset1:82
  s_add_u32 s26, s26, 4096
  buffer_load_dwordx4 a[224:227], v132, s[8:11], s26 offen offset:0
  v_lshlrev_b32 v186, 16, v153
  v_and_b32 v187, s33, v153
  s_waitcnt lgkmcnt(7)
  v_mfma_f32_32x32x16_bf16 v[20:35], a[152:155], v[156:159], v[20:35]
  ds_read2st64_b32 v[142:143], v175 offset0:88 offset1:90
  v_lshlrev_b32 v188, 16, v154
  v_and_b32 v189, s33, v154
  v_mfma_f32_32x32x16_bf16 v[84:99], a[156:159], v[156:159], v[84:99]
  ds_read2st64_b32 v[144:145], v175 offset0:96 offset1:98
  s_add_u32 s27, s27, 4096
  buffer_load_dwordx4 a[228:231], v132, s[8:11], s27 offen offset:0
  v_lshlrev_b32 v190, 16, v155
  v_and_b32 v191, s33, v155
  s_waitcnt lgkmcnt(7)
  v_mfma_f32_32x32x16_bf16 v[36:51], a[152:155], v[160:163], v[36:51]
  ds_read2st64_b32 v[146:147], v175 offset0:104 offset1:106
  v_fmac_f32 v180, v184, v184
  v_fmac_f32 v181, v185, v185
  v_mfma_f32_32x32x16_bf16 v[100:115], a[156:159], v[160:163], v[100:115]
  ds_read2st64_b32 v[148:149], v175 offset0:112 offset1:114
  buffer_load_dwordx4 a[232:235], v132, s[8:11], s26 offen offset:1024
  v_fmac_f32 v180, v186, v186
  v_fmac_f32 v181, v187, v187
  s_waitcnt lgkmcnt(7)
  v_mfma_f32_32x32x16_bf16 v[52:67], a[152:155], v[164:167], v[52:67]
  ds_read2st64_b32 v[150:151], v175 offset0:120 offset1:122
  v_fmac_f32 v180, v188, v188
  v_fmac_f32 v181, v189, v189
  v_mfma_f32_32x32x16_bf16 v[116:131], a[156:159], v[164:167], v[116:131]
  buffer_load_dwordx4 a[236:239], v132, s[8:11], s27 offen offset:1024
  v_fmac_f32 v180, v190, v190
  v_fmac_f32 v181, v191, v191
  v_lshlrev_b32 v168, 2, v133
  s_lshl_b32 s30, s3, 7
  s_add_u32 s30, s30, 131072
  v_add_u32 v210, s30, v168
  s_add_u32 s30, s3, 1
  s_and_b32 s30, s30, 3
  s_lshl_b32 s30, s30, 7
  s_add_u32 s30, s30, 131072
  v_add_u32 v211, s30, v168
  s_add_u32 s30, s3, 2
  s_and_b32 s30, s30, 3
  s_lshl_b32 s30, s30, 7
  s_add_u32 s30, s30, 131072
  v_add_u32 v212, s30, v168
  s_add_u32 s30, s3, 3
  s_and_b32 s30, s30, 3
  s_lshl_b32 s30, s30, 7
  s_add_u32 s30, s30, 131072
  v_add_u32 v213, s30, v168
  s_mov_b32 s30, 0x3b000000
  s_mov_b32 s31, 0xbfb8aa3b
  v_mov_b32 v169, 0x3727c5ac
  s_waitcnt vmcnt(24)
  s_barrier
  s_waitcnt vmcnt(23) lgkmcnt(6)
  v_mfma_f32_32x32x16_bf16 v[4:19], a[160:163], v[136:139], v[4:19]
  ds_read2st64_b32 v[152:153], v175 offset0:128 offset1:130
  buffer_load_dwordx4 a[240:243], v132, s[8:11], s26 offen offset:2048
  buffer_load_dwordx4 a[248:251], v132, s[8:11], s26 offen offset:3072
  v_lshlrev_b32 v184, 16, v136
  v_and_b32 v185, s33, v136
  v_lshlrev_b32 v186, 16, v137
  v_and_b32 v187, s33, v137
  v_lshlrev_b32 v188, 16, v138
  v_and_b32 v189, s33, v138
  v_lshlrev_b32 v190, 16, v139
  v_and_b32 v191, s33, v139
  s_waitcnt vmcnt(24)
  v_mfma_f32_32x32x16_bf16 v[68:83], a[164:167], v[136:139], v[68:83]
  ds_read2st64_b32 v[154:155], v175 offset0:136 offset1:138
  buffer_load_dwordx4 a[244:247], v132, s[8:11], s27 offen offset:2048
  buffer_load_dwordx4 a[252:255], v132, s[8:11], s27 offen offset:3072
  v_fmac_f32 v180, v184, v184
  v_fmac_f32 v181, v185, v185
  v_fmac_f32 v180, v186, v186
  v_fmac_f32 v181, v187, v187
  v_fmac_f32 v180, v188, v188
  v_fmac_f32 v181, v189, v189
  v_fmac_f32 v180, v190, v190
  v_fmac_f32 v181, v191, v191
  s_waitcnt vmcnt(25) lgkmcnt(6)
  v_mfma_f32_32x32x16_bf16 v[4:19], a[168:171], v[140:143], v[4:19]
  ds_read2st64_b32 v[156:157], v175 offset0:144 offset1:146
  v_lshlrev_b32 v184, 16, v140
  v_and_b32 v185, s33, v140
  v_lshlrev_b32 v186, 16, v141
  v_and_b32 v187, s33, v141
  v_lshlrev_b32 v188, 16, v142
  v_and_b32 v189, s33, v142
  v_lshlrev_b32 v190, 16, v143
  v_and_b32 v191, s33, v143
  s_waitcnt vmcnt(24)
  v_mfma_f32_32x32x16_bf16 v[68:83], a[172:175], v[140:143], v[68:83]
  ds_read2st64_b32 v[158:159], v175 offset0:152 offset1:154
  v_fmac_f32 v180, v184, v184
  v_fmac_f32 v181, v185, v185
  v_fmac_f32 v180, v186, v186
  v_fmac_f32 v181, v187, v187
  v_fmac_f32 v180, v188, v188
  v_fmac_f32 v181, v189, v189
  v_fmac_f32 v180, v190, v190
  v_fmac_f32 v181, v191, v191
  s_waitcnt vmcnt(23) lgkmcnt(6)
  v_mfma_f32_32x32x16_bf16 v[4:19], a[176:179], v[144:147], v[4:19]
  ds_read2st64_b32 v[160:161], v175 offset0:160 offset1:162
  v_lshlrev_b32 v184, 16, v144
  v_and_b32 v185, s33, v144
  v_lshlrev_b32 v186, 16, v145
  v_and_b32 v187, s33, v145
  v_lshlrev_b32 v188, 16, v146
  v_and_b32 v189, s33, v146
  v_lshlrev_b32 v190, 16, v147
  v_and_b32 v191, s33, v147
  s_waitcnt vmcnt(22)
  v_mfma_f32_32x32x16_bf16 v[68:83], a[180:183], v[144:147], v[68:83]
  ds_read2st64_b32 v[162:163], v175 offset0:168 offset1:170
  v_fmac_f32 v180, v184, v184
  v_fmac_f32 v181, v185, v185
  v_fmac_f32 v180, v186, v186
  v_fmac_f32 v181, v187, v187
  v_fmac_f32 v180, v188, v188
  v_fmac_f32 v181, v189, v189
  v_fmac_f32 v180, v190, v190
  v_fmac_f32 v181, v191, v191
  s_waitcnt vmcnt(21) lgkmcnt(6)
  v_mfma_f32_32x32x16_bf16 v[4:19], a[184:187], v[148:151], v[4:19]
  ds_read2st64_b32 v[164:165], v175 offset0:176 offset1:178
  v_lshlrev_b32 v184, 16, v148
  v_and_b32 v185, s33, v148
  v_lshlrev_b32 v186, 16, v149
  v_and_b32 v187, s33, v149
  v_lshlrev_b32 v188, 16, v150
  v_and_b32 v189, s33, v150
  v_lshlrev_b32 v190, 16, v151
  v_and_b32 v191, s33, v151
  s_waitcnt vmcnt(20)
  v_mfma_f32_32x32x16_bf16 v[68:83], a[188:191], v[148:151], v[68:83]
  ds_read2st64_b32 v[166:167], v175 offset0:184 offset1:186
  v_fmac_f32 v180, v184, v184
  v_fmac_f32 v181, v185, v185
  v_fmac_f32 v180, v186, v186
  v_fmac_f32 v181, v187, v187
  v_fmac_f32 v180, v188, v188
  v_fmac_f32 v181, v189, v189
  v_fmac_f32 v180, v190, v190
  v_fmac_f32 v181, v191, v191
  s_waitcnt vmcnt(16)
  s_barrier
  s_waitcnt vmcnt(15) lgkmcnt(6)
  v_mfma_f32_32x32x16_bf16 v[4:19], a[192:195], v[152:155], v[4:19]
  ds_read2st64_b32 v[136:137], v175 offset0:192 offset1:194
  v_lshlrev_b32 v184, 16, v152
  v_and_b32 v185, s33, v152
  v_lshlrev_b32 v186, 16, v153
  v_and_b32 v187, s33, v153
  v_lshlrev_b32 v188, 16, v154
  v_and_b32 v189, s33, v154
  v_lshlrev_b32 v190, 16, v155
  v_and_b32 v191, s33, v155
  s_waitcnt vmcnt(14)
  v_mfma_f32_32x32x16_bf16 v[68:83], a[196:199], v[152:155], v[68:83]
  ds_read2st64_b32 v[138:139], v175 offset0:200 offset1:202
  v_fmac_f32 v180, v184, v184
  v_fmac_f32 v181, v185, v185
  v_fmac_f32 v180, v186, v186
  v_fmac_f32 v181, v187, v187
  v_fmac_f32 v180, v188, v188
  v_fmac_f32 v181, v189, v189
  v_fmac_f32 v180, v190, v190
  v_fmac_f32 v181, v191, v191
  s_waitcnt vmcnt(13) lgkmcnt(6)
  v_mfma_f32_32x32x16_bf16 v[4:19], a[200:203], v[156:159], v[4:19]
  ds_read2st64_b32 v[140:141], v175 offset0:208 offset1:210
  v_lshlrev_b32 v184, 16, v156
  v_and_b32 v185, s33, v156
  v_lshlrev_b32 v186, 16, v157
  v_and_b32 v187, s33, v157
  v_lshlrev_b32 v188, 16, v158
  v_and_b32 v189, s33, v158
  v_lshlrev_b32 v190, 16, v159
  v_and_b32 v191, s33, v159
  s_waitcnt vmcnt(12)
  v_mfma_f32_32x32x16_bf16 v[68:83], a[204:207], v[156:159], v[68:83]
  ds_read2st64_b32 v[142:143], v175 offset0:216 offset1:218
  v_fmac_f32 v180, v184, v184
  v_fmac_f32 v181, v185, v185
  v_fmac_f32 v180, v186, v186
  v_fmac_f32 v181, v187, v187
  v_fmac_f32 v180, v188, v188
  v_fmac_f32 v181, v189, v189
  v_fmac_f32 v180, v190, v190
  v_fmac_f32 v181, v191, v191
  s_waitcnt vmcnt(11) lgkmcnt(6)
  v_mfma_f32_32x32x16_bf16 v[4:19], a[208:211], v[160:163], v[4:19]
  ds_read2st64_b32 v[144:145], v175 offset0:224 offset1:226
  v_lshlrev_b32 v184, 16, v160
  v_and_b32 v185, s33, v160
  v_lshlrev_b32 v186, 16, v161
  v_and_b32 v187, s33, v161
  v_lshlrev_b32 v188, 16, v162
  v_and_b32 v189, s33, v162
  v_lshlrev_b32 v190, 16, v163
  v_and_b32 v191, s33, v163
  s_waitcnt vmcnt(10)
  v_mfma_f32_32x32x16_bf16 v[68:83], a[212:215], v[160:163], v[68:83]
  ds_read2st64_b32 v[146:147], v175 offset0:232 offset1:234
  v_fmac_f32 v180, v184, v184
  v_fmac_f32 v181, v185, v185
  v_fmac_f32 v180, v186, v186
  v_fmac_f32 v181, v187, v187
  v_fmac_f32 v180, v188, v188
  v_fmac_f32 v181, v189, v189
  v_fmac_f32 v180, v190, v190
  v_fmac_f32 v181, v191, v191
  s_waitcnt vmcnt(9) lgkmcnt(6)
  v_mfma_f32_32x32x16_bf16 v[4:19], a[216:219], v[164:167], v[4:19]
  ds_read2st64_b32 v[148:149], v175 offset0:240 offset1:242
  v_lshlrev_b32 v184, 16, v164
  v_and_b32 v185, s33, v164
  v_lshlrev_b32 v186, 16, v165
  v_and_b32 v187, s33, v165
  v_lshlrev_b32 v188, 16, v166
  v_and_b32 v189, s33, v166
  v_lshlrev_b32 v190, 16, v167
  v_and_b32 v191, s33, v167
  s_waitcnt vmcnt(8)
  v_mfma_f32_32x32x16_bf16 v[68:83], a[220:223], v[164:167], v[68:83]
  ds_read2st64_b32 v[150:151], v175 offset0:248 offset1:250
  v_fmac_f32 v180, v184, v184
  v_fmac_f32 v181, v185, v185
  v_fmac_f32 v180, v186, v186
  v_fmac_f32 v181, v187, v187
  v_fmac_f32 v180, v188, v188
  v_fmac_f32 v181, v189, v189
  v_fmac_f32 v180, v190, v190
  v_fmac_f32 v181, v191, v191
  s_waitcnt vmcnt(7) lgkmcnt(6)
  v_mfma_f32_32x32x16_bf16 v[4:19], a[224:227], v[136:139], v[4:19]
  ds_read2st64_b32 v[152:153], v176 offset0:64 offset1:66
  v_lshlrev_b32 v184, 16, v136
  v_and_b32 v185, s33, v136
  v_lshlrev_b32 v186, 16, v137
  v_and_b32 v187, s33, v137
  v_lshlrev_b32 v188, 16, v138
  v_and_b32 v189, s33, v138
  v_lshlrev_b32 v190, 16, v139
  v_and_b32 v191, s33, v139
  s_waitcnt vmcnt(6)
  v_mfma_f32_32x32x16_bf16 v[68:83], a[228:231], v[136:139], v[68:83]
  ds_read2st64_b32 v[154:155], v176 offset0:72 offset1:74
  v_fmac_f32 v180, v184, v184
  v_fmac_f32 v181, v185, v185
  v_fmac_f32 v180, v186, v186
  v_fmac_f32 v181, v187, v187
  v_fmac_f32 v180, v188, v188
  v_fmac_f32 v181, v189, v189
  v_fmac_f32 v180, v190, v190
  v_fmac_f32 v181, v191, v191
  s_waitcnt vmcnt(5) lgkmcnt(6)
  v_mfma_f32_32x32x16_bf16 v[4:19], a[232:235], v[140:143], v[4:19]
  ds_read2st64_b32 v[156:157], v176 offset0:80 offset1:82
  v_lshlrev_b32 v184, 16, v140
  v_and_b32 v185, s33, v140
  v_lshlrev_b32 v186, 16, v141
  v_and_b32 v187, s33, v141
  v_lshlrev_b32 v188, 16, v142
  v_and_b32 v189, s33, v142
  v_lshlrev_b32 v190, 16, v143
  v_and_b32 v191, s33, v143
  s_waitcnt vmcnt(4)
  v_mfma_f32_32x32x16_bf16 v[68:83], a[236:239], v[140:143], v[68:83]
  ds_read2st64_b32 v[158:159], v176 offset0:88 offset1:90
  v_fmac_f32 v180, v184, v184
  v_fmac_f32 v181, v185, v185
  v_fmac_f32 v180, v186, v186
  v_fmac_f32 v181, v187, v187
  v_fmac_f32 v180, v188, v188
  v_fmac_f32 v181, v189, v189
  v_fmac_f32 v180, v190, v190
  v_fmac_f32 v181, v191, v191
  s_waitcnt vmcnt(3) lgkmcnt(6)
  v_mfma_f32_32x32x16_bf16 v[4:19], a[240:243], v[144:147], v[4:19]
  ds_read2st64_b32 v[160:161], v176 offset0:96 offset1:98
  v_lshlrev_b32 v184, 16, v144
  v_and_b32 v185, s33, v144
  v_lshlrev_b32 v186, 16, v145
  v_and_b32 v187, s33, v145
  v_lshlrev_b32 v188, 16, v146
  v_and_b32 v189, s33, v146
  v_lshlrev_b32 v190, 16, v147
  v_and_b32 v191, s33, v147
  s_waitcnt vmcnt(1)
  v_mfma_f32_32x32x16_bf16 v[68:83], a[244:247], v[144:147], v[68:83]
  ds_read2st64_b32 v[162:163], v176 offset0:104 offset1:106
  v_fmac_f32 v180, v184, v184
  v_fmac_f32 v181, v185, v185
  v_fmac_f32 v180, v186, v186
  v_fmac_f32 v181, v187, v187
  v_fmac_f32 v180, v188, v188
  v_fmac_f32 v181, v189, v189
  v_fmac_f32 v180, v190, v190
  v_fmac_f32 v181, v191, v191
  s_waitcnt lgkmcnt(6)
  v_mfma_f32_32x32x16_bf16 v[4:19], a[248:251], v[148:151], v[4:19]
  ds_read2st64_b32 v[164:165], v176 offset0:112 offset1:114
  v_lshlrev_b32 v184, 16, v148
  v_and_b32 v185, s33, v148
  v_lshlrev_b32 v186, 16, v149
  v_and_b32 v187, s33, v149
  v_lshlrev_b32 v188, 16, v150
  v_and_b32 v189, s33, v150
  v_lshlrev_b32 v190, 16, v151
  v_and_b32 v191, s33, v151
  s_waitcnt vmcnt(0)
  v_mfma_f32_32x32x16_bf16 v[68:83], a[252:255], v[148:151], v[68:83]
  ds_read2st64_b32 v[166:167], v176 offset0:120 offset1:122
  v_fmac_f32 v180, v184, v184
  v_fmac_f32 v181, v185, v185
  v_fmac_f32 v180, v186, v186
  v_fmac_f32 v181, v187, v187
  v_fmac_f32 v180, v188, v188
  v_fmac_f32 v181, v189, v189
  v_fmac_f32 v180, v190, v190
  v_fmac_f32 v181, v191, v191
  s_waitcnt lgkmcnt(6)
  v_mfma_f32_32x32x16_bf16 v[20:35], a[160:163], v[152:155], v[20:35]
  ds_read2st64_b32 v[136:137], v176 offset0:128 offset1:130
  v_add_f32 v180, v180, v181
  v_mov_b32 v181, v180
  s_nop 1
  v_permlane32_swap_b32 v180, v181
  v_add_f32 v180, v180, v181
  v_fma_f32 v194, v180, s30, v169
  ds_write_b32 v210, v194
  v_rsq_f32 v202, v194
  s_nop 0
  v_mul_f32 v202, s31, v202
  v_mfma_f32_32x32x16_bf16 v[84:99], a[164:167], v[152:155], v[84:99]
  ds_read2st64_b32 v[138:139], v176 offset0:136 offset1:138
  s_waitcnt lgkmcnt(7)
  v_mfma_f32_32x32x16_bf16 v[20:35], a[168:171], v[156:159], v[20:35]
  ds_read2st64_b32 v[140:141], v176 offset0:144 offset1:146
  v_mfma_f32_32x32x16_bf16 v[84:99], a[172:175], v[156:159], v[84:99]
  ds_read2st64_b32 v[142:143], v176 offset0:152 offset1:154
  v_mul_f32 v68, v4, v68
  v_mul_f32 v4, v4, v202
  v_exp_f32 v4, v4
  v_mul_f32 v69, v5, v69
  v_mul_f32 v5, v5, v202
  s_waitcnt lgkmcnt(7)
  v_mfma_f32_32x32x16_bf16 v[20:35], a[176:179], v[160:163], v[20:35]
  ds_read2st64_b32 v[144:145], v176 offset0:160 offset1:162
  v_exp_f32 v5, v5
  v_fma_f32 v4, v4, v194, v194
  v_rcp_f32 v4, v4
  v_mul_f32 v70, v6, v70
  v_mul_f32 v6, v6, v202
  v_mfma_f32_32x32x16_bf16 v[84:99], a[180:183], v[160:163], v[84:99]
  ds_read2st64_b32 v[146:147], v176 offset0:168 offset1:170
  v_exp_f32 v6, v6
  v_fma_f32 v5, v5, v194, v194
  v_rcp_f32 v5, v5
  v_mul_f32 v68, v68, v4
  s_waitcnt lgkmcnt(7)
  v_mfma_f32_32x32x16_bf16 v[20:35], a[184:187], v[164:167], v[20:35]
  ds_read2st64_b32 v[148:149], v176 offset0:176 offset1:178
  v_mul_f32 v71, v7, v71
  v_mul_f32 v7, v7, v202
  v_exp_f32 v7, v7
  v_fma_f32 v6, v6, v194, v194
  v_rcp_f32 v6, v6
  v_mfma_f32_32x32x16_bf16 v[84:99], a[188:191], v[164:167], v[84:99]
  ds_read2st64_b32 v[150:151], v176 offset0:184 offset1:186
  v_mul_f32 v69, v69, v5
  v_cvt_pk_bf16_f32 v4, v68, v69
  v_mul_f32 v72, v8, v72
  v_mul_f32 v8, v8, v202
  v_exp_f32 v8, v8
  s_waitcnt lgkmcnt(6)
  v_mfma_f32_32x32x16_bf16 v[20:35], a[192:195], v[136:139], v[20:35]
  ds_read2st64_b32 v[152:153], v176 offset0:192 offset1:194
  v_fma_f32 v7, v7, v194, v194
  v_rcp_f32 v7, v7
  v_mul_f32 v70, v70, v6
  v_mul_f32 v73, v9, v73
  v_mul_f32 v9, v9, v202
  v_mfma_f32_32x32x16_bf16 v[84:99], a[196:199], v[136:139], v[84:99]
  ds_read2st64_b32 v[154:155], v176 offset0:200 offset1:202
  v_exp_f32 v9, v9
  v_fma_f32 v8, v8, v194, v194
  v_rcp_f32 v8, v8
  v_mul_f32 v71, v71, v7
  v_cvt_pk_bf16_f32 v5, v70, v71
  s_waitcnt lgkmcnt(6)
  v_mfma_f32_32x32x16_bf16 v[20:35], a[200:203], v[140:143], v[20:35]
  ds_read2st64_b32 v[156:157], v176 offset0:208 offset1:210
  v_mul_f32 v74, v10, v74
  v_mul_f32 v10, v10, v202
  v_exp_f32 v10, v10
  v_fma_f32 v9, v9, v194, v194
  v_rcp_f32 v9, v9
  v_mfma_f32_32x32x16_bf16 v[84:99], a[204:207], v[140:143], v[84:99]
  ds_read2st64_b32 v[158:159], v176 offset0:216 offset1:218
  v_mul_f32 v72, v72, v8
  v_mul_f32 v75, v11, v75
  v_mul_f32 v11, v11, v202
  v_exp_f32 v11, v11
  v_fma_f32 v10, v10, v194, v194
  s_waitcnt lgkmcnt(6)
  v_mfma_f32_32x32x16_bf16 v[20:35], a[208:211], v[144:147], v[20:35]
  ds_read2st64_b32 v[160:161], v176 offset0:224 offset1:226
  s_waitcnt lgkmcnt(0)
  s_barrier
  ds_read_b32 v196, v211
  ds_read_b32 v198, v212
  ds_read_b32 v200, v213
  v_rcp_f32 v10, v10
  v_mul_f32 v73, v73, v9
  v_cvt_pk_bf16_f32 v6, v72, v73
  v_mul_f32 v76, v12, v76
  v_mul_f32 v12, v12, v202
  v_exp_f32 v12, v12
  v_mfma_f32_32x32x16_bf16 v[84:99], a[212:215], v[144:147], v[84:99]
  ds_read2st64_b32 v[162:163], v176 offset0:232 offset1:234
  v_fma_f32 v11, v11, v194, v194
  v_rcp_f32 v11, v11
  v_mul_f32 v74, v74, v10
  v_mul_f32 v77, v13, v77
  v_mul_f32 v13, v13, v202
  v_mfma_f32_32x32x16_bf16 v[20:35], a[216:219], v[148:151], v[20:35]
  ds_read2st64_b32 v[164:165], v176 offset0:240 offset1:242
  v_exp_f32 v13, v13
  v_fma_f32 v12, v12, v194, v194
  v_rcp_f32 v12, v12
  v_mfma_f32_32x32x16_bf16 v[84:99], a[220:223], v[148:151], v[84:99]
  ds_read2st64_b32 v[166:167], v176 offset0:248 offset1:250
  v_mul_f32 v75, v75, v11
  v_cvt_pk_bf16_f32 v7, v74, v75
  buffer_store_dwordx4 v[4:7], v132, s[16:19], s36 offen sc0 sc1
  v_mul_f32 v78, v14, v78
  v_mul_f32 v14, v14, v202
  v_exp_f32 v14, v14
  v_fma_f32 v13, v13, v194, v194
  v_mfma_f32_32x32x16_bf16 v[20:35], a[224:227], v[152:155], v[20:35]
  ds_read2st64_b32 v[136:137], v177 offset0:64 offset1:66
  v_rcp_f32 v13, v13
  v_mul_f32 v76, v76, v12
  v_mul_f32 v79, v15, v79
  v_mul_f32 v15, v15, v202
  v_exp_f32 v15, v15
  v_mfma_f32_32x32x16_bf16 v[84:99], a[228:231], v[152:155], v[84:99]
  ds_read2st64_b32 v[138:139], v177 offset0:72 offset1:74
  v_fma_f32 v14, v14, v194, v194
  v_rcp_f32 v14, v14
  v_mul_f32 v77, v77, v13
  v_cvt_pk_bf16_f32 v8, v76, v77
  v_mul_f32 v80, v16, v80
  v_mfma_f32_32x32x16_bf16 v[20:35], a[232:235], v[156:159], v[20:35]
  ds_read2st64_b32 v[140:141], v177 offset0:80 offset1:82
  v_mul_f32 v16, v16, v202
  v_exp_f32 v16, v16
  v_fma_f32 v15, v15, v194, v194
  v_rcp_f32 v15, v15
  v_mfma_f32_32x32x16_bf16 v[84:99], a[236:239], v[156:159], v[84:99]
  ds_read2st64_b32 v[142:143], v177 offset0:88 offset1:90
  v_mul_f32 v78, v78, v14
  v_mul_f32 v81, v17, v81
  v_mul_f32 v17, v17, v202
  v_exp_f32 v17, v17
  v_fma_f32 v16, v16, v194, v194
  s_waitcnt lgkmcnt(6)
  v_mfma_f32_32x32x16_bf16 v[20:35], a[240:243], v[160:163], v[20:35]
  ds_read2st64_b32 v[144:145], v177 offset0:96 offset1:98
  v_rsq_f32 v204, v196
  s_nop 0
  v_mul_f32 v204, s31, v204
  v_rsq_f32 v206, v198
  s_nop 0
  v_mul_f32 v206, s31, v206
  v_rsq_f32 v208, v200
  s_nop 0
  v_mul_f32 v208, s31, v208
  v_rcp_f32 v16, v16
  v_mul_f32 v79, v79, v15
  v_cvt_pk_bf16_f32 v9, v78, v79
  v_mul_f32 v82, v18, v82
  v_mul_f32 v18, v18, v202
  v_exp_f32 v18, v18
  v_mfma_f32_32x32x16_bf16 v[84:99], a[244:247], v[160:163], v[84:99]
  ds_read2st64_b32 v[146:147], v177 offset0:104 offset1:106
  v_fma_f32 v17, v17, v194, v194
  v_rcp_f32 v17, v17
  v_mul_f32 v80, v80, v16
  v_mul_f32 v83, v19, v83
  v_mul_f32 v19, v19, v202
  s_waitcnt lgkmcnt(6)
  v_mfma_f32_32x32x16_bf16 v[20:35], a[248:251], v[164:167], v[20:35]
  ds_read2st64_b32 v[148:149], v177 offset0:112 offset1:114
  v_exp_f32 v19, v19
  v_fma_f32 v18, v18, v194, v194
  v_rcp_f32 v18, v18
  v_mul_f32 v81, v81, v17
  v_mfma_f32_32x32x16_bf16 v[84:99], a[252:255], v[164:167], v[84:99]
  ds_read2st64_b32 v[150:151], v177 offset0:120 offset1:122
  v_cvt_pk_bf16_f32 v10, v80, v81
  v_fma_f32 v19, v19, v194, v194
  v_rcp_f32 v19, v19
  v_mul_f32 v82, v82, v18
  v_mul_f32 v83, v83, v19
  v_cvt_pk_bf16_f32 v11, v82, v83
  buffer_store_dwordx4 v[8:11], v132, s[16:19], s36 offen offset:1024 sc0 sc1
  s_waitcnt lgkmcnt(6)
  v_mfma_f32_32x32x16_bf16 v[36:51], a[160:163], v[136:139], v[36:51]
  ds_read2st64_b32 v[152:153], v177 offset0:128 offset1:130
  v_mfma_f32_32x32x16_bf16 v[100:115], a[164:167], v[136:139], v[100:115]
  ds_read2st64_b32 v[154:155], v177 offset0:136 offset1:138
  s_waitcnt lgkmcnt(6)
  v_mfma_f32_32x32x16_bf16 v[36:51], a[168:171], v[140:143], v[36:51]
  ds_read2st64_b32 v[156:157], v177 offset0:144 offset1:146
  v_mfma_f32_32x32x16_bf16 v[100:115], a[172:175], v[140:143], v[100:115]
  ds_read2st64_b32 v[158:159], v177 offset0:152 offset1:154
  v_mul_f32 v84, v20, v84
  v_mul_f32 v20, v20, v204
  v_exp_f32 v20, v20
  v_mul_f32 v85, v21, v85
  v_mul_f32 v21, v21, v204
  s_waitcnt lgkmcnt(6)
  v_mfma_f32_32x32x16_bf16 v[36:51], a[176:179], v[144:147], v[36:51]
  ds_read2st64_b32 v[160:161], v177 offset0:160 offset1:162
  v_exp_f32 v21, v21
  v_fma_f32 v20, v20, v196, v196
  v_rcp_f32 v20, v20
  v_mul_f32 v86, v22, v86
  v_mul_f32 v22, v22, v204
  v_mfma_f32_32x32x16_bf16 v[100:115], a[180:183], v[144:147], v[100:115]
  ds_read2st64_b32 v[162:163], v177 offset0:168 offset1:170
  v_exp_f32 v22, v22
  v_fma_f32 v21, v21, v196, v196
  v_rcp_f32 v21, v21
  v_mul_f32 v84, v84, v20
  s_waitcnt lgkmcnt(6)
  v_mfma_f32_32x32x16_bf16 v[36:51], a[184:187], v[148:151], v[36:51]
  ds_read2st64_b32 v[164:165], v177 offset0:176 offset1:178
  v_mul_f32 v87, v23, v87
  v_mul_f32 v23, v23, v204
  v_exp_f32 v23, v23
  v_fma_f32 v22, v22, v196, v196
  v_rcp_f32 v22, v22
  v_mfma_f32_32x32x16_bf16 v[100:115], a[188:191], v[148:151], v[100:115]
  ds_read2st64_b32 v[166:167], v177 offset0:184 offset1:186
  v_mul_f32 v85, v85, v21
  v_cvt_pk_bf16_f32 v20, v84, v85
  v_mul_f32 v88, v24, v88
  v_mul_f32 v24, v24, v204
  v_exp_f32 v24, v24
  s_waitcnt lgkmcnt(6)
  v_mfma_f32_32x32x16_bf16 v[36:51], a[192:195], v[152:155], v[36:51]
  ds_read2st64_b32 v[136:137], v177 offset0:192 offset1:194
  v_fma_f32 v23, v23, v196, v196
  v_rcp_f32 v23, v23
  v_mul_f32 v86, v86, v22
  v_mul_f32 v89, v25, v89
  v_mul_f32 v25, v25, v204
  v_mfma_f32_32x32x16_bf16 v[100:115], a[196:199], v[152:155], v[100:115]
  ds_read2st64_b32 v[138:139], v177 offset0:200 offset1:202
  v_exp_f32 v25, v25
  v_fma_f32 v24, v24, v196, v196
  v_rcp_f32 v24, v24
  v_mul_f32 v87, v87, v23
  v_cvt_pk_bf16_f32 v21, v86, v87
  s_waitcnt lgkmcnt(6)
  v_mfma_f32_32x32x16_bf16 v[36:51], a[200:203], v[156:159], v[36:51]
  ds_read2st64_b32 v[140:141], v177 offset0:208 offset1:210
  v_mul_f32 v90, v26, v90
  v_mul_f32 v26, v26, v204
  v_exp_f32 v26, v26
  v_fma_f32 v25, v25, v196, v196
  v_rcp_f32 v25, v25
  v_mfma_f32_32x32x16_bf16 v[100:115], a[204:207], v[156:159], v[100:115]
  ds_read2st64_b32 v[142:143], v177 offset0:216 offset1:218
  v_mul_f32 v88, v88, v24
  v_mul_f32 v91, v27, v91
  v_mul_f32 v27, v27, v204
  v_exp_f32 v27, v27
  v_fma_f32 v26, v26, v196, v196
  s_waitcnt lgkmcnt(6)
  v_mfma_f32_32x32x16_bf16 v[36:51], a[208:211], v[160:163], v[36:51]
  ds_read2st64_b32 v[144:145], v177 offset0:224 offset1:226
  v_rcp_f32 v26, v26
  v_mul_f32 v89, v89, v25
  v_cvt_pk_bf16_f32 v22, v88, v89
  v_mul_f32 v92, v28, v92
  v_mul_f32 v28, v28, v204
  v_exp_f32 v28, v28
  v_mfma_f32_32x32x16_bf16 v[100:115], a[212:215], v[160:163], v[100:115]
  ds_read2st64_b32 v[146:147], v177 offset0:232 offset1:234
  v_fma_f32 v27, v27, v196, v196
  v_rcp_f32 v27, v27
  v_mul_f32 v90, v90, v26
  v_mul_f32 v93, v29, v93
  v_mul_f32 v29, v29, v204
  s_waitcnt lgkmcnt(6)
  v_mfma_f32_32x32x16_bf16 v[36:51], a[216:219], v[164:167], v[36:51]
  ds_read2st64_b32 v[148:149], v177 offset0:240 offset1:242
  v_exp_f32 v29, v29
  v_fma_f32 v28, v28, v196, v196
  v_rcp_f32 v28, v28
  v_mfma_f32_32x32x16_bf16 v[100:115], a[220:223], v[164:167], v[100:115]
  ds_read2st64_b32 v[150:151], v177 offset0:248 offset1:250
  v_mul_f32 v91, v91, v27
  v_cvt_pk_bf16_f32 v23, v90, v91
  buffer_store_dwordx4 v[20:23], v132, s[16:19], s37 offen sc0 sc1
  v_mul_f32 v94, v30, v94
  v_mul_f32 v30, v30, v204
  v_exp_f32 v30, v30
  v_fma_f32 v29, v29, v196, v196
  s_waitcnt lgkmcnt(6)
  v_mfma_f32_32x32x16_bf16 v[36:51], a[224:227], v[136:139], v[36:51]
  ds_read2st64_b32 v[152:153], v178 offset0:64 offset1:66
  v_rcp_f32 v29, v29
  v_mul_f32 v92, v92, v28
  v_mul_f32 v95, v31, v95
  v_mul_f32 v31, v31, v204
  v_exp_f32 v31, v31
  v_mfma_f32_32x32x16_bf16 v[100:115], a[228:231], v[136:139], v[100:115]
  ds_read2st64_b32 v[154:155], v178 offset0:72 offset1:74
  v_fma_f32 v30, v30, v196, v196
  v_rcp_f32 v30, v30
  v_mul_f32 v93, v93, v29
  v_cvt_pk_bf16_f32 v24, v92, v93
  v_mul_f32 v96, v32, v96
  s_waitcnt lgkmcnt(6)
  v_mfma_f32_32x32x16_bf16 v[36:51], a[232:235], v[140:143], v[36:51]
  ds_read2st64_b32 v[156:157], v178 offset0:80 offset1:82
  v_mul_f32 v32, v32, v204
  v_exp_f32 v32, v32
  v_fma_f32 v31, v31, v196, v196
  v_rcp_f32 v31, v31
  v_mfma_f32_32x32x16_bf16 v[100:115], a[236:239], v[140:143], v[100:115]
  ds_read2st64_b32 v[158:159], v178 offset0:88 offset1:90
  v_mul_f32 v94, v94, v30
  v_mul_f32 v97, v33, v97
  v_mul_f32 v33, v33, v204
  v_exp_f32 v33, v33
  v_fma_f32 v32, v32, v196, v196
  s_waitcnt lgkmcnt(6)
  v_mfma_f32_32x32x16_bf16 v[36:51], a[240:243], v[144:147], v[36:51]
  ds_read2st64_b32 v[160:161], v178 offset0:96 offset1:98
  v_rcp_f32 v32, v32
  v_mul_f32 v95, v95, v31
  v_cvt_pk_bf16_f32 v25, v94, v95
  v_mul_f32 v98, v34, v98
  v_mul_f32 v34, v34, v204
  v_exp_f32 v34, v34
  v_mfma_f32_32x32x16_bf16 v[100:115], a[244:247], v[144:147], v[100:115]
  ds_read2st64_b32 v[162:163], v178 offset0:104 offset1:106
  v_fma_f32 v33, v33, v196, v196
  v_rcp_f32 v33, v33
  v_mul_f32 v96, v96, v32
  v_mul_f32 v99, v35, v99
  v_mul_f32 v35, v35, v204
  s_waitcnt lgkmcnt(6)
  v_mfma_f32_32x32x16_bf16 v[36:51], a[248:251], v[148:151], v[36:51]
  ds_read2st64_b32 v[164:165], v178 offset0:112 offset1:114
  v_exp_f32 v35, v35
  v_fma_f32 v34, v34, v196, v196
  v_rcp_f32 v34, v34
  v_mul_f32 v97, v97, v33
  v_mfma_f32_32x32x16_bf16 v[100:115], a[252:255], v[148:151], v[100:115]
  ds_read2st64_b32 v[166:167], v178 offset0:120 offset1:122
  v_cvt_pk_bf16_f32 v26, v96, v97
  v_fma_f32 v35, v35, v196, v196
  v_rcp_f32 v35, v35
  v_mul_f32 v98, v98, v34
  v_mul_f32 v99, v99, v35
  v_cvt_pk_bf16_f32 v27, v98, v99
  buffer_store_dwordx4 v[24:27], v132, s[16:19], s37 offen offset:1024 sc0 sc1
  s_waitcnt lgkmcnt(6)
  v_mfma_f32_32x32x16_bf16 v[52:67], a[160:163], v[152:155], v[52:67]
  ds_read2st64_b32 v[136:137], v178 offset0:128 offset1:130
  v_mfma_f32_32x32x16_bf16 v[116:131], a[164:167], v[152:155], v[116:131]
  ds_read2st64_b32 v[138:139], v178 offset0:136 offset1:138
  s_waitcnt lgkmcnt(6)
  v_mfma_f32_32x32x16_bf16 v[52:67], a[168:171], v[156:159], v[52:67]
  ds_read2st64_b32 v[140:141], v178 offset0:144 offset1:146
  v_mfma_f32_32x32x16_bf16 v[116:131], a[172:175], v[156:159], v[116:131]
  ds_read2st64_b32 v[142:143], v178 offset0:152 offset1:154
  v_mul_f32 v100, v36, v100
  v_mul_f32 v36, v36, v206
  v_exp_f32 v36, v36
  v_mul_f32 v101, v37, v101
  v_mul_f32 v37, v37, v206
  s_waitcnt lgkmcnt(6)
  v_mfma_f32_32x32x16_bf16 v[52:67], a[176:179], v[160:163], v[52:67]
  ds_read2st64_b32 v[144:145], v178 offset0:160 offset1:162
  v_exp_f32 v37, v37
  v_fma_f32 v36, v36, v198, v198
  v_rcp_f32 v36, v36
  v_mul_f32 v102, v38, v102
  v_mul_f32 v38, v38, v206
  v_mfma_f32_32x32x16_bf16 v[116:131], a[180:183], v[160:163], v[116:131]
  ds_read2st64_b32 v[146:147], v178 offset0:168 offset1:170
  v_exp_f32 v38, v38
  v_fma_f32 v37, v37, v198, v198
  v_rcp_f32 v37, v37
  v_mul_f32 v100, v100, v36
  s_waitcnt lgkmcnt(6)
  v_mfma_f32_32x32x16_bf16 v[52:67], a[184:187], v[164:167], v[52:67]
  ds_read2st64_b32 v[148:149], v178 offset0:176 offset1:178
  v_mul_f32 v103, v39, v103
  v_mul_f32 v39, v39, v206
  v_exp_f32 v39, v39
  v_fma_f32 v38, v38, v198, v198
  v_rcp_f32 v38, v38
  v_mfma_f32_32x32x16_bf16 v[116:131], a[188:191], v[164:167], v[116:131]
  ds_read2st64_b32 v[150:151], v178 offset0:184 offset1:186
  v_mul_f32 v101, v101, v37
  v_cvt_pk_bf16_f32 v36, v100, v101
  v_mul_f32 v104, v40, v104
  v_mul_f32 v40, v40, v206
  v_exp_f32 v40, v40
  s_waitcnt lgkmcnt(6)
  v_mfma_f32_32x32x16_bf16 v[52:67], a[192:195], v[136:139], v[52:67]
  ds_read2st64_b32 v[152:153], v178 offset0:192 offset1:194
  v_fma_f32 v39, v39, v198, v198
  v_rcp_f32 v39, v39
  v_mul_f32 v102, v102, v38
  v_mul_f32 v105, v41, v105
  v_mul_f32 v41, v41, v206
  v_mfma_f32_32x32x16_bf16 v[116:131], a[196:199], v[136:139], v[116:131]
  ds_read2st64_b32 v[154:155], v178 offset0:200 offset1:202
  v_exp_f32 v41, v41
  v_fma_f32 v40, v40, v198, v198
  v_rcp_f32 v40, v40
  v_mul_f32 v103, v103, v39
  v_cvt_pk_bf16_f32 v37, v102, v103
  s_waitcnt lgkmcnt(6)
  v_mfma_f32_32x32x16_bf16 v[52:67], a[200:203], v[140:143], v[52:67]
  ds_read2st64_b32 v[156:157], v178 offset0:208 offset1:210
  v_mul_f32 v106, v42, v106
  v_mul_f32 v42, v42, v206
  v_exp_f32 v42, v42
  v_fma_f32 v41, v41, v198, v198
  v_rcp_f32 v41, v41
  v_mfma_f32_32x32x16_bf16 v[116:131], a[204:207], v[140:143], v[116:131]
  ds_read2st64_b32 v[158:159], v178 offset0:216 offset1:218
  v_mul_f32 v104, v104, v40
  v_mul_f32 v107, v43, v107
  v_mul_f32 v43, v43, v206
  v_exp_f32 v43, v43
  v_fma_f32 v42, v42, v198, v198
  s_waitcnt lgkmcnt(6)
  v_mfma_f32_32x32x16_bf16 v[52:67], a[208:211], v[144:147], v[52:67]
  ds_read2st64_b32 v[160:161], v178 offset0:224 offset1:226
  v_rcp_f32 v42, v42
  v_mul_f32 v105, v105, v41
  v_cvt_pk_bf16_f32 v38, v104, v105
  v_mul_f32 v108, v44, v108
  v_mul_f32 v44, v44, v206
  v_exp_f32 v44, v44
  v_mfma_f32_32x32x16_bf16 v[116:131], a[212:215], v[144:147], v[116:131]
  ds_read2st64_b32 v[162:163], v178 offset0:232 offset1:234
  v_fma_f32 v43, v43, v198, v198
  v_rcp_f32 v43, v43
  v_mul_f32 v106, v106, v42
  v_mul_f32 v109, v45, v109
  v_mul_f32 v45, v45, v206
  s_waitcnt lgkmcnt(6)
  v_mfma_f32_32x32x16_bf16 v[52:67], a[216:219], v[148:151], v[52:67]
  ds_read2st64_b32 v[164:165], v178 offset0:240 offset1:242
  v_exp_f32 v45, v45
  v_fma_f32 v44, v44, v198, v198
  v_rcp_f32 v44, v44
  v_mfma_f32_32x32x16_bf16 v[116:131], a[220:223], v[148:151], v[116:131]
  ds_read2st64_b32 v[166:167], v178 offset0:248 offset1:250
  v_mul_f32 v107, v107, v43
  v_cvt_pk_bf16_f32 v39, v106, v107
  buffer_store_dwordx4 v[36:39], v132, s[16:19], s38 offen sc0 sc1
  v_mul_f32 v110, v46, v110
  v_mul_f32 v46, v46, v206
  v_exp_f32 v46, v46
  v_fma_f32 v45, v45, v198, v198
  s_waitcnt lgkmcnt(6)
  v_mfma_f32_32x32x16_bf16 v[52:67], a[224:227], v[152:155], v[52:67]
  v_rcp_f32 v45, v45
  v_mul_f32 v108, v108, v44
  v_mul_f32 v111, v47, v111
  v_mul_f32 v47, v47, v206
  v_exp_f32 v47, v47
  v_mfma_f32_32x32x16_bf16 v[116:131], a[228:231], v[152:155], v[116:131]
  v_fma_f32 v46, v46, v198, v198
  v_rcp_f32 v46, v46
  v_mul_f32 v109, v109, v45
  v_cvt_pk_bf16_f32 v40, v108, v109
  v_mul_f32 v112, v48, v112
  s_waitcnt lgkmcnt(4)
  v_mfma_f32_32x32x16_bf16 v[52:67], a[232:235], v[156:159], v[52:67]
  v_mul_f32 v48, v48, v206
  v_exp_f32 v48, v48
  v_fma_f32 v47, v47, v198, v198
  v_rcp_f32 v47, v47
  v_mfma_f32_32x32x16_bf16 v[116:131], a[236:239], v[156:159], v[116:131]
  v_mul_f32 v110, v110, v46
  v_mul_f32 v113, v49, v113
  v_mul_f32 v49, v49, v206
  v_exp_f32 v49, v49
  v_fma_f32 v48, v48, v198, v198
  s_waitcnt lgkmcnt(2)
  v_mfma_f32_32x32x16_bf16 v[52:67], a[240:243], v[160:163], v[52:67]
  v_rcp_f32 v48, v48
  v_mul_f32 v111, v111, v47
  v_cvt_pk_bf16_f32 v41, v110, v111
  v_mul_f32 v114, v50, v114
  v_mul_f32 v50, v50, v206
  v_exp_f32 v50, v50
  v_mfma_f32_32x32x16_bf16 v[116:131], a[244:247], v[160:163], v[116:131]
  v_fma_f32 v49, v49, v198, v198
  v_rcp_f32 v49, v49
  v_mul_f32 v112, v112, v48
  v_mul_f32 v115, v51, v115
  v_mul_f32 v51, v51, v206
  s_waitcnt lgkmcnt(0)
  v_mfma_f32_32x32x16_bf16 v[52:67], a[248:251], v[164:167], v[52:67]
  v_exp_f32 v51, v51
  v_fma_f32 v50, v50, v198, v198
  v_rcp_f32 v50, v50
  v_mul_f32 v113, v113, v49
  v_mfma_f32_32x32x16_bf16 v[116:131], a[252:255], v[164:167], v[116:131]
  v_cvt_pk_bf16_f32 v42, v112, v113
  v_fma_f32 v51, v51, v198, v198
  v_rcp_f32 v51, v51
  v_mul_f32 v114, v114, v50
  v_mul_f32 v115, v115, v51
  v_cvt_pk_bf16_f32 v43, v114, v115
  buffer_store_dwordx4 v[40:43], v132, s[16:19], s38 offen offset:1024 sc0 sc1
  s_nop 4
  v_mul_f32 v116, v52, v116
  v_mul_f32 v52, v52, v208
  v_exp_f32 v52, v52
  v_mul_f32 v117, v53, v117
  v_mul_f32 v53, v53, v208
  v_exp_f32 v53, v53
  v_fma_f32 v52, v52, v200, v200
  v_rcp_f32 v52, v52
  v_mul_f32 v118, v54, v118
  v_mul_f32 v54, v54, v208
  v_exp_f32 v54, v54
  v_fma_f32 v53, v53, v200, v200
  v_rcp_f32 v53, v53
  v_mul_f32 v116, v116, v52
  v_mul_f32 v119, v55, v119
  v_mul_f32 v55, v55, v208
  v_exp_f32 v55, v55
  v_fma_f32 v54, v54, v200, v200
  v_rcp_f32 v54, v54
  v_mul_f32 v117, v117, v53
  v_cvt_pk_bf16_f32 v52, v116, v117
  v_mul_f32 v120, v56, v120
  v_mul_f32 v56, v56, v208
  v_exp_f32 v56, v56
  v_fma_f32 v55, v55, v200, v200
  v_rcp_f32 v55, v55
  v_mul_f32 v118, v118, v54
  v_mul_f32 v121, v57, v121
  v_mul_f32 v57, v57, v208
  v_exp_f32 v57, v57
  v_fma_f32 v56, v56, v200, v200
  v_rcp_f32 v56, v56
  v_mul_f32 v119, v119, v55
  v_cvt_pk_bf16_f32 v53, v118, v119
  v_mul_f32 v122, v58, v122
  v_mul_f32 v58, v58, v208
  v_exp_f32 v58, v58
  v_fma_f32 v57, v57, v200, v200
  v_rcp_f32 v57, v57
  v_mul_f32 v120, v120, v56
  v_mul_f32 v123, v59, v123
  v_mul_f32 v59, v59, v208
  v_exp_f32 v59, v59
  v_fma_f32 v58, v58, v200, v200
  v_rcp_f32 v58, v58
  v_mul_f32 v121, v121, v57
  v_cvt_pk_bf16_f32 v54, v120, v121
  v_mul_f32 v124, v60, v124
  v_mul_f32 v60, v60, v208
  v_exp_f32 v60, v60
  v_fma_f32 v59, v59, v200, v200
  v_rcp_f32 v59, v59
  v_mul_f32 v122, v122, v58
  v_mul_f32 v125, v61, v125
  v_mul_f32 v61, v61, v208
  v_exp_f32 v61, v61
  v_fma_f32 v60, v60, v200, v200
  v_rcp_f32 v60, v60
  v_mul_f32 v123, v123, v59
  v_cvt_pk_bf16_f32 v55, v122, v123
  buffer_store_dwordx4 v[52:55], v132, s[16:19], s39 offen sc0 sc1
  v_mul_f32 v126, v62, v126
  v_mul_f32 v62, v62, v208
  v_exp_f32 v62, v62
  v_fma_f32 v61, v61, v200, v200
  v_rcp_f32 v61, v61
  v_mul_f32 v124, v124, v60
  v_mul_f32 v127, v63, v127
  v_mul_f32 v63, v63, v208
  v_exp_f32 v63, v63
  v_fma_f32 v62, v62, v200, v200
  v_rcp_f32 v62, v62
  v_mul_f32 v125, v125, v61
  v_cvt_pk_bf16_f32 v56, v124, v125
  v_mul_f32 v128, v64, v128
  v_mul_f32 v64, v64, v208
  v_exp_f32 v64, v64
  v_fma_f32 v63, v63, v200, v200
  v_rcp_f32 v63, v63
  v_mul_f32 v126, v126, v62
  v_mul_f32 v129, v65, v129
  v_mul_f32 v65, v65, v208
  v_exp_f32 v65, v65
  v_fma_f32 v64, v64, v200, v200
  v_rcp_f32 v64, v64
  v_mul_f32 v127, v127, v63
  v_cvt_pk_bf16_f32 v57, v126, v127
  v_mul_f32 v130, v66, v130
  v_mul_f32 v66, v66, v208
  v_exp_f32 v66, v66
  v_fma_f32 v65, v65, v200, v200
  v_rcp_f32 v65, v65
  v_mul_f32 v128, v128, v64
  v_mul_f32 v131, v67, v131
  v_mul_f32 v67, v67, v208
  v_exp_f32 v67, v67
  v_fma_f32 v66, v66, v200, v200
  v_rcp_f32 v66, v66
  v_mul_f32 v129, v129, v65
  v_cvt_pk_bf16_f32 v58, v128, v129
  v_fma_f32 v67, v67, v200, v200
  v_rcp_f32 v67, v67
  v_mul_f32 v130, v130, v66
  v_mul_f32 v131, v131, v67
  v_cvt_pk_bf16_f32 v59, v130, v131
  buffer_store_dwordx4 v[56:59], v132, s[16:19], s39 offen offset:1024 sc0 sc1
  s_endpgm
gs12:
  s_load_dwordx2 s[6:7], s[0:1], 48
  s_getpc_b64 s[96:97]
pf14:
  s_mov_b32 s98, text_end-pf14
  s_mov_b32 s99, 0x20000
  v_lshlrev_b32 v2, 6, v0
  buffer_load_dword v3, v2, s[96:99], 0 offen
  s_sub_u32 s20, s2, 224
  s_lshr_b32 s22, s20, 1
  s_and_b32 s23, s20, 1
  s_getpc_b64 s[34:35]
  s_add_u32 s34, s34, RF@rel32@lo+4
  s_addc_u32 s35, s35, RF@rel32@hi+12
  s_mov_b32 s8, s34
  s_mov_b32 s9, s35
  s_mov_b32 s10, 0x80000
  s_mov_b32 s11, 0x20000
  s_waitcnt lgkmcnt(0)
  s_mov_b32 s12, s6
  s_mov_b32 s13, s7
  s_mov_b32 s14, 0x1c0000
  s_mov_b32 s15, 0x20000
  s_add_u32 s16, s4, 0xc00000
  s_addc_u32 s17, s5, 0
  s_mov_b32 s18, 0x1c0000
  s_mov_b32 s19, 0x20000
  s_lshl_b32 s24, s22, 7
  s_lshl_b32 s25, s3, 5
  s_add_u32 s24, s24, s25
  s_lshl_b32 s24, s24, 10
  s_lshl_b32 s25, s23, 3
  s_lshl_b32 s26, s3, 1
  s_add_u32 s25, s25, s26
  s_lshl_b32 s26, s25, 15
  s_add_u32 s27, s26, 32768
  s_mul_i32 s30, s25, 114688
  s_lshl_b32 s31, s22, 13
  s_add_u32 s30, s30, s31
  s_add_u32 s36, s30, 0
  s_add_u32 s37, s30, 2048
  s_add_u32 s38, s30, 4096
  s_add_u32 s39, s30, 6144
  s_add_u32 s40, s30, 114688
  s_add_u32 s41, s30, 116736
  s_add_u32 s42, s30, 118784
  s_add_u32 s43, s30, 120832
  s_lshr_b32 s50, s20, 3
  s_lshl_b32 s50, s50, 1
  s_and_b32 s50, s50, 7
  v_and_b32 v135, 63, v0
  v_lshlrev_b32 v132, 4, v135
  v_and_b32 v133, 31, v135
  v_lshrrev_b32 v134, 5, v135
  v_lshrrev_b32 v168, 4, v135
  v_xor_b32 v168, v168, v135
  v_and_b32 v168, 7, v168
  v_lshlrev_b32 v168, 4, v168
  v_lshrrev_b32 v169, 3, v135
  v_lshl_or_b32 v170, v169, 10, v168
  v_lshrrev_b32 v168, 4, v135
  v_add_u32 v168, 4, v168
  v_xor_b32 v168, v168, v135
  v_and_b32 v168, 7, v168
  v_lshlrev_b32 v168, 4, v168
  v_lshrrev_b32 v169, 3, v135
  v_lshl_or_b32 v171, v169, 10, v168
  s_lshl_b32 s28, s3, 12
  s_add_u32 m0, s28, 0
  s_add_u32 s29, s24, 0
  buffer_load_dwordx4 v170, s[12:15], s29 offen lds
  s_add_u32 m0, s28, 1024
  s_add_u32 s29, s24, 8192
  buffer_load_dwordx4 v171, s[12:15], s29 offen lds
  s_add_u32 m0, s28, 2048
  s_add_u32 s29, s24, 16384
  buffer_load_dwordx4 v170, s[12:15], s29 offen lds
  s_add_u32 m0, s28, 3072
  s_add_u32 s29, s24, 24576
  buffer_load_dwordx4 v171, s[12:15], s29 offen lds
  buffer_load_dwordx4 a[0:3], v132, s[8:11], s26 offen offset:0
  buffer_load_dwordx4 a[4:7], v132, s[8:11], s27 offen offset:0
  buffer_load_dwordx4 a[8:11], v132, s[8:11], s26 offen offset:1024
  buffer_load_dwordx4 a[12:15], v132, s[8:11], s27 offen offset:1024
  buffer_load_dwordx4 a[16:19], v132, s[8:11], s26 offen offset:2048
  buffer_load_dwordx4 a[20:23], v132, s[8:11], s27 offen offset:2048
  s_add_u32 m0, s28, 16384
  s_add_u32 s29, s24, 128
  buffer_load_dwordx4 v170, s[12:15], s29 offen lds
  s_add_u32 m0, s28, 17408
  s_add_u32 s29, s24, 8320
  buffer_load_dwordx4 v171, s[12:15], s29 offen lds
  v_lshrrev_b32 v168, 1, v133
  v_and_b32 v168, 7, v168
  v_xor_b32 v168, v168, v134
  v_xor_b32 v169, 0, v168
  v_lshlrev_b32 v169, 4, v169
  v_lshl_or_b32 v172, v133, 7, v169
  v_add_u32 v176, 0x10000, v172
  v_xor_b32 v169, 2, v168
  v_lshlrev_b32 v169, 4, v169
  v_lshl_or_b32 v173, v133, 7, v169
  v_add_u32 v177, 0x10000, v173
  v_xor_b32 v169, 4, v168
  v_lshlrev_b32 v169, 4, v169
  v_lshl_or_b32 v174, v133, 7, v169
  v_add_u32 v178, 0x10000, v174
  v_xor_b32 v169, 6, v168
  v_lshlrev_b32 v169, 4, v169
  v_lshl_or_b32 v175, v133, 7, v169
  v_add_u32 v179, 0x10000, v175
  s_waitcnt vmcnt(8)
  s_barrier
  ds_read_b128 v[136:139], v172 offset:0
  ds_read_b128 v[140:143], v172 offset:4096
  ds_read_b128 v[144:147], v172 offset:8192
  ds_read_b128 v[148:151], v172 offset:12288
  s_waitcnt vmcnt(7) lgkmcnt(3)
  v_mfma_f32_32x32x16_bf16 v[4:19], v[136:139], a[0:3], 0
  ds_read_b128 v[152:155], v173 offset:0
  s_waitcnt vmcnt(6)
  v_mfma_f32_32x32x16_bf16 v[68:83], v[136:139], a[4:7], 0
  ds_read_b128 v[156:159], v173 offset:4096
  s_add_u32 m0, s28, 18432
  s_add_u32 s29, s24, 16512
  buffer_load_dwordx4 v170, s[12:15], s29 offen lds
  s_waitcnt lgkmcnt(4)
  v_mfma_f32_32x32x16_bf16 v[20:35], v[140:143], a[0:3], 0
  v_mfma_f32_32x32x16_bf16 v[84:99], v[140:143], a[4:7], 0
  ds_read_b128 v[160:163], v173 offset:8192
  s_add_u32 m0, s28, 19456
  s_add_u32 s29, s24, 24704
  buffer_load_dwordx4 v171, s[12:15], s29 offen lds
  s_waitcnt lgkmcnt(4)
  v_mfma_f32_32x32x16_bf16 v[36:51], v[144:147], a[0:3], 0
  v_mfma_f32_32x32x16_bf16 v[100:115], v[144:147], a[4:7], 0
  ds_read_b128 v[164:167], v173 offset:12288
  buffer_load_dwordx4 a[24:27], v132, s[8:11], s26 offen offset:3072
  s_waitcnt lgkmcnt(4)
  v_mfma_f32_32x32x16_bf16 v[52:67], v[148:151], a[0:3], 0
  v_mfma_f32_32x32x16_bf16 v[116:131], v[148:151], a[4:7], 0
  buffer_load_dwordx4 a[28:31], v132, s[8:11], s27 offen offset:3072
  s_waitcnt vmcnt(9) lgkmcnt(3)
  v_mfma_f32_32x32x16_bf16 v[4:19], v[152:155], a[8:11], v[4:19]
  ds_read_b128 v[136:139], v174 offset:0
  s_waitcnt vmcnt(8)
  v_mfma_f32_32x32x16_bf16 v[68:83], v[152:155], a[12:15], v[68:83]
  ds_read_b128 v[140:143], v174 offset:4096
  s_add_u32 s26, s26, 4096
  buffer_load_dwordx4 a[32:35], v132, s[8:11], s26 offen offset:0
  s_waitcnt lgkmcnt(4)
  v_mfma_f32_32x32x16_bf16 v[20:35], v[156:159], a[8:11], v[20:35]
  v_mfma_f32_32x32x16_bf16 v[84:99], v[156:159], a[12:15], v[84:99]
  ds_read_b128 v[144:147], v174 offset:8192
  s_add_u32 s27, s27, 4096
  buffer_load_dwordx4 a[36:39], v132, s[8:11], s27 offen offset:0
  s_waitcnt lgkmcnt(4)
  v_mfma_f32_32x32x16_bf16 v[36:51], v[160:163], a[8:11], v[36:51]
  v_mfma_f32_32x32x16_bf16 v[100:115], v[160:163], a[12:15], v[100:115]
  ds_read_b128 v[148:151], v174 offset:12288
  buffer_load_dwordx4 a[40:43], v132, s[8:11], s26 offen offset:1024
  s_waitcnt lgkmcnt(4)
  v_mfma_f32_32x32x16_bf16 v[52:67], v[164:167], a[8:11], v[52:67]
  v_mfma_f32_32x32x16_bf16 v[116:131], v[164:167], a[12:15], v[116:131]
  buffer_load_dwordx4 a[44:47], v132, s[8:11], s27 offen offset:1024
  s_waitcnt vmcnt(11) lgkmcnt(3)
  v_mfma_f32_32x32x16_bf16 v[4:19], v[136:139], a[16:19], v[4:19]
  ds_read_b128 v[152:155], v175 offset:0
  s_waitcnt vmcnt(10)
  v_mfma_f32_32x32x16_bf16 v[68:83], v[136:139], a[20:23], v[68:83]
  ds_read_b128 v[156:159], v175 offset:4096
  buffer_load_dwordx4 a[48:51], v132, s[8:11], s26 offen offset:2048
  s_waitcnt lgkmcnt(4)
  v_mfma_f32_32x32x16_bf16 v[20:35], v[140:143], a[16:19], v[20:35]
  v_mfma_f32_32x32x16_bf16 v[84:99], v[140:143], a[20:23], v[84:99]
  ds_read_b128 v[160:163], v175 offset:8192
  buffer_load_dwordx4 a[52:55], v132, s[8:11], s27 offen offset:2048
  s_waitcnt lgkmcnt(4)
  v_mfma_f32_32x32x16_bf16 v[36:51], v[144:147], a[16:19], v[36:51]
  v_mfma_f32_32x32x16_bf16 v[100:115], v[144:147], a[20:23], v[100:115]
  ds_read_b128 v[164:167], v175 offset:12288
  s_add_u32 m0, s28, 32768
  s_add_u32 s29, s24, 256
  buffer_load_dwordx4 v170, s[12:15], s29 offen lds
  s_waitcnt lgkmcnt(4)
  v_mfma_f32_32x32x16_bf16 v[52:67], v[148:151], a[16:19], v[52:67]
  v_mfma_f32_32x32x16_bf16 v[116:131], v[148:151], a[20:23], v[116:131]
  s_add_u32 m0, s28, 33792
  s_add_u32 s29, s24, 8448
  buffer_load_dwordx4 v171, s[12:15], s29 offen lds
  s_waitcnt vmcnt(10)
  s_barrier
  s_waitcnt vmcnt(9) lgkmcnt(3)
  v_mfma_f32_32x32x16_bf16 v[4:19], v[152:155], a[24:27], v[4:19]
  ds_read_b128 v[136:139], v172 offset:16384
  s_waitcnt vmcnt(8)
  v_mfma_f32_32x32x16_bf16 v[68:83], v[152:155], a[28:31], v[68:83]
  ds_read_b128 v[140:143], v172 offset:20480
  s_add_u32 m0, s28, 34816
  s_add_u32 s29, s24, 16640
  buffer_load_dwordx4 v170, s[12:15], s29 offen lds
  s_waitcnt lgkmcnt(4)
  v_mfma_f32_32x32x16_bf16 v[20:35], v[156:159], a[24:27], v[20:35]
  v_mfma_f32_32x32x16_bf16 v[84:99], v[156:159], a[28:31], v[84:99]
  ds_read_b128 v[144:147], v172 offset:24576
  s_add_u32 m0, s28, 35840
  s_add_u32 s29, s24, 24832
  buffer_load_dwordx4 v171, s[12:15], s29 offen lds
  s_waitcnt lgkmcnt(4)
  v_mfma_f32_32x32x16_bf16 v[36:51], v[160:163], a[24:27], v[36:51]
  v_mfma_f32_32x32x16_bf16 v[100:115], v[160:163], a[28:31], v[100:115]
  ds_read_b128 v[148:151], v172 offset:28672
  buffer_load_dwordx4 a[56:59], v132, s[8:11], s26 offen offset:3072
  s_waitcnt lgkmcnt(4)
  v_mfma_f32_32x32x16_bf16 v[52:67], v[164:167], a[24:27], v[52:67]
  v_mfma_f32_32x32x16_bf16 v[116:131], v[164:167], a[28:31], v[116:131]
  buffer_load_dwordx4 a[60:63], v132, s[8:11], s27 offen offset:3072
  s_waitcnt vmcnt(11) lgkmcnt(3)
  v_mfma_f32_32x32x16_bf16 v[4:19], v[136:139], a[32:35], v[4:19]
  ds_read_b128 v[152:155], v173 offset:16384
  s_waitcnt vmcnt(10)
  v_mfma_f32_32x32x16_bf16 v[68:83], v[136:139], a[36:39], v[68:83]
  ds_read_b128 v[156:159], v173 offset:20480
  s_add_u32 s26, s26, 4096
  buffer_load_dwordx4 a[64:67], v132, s[8:11], s26 offen offset:0
  s_waitcnt lgkmcnt(4)
  v_mfma_f32_32x32x16_bf16 v[20:35], v[140:143], a[32:35], v[20:35]
  v_mfma_f32_32x32x16_bf16 v[84:99], v[140:143], a[36:39], v[84:99]
  ds_read_b128 v[160:163], v173 offset:24576
  s_add_u32 s27, s27, 4096
  buffer_load_dwordx4 a[68:71], v132, s[8:11], s27 offen offset:0
  s_waitcnt lgkmcnt(4)
  v_mfma_f32_32x32x16_bf16 v[36:51], v[144:147], a[32:35], v[36:51]
  v_mfma_f32_32x32x16_bf16 v[100:115], v[144:147], a[36:39], v[100:115]
  ds_read_b128 v[164:167], v173 offset:28672
  buffer_load_dwordx4 a[72:75], v132, s[8:11], s26 offen offset:1024
  s_waitcnt lgkmcnt(4)
  v_mfma_f32_32x32x16_bf16 v[52:67], v[148:151], a[32:35], v[52:67]
  v_mfma_f32_32x32x16_bf16 v[116:131], v[148:151], a[36:39], v[116:131]
  buffer_load_dwordx4 a[76:79], v132, s[8:11], s27 offen offset:1024
  s_waitcnt vmcnt(13) lgkmcnt(3)
  v_mfma_f32_32x32x16_bf16 v[4:19], v[152:155], a[40:43], v[4:19]
  ds_read_b128 v[136:139], v174 offset:16384
  s_waitcnt vmcnt(12)
  v_mfma_f32_32x32x16_bf16 v[68:83], v[152:155], a[44:47], v[68:83]
  ds_read_b128 v[140:143], v174 offset:20480
  buffer_load_dwordx4 a[80:83], v132, s[8:11], s26 offen offset:2048
  s_waitcnt lgkmcnt(4)
  v_mfma_f32_32x32x16_bf16 v[20:35], v[156:159], a[40:43], v[20:35]
  v_mfma_f32_32x32x16_bf16 v[84:99], v[156:159], a[44:47], v[84:99]
  ds_read_b128 v[144:147], v174 offset:24576
  buffer_load_dwordx4 a[84:87], v132, s[8:11], s27 offen offset:2048
  s_waitcnt lgkmcnt(4)
  v_mfma_f32_32x32x16_bf16 v[36:51], v[160:163], a[40:43], v[36:51]
  v_mfma_f32_32x32x16_bf16 v[100:115], v[160:163], a[44:47], v[100:115]
  ds_read_b128 v[148:151], v174 offset:28672
  s_add_u32 m0, s28, 49152
  s_add_u32 s29, s24, 384
  buffer_load_dwordx4 v170, s[12:15], s29 offen lds
  s_waitcnt lgkmcnt(4)
  v_mfma_f32_32x32x16_bf16 v[52:67], v[164:167], a[40:43], v[52:67]
  v_mfma_f32_32x32x16_bf16 v[116:131], v[164:167], a[44:47], v[116:131]
  s_add_u32 m0, s28, 50176
  s_add_u32 s29, s24, 8576
  buffer_load_dwordx4 v171, s[12:15], s29 offen lds
  s_waitcnt vmcnt(15) lgkmcnt(3)
  v_mfma_f32_32x32x16_bf16 v[4:19], v[136:139], a[48:51], v[4:19]
  ds_read_b128 v[152:155], v175 offset:16384
  s_waitcnt vmcnt(14)
  v_mfma_f32_32x32x16_bf16 v[68:83], v[136:139], a[52:55], v[68:83]
  ds_read_b128 v[156:159], v175 offset:20480
  s_add_u32 m0, s28, 51200
  s_add_u32 s29, s24, 16768
  buffer_load_dwordx4 v170, s[12:15], s29 offen lds
  s_waitcnt lgkmcnt(4)
  v_mfma_f32_32x32x16_bf16 v[20:35], v[140:143], a[48:51], v[20:35]
  v_mfma_f32_32x32x16_bf16 v[84:99], v[140:143], a[52:55], v[84:99]
  ds_read_b128 v[160:163], v175 offset:24576
  s_add_u32 m0, s28, 52224
  s_add_u32 s29, s24, 24960
  buffer_load_dwordx4 v171, s[12:15], s29 offen lds
  s_waitcnt lgkmcnt(4)
  v_mfma_f32_32x32x16_bf16 v[36:51], v[144:147], a[48:51], v[36:51]
  v_mfma_f32_32x32x16_bf16 v[100:115], v[144:147], a[52:55], v[100:115]
  ds_read_b128 v[164:167], v175 offset:28672
  buffer_load_dwordx4 a[88:91], v132, s[8:11], s26 offen offset:3072
  s_waitcnt lgkmcnt(4)
  v_mfma_f32_32x32x16_bf16 v[52:67], v[148:151], a[48:51], v[52:67]
  v_mfma_f32_32x32x16_bf16 v[116:131], v[148:151], a[52:55], v[116:131]
  buffer_load_dwordx4 a[92:95], v132, s[8:11], s27 offen offset:3072
  s_waitcnt vmcnt(14)
  s_barrier
  s_waitcnt vmcnt(13) lgkmcnt(3)
  v_mfma_f32_32x32x16_bf16 v[4:19], v[152:155], a[56:59], v[4:19]
  ds_read_b128 v[136:139], v172 offset:32768
  s_waitcnt vmcnt(12)
  v_mfma_f32_32x32x16_bf16 v[68:83], v[152:155], a[60:63], v[68:83]
  ds_read_b128 v[140:143], v172 offset:36864
  s_add_u32 s26, s26, 4096
  buffer_load_dwordx4 a[96:99], v132, s[8:11], s26 offen offset:0
  s_waitcnt lgkmcnt(4)
  v_mfma_f32_32x32x16_bf16 v[20:35], v[156:159], a[56:59], v[20:35]
  v_mfma_f32_32x32x16_bf16 v[84:99], v[156:159], a[60:63], v[84:99]
  ds_read_b128 v[144:147], v172 offset:40960
  s_add_u32 s27, s27, 4096
  buffer_load_dwordx4 a[100:103], v132, s[8:11], s27 offen offset:0
  s_waitcnt lgkmcnt(4)
  v_mfma_f32_32x32x16_bf16 v[36:51], v[160:163], a[56:59], v[36:51]
  v_mfma_f32_32x32x16_bf16 v[100:115], v[160:163], a[60:63], v[100:115]
  ds_read_b128 v[148:151], v172 offset:45056
  buffer_load_dwordx4 a[104:107], v132, s[8:11], s26 offen offset:1024
  s_waitcnt lgkmcnt(4)
  v_mfma_f32_32x32x16_bf16 v[52:67], v[164:167], a[56:59], v[52:67]
  v_mfma_f32_32x32x16_bf16 v[116:131], v[164:167], a[60:63], v[116:131]
  buffer_load_dwordx4 a[108:111], v132, s[8:11], s27 offen offset:1024
  s_waitcnt vmcnt(15) lgkmcnt(3)
  v_mfma_f32_32x32x16_bf16 v[4:19], v[136:139], a[64:67], v[4:19]
  ds_read_b128 v[152:155], v173 offset:32768
  s_waitcnt vmcnt(14)
  v_mfma_f32_32x32x16_bf16 v[68:83], v[136:139], a[68:71], v[68:83]
  ds_read_b128 v[156:159], v173 offset:36864
  buffer_load_dwordx4 a[112:115], v132, s[8:11], s26 offen offset:2048
  s_waitcnt lgkmcnt(4)
  v_mfma_f32_32x32x16_bf16 v[20:35], v[140:143], a[64:67], v[20:35]
  v_mfma_f32_32x32x16_bf16 v[84:99], v[140:143], a[68:71], v[84:99]
  ds_read_b128 v[160:163], v173 offset:40960
  buffer_load_dwordx4 a[116:119], v132, s[8:11], s27 offen offset:2048
  s_waitcnt lgkmcnt(4)
  v_mfma_f32_32x32x16_bf16 v[36:51], v[144:147], a[64:67], v[36:51]
  v_mfma_f32_32x32x16_bf16 v[100:115], v[144:147], a[68:71], v[100:115]
  ds_read_b128 v[164:167], v173 offset:45056
  s_add_u32 m0, s28, 65536
  s_add_u32 s29, s24, 512
  buffer_load_dwordx4 v170, s[12:15], s29 offen lds
  s_waitcnt lgkmcnt(4)
  v_mfma_f32_32x32x16_bf16 v[52:67], v[148:151], a[64:67], v[52:67]
  v_mfma_f32_32x32x16_bf16 v[116:131], v[148:151], a[68:71], v[116:131]
  s_add_u32 m0, s28, 66560
  s_add_u32 s29, s24, 8704
  buffer_load_dwordx4 v171, s[12:15], s29 offen lds
  s_waitcnt vmcnt(17) lgkmcnt(3)
  v_mfma_f32_32x32x16_bf16 v[4:19], v[152:155], a[72:75], v[4:19]
  ds_read_b128 v[136:139], v174 offset:32768
  s_waitcnt vmcnt(16)
  v_mfma_f32_32x32x16_bf16 v[68:83], v[152:155], a[76:79], v[68:83]
  ds_read_b128 v[140:143], v174 offset:36864
  s_add_u32 m0, s28, 67584
  s_add_u32 s29, s24, 16896
  buffer_load_dwordx4 v170, s[12:15], s29 offen lds
  s_waitcnt lgkmcnt(4)
  v_mfma_f32_32x32x16_bf16 v[20:35], v[156:159], a[72:75], v[20:35]
  v_mfma_f32_32x32x16_bf16 v[84:99], v[156:159], a[76:79], v[84:99]
  ds_read_b128 v[144:147], v174 offset:40960
  s_add_u32 m0, s28, 68608
  s_add_u32 s29, s24, 25088
  buffer_load_dwordx4 v171, s[12:15], s29 offen lds
  s_waitcnt lgkmcnt(4)
  v_mfma_f32_32x32x16_bf16 v[36:51], v[160:163], a[72:75], v[36:51]
  v_mfma_f32_32x32x16_bf16 v[100:115], v[160:163], a[76:79], v[100:115]
  ds_read_b128 v[148:151], v174 offset:45056
  buffer_load_dwordx4 a[120:123], v132, s[8:11], s26 offen offset:3072
  s_waitcnt lgkmcnt(4)
  v_mfma_f32_32x32x16_bf16 v[52:67], v[164:167], a[72:75], v[52:67]
  v_mfma_f32_32x32x16_bf16 v[116:131], v[164:167], a[76:79], v[116:131]
  buffer_load_dwordx4 a[124:127], v132, s[8:11], s27 offen offset:3072
  s_waitcnt vmcnt(19) lgkmcnt(3)
  v_mfma_f32_32x32x16_bf16 v[4:19], v[136:139], a[80:83], v[4:19]
  ds_read_b128 v[152:155], v175 offset:32768
  s_waitcnt vmcnt(18)
  v_mfma_f32_32x32x16_bf16 v[68:83], v[136:139], a[84:87], v[68:83]
  ds_read_b128 v[156:159], v175 offset:36864
  s_add_u32 s26, s26, 4096
  buffer_load_dwordx4 a[128:131], v132, s[8:11], s26 offen offset:0
  s_waitcnt lgkmcnt(4)
  v_mfma_f32_32x32x16_bf16 v[20:35], v[140:143], a[80:83], v[20:35]
  v_mfma_f32_32x32x16_bf16 v[84:99], v[140:143], a[84:87], v[84:99]
  ds_read_b128 v[160:163], v175 offset:40960
  s_add_u32 s27, s27, 4096
  buffer_load_dwordx4 a[132:135], v132, s[8:11], s27 offen offset:0
  s_waitcnt lgkmcnt(4)
  v_mfma_f32_32x32x16_bf16 v[36:51], v[144:147], a[80:83], v[36:51]
  v_mfma_f32_32x32x16_bf16 v[100:115], v[144:147], a[84:87], v[100:115]
  ds_read_b128 v[164:167], v175 offset:45056
  buffer_load_dwordx4 a[136:139], v132, s[8:11], s26 offen offset:1024
  s_waitcnt lgkmcnt(4)
  v_mfma_f32_32x32x16_bf16 v[52:67], v[148:151], a[80:83], v[52:67]
  v_mfma_f32_32x32x16_bf16 v[116:131], v[148:151], a[84:87], v[116:131]
  buffer_load_dwordx4 a[140:143], v132, s[8:11], s27 offen offset:1024
  s_waitcnt vmcnt(18)
  s_barrier
  s_waitcnt vmcnt(17) lgkmcnt(3)
  v_mfma_f32_32x32x16_bf16 v[4:19], v[152:155], a[88:91], v[4:19]
  ds_read_b128 v[136:139], v172 offset:49152
  s_waitcnt vmcnt(16)
  v_mfma_f32_32x32x16_bf16 v[68:83], v[152:155], a[92:95], v[68:83]
  ds_read_b128 v[140:143], v172 offset:53248
  buffer_load_dwordx4 a[144:147], v132, s[8:11], s26 offen offset:2048
  s_waitcnt lgkmcnt(4)
  v_mfma_f32_32x32x16_bf16 v[20:35], v[156:159], a[88:91], v[20:35]
  v_mfma_f32_32x32x16_bf16 v[84:99], v[156:159], a[92:95], v[84:99]
  ds_read_b128 v[144:147], v172 offset:57344
  buffer_load_dwordx4 a[148:151], v132, s[8:11], s27 offen offset:2048
  s_waitcnt lgkmcnt(4)
  v_mfma_f32_32x32x16_bf16 v[36:51], v[160:163], a[88:91], v[36:51]
  v_mfma_f32_32x32x16_bf16 v[100:115], v[160:163], a[92:95], v[100:115]
  ds_read_b128 v[148:151], v172 offset:61440
  s_add_u32 m0, s28, 81920
  s_add_u32 s29, s24, 640
  buffer_load_dwordx4 v170, s[12:15], s29 offen lds
  s_waitcnt lgkmcnt(4)
  v_mfma_f32_32x32x16_bf16 v[52:67], v[164:167], a[88:91], v[52:67]
  v_mfma_f32_32x32x16_bf16 v[116:131], v[164:167], a[92:95], v[116:131]
  s_add_u32 m0, s28, 82944
  s_add_u32 s29, s24, 8832
  buffer_load_dwordx4 v171, s[12:15], s29 offen lds
  s_waitcnt vmcnt(19) lgkmcnt(3)
  v_mfma_f32_32x32x16_bf16 v[4:19], v[136:139], a[96:99], v[4:19]
  ds_read_b128 v[152:155], v173 offset:49152
  s_waitcnt vmcnt(18)
  v_mfma_f32_32x32x16_bf16 v[68:83], v[136:139], a[100:103], v[68:83]
  ds_read_b128 v[156:159], v173 offset:53248
  s_add_u32 m0, s28, 83968
  s_add_u32 s29, s24, 17024
  buffer_load_dwordx4 v170, s[12:15], s29 offen lds
  s_waitcnt lgkmcnt(4)
  v_mfma_f32_32x32x16_bf16 v[20:35], v[140:143], a[96:99], v[20:35]
  v_mfma_f32_32x32x16_bf16 v[84:99], v[140:143], a[100:103], v[84:99]
  ds_read_b128 v[160:163], v173 offset:57344
  s_add_u32 m0, s28, 84992
  s_add_u32 s29, s24, 25216
  buffer_load_dwordx4 v171, s[12:15], s29 offen lds
  s_waitcnt lgkmcnt(4)
  v_mfma_f32_32x32x16_bf16 v[36:51], v[144:147], a[96:99], v[36:51]
  v_mfma_f32_32x32x16_bf16 v[100:115], v[144:147], a[100:103], v[100:115]
  ds_read_b128 v[164:167], v173 offset:61440
  buffer_load_dwordx4 a[152:155], v132, s[8:11], s26 offen offset:3072
  s_waitcnt lgkmcnt(4)
  v_mfma_f32_32x32x16_bf16 v[52:67], v[148:151], a[96:99], v[52:67]
  v_mfma_f32_32x32x16_bf16 v[116:131], v[148:151], a[100:103], v[116:131]
  buffer_load_dwordx4 a[156:159], v132, s[8:11], s27 offen offset:3072
  s_waitcnt vmcnt(21) lgkmcnt(3)
  v_mfma_f32_32x32x16_bf16 v[4:19], v[152:155], a[104:107], v[4:19]
  ds_read_b128 v[136:139], v174 offset:49152
  s_waitcnt vmcnt(20)
  v_mfma_f32_32x32x16_bf16 v[68:83], v[152:155], a[108:111], v[68:83]
  ds_read_b128 v[140:143], v174 offset:53248
  s_add_u32 s26, s26, 4096
  buffer_load_dwordx4 a[160:163], v132, s[8:11], s26 offen offset:0
  s_waitcnt lgkmcnt(4)
  v_mfma_f32_32x32x16_bf16 v[20:35], v[156:159], a[104:107], v[20:35]
  v_mfma_f32_32x32x16_bf16 v[84:99], v[156:159], a[108:111], v[84:99]
  ds_read_b128 v[144:147], v174 offset:57344
  s_add_u32 s27, s27, 4096
  buffer_load_dwordx4 a[164:167], v132, s[8:11], s27 offen offset:0
  s_waitcnt lgkmcnt(4)
  v_mfma_f32_32x32x16_bf16 v[36:51], v[160:163], a[104:107], v[36:51]
  v_mfma_f32_32x32x16_bf16 v[100:115], v[160:163], a[108:111], v[100:115]
  ds_read_b128 v[148:151], v174 offset:61440
  buffer_load_dwordx4 a[168:171], v132, s[8:11], s26 offen offset:1024
  s_waitcnt lgkmcnt(4)
  v_mfma_f32_32x32x16_bf16 v[52:67], v[164:167], a[104:107], v[52:67]
  v_mfma_f32_32x32x16_bf16 v[116:131], v[164:167], a[108:111], v[116:131]
  buffer_load_dwordx4 a[172:175], v132, s[8:11], s27 offen offset:1024
  s_waitcnt vmcnt(23) lgkmcnt(3)
  v_mfma_f32_32x32x16_bf16 v[4:19], v[136:139], a[112:115], v[4:19]
  ds_read_b128 v[152:155], v175 offset:49152
  s_waitcnt vmcnt(22)
  v_mfma_f32_32x32x16_bf16 v[68:83], v[136:139], a[116:119], v[68:83]
  ds_read_b128 v[156:159], v175 offset:53248
  buffer_load_dwordx4 a[176:179], v132, s[8:11], s26 offen offset:2048
  s_waitcnt lgkmcnt(4)
  v_mfma_f32_32x32x16_bf16 v[20:35], v[140:143], a[112:115], v[20:35]
  v_mfma_f32_32x32x16_bf16 v[84:99], v[140:143], a[116:119], v[84:99]
  ds_read_b128 v[160:163], v175 offset:57344
  buffer_load_dwordx4 a[180:183], v132, s[8:11], s27 offen offset:2048
  s_waitcnt lgkmcnt(4)
  v_mfma_f32_32x32x16_bf16 v[36:51], v[144:147], a[112:115], v[36:51]
  v_mfma_f32_32x32x16_bf16 v[100:115], v[144:147], a[116:119], v[100:115]
  ds_read_b128 v[164:167], v175 offset:61440
  s_add_u32 m0, s28, 98304
  s_add_u32 s29, s24, 768
  buffer_load_dwordx4 v170, s[12:15], s29 offen lds
  s_waitcnt lgkmcnt(4)
  v_mfma_f32_32x32x16_bf16 v[52:67], v[148:151], a[112:115], v[52:67]
  v_mfma_f32_32x32x16_bf16 v[116:131], v[148:151], a[116:119], v[116:131]
  s_add_u32 m0, s28, 99328
  s_add_u32 s29, s24, 8960
  buffer_load_dwordx4 v171, s[12:15], s29 offen lds
  s_waitcnt vmcnt(22)
  s_barrier
  s_waitcnt vmcnt(21) lgkmcnt(3)
  v_mfma_f32_32x32x16_bf16 v[4:19], v[152:155], a[120:123], v[4:19]
  ds_read_b128 v[136:139], v176 offset:0
  s_waitcnt vmcnt(20)
  v_mfma_f32_32x32x16_bf16 v[68:83], v[152:155], a[124:127], v[68:83]
  ds_read_b128 v[140:143], v176 offset:4096
  s_add_u32 m0, s28, 100352
  s_add_u32 s29, s24, 17152
  buffer_load_dwordx4 v170, s[12:15], s29 offen lds
  s_waitcnt lgkmcnt(4)
  v_mfma_f32_32x32x16_bf16 v[20:35], v[156:159], a[120:123], v[20:35]
  v_mfma_f32_32x32x16_bf16 v[84:99], v[156:159], a[124:127], v[84:99]
  ds_read_b128 v[144:147], v176 offset:8192
  s_add_u32 m0, s28, 101376
  s_add_u32 s29, s24, 25344
  buffer_load_dwordx4 v171, s[12:15], s29 offen lds
  s_waitcnt lgkmcnt(4)
  v_mfma_f32_32x32x16_bf16 v[36:51], v[160:163], a[120:123], v[36:51]
  v_mfma_f32_32x32x16_bf16 v[100:115], v[160:163], a[124:127], v[100:115]
  ds_read_b128 v[148:151], v176 offset:12288
  buffer_load_dwordx4 a[184:187], v132, s[8:11], s26 offen offset:3072
  s_waitcnt lgkmcnt(4)
  v_mfma_f32_32x32x16_bf16 v[52:67], v[164:167], a[120:123], v[52:67]
  v_mfma_f32_32x32x16_bf16 v[116:131], v[164:167], a[124:127], v[116:131]
  buffer_load_dwordx4 a[188:191], v132, s[8:11], s27 offen offset:3072
  s_waitcnt vmcnt(23) lgkmcnt(3)
  v_mfma_f32_32x32x16_bf16 v[4:19], v[136:139], a[128:131], v[4:19]
  ds_read_b128 v[152:155], v177 offset:0
  s_waitcnt vmcnt(22)
  v_mfma_f32_32x32x16_bf16 v[68:83], v[136:139], a[132:135], v[68:83]
  ds_read_b128 v[156:159], v177 offset:4096
  s_add_u32 s26, s26, 4096
  buffer_load_dwordx4 a[192:195], v132, s[8:11], s26 offen offset:0
  s_waitcnt lgkmcnt(4)
  v_mfma_f32_32x32x16_bf16 v[20:35], v[140:143], a[128:131], v[20:35]
  v_mfma_f32_32x32x16_bf16 v[84:99], v[140:143], a[132:135], v[84:99]
  ds_read_b128 v[160:163], v177 offset:8192
  s_add_u32 s27, s27, 4096
  buffer_load_dwordx4 a[196:199], v132, s[8:11], s27 offen offset:0
  s_waitcnt lgkmcnt(4)
  v_mfma_f32_32x32x16_bf16 v[36:51], v[144:147], a[128:131], v[36:51]
  v_mfma_f32_32x32x16_bf16 v[100:115], v[144:147], a[132:135], v[100:115]
  ds_read_b128 v[164:167], v177 offset:12288
  buffer_load_dwordx4 a[200:203], v132, s[8:11], s26 offen offset:1024
  s_waitcnt lgkmcnt(4)
  v_mfma_f32_32x32x16_bf16 v[52:67], v[148:151], a[128:131], v[52:67]
  v_mfma_f32_32x32x16_bf16 v[116:131], v[148:151], a[132:135], v[116:131]
  buffer_load_dwordx4 a[204:207], v132, s[8:11], s27 offen offset:1024
  s_waitcnt vmcnt(25) lgkmcnt(3)
  v_mfma_f32_32x32x16_bf16 v[4:19], v[152:155], a[136:139], v[4:19]
  ds_read_b128 v[136:139], v178 offset:0
  s_waitcnt vmcnt(24)
  v_mfma_f32_32x32x16_bf16 v[68:83], v[152:155], a[140:143], v[68:83]
  ds_read_b128 v[140:143], v178 offset:4096
  buffer_load_dwordx4 a[208:211], v132, s[8:11], s26 offen offset:2048
  s_waitcnt lgkmcnt(4)
  v_mfma_f32_32x32x16_bf16 v[20:35], v[156:159], a[136:139], v[20:35]
  v_mfma_f32_32x32x16_bf16 v[84:99], v[156:159], a[140:143], v[84:99]
  ds_read_b128 v[144:147], v178 offset:8192
  buffer_load_dwordx4 a[212:215], v132, s[8:11], s27 offen offset:2048
  s_waitcnt lgkmcnt(4)
  v_mfma_f32_32x32x16_bf16 v[36:51], v[160:163], a[136:139], v[36:51]
  v_mfma_f32_32x32x16_bf16 v[100:115], v[160:163], a[140:143], v[100:115]
  ds_read_b128 v[148:151], v178 offset:12288
  s_add_u32 m0, s28, 114688
  s_add_u32 s29, s24, 896
  buffer_load_dwordx4 v170, s[12:15], s29 offen lds
  s_waitcnt lgkmcnt(4)
  v_mfma_f32_32x32x16_bf16 v[52:67], v[164:167], a[136:139], v[52:67]
  v_mfma_f32_32x32x16_bf16 v[116:131], v[164:167], a[140:143], v[116:131]
  s_add_u32 m0, s28, 115712
  s_add_u32 s29, s24, 9088
  buffer_load_dwordx4 v171, s[12:15], s29 offen lds
  s_waitcnt vmcnt(27) lgkmcnt(3)
  v_mfma_f32_32x32x16_bf16 v[4:19], v[136:139], a[144:147], v[4:19]
  ds_read_b128 v[152:155], v179 offset:0
  s_waitcnt vmcnt(26)
  v_mfma_f32_32x32x16_bf16 v[68:83], v[136:139], a[148:151], v[68:83]
  ds_read_b128 v[156:159], v179 offset:4096
  s_add_u32 m0, s28, 116736
  s_add_u32 s29, s24, 17280
  buffer_load_dwordx4 v170, s[12:15], s29 offen lds
  s_waitcnt lgkmcnt(4)
  v_mfma_f32_32x32x16_bf16 v[20:35], v[140:143], a[144:147], v[20:35]
  v_mfma_f32_32x32x16_bf16 v[84:99], v[140:143], a[148:151], v[84:99]
  ds_read_b128 v[160:163], v179 offset:8192
  s_add_u32 m0, s28, 117760
  s_add_u32 s29, s24, 25472
  buffer_load_dwordx4 v171, s[12:15], s29 offen lds
  s_waitcnt lgkmcnt(4)
  v_mfma_f32_32x32x16_bf16 v[36:51], v[144:147], a[144:147], v[36:51]
  v_mfma_f32_32x32x16_bf16 v[100:115], v[144:147], a[148:151], v[100:115]
  ds_read_b128 v[164:167], v179 offset:12288
  buffer_load_dwordx4 a[216:219], v132, s[8:11], s26 offen offset:3072
  s_waitcnt lgkmcnt(4)
  v_mfma_f32_32x32x16_bf16 v[52:67], v[148:151], a[144:147], v[52:67]
  v_mfma_f32_32x32x16_bf16 v[116:131], v[148:151], a[148:151], v[116:131]
  buffer_load_dwordx4 a[220:223], v132, s[8:11], s27 offen offset:3072
  s_waitcnt vmcnt(26)
  s_barrier
  s_waitcnt vmcnt(25) lgkmcnt(3)
  v_mfma_f32_32x32x16_bf16 v[4:19], v[152:155], a[152:155], v[4:19]
  ds_read_b128 v[136:139], v176 offset:16384
  s_waitcnt vmcnt(24)
  v_mfma_f32_32x32x16_bf16 v[68:83], v[152:155], a[156:159], v[68:83]
  ds_read_b128 v[140:143], v176 offset:20480
  s_add_u32 s26, s26, 4096
  buffer_load_dwordx4 a[224:227], v132, s[8:11], s26 offen offset:0
  s_waitcnt lgkmcnt(4)
  v_mfma_f32_32x32x16_bf16 v[20:35], v[156:159], a[152:155], v[20:35]
  v_mfma_f32_32x32x16_bf16 v[84:99], v[156:159], a[156:159], v[84:99]
  ds_read_b128 v[144:147], v176 offset:24576
  s_add_u32 s27, s27, 4096
  buffer_load_dwordx4 a[228:231], v132, s[8:11], s27 offen offset:0
  s_waitcnt lgkmcnt(4)
  v_mfma_f32_32x32x16_bf16 v[36:51], v[160:163], a[152:155], v[36:51]
  v_mfma_f32_32x32x16_bf16 v[100:115], v[160:163], a[156:159], v[100:115]
  ds_read_b128 v[148:151], v176 offset:28672
  buffer_load_dwordx4 a[232:235], v132, s[8:11], s26 offen offset:1024
  s_waitcnt lgkmcnt(4)
  v_mfma_f32_32x32x16_bf16 v[52:67], v[164:167], a[152:155], v[52:67]
  v_mfma_f32_32x32x16_bf16 v[116:131], v[164:167], a[156:159], v[116:131]
  buffer_load_dwordx4 a[236:239], v132, s[8:11], s27 offen offset:1024
  s_waitcnt vmcnt(27) lgkmcnt(3)
  v_mfma_f32_32x32x16_bf16 v[4:19], v[136:139], a[160:163], v[4:19]
  ds_read_b128 v[152:155], v177 offset:16384
  s_waitcnt vmcnt(26)
  v_mfma_f32_32x32x16_bf16 v[68:83], v[136:139], a[164:167], v[68:83]
  ds_read_b128 v[156:159], v177 offset:20480
  buffer_load_dwordx4 a[240:243], v132, s[8:11], s26 offen offset:2048
  s_waitcnt lgkmcnt(4)
  v_mfma_f32_32x32x16_bf16 v[20:35], v[140:143], a[160:163], v[20:35]
  v_mfma_f32_32x32x16_bf16 v[84:99], v[140:143], a[164:167], v[84:99]
  ds_read_b128 v[160:163], v177 offset:24576
  buffer_load_dwordx4 a[244:247], v132, s[8:11], s27 offen offset:2048
  s_waitcnt lgkmcnt(4)
  v_mfma_f32_32x32x16_bf16 v[36:51], v[144:147], a[160:163], v[36:51]
  v_mfma_f32_32x32x16_bf16 v[100:115], v[144:147], a[164:167], v[100:115]
  ds_read_b128 v[164:167], v177 offset:28672
  buffer_load_dwordx4 a[248:251], v132, s[8:11], s26 offen offset:3072
  s_waitcnt lgkmcnt(4)
  v_mfma_f32_32x32x16_bf16 v[52:67], v[148:151], a[160:163], v[52:67]
  v_mfma_f32_32x32x16_bf16 v[116:131], v[148:151], a[164:167], v[116:131]
  buffer_load_dwordx4 a[252:255], v132, s[8:11], s27 offen offset:3072
  s_waitcnt vmcnt(29) lgkmcnt(3)
  v_mfma_f32_32x32x16_bf16 v[4:19], v[152:155], a[168:171], v[4:19]
  ds_read_b128 v[136:139], v178 offset:16384
  s_waitcnt vmcnt(28)
  v_mfma_f32_32x32x16_bf16 v[68:83], v[152:155], a[172:175], v[68:83]
  ds_read_b128 v[140:143], v178 offset:20480
  s_waitcnt lgkmcnt(4)
  v_mfma_f32_32x32x16_bf16 v[20:35], v[156:159], a[168:171], v[20:35]
  v_mfma_f32_32x32x16_bf16 v[84:99], v[156:159], a[172:175], v[84:99]
  ds_read_b128 v[144:147], v178 offset:24576
  s_waitcnt lgkmcnt(4)
  v_mfma_f32_32x32x16_bf16 v[36:51], v[160:163], a[168:171], v[36:51]
  v_mfma_f32_32x32x16_bf16 v[100:115], v[160:163], a[172:175], v[100:115]
  ds_read_b128 v[148:151], v178 offset:28672
  s_waitcnt lgkmcnt(4)
  v_mfma_f32_32x32x16_bf16 v[52:67], v[164:167], a[168:171], v[52:67]
  v_mfma_f32_32x32x16_bf16 v[116:131], v[164:167], a[172:175], v[116:131]
  s_waitcnt vmcnt(27) lgkmcnt(3)
  v_mfma_f32_32x32x16_bf16 v[4:19], v[136:139], a[176:179], v[4:19]
  ds_read_b128 v[152:155], v179 offset:16384
  s_waitcnt vmcnt(26)
  v_mfma_f32_32x32x16_bf16 v[68:83], v[136:139], a[180:183], v[68:83]
  ds_read_b128 v[156:159], v179 offset:20480
  s_waitcnt lgkmcnt(4)
  v_mfma_f32_32x32x16_bf16 v[20:35], v[140:143], a[176:179], v[20:35]
  v_mfma_f32_32x32x16_bf16 v[84:99], v[140:143], a[180:183], v[84:99]
  ds_read_b128 v[160:163], v179 offset:24576
  s_waitcnt lgkmcnt(4)
  v_mfma_f32_32x32x16_bf16 v[36:51], v[144:147], a[176:179], v[36:51]
  v_mfma_f32_32x32x16_bf16 v[100:115], v[144:147], a[180:183], v[100:115]
  ds_read_b128 v[164:167], v179 offset:28672
  s_waitcnt lgkmcnt(4)
  v_mfma_f32_32x32x16_bf16 v[52:67], v[148:151], a[176:179], v[52:67]
  v_mfma_f32_32x32x16_bf16 v[116:131], v[148:151], a[180:183], v[116:131]
  s_waitcnt vmcnt(22)
  s_barrier
  s_waitcnt vmcnt(21) lgkmcnt(3)
  v_mfma_f32_32x32x16_bf16 v[4:19], v[152:155], a[184:187], v[4:19]
  ds_read_b128 v[136:139], v176 offset:32768
  s_waitcnt vmcnt(20)
  v_mfma_f32_32x32x16_bf16 v[68:83], v[152:155], a[188:191], v[68:83]
  ds_read_b128 v[140:143], v176 offset:36864
  s_waitcnt lgkmcnt(4)
  v_mfma_f32_32x32x16_bf16 v[20:35], v[156:159], a[184:187], v[20:35]
  v_mfma_f32_32x32x16_bf16 v[84:99], v[156:159], a[188:191], v[84:99]
  ds_read_b128 v[144:147], v176 offset:40960
  s_waitcnt lgkmcnt(4)
  v_mfma_f32_32x32x16_bf16 v[36:51], v[160:163], a[184:187], v[36:51]
  v_mfma_f32_32x32x16_bf16 v[100:115], v[160:163], a[188:191], v[100:115]
  ds_read_b128 v[148:151], v176 offset:45056
  s_waitcnt lgkmcnt(4)
  v_mfma_f32_32x32x16_bf16 v[52:67], v[164:167], a[184:187], v[52:67]
  v_mfma_f32_32x32x16_bf16 v[116:131], v[164:167], a[188:191], v[116:131]
  s_waitcnt vmcnt(19) lgkmcnt(3)
  v_mfma_f32_32x32x16_bf16 v[4:19], v[136:139], a[192:195], v[4:19]
  ds_read_b128 v[152:155], v177 offset:32768
  s_waitcnt vmcnt(18)
  v_mfma_f32_32x32x16_bf16 v[68:83], v[136:139], a[196:199], v[68:83]
  ds_read_b128 v[156:159], v177 offset:36864
  s_waitcnt lgkmcnt(4)
  v_mfma_f32_32x32x16_bf16 v[20:35], v[140:143], a[192:195], v[20:35]
  v_mfma_f32_32x32x16_bf16 v[84:99], v[140:143], a[196:199], v[84:99]
  ds_read_b128 v[160:163], v177 offset:40960
  s_waitcnt lgkmcnt(4)
  v_mfma_f32_32x32x16_bf16 v[36:51], v[144:147], a[192:195], v[36:51]
  v_mfma_f32_32x32x16_bf16 v[100:115], v[144:147], a[196:199], v[100:115]
  ds_read_b128 v[164:167], v177 offset:45056
  s_waitcnt lgkmcnt(4)
  v_mfma_f32_32x32x16_bf16 v[52:67], v[148:151], a[192:195], v[52:67]
  v_mfma_f32_32x32x16_bf16 v[116:131], v[148:151], a[196:199], v[116:131]
  s_waitcnt vmcnt(17) lgkmcnt(3)
  v_mfma_f32_32x32x16_bf16 v[4:19], v[152:155], a[200:203], v[4:19]
  ds_read_b128 v[136:139], v178 offset:32768
  s_waitcnt vmcnt(16)
  v_mfma_f32_32x32x16_bf16 v[68:83], v[152:155], a[204:207], v[68:83]
  ds_read_b128 v[140:143], v178 offset:36864
  s_waitcnt lgkmcnt(4)
  v_mfma_f32_32x32x16_bf16 v[20:35], v[156:159], a[200:203], v[20:35]
  v_mfma_f32_32x32x16_bf16 v[84:99], v[156:159], a[204:207], v[84:99]
  ds_read_b128 v[144:147], v178 offset:40960
  s_waitcnt lgkmcnt(4)
  v_mfma_f32_32x32x16_bf16 v[36:51], v[160:163], a[200:203], v[36:51]
  v_mfma_f32_32x32x16_bf16 v[100:115], v[160:163], a[204:207], v[100:115]
  ds_read_b128 v[148:151], v178 offset:45056
  s_waitcnt lgkmcnt(4)
  v_mfma_f32_32x32x16_bf16 v[52:67], v[164:167], a[200:203], v[52:67]
  v_mfma_f32_32x32x16_bf16 v[116:131], v[164:167], a[204:207], v[116:131]
  s_waitcnt vmcnt(15) lgkmcnt(3)
  v_mfma_f32_32x32x16_bf16 v[4:19], v[136:139], a[208:211], v[4:19]
  ds_read_b128 v[152:155], v179 offset:32768
  s_waitcnt vmcnt(14)
  v_mfma_f32_32x32x16_bf16 v[68:83], v[136:139], a[212:215], v[68:83]
  ds_read_b128 v[156:159], v179 offset:36864
  s_waitcnt lgkmcnt(4)
  v_mfma_f32_32x32x16_bf16 v[20:35], v[140:143], a[208:211], v[20:35]
  v_mfma_f32_32x32x16_bf16 v[84:99], v[140:143], a[212:215], v[84:99]
  ds_read_b128 v[160:163], v179 offset:40960
  s_waitcnt lgkmcnt(4)
  v_mfma_f32_32x32x16_bf16 v[36:51], v[144:147], a[208:211], v[36:51]
  v_mfma_f32_32x32x16_bf16 v[100:115], v[144:147], a[212:215], v[100:115]
  ds_read_b128 v[164:167], v179 offset:45056
  s_waitcnt lgkmcnt(4)
  v_mfma_f32_32x32x16_bf16 v[52:67], v[148:151], a[208:211], v[52:67]
  v_mfma_f32_32x32x16_bf16 v[116:131], v[148:151], a[212:215], v[116:131]
  s_waitcnt vmcnt(10)
  s_barrier
  s_waitcnt vmcnt(9) lgkmcnt(3)
  v_mfma_f32_32x32x16_bf16 v[4:19], v[152:155], a[216:219], v[4:19]
  ds_read_b128 v[136:139], v176 offset:49152
  s_waitcnt vmcnt(8)
  v_mfma_f32_32x32x16_bf16 v[68:83], v[152:155], a[220:223], v[68:83]
  ds_read_b128 v[140:143], v177 offset:49152
  s_waitcnt lgkmcnt(4)
  v_mfma_f32_32x32x16_bf16 v[20:35], v[156:159], a[216:219], v[20:35]
  v_mfma_f32_32x32x16_bf16 v[84:99], v[156:159], a[220:223], v[84:99]
  ds_read_b128 v[144:147], v178 offset:49152
  s_waitcnt lgkmcnt(4)
  v_mfma_f32_32x32x16_bf16 v[36:51], v[160:163], a[216:219], v[36:51]
  v_mfma_f32_32x32x16_bf16 v[100:115], v[160:163], a[220:223], v[100:115]
  ds_read_b128 v[148:151], v179 offset:49152
  s_waitcnt lgkmcnt(4)
  v_mfma_f32_32x32x16_bf16 v[52:67], v[164:167], a[216:219], v[52:67]
  v_mfma_f32_32x32x16_bf16 v[116:131], v[164:167], a[220:223], v[116:131]
  s_waitcnt vmcnt(7) lgkmcnt(3)
  v_mfma_f32_32x32x16_bf16 v[4:19], v[136:139], a[224:227], v[4:19]
  ds_read_b128 v[152:155], v176 offset:53248
  s_waitcnt vmcnt(6)
  v_mfma_f32_32x32x16_bf16 v[68:83], v[136:139], a[228:231], v[68:83]
  s_waitcnt vmcnt(5) lgkmcnt(3)
  v_mfma_f32_32x32x16_bf16 v[4:19], v[140:143], a[232:235], v[4:19]
  ds_read_b128 v[156:159], v177 offset:53248
  s_waitcnt vmcnt(4)
  v_mfma_f32_32x32x16_bf16 v[68:83], v[140:143], a[236:239], v[68:83]
  s_waitcnt vmcnt(3) lgkmcnt(3)
  v_mfma_f32_32x32x16_bf16 v[4:19], v[144:147], a[240:243], v[4:19]
  ds_read_b128 v[160:163], v178 offset:53248
  s_waitcnt vmcnt(2)
  v_mfma_f32_32x32x16_bf16 v[68:83], v[144:147], a[244:247], v[68:83]
  s_waitcnt vmcnt(1) lgkmcnt(3)
  v_mfma_f32_32x32x16_bf16 v[4:19], v[148:151], a[248:251], v[4:19]
  ds_read_b128 v[164:167], v179 offset:53248
  s_waitcnt vmcnt(0)
  v_mfma_f32_32x32x16_bf16 v[68:83], v[148:151], a[252:255], v[68:83]
  s_waitcnt lgkmcnt(3)
  v_mfma_f32_32x32x16_bf16 v[20:35], v[152:155], a[224:227], v[20:35]
  ds_read_b128 v[136:139], v176 offset:57344
  v_mfma_f32_32x32x16_bf16 v[84:99], v[152:155], a[228:231], v[84:99]
  s_waitcnt lgkmcnt(3)
  v_mfma_f32_32x32x16_bf16 v[20:35], v[156:159], a[232:235], v[20:35]
  ds_read_b128 v[140:143], v177 offset:57344
  v_mfma_f32_32x32x16_bf16 v[84:99], v[156:159], a[236:239], v[84:99]
  s_waitcnt lgkmcnt(3)
  v_mfma_f32_32x32x16_bf16 v[20:35], v[160:163], a[240:243], v[20:35]
  ds_read_b128 v[144:147], v178 offset:57344
  v_mfma_f32_32x32x16_bf16 v[84:99], v[160:163], a[244:247], v[84:99]
  v_cvt_pk_bf16_f32 v4, v4, v5
  v_cvt_pk_bf16_f32 v5, v6, v7
  v_cvt_pk_bf16_f32 v6, v8, v9
  v_cvt_pk_bf16_f32 v7, v10, v11
  buffer_store_dwordx4 v[4:7], v132, s[16:19], s36 offen sc0 sc1
  v_cvt_pk_bf16_f32 v8, v12, v13
  v_cvt_pk_bf16_f32 v9, v14, v15
  s_waitcnt lgkmcnt(3)
  v_mfma_f32_32x32x16_bf16 v[20:35], v[164:167], a[248:251], v[20:35]
  ds_read_b128 v[148:151], v179 offset:57344
  v_cvt_pk_bf16_f32 v10, v16, v17
  v_cvt_pk_bf16_f32 v11, v18, v19
  buffer_store_dwordx4 v[8:11], v132, s[16:19], s36 offen offset:1024 sc0 sc1
  v_cvt_pk_bf16_f32 v68, v68, v69
  v_cvt_pk_bf16_f32 v69, v70, v71
  v_cvt_pk_bf16_f32 v70, v72, v73
  v_cvt_pk_bf16_f32 v71, v74, v75
  v_mfma_f32_32x32x16_bf16 v[84:99], v[164:167], a[252:255], v[84:99]
  buffer_store_dwordx4 v[68:71], v132, s[16:19], s40 offen sc0 sc1
  v_cvt_pk_bf16_f32 v72, v76, v77
  v_cvt_pk_bf16_f32 v73, v78, v79
  v_cvt_pk_bf16_f32 v74, v80, v81
  v_cvt_pk_bf16_f32 v75, v82, v83
  buffer_store_dwordx4 v[72:75], v132, s[16:19], s40 offen offset:1024 sc0 sc1
  s_waitcnt lgkmcnt(3)
  v_mfma_f32_32x32x16_bf16 v[36:51], v[136:139], a[224:227], v[36:51]
  ds_read_b128 v[152:155], v176 offset:61440
  v_mfma_f32_32x32x16_bf16 v[100:115], v[136:139], a[228:231], v[100:115]
  s_waitcnt lgkmcnt(3)
  v_mfma_f32_32x32x16_bf16 v[36:51], v[140:143], a[232:235], v[36:51]
  ds_read_b128 v[156:159], v177 offset:61440
  v_mfma_f32_32x32x16_bf16 v[100:115], v[140:143], a[236:239], v[100:115]
  s_waitcnt lgkmcnt(3)
  v_mfma_f32_32x32x16_bf16 v[36:51], v[144:147], a[240:243], v[36:51]
  ds_read_b128 v[160:163], v178 offset:61440
  v_mfma_f32_32x32x16_bf16 v[100:115], v[144:147], a[244:247], v[100:115]
  v_cvt_pk_bf16_f32 v20, v20, v21
  v_cvt_pk_bf16_f32 v21, v22, v23
  v_cvt_pk_bf16_f32 v22, v24, v25
  v_cvt_pk_bf16_f32 v23, v26, v27
  buffer_store_dwordx4 v[20:23], v132, s[16:19], s37 offen sc0 sc1
  v_cvt_pk_bf16_f32 v24, v28, v29
  v_cvt_pk_bf16_f32 v25, v30, v31
  s_waitcnt lgkmcnt(3)
  v_mfma_f32_32x32x16_bf16 v[36:51], v[148:151], a[248:251], v[36:51]
  ds_read_b128 v[164:167], v179 offset:61440
  v_cvt_pk_bf16_f32 v26, v32, v33
  v_cvt_pk_bf16_f32 v27, v34, v35
  buffer_store_dwordx4 v[24:27], v132, s[16:19], s37 offen offset:1024 sc0 sc1
  v_cvt_pk_bf16_f32 v84, v84, v85
  v_cvt_pk_bf16_f32 v85, v86, v87
  v_cvt_pk_bf16_f32 v86, v88, v89
  v_cvt_pk_bf16_f32 v87, v90, v91
  v_mfma_f32_32x32x16_bf16 v[100:115], v[148:151], a[252:255], v[100:115]
  buffer_store_dwordx4 v[84:87], v132, s[16:19], s41 offen sc0 sc1
  v_cvt_pk_bf16_f32 v88, v92, v93
  v_cvt_pk_bf16_f32 v89, v94, v95
  v_cvt_pk_bf16_f32 v90, v96, v97
  v_cvt_pk_bf16_f32 v91, v98, v99
  buffer_store_dwordx4 v[88:91], v132, s[16:19], s41 offen offset:1024 sc0 sc1
  s_waitcnt lgkmcnt(3)
  v_mfma_f32_32x32x16_bf16 v[52:67], v[152:155], a[224:227], v[52:67]
  v_mfma_f32_32x32x16_bf16 v[116:131], v[152:155], a[228:231], v[116:131]
  s_waitcnt lgkmcnt(2)
  v_mfma_f32_32x32x16_bf16 v[52:67], v[156:159], a[232:235], v[52:67]
  v_mfma_f32_32x32x16_bf16 v[116:131], v[156:159], a[236:239], v[116:131]
  s_waitcnt lgkmcnt(1)
  v_mfma_f32_32x32x16_bf16 v[52:67], v[160:163], a[240:243], v[52:67]
  v_mfma_f32_32x32x16_bf16 v[116:131], v[160:163], a[244:247], v[116:131]
  v_cvt_pk_bf16_f32 v36, v36, v37
  v_cvt_pk_bf16_f32 v37, v38, v39
  v_cvt_pk_bf16_f32 v38, v40, v41
  v_cvt_pk_bf16_f32 v39, v42, v43
  buffer_store_dwordx4 v[36:39], v132, s[16:19], s38 offen sc0 sc1
  v_cvt_pk_bf16_f32 v40, v44, v45
  v_cvt_pk_bf16_f32 v41, v46, v47
  s_waitcnt lgkmcnt(0)
  v_mfma_f32_32x32x16_bf16 v[52:67], v[164:167], a[248:251], v[52:67]
  v_cvt_pk_bf16_f32 v42, v48, v49
  v_cvt_pk_bf16_f32 v43, v50, v51
  buffer_store_dwordx4 v[40:43], v132, s[16:19], s38 offen offset:1024 sc0 sc1
  v_cvt_pk_bf16_f32 v100, v100, v101
  v_cvt_pk_bf16_f32 v101, v102, v103
  v_cvt_pk_bf16_f32 v102, v104, v105
  v_cvt_pk_bf16_f32 v103, v106, v107
  v_mfma_f32_32x32x16_bf16 v[116:131], v[164:167], a[252:255], v[116:131]
  buffer_store_dwordx4 v[100:103], v132, s[16:19], s42 offen sc0 sc1
  v_cvt_pk_bf16_f32 v104, v108, v109
  v_cvt_pk_bf16_f32 v105, v110, v111
  v_cvt_pk_bf16_f32 v106, v112, v113
  v_cvt_pk_bf16_f32 v107, v114, v115
  buffer_store_dwordx4 v[104:107], v132, s[16:19], s42 offen offset:1024 sc0 sc1
  v_cvt_pk_bf16_f32 v52, v52, v53
  v_cvt_pk_bf16_f32 v53, v54, v55
  v_cvt_pk_bf16_f32 v54, v56, v57
  v_cvt_pk_bf16_f32 v55, v58, v59
  buffer_store_dwordx4 v[52:55], v132, s[16:19], s39 offen sc0 sc1
  v_cvt_pk_bf16_f32 v56, v60, v61
  v_cvt_pk_bf16_f32 v57, v62, v63
  v_cvt_pk_bf16_f32 v58, v64, v65
  v_cvt_pk_bf16_f32 v59, v66, v67
  buffer_store_dwordx4 v[56:59], v132, s[16:19], s39 offen offset:1024 sc0 sc1
  v_cvt_pk_bf16_f32 v116, v116, v117
  v_cvt_pk_bf16_f32 v117, v118, v119
  v_cvt_pk_bf16_f32 v118, v120, v121
  v_cvt_pk_bf16_f32 v119, v122, v123
  buffer_store_dwordx4 v[116:119], v132, s[16:19], s43 offen sc0 sc1
  v_cvt_pk_bf16_f32 v120, v124, v125
  v_cvt_pk_bf16_f32 v121, v126, v127
  v_cvt_pk_bf16_f32 v122, v128, v129
  v_cvt_pk_bf16_f32 v123, v130, v131
  buffer_store_dwordx4 v[120:123], v132, s[16:19], s43 offen offset:1024 sc0 sc1
  s_endpgm
ge11:
  s_endpgm
.section .rodata,"a"
.p2align 6
.amdhsa_kernel q2_kernel
  .amdhsa_next_free_vgpr 472
  .amdhsa_next_free_sgpr 102
  .amdhsa_accum_offset 216
  .amdhsa_group_segment_fixed_size 0
  .amdhsa_kernarg_size 80
  .amdhsa_user_sgpr_count 2
  .amdhsa_user_sgpr_kernarg_segment_ptr 1
  .amdhsa_system_sgpr_workgroup_id_x 1
.end_amdhsa_kernel
.text
.globl q3_kernel
.p2align 8
.type q3_kernel,@function
q3_kernel:
L_q3_kernel:
  s_cmp_ge_u32 s2, 256
  s_cbranch_scc1 he15
  s_load_dwordx2 s[4:5], s[0:1], 72
  v_lshrrev_b32 v1, 6, v0
  s_nop 0
  v_readfirstlane_b32 s3, v1
  s_getpc_b64 s[96:97]
pf16:
  s_mov_b32 s98, text_end-pf16
  s_mov_b32 s99, 0x20000
  v_lshlrev_b32 v2, 6, v0
  buffer_load_dword v3, v2, s[96:99], 0 offen
  s_and_b32 s20, s2, 7
  s_lshr_b32 s21, s2, 3
  s_and_b32 s22, s20, 3
  s_lshl_b32 s22, s22, 3
  s_and_b32 s23, s21, 7
  s_add_u32 s22, s22, s23
  s_lshr_b32 s23, s20, 2
  s_lshl_b32 s23, s23, 2
  s_lshr_b32 s24, s21, 3
  s_add_u32 s23, s23, s24
  s_waitcnt lgkmcnt(0)
  s_add_u32 s8, s4, 0xc00000
  s_addc_u32 s9, s5, 0
  s_mov_b32 s10, 0x1c0000
  s_mov_b32 s11, 0x20000
  s_add_u32 s12, s4, 0x1000000
  s_addc_u32 s13, s5, 0
  s_mov_b32 s14, 0x700000
  s_mov_b32 s15, 0x20000
  s_mul_i32 s24, s3, 28672
  s_mul_i32 s26, s23, 229376
  s_add_u32 s26, s26, s24
  s_add_u32 s27, s26, 114688
  s_mul_i32 s28, s22, 229376
  s_add_u32 s28, s28, s24
  s_add_u32 s29, s28, 114688
  v_and_b32 v4, 63, v0
  v_lshlrev_b32 v5, 4, v4
  buffer_load_dwordx4 v[76:79], v5, s[8:11], s26 offen offset:0
  buffer_load_dwordx4 v[80:83], v5, s[8:11], s27 offen offset:0
  buffer_load_dwordx4 v[84:87], v5, s[12:15], s28 offen offset:0
  buffer_load_dwordx4 v[88:91], v5, s[12:15], s29 offen offset:0
  buffer_load_dwordx4 v[92:95], v5, s[8:11], s26 offen offset:1024
  buffer_load_dwordx4 v[96:99], v5, s[8:11], s27 offen offset:1024
  buffer_load_dwordx4 v[100:103], v5, s[12:15], s28 offen offset:1024
  buffer_load_dwordx4 v[104:107], v5, s[12:15], s29 offen offset:1024
  buffer_load_dwordx4 v[108:111], v5, s[8:11], s26 offen offset:2048
  buffer_load_dwordx4 v[112:115], v5, s[8:11], s27 offen offset:2048
  buffer_load_dwordx4 v[116:119], v5, s[12:15], s28 offen offset:2048
  buffer_load_dwordx4 v[120:123], v5, s[12:15], s29 offen offset:2048
  buffer_load_dwordx4 v[124:127], v5, s[8:11], s26 offen offset:3072
  buffer_load_dwordx4 v[128:131], v5, s[8:11], s27 offen offset:3072
  buffer_load_dwordx4 v[132:135], v5, s[12:15], s28 offen offset:3072
  buffer_load_dwordx4 v[136:139], v5, s[12:15], s29 offen offset:3072
  s_add_u32 s26, s26, 4096
  buffer_load_dwordx4 v[140:143], v5, s[8:11], s26 offen offset:0
  s_add_u32 s27, s27, 4096
  buffer_load_dwordx4 v[144:147], v5, s[8:11], s27 offen offset:0
  s_add_u32 s28, s28, 4096
  buffer_load_dwordx4 v[148:151], v5, s[12:15], s28 offen offset:0
  s_add_u32 s29, s29, 4096
  buffer_load_dwordx4 v[152:155], v5, s[12:15], s29 offen offset:0
  buffer_load_dwordx4 v[156:159], v5, s[8:11], s26 offen offset:1024
  buffer_load_dwordx4 v[160:163], v5, s[8:11], s27 offen offset:1024
  buffer_load_dwordx4 v[164:167], v5, s[12:15], s28 offen offset:1024
  buffer_load_dwordx4 v[168:171], v5, s[12:15], s29 offen offset:1024
  buffer_load_dwordx4 v[172:175], v5, s[8:11], s26 offen offset:2048
  buffer_load_dwordx4 v[176:179], v5, s[8:11], s27 offen offset:2048
  buffer_load_dwordx4 v[180:183], v5, s[12:15], s28 offen offset:2048
  buffer_load_dwordx4 v[184:187], v5, s[12:15], s29 offen offset:2048
  buffer_load_dwordx4 v[188:191], v5, s[8:11], s26 offen offset:3072
  buffer_load_dwordx4 v[192:195], v5, s[8:11], s27 offen offset:3072
  buffer_load_dwordx4 v[196:199], v5, s[12:15], s28 offen offset:3072
  buffer_load_dwordx4 v[200:203], v5, s[12:15], s29 offen offset:3072
  s_add_u32 s26, s26, 4096
  buffer_load_dwordx4 v[204:207], v5, s[8:11], s26 offen offset:0
  s_add_u32 s27, s27, 4096
  buffer_load_dwordx4 v[208:211], v5, s[8:11], s27 offen offset:0
  s_add_u32 s28, s28, 4096
  buffer_load_dwordx4 v[212:215], v5, s[12:15], s28 offen offset:0
  s_add_u32 s29, s29, 4096
  buffer_load_dwordx4 v[216:219], v5, s[12:15], s29 offen offset:0
  buffer_load_dwordx4 v[220:223], v5, s[8:11], s26 offen offset:1024
  buffer_load_dwordx4 v[224:227], v5, s[8:11], s27 offen offset:1024
  buffer_load_dwordx4 v[228:231], v5, s[12:15], s28 offen offset:1024
  buffer_load_dwordx4 v[232:235], v5, s[12:15], s29 offen offset:1024
  v_and_b32 v6, 31, v4
  v_lshrrev_b32 v7, 5, v4
  s_lshr_b32 s30, s3, 1
  s_and_b32 s31, s3, 1
  s_lshl_b32 s32, s23, 1
  s_add_u32 s32, s32, s30
  s_lshl_b32 s33, s22, 1
  s_add_u32 s33, s33, s31
  s_add_u32 s16, s4, 0x200000
  s_addc_u32 s17, s5, 0
  s_mov_b32 s18, 0x200000
  s_mov_b32 s19, 0x20000
  s_add_u32 s36, s4, 0x400000
  s_addc_u32 s37, s5, 0
  s_mov_b32 s38, 0x200000
  s_mov_b32 s39, 0x20000
  s_add_u32 s40, s4, 0x1a02000
  s_addc_u32 s41, s5, 0
  s_mov_b32 s42, 0x2000
  s_mov_b32 s43, 0x20000
  v_lshlrev_b32 v244, 2, v6
  v_lshl_or_b32 v244, v7, 14, v244
  s_lshl_b32 s34, s32, 17
  s_lshl_b32 s35, s33, 7
  s_add_u32 s34, s34, s35
  s_add_u32 s44, s34, 0
  s_add_u32 s45, s34, 8192
  s_add_u32 s46, s34, 32768
  s_add_u32 s47, s34, 40960
  s_add_u32 s48, s34, 65536
  s_add_u32 s49, s34, 73728
  s_add_u32 s50, s34, 98304
  s_add_u32 s51, s34, 106496
  s_waitcnt vmcnt(37)
  v_mfma_f32_32x32x16_bf16 v[12:27], v[76:79], v[84:87], 0
  s_waitcnt vmcnt(36)
  v_mfma_f32_32x32x16_bf16 v[28:43], v[76:79], v[88:91], 0
  v_mfma_f32_32x32x16_bf16 v[44:59], v[80:83], v[84:87], 0
  v_mfma_f32_32x32x16_bf16 v[60:75], v[80:83], v[88:91], 0
  s_waitcnt vmcnt(33)
  v_mfma_f32_32x32x16_bf16 v[12:27], v[92:95], v[100:103], v[12:27]
  buffer_load_dwordx4 v[76:79], v5, s[8:11], s26 offen offset:2048
  s_waitcnt vmcnt(33)
  v_mfma_f32_32x32x16_bf16 v[28:43], v[92:95], v[104:107], v[28:43]
  buffer_load_dwordx4 v[80:83], v5, s[8:11], s27 offen offset:2048
  v_mfma_f32_32x32x16_bf16 v[44:59], v[96:99], v[100:103], v[44:59]
  buffer_load_dwordx4 v[84:87], v5, s[12:15], s28 offen offset:2048
  v_mfma_f32_32x32x16_bf16 v[60:75], v[96:99], v[104:107], v[60:75]
  buffer_load_dwordx4 v[88:91], v5, s[12:15], s29 offen offset:2048
  s_waitcnt vmcnt(33)
  v_mfma_f32_32x32x16_bf16 v[12:27], v[108:111], v[116:119], v[12:27]
  buffer_load_dwordx4 v[92:95], v5, s[8:11], s26 offen offset:3072
  s_waitcnt vmcnt(33)
  v_mfma_f32_32x32x16_bf16 v[28:43], v[108:111], v[120:123], v[28:43]
  buffer_load_dwordx4 v[96:99], v5, s[8:11], s27 offen offset:3072
  v_mfma_f32_32x32x16_bf16 v[44:59], v[112:115], v[116:119], v[44:59]
  buffer_load_dwordx4 v[100:103], v5, s[12:15], s28 offen offset:3072
  v_mfma_f32_32x32x16_bf16 v[60:75], v[112:115], v[120:123], v[60:75]
  buffer_load_dwordx4 v[104:107], v5, s[12:15], s29 offen offset:3072
  s_waitcnt vmcnt(33)
  v_mfma_f32_32x32x16_bf16 v[12:27], v[124:127], v[132:135], v[12:27]
  s_add_u32 s26, s26, 4096
  buffer_load_dwordx4 v[108:111], v5, s[8:11], s26 offen offset:0
  s_waitcnt vmcnt(33)
  v_mfma_f32_32x32x16_bf16 v[28:43], v[124:127], v[136:139], v[28:43]
  s_add_u32 s27, s27, 4096
  buffer_load_dwordx4 v[112:115], v5, s[8:11], s27 offen offset:0
  v_mfma_f32_32x32x16_bf16 v[44:59], v[128:131], v[132:135], v[44:59]
  s_add_u32 s28, s28, 4096
  buffer_load_dwordx4 v[116:119], v5, s[12:15], s28 offen offset:0
  v_mfma_f32_32x32x16_bf16 v[60:75], v[128:131], v[136:139], v[60:75]
  s_add_u32 s29, s29, 4096
  buffer_load_dwordx4 v[120:123], v5, s[12:15], s29 offen offset:0
  s_waitcnt vmcnt(33)
  v_mfma_f32_32x32x16_bf16 v[12:27], v[140:143], v[148:151], v[12:27]
  buffer_load_dwordx4 v[124:127], v5, s[8:11], s26 offen offset:1024
  s_waitcnt vmcnt(33)
  v_mfma_f32_32x32x16_bf16 v[28:43], v[140:143], v[152:155], v[28:43]
  buffer_load_dwordx4 v[128:131], v5, s[8:11], s27 offen offset:1024
  v_mfma_f32_32x32x16_bf16 v[44:59], v[144:147], v[148:151], v[44:59]
  buffer_load_dwordx4 v[132:135], v5, s[12:15], s28 offen offset:1024
  v_mfma_f32_32x32x16_bf16 v[60:75], v[144:147], v[152:155], v[60:75]
  buffer_load_dwordx4 v[136:139], v5, s[12:15], s29 offen offset:1024
  s_waitcnt vmcnt(33)
  v_mfma_f32_32x32x16_bf16 v[12:27], v[156:159], v[164:167], v[12:27]
  buffer_load_dwordx4 v[140:143], v5, s[8:11], s26 offen offset:2048
  s_waitcnt vmcnt(33)
  v_mfma_f32_32x32x16_bf16 v[28:43], v[156:159], v[168:171], v[28:43]
  buffer_load_dwordx4 v[144:147], v5, s[8:11], s27 offen offset:2048
  v_mfma_f32_32x32x16_bf16 v[44:59], v[160:163], v[164:167], v[44:59]
  buffer_load_dwordx4 v[148:151], v5, s[12:15], s28 offen offset:2048
  v_mfma_f32_32x32x16_bf16 v[60:75], v[160:163], v[168:171], v[60:75]
  buffer_load_dwordx4 v[152:155], v5, s[12:15], s29 offen offset:2048
  s_waitcnt vmcnt(33)
  v_mfma_f32_32x32x16_bf16 v[12:27], v[172:175], v[180:183], v[12:27]
  buffer_load_dwordx4 v[156:159], v5, s[8:11], s26 offen offset:3072
  s_waitcnt vmcnt(33)
  v_mfma_f32_32x32x16_bf16 v[28:43], v[172:175], v[184:187], v[28:43]
  buffer_load_dwordx4 v[160:163], v5, s[8:11], s27 offen offset:3072
  v_mfma_f32_32x32x16_bf16 v[44:59], v[176:179], v[180:183], v[44:59]
  buffer_load_dwordx4 v[164:167], v5, s[12:15], s28 offen offset:3072
  v_mfma_f32_32x32x16_bf16 v[60:75], v[176:179], v[184:187], v[60:75]
  buffer_load_dwordx4 v[168:171], v5, s[12:15], s29 offen offset:3072
  s_waitcnt vmcnt(33)
  v_mfma_f32_32x32x16_bf16 v[12:27], v[188:191], v[196:199], v[12:27]
  s_add_u32 s26, s26, 4096
  buffer_load_dwordx4 v[172:175], v5, s[8:11], s26 offen offset:0
  s_waitcnt vmcnt(33)
  v_mfma_f32_32x32x16_bf16 v[28:43], v[188:191], v[200:203], v[28:43]
  s_add_u32 s27, s27, 4096
  buffer_load_dwordx4 v[176:179], v5, s[8:11], s27 offen offset:0
  v_mfma_f32_32x32x16_bf16 v[44:59], v[192:195], v[196:199], v[44:59]
  s_add_u32 s28, s28, 4096
  buffer_load_dwordx4 v[180:183], v5, s[12:15], s28 offen offset:0
  v_mfma_f32_32x32x16_bf16 v[60:75], v[192:195], v[200:203], v[60:75]
  s_add_u32 s29, s29, 4096
  buffer_load_dwordx4 v[184:187], v5, s[12:15], s29 offen offset:0
  s_waitcnt vmcnt(33)
  v_mfma_f32_32x32x16_bf16 v[12:27], v[204:207], v[212:215], v[12:27]
  buffer_load_dwordx4 v[188:191], v5, s[8:11], s26 offen offset:1024
  s_waitcnt vmcnt(33)
  v_mfma_f32_32x32x16_bf16 v[28:43], v[204:207], v[216:219], v[28:43]
  buffer_load_dwordx4 v[192:195], v5, s[8:11], s27 offen offset:1024
  v_mfma_f32_32x32x16_bf16 v[44:59], v[208:211], v[212:215], v[44:59]
  buffer_load_dwordx4 v[196:199], v5, s[12:15], s28 offen offset:1024
  v_mfma_f32_32x32x16_bf16 v[60:75], v[208:211], v[216:219], v[60:75]
  buffer_load_dwordx4 v[200:203], v5, s[12:15], s29 offen offset:1024
  s_waitcnt vmcnt(33)
  v_mfma_f32_32x32x16_bf16 v[12:27], v[220:223], v[228:231], v[12:27]
  buffer_load_dwordx4 v[204:207], v5, s[8:11], s26 offen offset:2048
  s_waitcnt vmcnt(33)
  v_mfma_f32_32x32x16_bf16 v[28:43], v[220:223], v[232:235], v[28:43]
  buffer_load_dwordx4 v[208:211], v5, s[8:11], s27 offen offset:2048
  v_mfma_f32_32x32x16_bf16 v[44:59], v[224:227], v[228:231], v[44:59]
  buffer_load_dwordx4 v[212:215], v5, s[12:15], s28 offen offset:2048
  v_mfma_f32_32x32x16_bf16 v[60:75], v[224:227], v[232:235], v[60:75]
  buffer_load_dwordx4 v[216:219], v5, s[12:15], s29 offen offset:2048
  s_waitcnt vmcnt(33)
  v_mfma_f32_32x32x16_bf16 v[12:27], v[76:79], v[84:87], v[12:27]
  buffer_load_dwordx4 v[220:223], v5, s[8:11], s26 offen offset:3072
  s_waitcnt vmcnt(33)
  v_mfma_f32_32x32x16_bf16 v[28:43], v[76:79], v[88:91], v[28:43]
  buffer_load_dwordx4 v[224:227], v5, s[8:11], s27 offen offset:3072
  v_mfma_f32_32x32x16_bf16 v[44:59], v[80:83], v[84:87], v[44:59]
  buffer_load_dwordx4 v[228:231], v5, s[12:15], s28 offen offset:3072
  v_mfma_f32_32x32x16_bf16 v[60:75], v[80:83], v[88:91], v[60:75]
  buffer_load_dwordx4 v[232:235], v5, s[12:15], s29 offen offset:3072
  s_waitcnt vmcnt(33)
  v_mfma_f32_32x32x16_bf16 v[12:27], v[92:95], v[100:103], v[12:27]
  s_add_u32 s26, s26, 4096
  buffer_load_dwordx4 v[76:79], v5, s[8:11], s26 offen offset:0
  s_waitcnt vmcnt(33)
  v_mfma_f32_32x32x16_bf16 v[28:43], v[92:95], v[104:107], v[28:43]
  s_add_u32 s27, s27, 4096
  buffer_load_dwordx4 v[80:83], v5, s[8:11], s27 offen offset:0
  v_mfma_f32_32x32x16_bf16 v[44:59], v[96:99], v[100:103], v[44:59]
  s_add_u32 s28, s28, 4096
  buffer_load_dwordx4 v[84:87], v5, s[12:15], s28 offen offset:0
  v_mfma_f32_32x32x16_bf16 v[60:75], v[96:99], v[104:107], v[60:75]
  s_add_u32 s29, s29, 4096
  buffer_load_dwordx4 v[88:91], v5, s[12:15], s29 offen offset:0
  s_waitcnt vmcnt(33)
  v_mfma_f32_32x32x16_bf16 v[12:27], v[108:111], v[116:119], v[12:27]
  buffer_load_dwordx4 v[92:95], v5, s[8:11], s26 offen offset:1024
  s_waitcnt vmcnt(33)
  v_mfma_f32_32x32x16_bf16 v[28:43], v[108:111], v[120:123], v[28:43]
  buffer_load_dwordx4 v[96:99], v5, s[8:11], s27 offen offset:1024
  v_mfma_f32_32x32x16_bf16 v[44:59], v[112:115], v[116:119], v[44:59]
  buffer_load_dwordx4 v[100:103], v5, s[12:15], s28 offen offset:1024
  v_mfma_f32_32x32x16_bf16 v[60:75], v[112:115], v[120:123], v[60:75]
  buffer_load_dwordx4 v[104:107], v5, s[12:15], s29 offen offset:1024
  s_waitcnt vmcnt(33)
  v_mfma_f32_32x32x16_bf16 v[12:27], v[124:127], v[132:135], v[12:27]
  buffer_load_dwordx4 v[108:111], v5, s[8:11], s26 offen offset:2048
  s_waitcnt vmcnt(33)
  v_mfma_f32_32x32x16_bf16 v[28:43], v[124:127], v[136:139], v[28:43]
  buffer_load_dwordx4 v[112:115], v5, s[8:11], s27 offen offset:2048
  v_mfma_f32_32x32x16_bf16 v[44:59], v[128:131], v[132:135], v[44:59]
  buffer_load_dwordx4 v[116:119], v5, s[12:15], s28 offen offset:2048
  v_mfma_f32_32x32x16_bf16 v[60:75], v[128:131], v[136:139], v[60:75]
  buffer_load_dwordx4 v[120:123], v5, s[12:15], s29 offen offset:2048
  s_waitcnt vmcnt(33)
  v_mfma_f32_32x32x16_bf16 v[12:27], v[140:143], v[148:151], v[12:27]
  buffer_load_dwordx4 v[124:127], v5, s[8:11], s26 offen offset:3072
  s_waitcnt vmcnt(33)
  v_mfma_f32_32x32x16_bf16 v[28:43], v[140:143], v[152:155], v[28:43]
  buffer_load_dwordx4 v[128:131], v5, s[8:11], s27 offen offset:3072
  v_mfma_f32_32x32x16_bf16 v[44:59], v[144:147], v[148:151], v[44:59]
  buffer_load_dwordx4 v[132:135], v5, s[12:15], s28 offen offset:3072
  v_mfma_f32_32x32x16_bf16 v[60:75], v[144:147], v[152:155], v[60:75]
  buffer_load_dwordx4 v[136:139], v5, s[12:15], s29 offen offset:3072
  s_waitcnt vmcnt(33)
  v_mfma_f32_32x32x16_bf16 v[12:27], v[156:159], v[164:167], v[12:27]
  s_add_u32 s26, s26, 4096
  buffer_load_dwordx4 v[140:143], v5, s[8:11], s26 offen offset:0
  s_waitcnt vmcnt(33)
  v_mfma_f32_32x32x16_bf16 v[28:43], v[156:159], v[168:171], v[28:43]
  s_add_u32 s27, s27, 4096
  buffer_load_dwordx4 v[144:147], v5, s[8:11], s27 offen offset:0
  v_mfma_f32_32x32x16_bf16 v[44:59], v[160:163], v[164:167], v[44:59]
  s_add_u32 s28, s28, 4096
  buffer_load_dwordx4 v[148:151], v5, s[12:15], s28 offen offset:0
  v_mfma_f32_32x32x16_bf16 v[60:75], v[160:163], v[168:171], v[60:75]
  s_add_u32 s29, s29, 4096
  buffer_load_dwordx4 v[152:155], v5, s[12:15], s29 offen offset:0
  s_waitcnt vmcnt(33)
  v_mfma_f32_32x32x16_bf16 v[12:27], v[172:175], v[180:183], v[12:27]
  buffer_load_dwordx4 v[156:159], v5, s[8:11], s26 offen offset:1024
  s_waitcnt vmcnt(33)
  v_mfma_f32_32x32x16_bf16 v[28:43], v[172:175], v[184:187], v[28:43]
  buffer_load_dwordx4 v[160:163], v5, s[8:11], s27 offen offset:1024
  v_mfma_f32_32x32x16_bf16 v[44:59], v[176:179], v[180:183], v[44:59]
  buffer_load_dwordx4 v[164:167], v5, s[12:15], s28 offen offset:1024
  v_mfma_f32_32x32x16_bf16 v[60:75], v[176:179], v[184:187], v[60:75]
  buffer_load_dwordx4 v[168:171], v5, s[12:15], s29 offen offset:1024
  s_waitcnt vmcnt(33)
  v_mfma_f32_32x32x16_bf16 v[12:27], v[188:191], v[196:199], v[12:27]
  buffer_load_dwordx4 v[172:175], v5, s[8:11], s26 offen offset:2048
  s_waitcnt vmcnt(33)
  v_mfma_f32_32x32x16_bf16 v[28:43], v[188:191], v[200:203], v[28:43]
  buffer_load_dwordx4 v[176:179], v5, s[8:11], s27 offen offset:2048
  v_mfma_f32_32x32x16_bf16 v[44:59], v[192:195], v[196:199], v[44:59]
  buffer_load_dwordx4 v[180:183], v5, s[12:15], s28 offen offset:2048
  v_mfma_f32_32x32x16_bf16 v[60:75], v[192:195], v[200:203], v[60:75]
  buffer_load_dwordx4 v[184:187], v5, s[12:15], s29 offen offset:2048
  s_waitcnt vmcnt(33)
  v_mfma_f32_32x32x16_bf16 v[12:27], v[204:207], v[212:215], v[12:27]
  buffer_load_dwordx4 v[188:191], v5, s[8:11], s26 offen offset:3072
  s_waitcnt vmcnt(33)
  v_mfma_f32_32x32x16_bf16 v[28:43], v[204:207], v[216:219], v[28:43]
  buffer_load_dwordx4 v[192:195], v5, s[8:11], s27 offen offset:3072
  v_mfma_f32_32x32x16_bf16 v[44:59], v[208:211], v[212:215], v[44:59]
  buffer_load_dwordx4 v[196:199], v5, s[12:15], s28 offen offset:3072
  v_mfma_f32_32x32x16_bf16 v[60:75], v[208:211], v[216:219], v[60:75]
  buffer_load_dwordx4 v[200:203], v5, s[12:15], s29 offen offset:3072
  s_waitcnt vmcnt(33)
  v_mfma_f32_32x32x16_bf16 v[12:27], v[220:223], v[228:231], v[12:27]
  buffer_load_dword v236, v244, s[16:19], s44 offen
  buffer_load_dword v237, v244, s[16:19], s45 offen
  buffer_load_dword v238, v244, s[16:19], s46 offen
  buffer_load_dword v239, v244, s[16:19], s47 offen
  buffer_load_dword v240, v244, s[16:19], s48 offen
  buffer_load_dword v241, v244, s[16:19], s49 offen
  buffer_load_dword v242, v244, s[16:19], s50 offen
  buffer_load_dword v243, v244, s[16:19], s51 offen
  s_waitcnt vmcnt(40)
  v_mfma_f32_32x32x16_bf16 v[28:43], v[220:223], v[232:235], v[28:43]
  v_mfma_f32_32x32x16_bf16 v[44:59], v[224:227], v[228:231], v[44:59]
  v_mfma_f32_32x32x16_bf16 v[60:75], v[224:227], v[232:235], v[60:75]
  s_waitcnt vmcnt(37)
  v_mfma_f32_32x32x16_bf16 v[12:27], v[76:79], v[84:87], v[12:27]
  s_waitcnt vmcnt(36)
  v_mfma_f32_32x32x16_bf16 v[28:43], v[76:79], v[88:91], v[28:43]
  v_mfma_f32_32x32x16_bf16 v[44:59], v[80:83], v[84:87], v[44:59]
  v_mfma_f32_32x32x16_bf16 v[60:75], v[80:83], v[88:91], v[60:75]
  s_waitcnt vmcnt(33)
  v_mfma_f32_32x32x16_bf16 v[12:27], v[92:95], v[100:103], v[12:27]
  s_waitcnt vmcnt(32)
  v_mfma_f32_32x32x16_bf16 v[28:43], v[92:95], v[104:107], v[28:43]
  v_mfma_f32_32x32x16_bf16 v[44:59], v[96:99], v[100:103], v[44:59]
  v_mfma_f32_32x32x16_bf16 v[60:75], v[96:99], v[104:107], v[60:75]
  s_waitcnt vmcnt(29)
  v_mfma_f32_32x32x16_bf16 v[12:27], v[108:111], v[116:119], v[12:27]
  s_waitcnt vmcnt(28)
  v_mfma_f32_32x32x16_bf16 v[28:43], v[108:111], v[120:123], v[28:43]
  v_mfma_f32_32x32x16_bf16 v[44:59], v[112:115], v[116:119], v[44:59]
  v_mfma_f32_32x32x16_bf16 v[60:75], v[112:115], v[120:123], v[60:75]
  s_waitcnt vmcnt(25)
  v_mfma_f32_32x32x16_bf16 v[12:27], v[124:127], v[132:135], v[12:27]
  s_waitcnt vmcnt(24)
  v_mfma_f32_32x32x16_bf16 v[28:43], v[124:127], v[136:139], v[28:43]
  v_mfma_f32_32x32x16_bf16 v[44:59], v[128:131], v[132:135], v[44:59]
  v_mfma_f32_32x32x16_bf16 v[60:75], v[128:131], v[136:139], v[60:75]
  s_waitcnt vmcnt(21)
  v_mfma_f32_32x32x16_bf16 v[12:27], v[140:143], v[148:151], v[12:27]
  s_waitcnt vmcnt(20)
  v_mfma_f32_32x32x16_bf16 v[28:43], v[140:143], v[152:155], v[28:43]
  v_mfma_f32_32x32x16_bf16 v[44:59], v[144:147], v[148:151], v[44:59]
  v_mfma_f32_32x32x16_bf16 v[60:75], v[144:147], v[152:155], v[60:75]
  s_waitcnt vmcnt(17)
  v_mfma_f32_32x32x16_bf16 v[12:27], v[156:159], v[164:167], v[12:27]
  s_waitcnt vmcnt(16)
  v_mfma_f32_32x32x16_bf16 v[28:43], v[156:159], v[168:171], v[28:43]
  v_mfma_f32_32x32x16_bf16 v[44:59], v[160:163], v[164:167], v[44:59]
  v_mfma_f32_32x32x16_bf16 v[60:75], v[160:163], v[168:171], v[60:75]
  s_waitcnt vmcnt(13)
  v_mfma_f32_32x32x16_bf16 v[12:27], v[172:175], v[180:183], v[12:27]
  s_waitcnt vmcnt(12)
  v_mfma_f32_32x32x16_bf16 v[28:43], v[172:175], v[184:187], v[28:43]
  v_mfma_f32_32x32x16_bf16 v[44:59], v[176:179], v[180:183], v[44:59]
  v_mfma_f32_32x32x16_bf16 v[60:75], v[176:179], v[184:187], v[60:75]
  s_waitcnt vmcnt(9)
  v_mfma_f32_32x32x16_bf16 v[12:27], v[188:191], v[196:199], v[12:27]
  s_waitcnt vmcnt(8)
  v_mfma_f32_32x32x16_bf16 v[28:43], v[188:191], v[200:203], v[28:43]
  v_mfma_f32_32x32x16_bf16 v[44:59], v[192:195], v[196:199], v[44:59]
  v_mfma_f32_32x32x16_bf16 v[60:75], v[192:195], v[200:203], v[60:75]
  v_mov_b32 v8, v5
  s_cmp_lg_u32 s3, 0
  s_cbranch_scc1 rq18
  s_nop 6
  ds_write_b128 v5, v[28:31] offset:20480
  ds_write_b128 v5, v[32:35] offset:21504
  ds_write_b128 v5, v[36:39] offset:22528
  ds_write_b128 v5, v[40:43] offset:23552
  ds_write_b128 v5, v[44:47] offset:28672
  ds_write_b128 v5, v[48:51] offset:29696
  ds_write_b128 v5, v[52:55] offset:30720
  ds_write_b128 v5, v[56:59] offset:31744
  ds_write_b128 v5, v[60:63] offset:36864
  ds_write_b128 v5, v[64:67] offset:37888
  ds_write_b128 v5, v[68:71] offset:38912
  ds_write_b128 v5, v[72:75] offset:39936
  s_waitcnt lgkmcnt(0)
  s_barrier
  ds_read_b128 v[76:79], v5 offset:0
  ds_read_b128 v[80:83], v5 offset:1024
  ds_read_b128 v[84:87], v5 offset:2048
  ds_read_b128 v[88:91], v5 offset:3072
  ds_read_b128 v[92:95], v5 offset:4096
  ds_read_b128 v[96:99], v5 offset:5120
  ds_read_b128 v[100:103], v5 offset:6144
  ds_read_b128 v[104:107], v5 offset:7168
  ds_read_b128 v[108:111], v5 offset:8192
  ds_read_b128 v[112:115], v5 offset:9216
  ds_read_b128 v[116:119], v5 offset:10240
  ds_read_b128 v[120:123], v5 offset:11264
  s_waitcnt lgkmcnt(11)
  v_add_f32 v124, v12, v76
  v_add_f32 v125, v13, v77
  v_add_f32 v126, v14, v78
  v_add_f32 v127, v15, v79
  s_waitcnt lgkmcnt(10)
  v_add_f32 v128, v16, v80
  v_add_f32 v129, v17, v81
  v_add_f32 v130, v18, v82
  v_add_f32 v131, v19, v83
  s_waitcnt lgkmcnt(9)
  v_add_f32 v132, v20, v84
  v_add_f32 v133, v21, v85
  v_add_f32 v134, v22, v86
  v_add_f32 v135, v23, v87
  s_waitcnt lgkmcnt(8)
  v_add_f32 v136, v24, v88
  v_add_f32 v137, v25, v89
  v_add_f32 v138, v26, v90
  v_add_f32 v139, v27, v91
  s_waitcnt lgkmcnt(3)
  v_add_f32 v92, v92, v108
  v_add_f32 v93, v93, v109
  v_add_f32 v94, v94, v110
  v_add_f32 v95, v95, v111
  s_waitcnt lgkmcnt(2)
  v_add_f32 v96, v96, v112
  v_add_f32 v97, v97, v113
  v_add_f32 v98, v98, v114
  v_add_f32 v99, v99, v115
  s_waitcnt lgkmcnt(1)
  v_add_f32 v100, v100, v116
  v_add_f32 v101, v101, v117
  v_add_f32 v102, v102, v118
  v_add_f32 v103, v103, v119
  s_waitcnt lgkmcnt(0)
  v_add_f32 v104, v104, v120
  v_add_f32 v105, v105, v121
  v_add_f32 v106, v106, v122
  v_add_f32 v107, v107, v123
  v_add_f32 v124, v124, v92
  v_add_f32 v125, v125, v93
  v_add_f32 v126, v126, v94
  v_add_f32 v127, v127, v95
  v_add_f32 v128, v128, v96
  v_add_f32 v129, v129, v97
  v_add_f32 v130, v130, v98
  v_add_f32 v131, v131, v99
  v_add_f32 v132, v132, v100
  v_add_f32 v133, v133, v101
  v_add_f32 v134, v134, v102
  v_add_f32 v135, v135, v103
  v_add_f32 v136, v136, v104
  v_add_f32 v137, v137, v105
  v_add_f32 v138, v138, v106
  v_add_f32 v139, v139, v107
  s_branch rd21
rq18:
  s_cmp_lg_u32 s3, 1
  s_cbranch_scc1 rq19
  s_nop 5
  ds_write_b128 v5, v[44:47] offset:32768
  ds_write_b128 v5, v[48:51] offset:33792
  ds_write_b128 v5, v[52:55] offset:34816
  ds_write_b128 v5, v[56:59] offset:35840
  ds_write_b128 v5, v[60:63] offset:40960
  ds_write_b128 v5, v[64:67] offset:41984
  ds_write_b128 v5, v[68:71] offset:43008
  ds_write_b128 v5, v[72:75] offset:44032
  ds_write_b128 v5, v[12:15] offset:0
  ds_write_b128 v5, v[16:19] offset:1024
  ds_write_b128 v5, v[20:23] offset:2048
  ds_write_b128 v5, v[24:27] offset:3072
  s_waitcnt lgkmcnt(0)
  s_barrier
  ds_read_b128 v[76:79], v5 offset:12288
  ds_read_b128 v[80:83], v5 offset:13312
  ds_read_b128 v[84:87], v5 offset:14336
  ds_read_b128 v[88:91], v5 offset:15360
  ds_read_b128 v[92:95], v5 offset:16384
  ds_read_b128 v[96:99], v5 offset:17408
  ds_read_b128 v[100:103], v5 offset:18432
  ds_read_b128 v[104:107], v5 offset:19456
  ds_read_b128 v[108:111], v5 offset:20480
  ds_read_b128 v[112:115], v5 offset:21504
  ds_read_b128 v[116:119], v5 offset:22528
  ds_read_b128 v[120:123], v5 offset:23552
  s_waitcnt lgkmcnt(11)
  v_add_f32 v124, v28, v76
  v_add_f32 v125, v29, v77
  v_add_f32 v126, v30, v78
  v_add_f32 v127, v31, v79
  s_waitcnt lgkmcnt(10)
  v_add_f32 v128, v32, v80
  v_add_f32 v129, v33, v81
  v_add_f32 v130, v34, v82
  v_add_f32 v131, v35, v83
  s_waitcnt lgkmcnt(9)
  v_add_f32 v132, v36, v84
  v_add_f32 v133, v37, v85
  v_add_f32 v134, v38, v86
  v_add_f32 v135, v39, v87
  s_waitcnt lgkmcnt(8)
  v_add_f32 v136, v40, v88
  v_add_f32 v137, v41, v89
  v_add_f32 v138, v42, v90
  v_add_f32 v139, v43, v91
  s_waitcnt lgkmcnt(3)
  v_add_f32 v92, v92, v108
  v_add_f32 v93, v93, v109
  v_add_f32 v94, v94, v110
  v_add_f32 v95, v95, v111
  s_waitcnt lgkmcnt(2)
  v_add_f32 v96, v96, v112
  v_add_f32 v97, v97, v113
  v_add_f32 v98, v98, v114
  v_add_f32 v99, v99, v115
  s_waitcnt lgkmcnt(1)
  v_add_f32 v100, v100, v116
  v_add_f32 v101, v101, v117
  v_add_f32 v102, v102, v118
  v_add_f32 v103, v103, v119
  s_waitcnt lgkmcnt(0)
  v_add_f32 v104, v104, v120
  v_add_f32 v105, v105, v121
  v_add_f32 v106, v106, v122
  v_add_f32 v107, v107, v123
  v_add_f32 v124, v124, v92
  v_add_f32 v125, v125, v93
  v_add_f32 v126, v126, v94
  v_add_f32 v127, v127, v95
  v_add_f32 v128, v128, v96
  v_add_f32 v129, v129, v97
  v_add_f32 v130, v130, v98
  v_add_f32 v131, v131, v99
  v_add_f32 v132, v132, v100
  v_add_f32 v133, v133, v101
  v_add_f32 v134, v134, v102
  v_add_f32 v135, v135, v103
  v_add_f32 v136, v136, v104
  v_add_f32 v137, v137, v105
  v_add_f32 v138, v138, v106
  v_add_f32 v139, v139, v107
  s_branch rd21
rq19:
  s_cmp_lg_u32 s3, 2
  s_cbranch_scc1 rq20
  s_nop 4
  ds_write_b128 v5, v[60:63] offset:45056
  ds_write_b128 v5, v[64:67] offset:46080
  ds_write_b128 v5, v[68:71] offset:47104
  ds_write_b128 v5, v[72:75] offset:48128
  ds_write_b128 v5, v[12:15] offset:4096
  ds_write_b128 v5, v[16:19] offset:5120
  ds_write_b128 v5, v[20:23] offset:6144
  ds_write_b128 v5, v[24:27] offset:7168
  ds_write_b128 v5, v[28:31] offset:12288
  ds_write_b128 v5, v[32:35] offset:13312
  ds_write_b128 v5, v[36:39] offset:14336
  ds_write_b128 v5, v[40:43] offset:15360
  s_waitcnt lgkmcnt(0)
  s_barrier
  ds_read_b128 v[76:79], v5 offset:24576
  ds_read_b128 v[80:83], v5 offset:25600
  ds_read_b128 v[84:87], v5 offset:26624
  ds_read_b128 v[88:91], v5 offset:27648
  ds_read_b128 v[92:95], v5 offset:28672
  ds_read_b128 v[96:99], v5 offset:29696
  ds_read_b128 v[100:103], v5 offset:30720
  ds_read_b128 v[104:107], v5 offset:31744
  ds_read_b128 v[108:111], v5 offset:32768
  ds_read_b128 v[112:115], v5 offset:33792
  ds_read_b128 v[116:119], v5 offset:34816
  ds_read_b128 v[120:123], v5 offset:35840
  s_waitcnt lgkmcnt(11)
  v_add_f32 v124, v44, v76
  v_add_f32 v125, v45, v77
  v_add_f32 v126, v46, v78
  v_add_f32 v127, v47, v79
  s_waitcnt lgkmcnt(10)
  v_add_f32 v128, v48, v80
  v_add_f32 v129, v49, v81
  v_add_f32 v130, v50, v82
  v_add_f32 v131, v51, v83
  s_waitcnt lgkmcnt(9)
  v_add_f32 v132, v52, v84
  v_add_f32 v133, v53, v85
  v_add_f32 v134, v54, v86
  v_add_f32 v135, v55, v87
  s_waitcnt lgkmcnt(8)
  v_add_f32 v136, v56, v88
  v_add_f32 v137, v57, v89
  v_add_f32 v138, v58, v90
  v_add_f32 v139, v59, v91
  s_waitcnt lgkmcnt(3)
  v_add_f32 v92, v92, v108
  v_add_f32 v93, v93, v109
  v_add_f32 v94, v94, v110
  v_add_f32 v95, v95, v111
  s_waitcnt lgkmcnt(2)
  v_add_f32 v96, v96, v112
  v_add_f32 v97, v97, v113
  v_add_f32 v98, v98, v114
  v_add_f32 v99, v99, v115
  s_waitcnt lgkmcnt(1)
  v_add_f32 v100, v100, v116
  v_add_f32 v101, v101, v117
  v_add_f32 v102, v102, v118
  v_add_f32 v103, v103, v119
  s_waitcnt lgkmcnt(0)
  v_add_f32 v104, v104, v120
  v_add_f32 v105, v105, v121
  v_add_f32 v106, v106, v122
  v_add_f32 v107, v107, v123
  v_add_f32 v124, v124, v92
  v_add_f32 v125, v125, v93
  v_add_f32 v126, v126, v94
  v_add_f32 v127, v127, v95
  v_add_f32 v128, v128, v96
  v_add_f32 v129, v129, v97
  v_add_f32 v130, v130, v98
  v_add_f32 v131, v131, v99
  v_add_f32 v132, v132, v100
  v_add_f32 v133, v133, v101
  v_add_f32 v134, v134, v102
  v_add_f32 v135, v135, v103
  v_add_f32 v136, v136, v104
  v_add_f32 v137, v137, v105
  v_add_f32 v138, v138, v106
  v_add_f32 v139, v139, v107
  s_branch rd21
rq20:
  s_nop 0
  ds_write_b128 v5, v[12:15] offset:8192
  ds_write_b128 v5, v[16:19] offset:9216
  ds_write_b128 v5, v[20:23] offset:10240
  ds_write_b128 v5, v[24:27] offset:11264
  ds_write_b128 v5, v[28:31] offset:16384
  ds_write_b128 v5, v[32:35] offset:17408
  ds_write_b128 v5, v[36:39] offset:18432
  ds_write_b128 v5, v[40:43] offset:19456
  ds_write_b128 v5, v[44:47] offset:24576
  ds_write_b128 v5, v[48:51] offset:25600
  ds_write_b128 v5, v[52:55] offset:26624
  ds_write_b128 v5, v[56:59] offset:27648
  s_waitcnt lgkmcnt(0)
  s_barrier
  ds_read_b128 v[76:79], v5 offset:36864
  ds_read_b128 v[80:83], v5 offset:37888
  ds_read_b128 v[84:87], v5 offset:38912
  ds_read_b128 v[88:91], v5 offset:39936
  ds_read_b128 v[92:95], v5 offset:40960
  ds_read_b128 v[96:99], v5 offset:41984
  ds_read_b128 v[100:103], v5 offset:43008
  ds_read_b128 v[104:107], v5 offset:44032
  ds_read_b128 v[108:111], v5 offset:45056
  ds_read_b128 v[112:115], v5 offset:46080
  ds_read_b128 v[116:119], v5 offset:47104
  ds_read_b128 v[120:123], v5 offset:48128
  s_waitcnt lgkmcnt(11)
  v_add_f32 v124, v60, v76
  v_add_f32 v125, v61, v77
  v_add_f32 v126, v62, v78
  v_add_f32 v127, v63, v79
  s_waitcnt lgkmcnt(10)
  v_add_f32 v128, v64, v80
  v_add_f32 v129, v65, v81
  v_add_f32 v130, v66, v82
  v_add_f32 v131, v67, v83
  s_waitcnt lgkmcnt(9)
  v_add_f32 v132, v68, v84
  v_add_f32 v133, v69, v85
  v_add_f32 v134, v70, v86
  v_add_f32 v135, v71, v87
  s_waitcnt lgkmcnt(8)
  v_add_f32 v136, v72, v88
  v_add_f32 v137, v73, v89
  v_add_f32 v138, v74, v90
  v_add_f32 v139, v75, v91
  s_waitcnt lgkmcnt(3)
  v_add_f32 v92, v92, v108
  v_add_f32 v93, v93, v109
  v_add_f32 v94, v94, v110
  v_add_f32 v95, v95, v111
  s_waitcnt lgkmcnt(2)
  v_add_f32 v96, v96, v112
  v_add_f32 v97, v97, v113
  v_add_f32 v98, v98, v114
  v_add_f32 v99, v99, v115
  s_waitcnt lgkmcnt(1)
  v_add_f32 v100, v100, v116
  v_add_f32 v101, v101, v117
  v_add_f32 v102, v102, v118
  v_add_f32 v103, v103, v119
  s_waitcnt lgkmcnt(0)
  v_add_f32 v104, v104, v120
  v_add_f32 v105, v105, v121
  v_add_f32 v106, v106, v122
  v_add_f32 v107, v107, v123
  v_add_f32 v124, v124, v92
  v_add_f32 v125, v125, v93
  v_add_f32 v126, v126, v94
  v_add_f32 v127, v127, v95
  v_add_f32 v128, v128, v96
  v_add_f32 v129, v129, v97
  v_add_f32 v130, v130, v98
  v_add_f32 v131, v131, v99
  v_add_f32 v132, v132, v100
  v_add_f32 v133, v133, v101
  v_add_f32 v134, v134, v102
  v_add_f32 v135, v135, v103
  v_add_f32 v136, v136, v104
  v_add_f32 v137, v137, v105
  v_add_f32 v138, v138, v106
  v_add_f32 v139, v139, v107
rd21:
  s_waitcnt vmcnt(7)
  v_lshlrev_b32 v140, 16, v236
  v_and_b32 v141, 0xffff0000, v236
  s_waitcnt vmcnt(6)
  v_lshlrev_b32 v142, 16, v237
  v_and_b32 v143, 0xffff0000, v237
  s_waitcnt vmcnt(5)
  v_lshlrev_b32 v144, 16, v238
  v_and_b32 v145, 0xffff0000, v238
  s_waitcnt vmcnt(4)
  v_lshlrev_b32 v146, 16, v239
  v_and_b32 v147, 0xffff0000, v239
  s_waitcnt vmcnt(3)
  v_lshlrev_b32 v148, 16, v240
  v_and_b32 v149, 0xffff0000, v240
  s_waitcnt vmcnt(2)
  v_lshlrev_b32 v150, 16, v241
  v_and_b32 v151, 0xffff0000, v241
  s_waitcnt vmcnt(1)
  v_lshlrev_b32 v152, 16, v242
  v_and_b32 v153, 0xffff0000, v242
  s_waitcnt vmcnt(0)
  v_lshlrev_b32 v154, 16, v243
  v_and_b32 v155, 0xffff0000, v243
  v_add_f32 v124, v124, v140
  v_add_f32 v125, v125, v141
  v_add_f32 v126, v126, v142
  v_add_f32 v127, v127, v143
  v_add_f32 v128, v128, v144
  v_add_f32 v129, v129, v145
  v_add_f32 v130, v130, v146
  v_add_f32 v131, v131, v147
  v_add_f32 v132, v132, v148
  v_add_f32 v133, v133, v149
  v_add_f32 v134, v134, v150
  v_add_f32 v135, v135, v151
  v_add_f32 v136, v136, v152
  v_add_f32 v137, v137, v153
  v_add_f32 v138, v138, v154
  v_add_f32 v139, v139, v155
  v_cvt_pk_bf16_f32 v204, v124, v125
  v_cvt_pk_bf16_f32 v205, v126, v127
  v_cvt_pk_bf16_f32 v206, v128, v129
  v_cvt_pk_bf16_f32 v207, v130, v131
  v_cvt_pk_bf16_f32 v208, v132, v133
  v_cvt_pk_bf16_f32 v209, v134, v135
  v_cvt_pk_bf16_f32 v210, v136, v137
  v_cvt_pk_bf16_f32 v211, v138, v139
  buffer_store_dword v204, v244, s[36:39], s44 offen sc0 sc1
  buffer_store_dword v205, v244, s[36:39], s45 offen sc0 sc1
  buffer_store_dword v206, v244, s[36:39], s46 offen sc0 sc1
  buffer_store_dword v207, v244, s[36:39], s47 offen sc0 sc1
  buffer_store_dword v208, v244, s[36:39], s48 offen sc0 sc1
  buffer_store_dword v209, v244, s[36:39], s49 offen sc0 sc1
  buffer_store_dword v210, v244, s[36:39], s50 offen sc0 sc1
  buffer_store_dword v211, v244, s[36:39], s51 offen sc0 sc1
  s_cmp_eq_u32 s32, 0
  s_cselect_b32 s52, -1, 0
  s_mov_b32 s53, 0
  v_mov_b32 v9, 0
  v_cndmask_b32 v125, v125, v9, s[52:53]
  v_mul_f32 v8, v124, v124
  v_mul_f32 v9, v125, v125
  v_fmac_f32 v8, v126, v126
  v_fmac_f32 v9, v127, v127
  v_fmac_f32 v8, v128, v128
  v_fmac_f32 v9, v129, v129
  v_fmac_f32 v8, v130, v130
  v_fmac_f32 v9, v131, v131
  v_fmac_f32 v8, v132, v132
  v_fmac_f32 v9, v133, v133
  v_fmac_f32 v8, v134, v134
  v_fmac_f32 v9, v135, v135
  v_fmac_f32 v8, v136, v136
  v_fmac_f32 v9, v137, v137
  v_fmac_f32 v8, v138, v138
  v_fmac_f32 v9, v139, v139
  v_add_f32 v8, v8, v9
  v_mov_b32 v9, v8
  s_nop 1
  v_permlane32_swap_b32 v8, v9
  v_add_f32 v8, v8, v9
  v_lshlrev_b32 v9, 2, v6
  s_lshl_b32 s35, s33, 7
  s_mov_b32 exec_lo, -1
  s_mov_b32 exec_hi, 0
  buffer_atomic_add_f32 v8, v9, s[40:43], s35 offen
  s_endpgm
he15:
  s_endpgm
.section .rodata,"a"
.p2align 6
.amdhsa_kernel q3_kernel
  .amdhsa_next_free_vgpr 245
  .amdhsa_next_free_sgpr 102
  .amdhsa_accum_offset 248
  .amdhsa_group_segment_fixed_size 0
  .amdhsa_kernarg_size 80
  .amdhsa_user_sgpr_count 2
  .amdhsa_user_sgpr_kernarg_segment_ptr 1
  .amdhsa_system_sgpr_workgroup_id_x 1
.end_amdhsa_kernel
.text
.globl q4_kernel
.p2align 8
.type q4_kernel,@function
q4_kernel:
L_q4_kernel:
  s_cmp_ge_u32 s2, 368
  s_cbranch_scc1 ce22
  s_load_dwordx2 s[4:5], s[0:1], 72
  v_lshrrev_b32 v1, 6, v0
  s_nop 0
  v_readfirstlane_b32 s3, v1
  s_cmp_ge_u32 s2, 256
  s_cbranch_scc1 cw23
  s_getpc_b64 s[96:97]
pf24:
  s_mov_b32 s98, text_end-pf24
  s_mov_b32 s99, 0x20000
  v_lshlrev_b32 v2, 6, v0
  buffer_load_dword v3, v2, s[96:99], 0 offen
  s_getpc_b64 s[6:7]
  s_add_u32 s6, s6, CT@rel32@lo+4
  s_addc_u32 s7, s7, CT@rel32@hi+12
  s_lshl_b32 s28, s2, 13
  s_add_u32 s29, s28, 0x400000
  s_waitcnt lgkmcnt(0)
  s_add_u32 s12, s4, s29
  s_addc_u32 s13, s5, 0
  s_mov_b32 s14, 0x2000
  s_mov_b32 s15, 0x20000
  s_add_u32 s16, s4, 0x1a02000
  s_addc_u32 s17, s5, 0
  s_mov_b32 s18, 0x2000
  s_mov_b32 s19, 0x20000
  v_lshlrev_b32 v20, 5, v0
  buffer_load_dwordx4 v[4:7], v20, s[12:15], 0 offen
  buffer_load_dwordx4 v[8:11], v20, s[12:15], 0 offen offset:16
  buffer_load_dwordx4 v[12:15], v20, s[16:19], 0 offen
  buffer_load_dwordx4 v[16:19], v20, s[16:19], 0 offen offset:16
  s_add_u32 s29, s28, 0x1800000
  s_add_u32 s20, s4, s29
  s_addc_u32 s21, s5, 0
  s_mov_b32 s22, 0x2000
  s_mov_b32 s23, 0x20000
  v_lshlrev_b32 v32, 4, v0
  s_movk_i32 s37, 0x1000
  s_mov_b32 s8, s6
  s_mov_b32 s9, s7
  s_mov_b32 s10, 0xd000
  s_mov_b32 s11, 0x20000
  s_add_u32 s29, s28, 0x600000
  s_add_u32 s24, s4, s29
  s_addc_u32 s25, s5, 0
  s_mov_b32 s26, 0x2000
  s_mov_b32 s27, 0x20000
  v_and_b32 v22, 63, v0
  v_lshlrev_b32 v21, 4, v22
  s_and_b32 s30, s3, 1
  s_lshr_b32 s31, s3, 1
  s_lshl_b32 s32, s31, 12
  s_add_u32 s33, s32, 8192
  buffer_load_dwordx4 v[36:39], v21, s[8:11], s32 offen offset:0
  buffer_load_dwordx4 v[52:55], v21, s[8:11], s33 offen offset:0
  buffer_load_dwordx4 v[40:43], v21, s[8:11], s32 offen offset:1024
  buffer_load_dwordx4 v[56:59], v21, s[8:11], s33 offen offset:1024
  buffer_load_dwordx4 v[44:47], v21, s[8:11], s32 offen offset:2048
  buffer_load_dwordx4 v[60:63], v21, s[8:11], s33 offen offset:2048
  buffer_load_dwordx4 v[48:51], v21, s[8:11], s32 offen offset:3072
  buffer_load_dwordx4 v[64:67], v21, s[8:11], s33 offen offset:3072
  s_lshl_b32 s34, s3, 12
  s_add_u32 s35, s34, 36864
  s_add_u32 s34, s34, 20480
  buffer_load_dwordx4 v[84:87], v21, s[8:11], s34 offen offset:0
  buffer_load_dwordx4 v[88:91], v21, s[8:11], s34 offen offset:1024
  buffer_load_dwordx4 v[92:95], v21, s[8:11], s34 offen offset:2048
  buffer_load_dwordx4 v[96:99], v21, s[8:11], s34 offen offset:3072
  s_mov_b32 s36, 16384
  buffer_load_dwordx4 v[100:103], v21, s[8:11], s36 offen offset:0
  buffer_load_dwordx4 v[108:111], v21, s[8:11], s36 offen offset:2048
  buffer_load_dwordx4 v[104:107], v21, s[8:11], s36 offen offset:1024
  buffer_load_dwordx4 v[112:115], v21, s[8:11], s36 offen offset:3072
  buffer_load_dwordx4 v[24:27], v32, s[20:23], 0 offen
  buffer_load_dwordx4 v[28:31], v32, s[20:23], s37 offen
  buffer_load_dwordx4 v[124:127], v21, s[8:11], s35 offen offset:0
  buffer_load_dwordx4 v[128:131], v21, s[8:11], s35 offen offset:1024
  buffer_load_dwordx4 v[132:135], v21, s[8:11], s35 offen offset:2048
  buffer_load_dwordx4 v[136:139], v21, s[8:11], s35 offen offset:3072
  v_and_b32 v140, 15, v22
  v_lshrrev_b32 v141, 4, v22
  v_lshlrev_b32 v142, 7, v140
  v_lshl_or_b32 v142, v141, 4, v142
  s_lshl_b32 s38, s31, 12
  s_lshl_b32 s39, s30, 6
  s_add_u32 s38, s38, s39
  buffer_load_dwordx4 v[148:151], v142, s[12:15], s38 offen offset:0
  buffer_load_dwordx4 v[152:155], v142, s[12:15], s38 offen offset:2048
  s_mov_b32 s40, 0x3b000000
  s_cmp_eq_u32 s2, 0
  s_cselect_b32 s41, 0, 0xffff0000
  s_cselect_b32 s43, 0, 0x3a000000
  s_mov_b32 s42, 0x3a000000
  s_mov_b32 s44, 0x80008000
  v_mov_b32 v156, 0x3727c5ac
  v_bfe_u32 v143, v0, 5, 1
  v_lshlrev_b32 v143, 1, v143
  v_xor_b32 v143, v143, v0
  v_and_b32 v143, 3, v143
  v_lshlrev_b32 v143, 4, v143
  v_lshrrev_b32 v144, 2, v0
  v_lshl_or_b32 v157, v144, 6, v143
  v_bfe_u32 v143, v22, 2, 2
  v_lshl_add_u32 v143, v141, 3, v143
  v_lshlrev_b32 v143, 6, v143
  v_xor_b32 v144, s30, v141
  v_and_b32 v144, 1, v144
  v_lshl_or_b32 v143, v144, 5, v143
  v_and_b32 v144, 3, v22
  v_lshl_or_b32 v158, v144, 3, v143
  v_lshrrev_b32 v143, 2, v140
  v_sub_u32 v143, 0, v143
  v_xor_b32 v143, v143, v141
  v_and_b32 v143, 3, v143
  v_lshlrev_b32 v164, 4, v143
  v_lshl_or_b32 v164, v140, 6, v164
  s_lshl_b32 s45, s31, 11
  s_lshl_b32 s46, s30, 3
  s_add_u32 s45, s45, s46
  s_add_u32 s45, s45, 8192
  v_add_u32 v159, s45, v164
  s_lshl_b32 s45, s3, 10
  s_add_u32 s45, s45, 8192
  v_add_u32 v160, s45, v164
  v_lshrrev_b32 v143, 1, v141
  s_lshl_b32 s45, s3, 1
  v_add_u32 v143, s45, v143
  v_xor_b32 v143, v143, v140
  v_and_b32 v143, 7, v143
  v_lshlrev_b32 v143, 4, v143
  v_and_b32 v144, 1, v141
  v_lshl_or_b32 v143, v144, 3, v143
  v_lshl_or_b32 v143, v140, 7, v143
  v_add_u32 v161, 16384, v143
  v_add_u32 v143, 0, v141
  v_xor_b32 v143, v143, v140
  v_and_b32 v143, 7, v143
  v_lshlrev_b32 v143, 4, v143
  v_lshl_or_b32 v143, v140, 7, v143
  s_lshl_b32 s45, s30, 11
  s_add_u32 s45, s45, 16384
  v_add_u32 v162, s45, v143
  v_add_u32 v143, 4, v141
  v_xor_b32 v143, v143, v140
  v_and_b32 v143, 7, v143
  v_lshlrev_b32 v143, 4, v143
  v_lshl_or_b32 v143, v140, 7, v143
  s_lshl_b32 s45, s30, 11
  s_add_u32 s45, s45, 16384
  v_add_u32 v163, s45, v143
  s_waitcnt vmcnt(25)
  v_fma_f32 v12, v12, s40, v156
  v_fma_f32 v13, v13, s40, v156
  v_fma_f32 v14, v14, s40, v156
  v_fma_f32 v15, v15, s40, v156
  s_waitcnt vmcnt(24)
  v_fma_f32 v16, v16, s40, v156
  v_fma_f32 v17, v17, s40, v156
  v_fma_f32 v18, v18, s40, v156
  v_fma_f32 v19, v19, s40, v156
  v_rsq_f32 v12, v12
  v_rsq_f32 v13, v13
  v_rsq_f32 v14, v14
  v_rsq_f32 v15, v15
  v_rsq_f32 v16, v16
  v_rsq_f32 v17, v17
  v_rsq_f32 v18, v18
  v_rsq_f32 v19, v19
  v_lshlrev_b32 v168, 16, v4
  v_and_b32 v176, s41, v4
  v_lshlrev_b32 v169, 16, v5
  v_and_b32 v177, s41, v5
  v_lshlrev_b32 v170, 16, v6
  v_and_b32 v178, s41, v6
  v_lshlrev_b32 v171, 16, v7
  v_and_b32 v179, s41, v7
  v_lshlrev_b32 v172, 16, v8
  v_and_b32 v180, s41, v8
  v_lshlrev_b32 v173, 16, v9
  v_and_b32 v181, s41, v9
  v_lshlrev_b32 v174, 16, v10
  v_and_b32 v182, s41, v10
  v_lshlrev_b32 v175, 16, v11
  v_and_b32 v183, s41, v11
  v_mul_f32 v168, v168, v12
  v_mul_f32 v176, v176, v12
  v_mul_f32 v169, v169, v13
  v_mul_f32 v177, v177, v13
  v_mul_f32 v170, v170, v14
  v_mul_f32 v178, v178, v14
  v_mul_f32 v171, v171, v15
  v_mul_f32 v179, v179, v15
  v_mul_f32 v172, v172, v16
  v_mul_f32 v180, v180, v16
  v_mul_f32 v173, v173, v17
  v_mul_f32 v181, v181, v17
  v_mul_f32 v174, v174, v18
  v_mul_f32 v182, v182, v18
  v_mul_f32 v175, v175, v19
  v_mul_f32 v183, v183, v19
  v_cvt_pk_bf16_f32 v184, v168, v169
  v_cvt_pk_bf16_f32 v185, v170, v171
  v_cvt_pk_bf16_f32 v186, v172, v173
  v_cvt_pk_bf16_f32 v187, v174, v175
  ds_write_b128 v157, v[184:187] offset:0
  v_cvt_pk_bf16_f32 v188, v176, v177
  v_cvt_pk_bf16_f32 v189, v178, v179
  v_cvt_pk_bf16_f32 v190, v180, v181
  v_cvt_pk_bf16_f32 v191, v182, v183
  ds_write_b128 v157, v[188:191] offset:4096
  s_waitcnt vmcnt(22)
  v_xor_b32 v68, s44, v52
  v_xor_b32 v69, s44, v53
  v_xor_b32 v70, s44, v54
  v_xor_b32 v71, s44, v55
  s_waitcnt vmcnt(20)
  v_xor_b32 v72, s44, v56
  v_xor_b32 v73, s44, v57
  v_xor_b32 v74, s44, v58
  v_xor_b32 v75, s44, v59
  s_waitcnt vmcnt(18)
  v_xor_b32 v76, s44, v60
  v_xor_b32 v77, s44, v61
  v_xor_b32 v78, s44, v62
  v_xor_b32 v79, s44, v63
  s_waitcnt vmcnt(16)
  v_xor_b32 v80, s44, v64
  v_xor_b32 v81, s44, v65
  v_xor_b32 v82, s44, v66
  v_xor_b32 v83, s44, v67
  s_waitcnt lgkmcnt(0)
  s_barrier
  ds_read_b64_tr_b16 v[168:169], v158 offset:0
  ds_read_b64_tr_b16 v[170:171], v158 offset:256
  ds_read_b64_tr_b16 v[172:173], v158 offset:4096
  ds_read_b64_tr_b16 v[174:175], v158 offset:4352
  ds_read_b64_tr_b16 v[176:177], v158 offset:2048
  ds_read_b64_tr_b16 v[178:179], v158 offset:2304
  ds_read_b64_tr_b16 v[180:181], v158 offset:6144
  ds_read_b64_tr_b16 v[182:183], v158 offset:6400
  s_waitcnt lgkmcnt(6)
  v_mfma_f32_16x16x32_bf16 v[200:203], v[168:171], v[36:39], 0
  v_mfma_f32_16x16x32_bf16 v[204:207], v[168:171], v[44:47], 0
  s_waitcnt lgkmcnt(4)
  v_mfma_f32_16x16x32_bf16 v[208:211], v[172:175], v[36:39], 0
  v_mfma_f32_16x16x32_bf16 v[212:215], v[172:175], v[44:47], 0
  v_mfma_f32_16x16x32_bf16 v[200:203], v[172:175], v[52:55], v[200:203]
  v_mfma_f32_16x16x32_bf16 v[204:207], v[172:175], v[60:63], v[204:207]
  v_mfma_f32_16x16x32_bf16 v[208:211], v[168:171], v[68:71], v[208:211]
  v_mfma_f32_16x16x32_bf16 v[212:215], v[168:171], v[76:79], v[212:215]
  s_waitcnt lgkmcnt(2)
  v_mfma_f32_16x16x32_bf16 v[200:203], v[176:179], v[40:43], v[200:203]
  v_mfma_f32_16x16x32_bf16 v[204:207], v[176:179], v[48:51], v[204:207]
  s_waitcnt lgkmcnt(0)
  v_mfma_f32_16x16x32_bf16 v[208:211], v[180:183], v[40:43], v[208:211]
  v_mfma_f32_16x16x32_bf16 v[212:215], v[180:183], v[48:51], v[212:215]
  v_mfma_f32_16x16x32_bf16 v[200:203], v[180:183], v[56:59], v[200:203]
  v_mfma_f32_16x16x32_bf16 v[204:207], v[180:183], v[64:67], v[204:207]
  v_mfma_f32_16x16x32_bf16 v[208:211], v[176:179], v[72:75], v[208:211]
  v_mfma_f32_16x16x32_bf16 v[212:215], v[176:179], v[80:83], v[212:215]
  s_waitcnt vmcnt(10)
  v_xor_b32 v116, s44, v108
  v_xor_b32 v117, s44, v109
  v_xor_b32 v118, s44, v110
  v_xor_b32 v119, s44, v111
  s_waitcnt vmcnt(8)
  v_xor_b32 v120, s44, v112
  v_xor_b32 v121, s44, v113
  v_xor_b32 v122, s44, v114
  v_xor_b32 v123, s44, v115
  v_mul_f32 v168, v208, v88
  v_mul_f32 v172, v200, v88
  v_mul_f32 v169, v209, v89
  v_mul_f32 v173, v201, v89
  v_mul_f32 v170, v210, v90
  v_mul_f32 v174, v202, v90
  v_mul_f32 v171, v211, v91
  v_mul_f32 v175, v203, v91
  v_fma_f32 v168, v200, v84, v168
  v_fma_f32 v172, v208, v84, -v172
  v_fma_f32 v169, v201, v85, v169
  v_fma_f32 v173, v209, v85, -v173
  v_fma_f32 v170, v202, v86, v170
  v_fma_f32 v174, v210, v86, -v174
  v_fma_f32 v171, v203, v87, v171
  v_fma_f32 v175, v211, v87, -v175
  v_cvt_pk_bf16_f32 v216, v168, v169
  v_cvt_pk_bf16_f32 v218, v172, v173
  v_cvt_pk_bf16_f32 v217, v170, v171
  v_cvt_pk_bf16_f32 v219, v174, v175
  ds_write_b64 v159, v[216:217] offset:0
  ds_write_b64 v159, v[218:219] offset:4096
  v_mul_f32 v176, v212, v96
  v_mul_f32 v180, v204, v96
  v_mul_f32 v177, v213, v97
  v_mul_f32 v181, v205, v97
  v_mul_f32 v178, v214, v98
  v_mul_f32 v182, v206, v98
  v_mul_f32 v179, v215, v99
  v_mul_f32 v183, v207, v99
  v_fma_f32 v176, v204, v92, v176
  v_fma_f32 v180, v212, v92, -v180
  v_fma_f32 v177, v205, v93, v177
  v_fma_f32 v181, v213, v93, -v181
  v_fma_f32 v178, v206, v94, v178
  v_fma_f32 v182, v214, v94, -v182
  v_fma_f32 v179, v207, v95, v179
  v_fma_f32 v183, v215, v95, -v183
  v_cvt_pk_bf16_f32 v220, v176, v177
  v_cvt_pk_bf16_f32 v222, v180, v181
  v_cvt_pk_bf16_f32 v221, v178, v179
  v_cvt_pk_bf16_f32 v223, v182, v183
  ds_write_b64 v159, v[220:221] offset:1024
  ds_write_b64 v159, v[222:223] offset:5120
  s_waitcnt vmcnt(7)
  v_lshlrev_b32 v232, 16, v24
  v_and_b32 v24, 0xffff0000, v24
  v_lshlrev_b32 v233, 16, v25
  v_and_b32 v25, 0xffff0000, v25
  v_lshlrev_b32 v234, 16, v26
  v_and_b32 v26, 0xffff0000, v26
  v_lshlrev_b32 v235, 16, v27
  v_and_b32 v27, 0xffff0000, v27
  s_waitcnt vmcnt(6)
  v_lshlrev_b32 v236, 16, v28
  v_and_b32 v28, 0xffff0000, v28
  v_lshlrev_b32 v237, 16, v29
  v_and_b32 v29, 0xffff0000, v29
  v_lshlrev_b32 v238, 16, v30
  v_and_b32 v30, 0xffff0000, v30
  v_lshlrev_b32 v239, 16, v31
  v_and_b32 v31, 0xffff0000, v31
  s_waitcnt lgkmcnt(0)
  s_barrier
  ds_read_b128 v[168:171], v160
  ds_read_b128 v[172:175], v160 offset:4096
  s_waitcnt lgkmcnt(1)
  v_mfma_f32_16x16x32_bf16 v[200:203], v[100:103], v[168:171], 0
  v_mfma_f32_16x16x32_bf16 v[204:207], v[104:107], v[168:171], 0
  v_mfma_f32_16x16x32_bf16 v[208:211], v[116:119], v[168:171], 0
  v_mfma_f32_16x16x32_bf16 v[212:215], v[120:123], v[168:171], 0
  s_waitcnt lgkmcnt(0)
  v_mfma_f32_16x16x32_bf16 v[200:203], v[108:111], v[172:175], v[200:203]
  v_mfma_f32_16x16x32_bf16 v[204:207], v[112:115], v[172:175], v[204:207]
  v_mfma_f32_16x16x32_bf16 v[208:211], v[100:103], v[172:175], v[208:211]
  v_mfma_f32_16x16x32_bf16 v[212:215], v[104:107], v[172:175], v[212:215]
  s_nop 6
  v_mul_f32 v176, v208, v24
  v_mul_f32 v180, v208, v232
  v_mul_f32 v177, v209, v25
  v_mul_f32 v181, v209, v233
  v_mul_f32 v178, v210, v26
  v_mul_f32 v182, v210, v234
  v_mul_f32 v179, v211, v27
  v_mul_f32 v183, v211, v235
  v_fma_f32 v176, v200, v232, -v176
  v_fma_f32 v180, v200, v24, v180
  v_fma_f32 v177, v201, v233, -v177
  v_fma_f32 v181, v201, v25, v181
  v_fma_f32 v178, v202, v234, -v178
  v_fma_f32 v182, v202, v26, v182
  v_fma_f32 v179, v203, v235, -v179
  v_fma_f32 v183, v203, v27, v183
  v_cvt_pk_bf16_f32 v216, v176, v177
  v_cvt_pk_bf16_f32 v220, v180, v181
  v_cvt_pk_bf16_f32 v217, v178, v179
  v_cvt_pk_bf16_f32 v221, v182, v183
  v_mul_f32 v184, v212, v28
  v_mul_f32 v188, v212, v236
  v_mul_f32 v185, v213, v29
  v_mul_f32 v189, v213, v237
  v_mul_f32 v186, v214, v30
  v_mul_f32 v190, v214, v238
  v_mul_f32 v187, v215, v31
  v_mul_f32 v191, v215, v239
  v_fma_f32 v184, v204, v236, -v184
  v_fma_f32 v188, v204, v28, v188
  v_fma_f32 v185, v205, v237, -v185
  v_fma_f32 v189, v205, v29, v189
  v_fma_f32 v186, v206, v238, -v186
  v_fma_f32 v190, v206, v30, v190
  v_fma_f32 v187, v207, v239, -v187
  v_fma_f32 v191, v207, v31, v191
  v_cvt_pk_bf16_f32 v218, v184, v185
  v_cvt_pk_bf16_f32 v222, v188, v189
  v_cvt_pk_bf16_f32 v219, v186, v187
  v_cvt_pk_bf16_f32 v223, v190, v191
  s_nop 0
  v_mfma_f32_16x16x32_bf16 v[4:7], v[216:219], v[100:103], 0
  v_mfma_f32_16x16x32_bf16 v[8:11], v[216:219], v[104:107], 0
  v_mfma_f32_16x16x32_bf16 v[12:15], v[216:219], v[108:111], 0
  v_mfma_f32_16x16x32_bf16 v[16:19], v[216:219], v[112:115], 0
  v_mfma_f32_16x16x32_bf16 v[4:7], v[220:223], v[116:119], v[4:7]
  v_mfma_f32_16x16x32_bf16 v[8:11], v[220:223], v[120:123], v[8:11]
  v_mfma_f32_16x16x32_bf16 v[12:15], v[220:223], v[100:103], v[12:15]
  v_mfma_f32_16x16x32_bf16 v[16:19], v[220:223], v[104:107], v[16:19]
  s_waitcnt vmcnt(1)
  v_lshlrev_b32 v240, 16, v148
  v_and_b32 v148, 0xffff0000, v148
  v_lshlrev_b32 v241, 16, v149
  v_and_b32 v149, 0xffff0000, v149
  v_lshlrev_b32 v242, 16, v150
  v_and_b32 v150, 0xffff0000, v150
  v_lshlrev_b32 v243, 16, v151
  v_and_b32 v151, 0xffff0000, v151
  s_waitcnt vmcnt(0)
  v_lshlrev_b32 v244, 16, v152
  v_and_b32 v152, 0xffff0000, v152
  v_lshlrev_b32 v245, 16, v153
  v_and_b32 v153, 0xffff0000, v153
  v_lshlrev_b32 v246, 16, v154
  v_and_b32 v154, 0xffff0000, v154
  v_lshlrev_b32 v247, 16, v155
  v_and_b32 v155, 0xffff0000, v155
  v_mul_f32 v168, v12, v128
  v_mul_f32 v172, v4, v128
  v_mul_f32 v169, v13, v129
  v_mul_f32 v173, v5, v129
  v_mul_f32 v170, v14, v130
  v_mul_f32 v174, v6, v130
  v_mul_f32 v171, v15, v131
  v_mul_f32 v175, v7, v131
  v_fma_f32 v168, v4, v124, -v168
  v_fma_f32 v172, v12, v124, v172
  v_fma_f32 v169, v5, v125, -v169
  v_fma_f32 v173, v13, v125, v173
  v_fma_f32 v170, v6, v126, -v170
  v_fma_f32 v174, v14, v126, v174
  v_fma_f32 v171, v7, v127, -v171
  v_fma_f32 v175, v15, v127, v175
  v_cvt_pk_bf16_f32 v224, v168, v169
  v_cvt_pk_bf16_f32 v226, v172, v173
  v_cvt_pk_bf16_f32 v225, v170, v171
  v_cvt_pk_bf16_f32 v227, v174, v175
  ds_write_b64 v161, v[224:225] offset:0
  ds_write_b64 v161, v[226:227] offset:4096
  v_mul_f32 v176, v16, v136
  v_mul_f32 v180, v8, v136
  v_mul_f32 v177, v17, v137
  v_mul_f32 v181, v9, v137
  v_mul_f32 v178, v18, v138
  v_mul_f32 v182, v10, v138
  v_mul_f32 v179, v19, v139
  v_mul_f32 v183, v11, v139
  v_fma_f32 v176, v8, v132, -v176
  v_fma_f32 v180, v16, v132, v180
  v_fma_f32 v177, v9, v133, -v177
  v_fma_f32 v181, v17, v133, v181
  v_fma_f32 v178, v10, v134, -v178
  v_fma_f32 v182, v18, v134, v182
  v_fma_f32 v179, v11, v135, -v179
  v_fma_f32 v183, v19, v135, v183
  v_cvt_pk_bf16_f32 v228, v176, v177
  v_cvt_pk_bf16_f32 v230, v180, v181
  v_cvt_pk_bf16_f32 v229, v178, v179
  v_cvt_pk_bf16_f32 v231, v182, v183
  ds_write_b64 v161, v[228:229] offset:2048
  ds_write_b64 v161, v[230:231] offset:6144
  s_waitcnt lgkmcnt(0)
  s_barrier
  ds_read_b128 v[168:171], v162 offset:0
  ds_read_b128 v[172:175], v162 offset:4096
  ds_read_b128 v[176:179], v163 offset:0
  ds_read_b128 v[180:183], v163 offset:4096
  s_waitcnt lgkmcnt(3)
  v_mfma_f32_16x16x32_bf16 v[200:203], v[168:171], v[36:39], 0
  v_mfma_f32_16x16x32_bf16 v[204:207], v[168:171], v[44:47], 0
  v_mfma_f32_16x16x32_bf16 v[208:211], v[168:171], v[52:55], 0
  v_mfma_f32_16x16x32_bf16 v[212:215], v[168:171], v[60:63], 0
  s_waitcnt lgkmcnt(2)
  v_mfma_f32_16x16x32_bf16 v[200:203], v[172:175], v[68:71], v[200:203]
  v_mfma_f32_16x16x32_bf16 v[204:207], v[172:175], v[76:79], v[204:207]
  v_mfma_f32_16x16x32_bf16 v[208:211], v[172:175], v[36:39], v[208:211]
  v_mfma_f32_16x16x32_bf16 v[212:215], v[172:175], v[44:47], v[212:215]
  s_waitcnt lgkmcnt(1)
  v_mfma_f32_16x16x32_bf16 v[200:203], v[176:179], v[40:43], v[200:203]
  v_mfma_f32_16x16x32_bf16 v[204:207], v[176:179], v[48:51], v[204:207]
  v_mfma_f32_16x16x32_bf16 v[208:211], v[176:179], v[56:59], v[208:211]
  v_mfma_f32_16x16x32_bf16 v[212:215], v[176:179], v[64:67], v[212:215]
  s_waitcnt lgkmcnt(0)
  v_mfma_f32_16x16x32_bf16 v[200:203], v[180:183], v[72:75], v[200:203]
  v_mfma_f32_16x16x32_bf16 v[204:207], v[180:183], v[80:83], v[204:207]
  v_mfma_f32_16x16x32_bf16 v[208:211], v[180:183], v[40:43], v[208:211]
  v_mfma_f32_16x16x32_bf16 v[212:215], v[180:183], v[48:51], v[212:215]
  s_nop 4
  v_fma_f32 v240, v200, s42, v240
  s_nop 0
  v_fma_f32 v148, v208, s43, v148
  v_fma_f32 v241, v201, s42, v241
  v_fma_f32 v149, v209, s43, v149
  v_fma_f32 v242, v202, s42, v242
  v_fma_f32 v150, v210, s43, v150
  v_fma_f32 v243, v203, s42, v243
  v_fma_f32 v151, v211, s43, v151
  v_cvt_pk_bf16_f32 v216, v240, v148
  v_cvt_pk_bf16_f32 v217, v241, v149
  v_cvt_pk_bf16_f32 v218, v242, v150
  v_cvt_pk_bf16_f32 v219, v243, v151
  buffer_store_dwordx4 v[216:219], v142, s[24:27], s38 offen offset:0 sc0 sc1
  v_fma_f32 v244, v204, s42, v244
  v_fma_f32 v152, v212, s43, v152
  v_fma_f32 v245, v205, s42, v245
  v_fma_f32 v153, v213, s43, v153
  v_fma_f32 v246, v206, s42, v246
  v_fma_f32 v154, v214, s43, v154
  v_fma_f32 v247, v207, s42, v247
  v_fma_f32 v155, v215, s43, v155
  v_cvt_pk_bf16_f32 v220, v244, v152
  v_cvt_pk_bf16_f32 v221, v245, v153
  v_cvt_pk_bf16_f32 v222, v246, v154
  v_cvt_pk_bf16_f32 v223, v247, v155
  buffer_store_dwordx4 v[220:223], v142, s[24:27], s38 offen offset:2048 sc0 sc1
  s_endpgm
cw23:
  s_load_dwordx2 s[6:7], s[0:1], 48
  s_sub_u32 s20, s2, 256
  s_waitcnt lgkmcnt(0)
  s_mov_b32 s8, s6
  s_mov_b32 s9, s7
  s_mov_b32 s10, 0x1c0000
  s_mov_b32 s11, 0x20000
  s_add_u32 s12, s4, 0xe00000
  s_addc_u32 s13, s5, 0
  s_mov_b32 s14, 0x1c0000
  s_mov_b32 s15, 0x20000
  v_and_b32 v1, 63, v0
  v_lshlrev_b32 v3, 4, v1
  v_and_b32 v4, 31, v1
  v_lshlrev_b32 v4, 1, v4
  v_lshrrev_b32 v2, 5, v1
  v_lshl_or_b32 v2, v2, 12, v4
  s_lshl_b32 s21, s20, 14
  s_lshl_b32 s22, s3, 8
  s_add_u32 s21, s21, s22
  s_add_u32 s24, s21, 0
  s_add_u32 s25, s21, 1024
  s_add_u32 s26, s21, 2048
  s_add_u32 s27, s21, 3072
  s_add_u32 s28, s21, 8192
  s_add_u32 s29, s21, 9216
  s_add_u32 s30, s21, 10240
  s_add_u32 s31, s21, 11264
  buffer_load_ushort v8, v2, s[8:11], s24 offen offset:0
  buffer_load_ushort v9, v2, s[8:11], s25 offen offset:0
  buffer_load_ushort v10, v2, s[8:11], s26 offen offset:0
  buffer_load_ushort v11, v2, s[8:11], s27 offen offset:0
  buffer_load_ushort v12, v2, s[8:11], s28 offen offset:0
  buffer_load_ushort v13, v2, s[8:11], s29 offen offset:0
  buffer_load_ushort v14, v2, s[8:11], s30 offen offset:0
  buffer_load_ushort v15, v2, s[8:11], s31 offen offset:0
  buffer_load_ushort v16, v2, s[8:11], s24 offen offset:64
  buffer_load_ushort v17, v2, s[8:11], s25 offen offset:64
  buffer_load_ushort v18, v2, s[8:11], s26 offen offset:64
  buffer_load_ushort v19, v2, s[8:11], s27 offen offset:64
  buffer_load_ushort v20, v2, s[8:11], s28 offen offset:64
  buffer_load_ushort v21, v2, s[8:11], s29 offen offset:64
  buffer_load_ushort v22, v2, s[8:11], s30 offen offset:64
  buffer_load_ushort v23, v2, s[8:11], s31 offen offset:64
  buffer_load_ushort v24, v2, s[8:11], s24 offen offset:128
  buffer_load_ushort v25, v2, s[8:11], s25 offen offset:128
  buffer_load_ushort v26, v2, s[8:11], s26 offen offset:128
  buffer_load_ushort v27, v2, s[8:11], s27 offen offset:128
  buffer_load_ushort v28, v2, s[8:11], s28 offen offset:128
  buffer_load_ushort v29, v2, s[8:11], s29 offen offset:128
  buffer_load_ushort v30, v2, s[8:11], s30 offen offset:128
  buffer_load_ushort v31, v2, s[8:11], s31 offen offset:128
  buffer_load_ushort v32, v2, s[8:11], s24 offen offset:192
  buffer_load_ushort v33, v2, s[8:11], s25 offen offset:192
  buffer_load_ushort v34, v2, s[8:11], s26 offen offset:192
  buffer_load_ushort v35, v2, s[8:11], s27 offen offset:192
  buffer_load_ushort v36, v2, s[8:11], s28 offen offset:192
  buffer_load_ushort v37, v2, s[8:11], s29 offen offset:192
  buffer_load_ushort v38, v2, s[8:11], s30 offen offset:192
  buffer_load_ushort v39, v2, s[8:11], s31 offen offset:192
  s_mul_i32 s22, s3, 458752
  s_lshl_b32 s23, s20, 10
  s_add_u32 s22, s22, s23
  s_waitcnt vmcnt(30)
  v_lshl_or_b32 v40, v9, 16, v8
  s_waitcnt vmcnt(28)
  v_lshl_or_b32 v41, v11, 16, v10
  s_waitcnt vmcnt(26)
  v_lshl_or_b32 v42, v13, 16, v12
  s_waitcnt vmcnt(24)
  v_lshl_or_b32 v43, v15, 16, v14
  buffer_store_dwordx4 v[40:43], v3, s[12:15], s22 offen sc0 sc1
  s_add_u32 s22, s22, 114688
  s_waitcnt vmcnt(23)
  v_lshl_or_b32 v44, v17, 16, v16
  s_waitcnt vmcnt(21)
  v_lshl_or_b32 v45, v19, 16, v18
  s_waitcnt vmcnt(19)
  v_lshl_or_b32 v46, v21, 16, v20
  s_waitcnt vmcnt(17)
  v_lshl_or_b32 v47, v23, 16, v22
  buffer_store_dwordx4 v[44:47], v3, s[12:15], s22 offen sc0 sc1
  s_add_u32 s22, s22, 114688
  s_waitcnt vmcnt(16)
  v_lshl_or_b32 v48, v25, 16, v24
  s_waitcnt vmcnt(14)
  v_lshl_or_b32 v49, v27, 16, v26
  s_waitcnt vmcnt(12)
  v_lshl_or_b32 v50, v29, 16, v28
  s_waitcnt vmcnt(10)
  v_lshl_or_b32 v51, v31, 16, v30
  buffer_store_dwordx4 v[48:51], v3, s[12:15], s22 offen sc0 sc1
  s_add_u32 s22, s22, 114688
  s_waitcnt vmcnt(9)
  v_lshl_or_b32 v52, v33, 16, v32
  s_waitcnt vmcnt(7)
  v_lshl_or_b32 v53, v35, 16, v34
  s_waitcnt vmcnt(5)
  v_lshl_or_b32 v54, v37, 16, v36
  s_waitcnt vmcnt(3)
  v_lshl_or_b32 v55, v39, 16, v38
  buffer_store_dwordx4 v[52:55], v3, s[12:15], s22 offen sc0 sc1
  s_endpgm
ce22:
  s_endpgm
.section .rodata,"a"
.p2align 6
.amdhsa_kernel q4_kernel
  .amdhsa_next_free_vgpr 248
  .amdhsa_next_free_sgpr 102
  .amdhsa_accum_offset 248
  .amdhsa_group_segment_fixed_size 0
  .amdhsa_kernarg_size 80
  .amdhsa_user_sgpr_count 2
  .amdhsa_user_sgpr_kernarg_segment_ptr 1
  .amdhsa_system_sgpr_workgroup_id_x 1
.end_amdhsa_kernel
.text
.globl q5_kernel
.p2align 8
.type q5_kernel,@function
q5_kernel:
L_q5_kernel:
  s_cmp_ge_u32 s2, 256
  s_cbranch_scc1 ge25
  s_load_dwordx2 s[4:5], s[0:1], 72
  s_load_dwordx2 s[6:7], s[0:1], 56
  v_lshrrev_b32 v1, 6, v0
  s_nop 0
  v_readfirstlane_b32 s3, v1
  s_cmp_ge_u32 s2, 224
  s_cbranch_scc1 gs26
  s_getpc_b64 s[96:97]
pf28:
  s_mov_b32 s98, text_end-pf28
  s_mov_b32 s99, 0x20000
  v_lshlrev_b32 v2, 6, v0
  buffer_load_dword v3, v2, s[96:99], 0 offen
  s_and_b32 s20, s2, 7
  s_lshr_b32 s21, s2, 3
  s_and_b32 s22, s20, 3
  s_lshl_b32 s22, s22, 2
  s_and_b32 s23, s21, 3
  s_add_u32 s22, s22, s23
  s_lshr_b32 s23, s20, 2
  s_mul_i32 s23, s23, 7
  s_lshr_b32 s24, s21, 2
  s_add_u32 s23, s23, s24
  s_waitcnt lgkmcnt(0)
  s_add_u32 s12, s4, 0x600000
  s_addc_u32 s13, s5, 0
  s_mov_b32 s14, 0x200000
  s_mov_b32 s15, 0x20000
  s_add_u32 s8, s4, 0x800000
  s_addc_u32 s9, s5, 0
  s_mov_b32 s10, 0x380000
  s_mov_b32 s11, 0x20000
  s_add_u32 s16, s4, 0x1000000
  s_addc_u32 s17, s5, 0
  s_mov_b32 s18, 0x700000
  s_mov_b32 s19, 0x20000
  s_lshl_b32 s24, s3, 14
  s_lshl_b32 s25, s22, 9
  s_add_u32 s24, s24, s25
  s_lshl_b32 s25, s23, 2
  s_add_u32 s25, s25, s3
  s_lshl_b32 s26, s25, 16
  s_add_u32 s27, s26, 32768
  s_lshl_b32 s31, s25, 11
  s_lshl_b32 s34, s22, 2
  s_add_u32 s30, s3, 0
  s_and_b32 s30, s30, 3
  s_add_u32 s30, s30, s34
  s_mul_i32 s30, s30, 114688
  s_add_u32 s36, s30, s31
  s_add_u32 s30, s3, 1
  s_and_b32 s30, s30, 3
  s_add_u32 s30, s30, s34
  s_mul_i32 s30, s30, 114688
  s_add_u32 s37, s30, s31
  s_add_u32 s30, s3, 2
  s_and_b32 s30, s30, 3
  s_add_u32 s30, s30, s34
  s_mul_i32 s30, s30, 114688
  s_add_u32 s38, s30, s31
  s_add_u32 s30, s3, 3
  s_and_b32 s30, s30, 3
  s_add_u32 s30, s30, s34
  s_mul_i32 s30, s30, 114688
  s_add_u32 s39, s30, s31
  s_and_b32 s50, s21, 3
  s_lshl_b32 s50, s50, 1
  s_lshr_b32 s51, s21, 2
  s_add_u32 s50, s50, s51
  s_and_b32 s50, s50, 7
  v_and_b32 v135, 63, v0
  v_lshlrev_b32 v132, 4, v135
  v_and_b32 v133, 31, v135
  v_lshrrev_b32 v134, 5, v135
  v_lshlrev_b32 v168, 4, v133
  v_lshl_or_b32 v170, v134, 13, v168
  s_lshl_b32 s28, s3, 10
  s_add_u32 m0, s28, 0
  s_add_u32 s29, s24, 0
  buffer_load_dwordx4 v170, s[12:15], s29 offen lds
  s_add_u32 m0, s28, 4096
  s_add_u32 s29, s24, 65536
  buffer_load_dwordx4 v170, s[12:15], s29 offen lds
  buffer_load_dwordx4 a[0:3], v132, s[8:11], s26 offen offset:0
  buffer_load_dwordx4 a[4:7], v132, s[8:11], s27 offen offset:0
  s_add_u32 m0, s28, 8192
  s_add_u32 s29, s24, 131072
  buffer_load_dwordx4 v170, s[12:15], s29 offen lds
  s_add_u32 m0, s28, 12288
  s_add_u32 s29, s24, 196608
  buffer_load_dwordx4 v170, s[12:15], s29 offen lds
  buffer_load_dwordx4 a[8:11], v132, s[8:11], s26 offen offset:1024
  buffer_load_dwordx4 a[12:15], v132, s[8:11], s27 offen offset:1024
  buffer_load_dwordx4 a[16:19], v132, s[8:11], s26 offen offset:2048
  buffer_load_dwordx4 a[20:23], v132, s[8:11], s27 offen offset:2048
  s_add_u32 m0, s28, 16384
  s_add_u32 s29, s24, 262144
  buffer_load_dwordx4 v170, s[12:15], s29 offen lds
  s_add_u32 m0, s28, 20480
  s_add_u32 s29, s24, 327680
  buffer_load_dwordx4 v170, s[12:15], s29 offen lds
  v_lshlrev_b32 v168, 2, v133
  v_lshl_or_b32 v168, v134, 10, v168
  s_add_u32 s29, s3, 0
  s_and_b32 s29, s29, 3
  s_lshl_b32 s29, s29, 7
  v_add_u32 v171, s29, v168
  v_add_u32 v175, 0x10000, v171
  s_add_u32 s29, s3, 1
  s_and_b32 s29, s29, 3
  s_lshl_b32 s29, s29, 7
  v_add_u32 v172, s29, v168
  v_add_u32 v176, 0x10000, v172
  s_add_u32 s29, s3, 2
  s_and_b32 s29, s29, 3
  s_lshl_b32 s29, s29, 7
  v_add_u32 v173, s29, v168
  v_add_u32 v177, 0x10000, v173
  s_add_u32 s29, s3, 3
  s_and_b32 s29, s29, 3
  s_lshl_b32 s29, s29, 7
  v_add_u32 v174, s29, v168
  v_add_u32 v178, 0x10000, v174
  v_mov_b32 v180, 0
  v_mov_b32 v181, 0
  s_mov_b32 s33, 0xffff0000
  v_mov_b32 v192, s33
  v_cmp_gt_u32 vcc, 32, v135
  v_mov_b32 v184, 0
  s_nop 0
  v_cndmask_b32 v192, v192, v184, vcc
  s_waitcnt vmcnt(11)
  s_barrier
  ds_read2st64_b32 v[136:137], v171 offset0:0 offset1:2
  ds_read2st64_b32 v[138:139], v171 offset0:8 offset1:10
  ds_read2st64_b32 v[140:141], v172 offset0:0 offset1:2
  ds_read2st64_b32 v[142:143], v172 offset0:8 offset1:10
  ds_read2st64_b32 v[144:145], v173 offset0:0 offset1:2
  ds_read2st64_b32 v[146:147], v173 offset0:8 offset1:10
  ds_read2st64_b32 v[148:149], v174 offset0:0 offset1:2
  ds_read2st64_b32 v[150:151], v174 offset0:8 offset1:10
  s_waitcnt vmcnt(10)
  s_barrier
  s_waitcnt vmcnt(9) lgkmcnt(6)
  v_mfma_f32_32x32x16_bf16 v[4:19], a[0:3], v[136:139], 0
  ds_read2st64_b32 v[152:153], v171 offset0:16 offset1:18
  ds_read2st64_b32 v[154:155], v171 offset0:24 offset1:26
  v_lshlrev_b32 v184, 16, v136
  v_and_b32 v185, v192, v136
  s_waitcnt vmcnt(8)
  v_mfma_f32_32x32x16_bf16 v[68:83], a[4:7], v[136:139], 0
  ds_read2st64_b32 v[156:157], v172 offset0:16 offset1:18
  s_add_u32 m0, s28, 24576
  s_add_u32 s29, s24, 393216
  buffer_load_dwordx4 v170, s[12:15], s29 offen lds
  v_lshlrev_b32 v186, 16, v137
  v_and_b32 v187, s33, v137
  s_waitcnt lgkmcnt(7)
  v_mfma_f32_32x32x16_bf16 v[20:35], a[0:3], v[140:143], 0
  ds_read2st64_b32 v[158:159], v172 offset0:24 offset1:26
  v_lshlrev_b32 v188, 16, v138
  v_and_b32 v189, s33, v138
  v_mfma_f32_32x32x16_bf16 v[84:99], a[4:7], v[140:143], 0
  ds_read2st64_b32 v[160:161], v173 offset0:16 offset1:18
  s_add_u32 m0, s28, 28672
  s_add_u32 s29, s24, 458752
  buffer_load_dwordx4 v170, s[12:15], s29 offen lds
  v_lshlrev_b32 v190, 16, v139
  v_and_b32 v191, s33, v139
  s_waitcnt lgkmcnt(7)
  v_mfma_f32_32x32x16_bf16 v[36:51], a[0:3], v[144:147], 0
  ds_read2st64_b32 v[162:163], v173 offset0:24 offset1:26
  v_fmac_f32 v180, v184, v184
  v_fmac_f32 v181, v185, v185
  v_mfma_f32_32x32x16_bf16 v[100:115], a[4:7], v[144:147], 0
  ds_read2st64_b32 v[164:165], v174 offset0:16 offset1:18
  buffer_load_dwordx4 a[24:27], v132, s[8:11], s26 offen offset:3072
  v_fmac_f32 v180, v186, v186
  v_fmac_f32 v181, v187, v187
  s_waitcnt lgkmcnt(7)
  v_mfma_f32_32x32x16_bf16 v[52:67], a[0:3], v[148:151], 0
  ds_read2st64_b32 v[166:167], v174 offset0:24 offset1:26
  v_fmac_f32 v180, v188, v188
  v_fmac_f32 v181, v189, v189
  v_mfma_f32_32x32x16_bf16 v[116:131], a[4:7], v[148:151], 0
  buffer_load_dwordx4 a[28:31], v132, s[8:11], s27 offen offset:3072
  v_fmac_f32 v180, v190, v190
  v_fmac_f32 v181, v191, v191
  s_waitcnt vmcnt(10)
  s_barrier
  s_waitcnt vmcnt(9) lgkmcnt(6)
  v_mfma_f32_32x32x16_bf16 v[4:19], a[8:11], v[152:155], v[4:19]
  ds_read2st64_b32 v[136:137], v171 offset0:32 offset1:34
  ds_read2st64_b32 v[138:139], v171 offset0:40 offset1:42
  v_lshlrev_b32 v184, 16, v152
  v_and_b32 v185, s33, v152
  s_waitcnt vmcnt(8)
  v_mfma_f32_32x32x16_bf16 v[68:83], a[12:15], v[152:155], v[68:83]
  ds_read2st64_b32 v[140:141], v172 offset0:32 offset1:34
  s_add_u32 s26, s26, 4096
  buffer_load_dwordx4 a[32:35], v132, s[8:11], s26 offen offset:0
  v_lshlrev_b32 v186, 16, v153
  v_and_b32 v187, s33, v153
  s_waitcnt lgkmcnt(7)
  v_mfma_f32_32x32x16_bf16 v[20:35], a[8:11], v[156:159], v[20:35]
  ds_read2st64_b32 v[142:143], v172 offset0:40 offset1:42
  v_lshlrev_b32 v188, 16, v154
  v_and_b32 v189, s33, v154
  v_mfma_f32_32x32x16_bf16 v[84:99], a[12:15], v[156:159], v[84:99]
  ds_read2st64_b32 v[144:145], v173 offset0:32 offset1:34
  s_add_u32 s27, s27, 4096
  buffer_load_dwordx4 a[36:39], v132, s[8:11], s27 offen offset:0
  v_lshlrev_b32 v190, 16, v155
  v_and_b32 v191, s33, v155
  s_waitcnt lgkmcnt(7)
  v_mfma_f32_32x32x16_bf16 v[36:51], a[8:11], v[160:163], v[36:51]
  ds_read2st64_b32 v[146:147], v173 offset0:40 offset1:42
  v_fmac_f32 v180, v184, v184
  v_fmac_f32 v181, v185, v185
  v_mfma_f32_32x32x16_bf16 v[100:115], a[12:15], v[160:163], v[100:115]
  ds_read2st64_b32 v[148:149], v174 offset0:32 offset1:34
  buffer_load_dwordx4 a[40:43], v132, s[8:11], s26 offen offset:1024
  v_fmac_f32 v180, v186, v186
  v_fmac_f32 v181, v187, v187
  s_waitcnt lgkmcnt(7)
  v_mfma_f32_32x32x16_bf16 v[52:67], a[8:11], v[164:167], v[52:67]
  ds_read2st64_b32 v[150:151], v174 offset0:40 offset1:42
  v_fmac_f32 v180, v188, v188
  v_fmac_f32 v181, v189, v189
  v_mfma_f32_32x32x16_bf16 v[116:131], a[12:15], v[164:167], v[116:131]
  buffer_load_dwordx4 a[44:47], v132, s[8:11], s27 offen offset:1024
  v_fmac_f32 v180, v190, v190
  v_fmac_f32 v181, v191, v191
  s_waitcnt vmcnt(11) lgkmcnt(6)
  v_mfma_f32_32x32x16_bf16 v[4:19], a[16:19], v[136:139], v[4:19]
  ds_read2st64_b32 v[152:153], v171 offset0:48 offset1:50
  ds_read2st64_b32 v[154:155], v171 offset0:56 offset1:58
  v_lshlrev_b32 v184, 16, v136
  v_and_b32 v185, s33, v136
  s_waitcnt vmcnt(10)
  v_mfma_f32_32x32x16_bf16 v[68:83], a[20:23], v[136:139], v[68:83]
  ds_read2st64_b32 v[156:157], v172 offset0:48 offset1:50
  buffer_load_dwordx4 a[48:51], v132, s[8:11], s26 offen offset:2048
  v_lshlrev_b32 v186, 16, v137
  v_and_b32 v187, s33, v137
  s_waitcnt lgkmcnt(7)
  v_mfma_f32_32x32x16_bf16 v[20:35], a[16:19], v[140:143], v[20:35]
  ds_read2st64_b32 v[158:159], v172 offset0:56 offset1:58
  v_lshlrev_b32 v188, 16, v138
  v_and_b32 v189, s33, v138
  v_mfma_f32_32x32x16_bf16 v[84:99], a[20:23], v[140:143], v[84:99]
  ds_read2st64_b32 v[160:161], v173 offset0:48 offset1:50
  buffer_load_dwordx4 a[52:55], v132, s[8:11], s27 offen offset:2048
  v_lshlrev_b32 v190, 16, v139
  v_and_b32 v191, s33, v139
  s_waitcnt lgkmcnt(7)
  v_mfma_f32_32x32x16_bf16 v[36:51], a[16:19], v[144:147], v[36:51]
  ds_read2st64_b32 v[162:163], v173 offset0:56 offset1:58
  v_fmac_f32 v180, v184, v184
  v_fmac_f32 v181, v185, v185
  v_mfma_f32_32x32x16_bf16 v[100:115], a[20:23], v[144:147], v[100:115]
  ds_read2st64_b32 v[164:165], v174 offset0:48 offset1:50
  s_add_u32 m0, s28, 32768
  s_add_u32 s29, s24, 524288
  buffer_load_dwordx4 v170, s[12:15], s29 offen lds
  v_fmac_f32 v180, v186, v186
  v_fmac_f32 v181, v187, v187
  s_waitcnt lgkmcnt(7)
  v_mfma_f32_32x32x16_bf16 v[52:67], a[16:19], v[148:151], v[52:67]
  ds_read2st64_b32 v[166:167], v174 offset0:56 offset1:58
  v_fmac_f32 v180, v188, v188
  v_fmac_f32 v181, v189, v189
  v_mfma_f32_32x32x16_bf16 v[116:131], a[20:23], v[148:151], v[116:131]
  s_add_u32 m0, s28, 36864
  s_add_u32 s29, s24, 589824
  buffer_load_dwordx4 v170, s[12:15], s29 offen lds
  v_fmac_f32 v180, v190, v190
  v_fmac_f32 v181, v191, v191
  s_waitcnt vmcnt(10)
  s_barrier
  s_waitcnt vmcnt(9) lgkmcnt(6)
  v_mfma_f32_32x32x16_bf16 v[4:19], a[24:27], v[152:155], v[4:19]
  ds_read2st64_b32 v[136:137], v171 offset0:64 offset1:66
  ds_read2st64_b32 v[138:139], v171 offset0:72 offset1:74
  v_lshlrev_b32 v184, 16, v152
  v_and_b32 v185, s33, v152
  s_waitcnt vmcnt(8)
  v_mfma_f32_32x32x16_bf16 v[68:83], a[28:31], v[152:155], v[68:83]
  ds_read2st64_b32 v[140:141], v172 offset0:64 offset1:66
  s_add_u32 m0, s28, 40960
  s_add_u32 s29, s24, 655360
  buffer_load_dwordx4 v170, s[12:15], s29 offen lds
  v_lshlrev_b32 v186, 16, v153
  v_and_b32 v187, s33, v153
  s_waitcnt lgkmcnt(7)
  v_mfma_f32_32x32x16_bf16 v[20:35], a[24:27], v[156:159], v[20:35]
  ds_read2st64_b32 v[142:143], v172 offset0:72 offset1:74
  v_lshlrev_b32 v188, 16, v154
  v_and_b32 v189, s33, v154
  v_mfma_f32_32x32x16_bf16 v[84:99], a[28:31], v[156:159], v[84:99]
  ds_read2st64_b32 v[144:145], v173 offset0:64 offset1:66
  s_add_u32 m0, s28, 45056
  s_add_u32 s29, s24, 720896
  buffer_load_dwordx4 v170, s[12:15], s29 offen lds
  v_lshlrev_b32 v190, 16, v155
  v_and_b32 v191, s33, v155
  s_waitcnt lgkmcnt(7)
  v_mfma_f32_32x32x16_bf16 v[36:51], a[24:27], v[160:163], v[36:51]
  ds_read2st64_b32 v[146:147], v173 offset0:72 offset1:74
  v_fmac_f32 v180, v184, v184
  v_fmac_f32 v181, v185, v185
  v_mfma_f32_32x32x16_bf16 v[100:115], a[28:31], v[160:163], v[100:115]
  ds_read2st64_b32 v[148:149], v174 offset0:64 offset1:66
  buffer_load_dwordx4 a[56:59], v132, s[8:11], s26 offen offset:3072
  v_fmac_f32 v180, v186, v186
  v_fmac_f32 v181, v187, v187
  s_waitcnt lgkmcnt(7)
  v_mfma_f32_32x32x16_bf16 v[52:67], a[24:27], v[164:167], v[52:67]
  ds_read2st64_b32 v[150:151], v174 offset0:72 offset1:74
  v_fmac_f32 v180, v188, v188
  v_fmac_f32 v181, v189, v189
  v_mfma_f32_32x32x16_bf16 v[116:131], a[28:31], v[164:167], v[116:131]
  buffer_load_dwordx4 a[60:63], v132, s[8:11], s27 offen offset:3072
  v_fmac_f32 v180, v190, v190
  v_fmac_f32 v181, v191, v191
  s_waitcnt vmcnt(11) lgkmcnt(6)
  v_mfma_f32_32x32x16_bf16 v[4:19], a[32:35], v[136:139], v[4:19]
  ds_read2st64_b32 v[152:153], v171 offset0:80 offset1:82
  ds_read2st64_b32 v[154:155], v171 offset0:88 offset1:90
  v_lshlrev_b32 v184, 16, v136
  v_and_b32 v185, s33, v136
  s_waitcnt vmcnt(10)
  v_mfma_f32_32x32x16_bf16 v[68:83], a[36:39], v[136:139], v[68:83]
  ds_read2st64_b32 v[156:157], v172 offset0:80 offset1:82
  s_add_u32 s26, s26, 4096
  buffer_load_dwordx4 a[64:67], v132, s[8:11], s26 offen offset:0
  v_lshlrev_b32 v186, 16, v137
  v_and_b32 v187, s33, v137
  s_waitcnt lgkmcnt(7)
  v_mfma_f32_32x32x16_bf16 v[20:35], a[32:35], v[140:143], v[20:35]
  ds_read2st64_b32 v[158:159], v172 offset0:88 offset1:90
  v_lshlrev_b32 v188, 16, v138
  v_and_b32 v189, s33, v138
  v_mfma_f32_32x32x16_bf16 v[84:99], a[36:39], v[140:143], v[84:99]
  ds_read2st64_b32 v[160:161], v173 offset0:80 offset1:82
  s_add_u32 s27, s27, 4096
  buffer_load_dwordx4 a[68:71], v132, s[8:11], s27 offen offset:0
  v_lshlrev_b32 v190, 16, v139
  v_and_b32 v191, s33, v139
  s_waitcnt lgkmcnt(7)
  v_mfma_f32_32x32x16_bf16 v[36:51], a[32:35], v[144:147], v[36:51]
  ds_read2st64_b32 v[162:163], v173 offset0:88 offset1:90
  v_fmac_f32 v180, v184, v184
  v_fmac_f32 v181, v185, v185
  v_mfma_f32_32x32x16_bf16 v[100:115], a[36:39], v[144:147], v[100:115]
  ds_read2st64_b32 v[164:165], v174 offset0:80 offset1:82
  buffer_load_dwordx4 a[72:75], v132, s[8:11], s26 offen offset:1024
  v_fmac_f32 v180, v186, v186
  v_fmac_f32 v181, v187, v187
  s_waitcnt lgkmcnt(7)
  v_mfma_f32_32x32x16_bf16 v[52:67], a[32:35], v[148:151], v[52:67]
  ds_read2st64_b32 v[166:167], v174 offset0:88 offset1:90
  v_fmac_f32 v180, v188, v188
  v_fmac_f32 v181, v189, v189
  v_mfma_f32_32x32x16_bf16 v[116:131], a[36:39], v[148:151], v[116:131]
  buffer_load_dwordx4 a[76:79], v132, s[8:11], s27 offen offset:1024
  v_fmac_f32 v180, v190, v190
  v_fmac_f32 v181, v191, v191
  s_waitcnt vmcnt(13) lgkmcnt(6)
  v_mfma_f32_32x32x16_bf16 v[4:19], a[40:43], v[152:155], v[4:19]
  ds_read2st64_b32 v[136:137], v171 offset0:96 offset1:98
  ds_read2st64_b32 v[138:139], v171 offset0:104 offset1:106
  v_lshlrev_b32 v184, 16, v152
  v_and_b32 v185, s33, v152
  s_waitcnt vmcnt(12)
  v_mfma_f32_32x32x16_bf16 v[68:83], a[44:47], v[152:155], v[68:83]
  ds_read2st64_b32 v[140:141], v172 offset0:96 offset1:98
  buffer_load_dwordx4 a[80:83], v132, s[8:11], s26 offen offset:2048
  v_lshlrev_b32 v186, 16, v153
  v_and_b32 v187, s33, v153
  s_waitcnt lgkmcnt(7)
  v_mfma_f32_32x32x16_bf16 v[20:35], a[40:43], v[156:159], v[20:35]
  ds_read2st64_b32 v[142:143], v172 offset0:104 offset1:106
  v_lshlrev_b32 v188, 16, v154
  v_and_b32 v189, s33, v154
  v_mfma_f32_32x32x16_bf16 v[84:99], a[44:47], v[156:159], v[84:99]
  ds_read2st64_b32 v[144:145], v173 offset0:96 offset1:98
  buffer_load_dwordx4 a[84:87], v132, s[8:11], s27 offen offset:2048
  v_lshlrev_b32 v190, 16, v155
  v_and_b32 v191, s33, v155
  s_waitcnt lgkmcnt(7)
  v_mfma_f32_32x32x16_bf16 v[36:51], a[40:43], v[160:163], v[36:51]
  ds_read2st64_b32 v[146:147], v173 offset0:104 offset1:106
  v_fmac_f32 v180, v184, v184
  v_fmac_f32 v181, v185, v185
  v_mfma_f32_32x32x16_bf16 v[100:115], a[44:47], v[160:163], v[100:115]
  ds_read2st64_b32 v[148:149], v174 offset0:96 offset1:98
  s_add_u32 m0, s28, 49152
  s_add_u32 s29, s24, 786432
  buffer_load_dwordx4 v170, s[12:15], s29 offen lds
  v_fmac_f32 v180, v186, v186
  v_fmac_f32 v181, v187, v187
  s_waitcnt lgkmcnt(7)
  v_mfma_f32_32x32x16_bf16 v[52:67], a[40:43], v[164:167], v[52:67]
  ds_read2st64_b32 v[150:151], v174 offset0:104 offset1:106
  v_fmac_f32 v180, v188, v188
  v_fmac_f32 v181, v189, v189
  v_mfma_f32_32x32x16_bf16 v[116:131], a[44:47], v[164:167], v[116:131]
  s_add_u32 m0, s28, 53248
  s_add_u32 s29, s24, 851968
  buffer_load_dwordx4 v170, s[12:15], s29 offen lds
  v_fmac_f32 v180, v190, v190
  v_fmac_f32 v181, v191, v191
  s_waitcnt vmcnt(15) lgkmcnt(6)
  v_mfma_f32_32x32x16_bf16 v[4:19], a[48:51], v[136:139], v[4:19]
  ds_read2st64_b32 v[152:153], v171 offset0:112 offset1:114
  ds_read2st64_b32 v[154:155], v171 offset0:120 offset1:122
  v_lshlrev_b32 v184, 16, v136
  v_and_b32 v185, s33, v136
  s_waitcnt vmcnt(14)
  v_mfma_f32_32x32x16_bf16 v[68:83], a[52:55], v[136:139], v[68:83]
  ds_read2st64_b32 v[156:157], v172 offset0:112 offset1:114
  s_add_u32 m0, s28, 57344
  s_add_u32 s29, s24, 917504
  buffer_load_dwordx4 v170, s[12:15], s29 offen lds
  v_lshlrev_b32 v186, 16, v137
  v_and_b32 v187, s33, v137
  s_waitcnt lgkmcnt(7)
  v_mfma_f32_32x32x16_bf16 v[20:35], a[48:51], v[140:143], v[20:35]
  ds_read2st64_b32 v[158:159], v172 offset0:120 offset1:122
  v_lshlrev_b32 v188, 16, v138
  v_and_b32 v189, s33, v138
  v_mfma_f32_32x32x16_bf16 v[84:99], a[52:55], v[140:143], v[84:99]
  ds_read2st64_b32 v[160:161], v173 offset0:112 offset1:114
  s_add_u32 m0, s28, 61440
  s_add_u32 s29, s24, 983040
  buffer_load_dwordx4 v170, s[12:15], s29 offen lds
  v_lshlrev_b32 v190, 16, v139
  v_and_b32 v191, s33, v139
  s_waitcnt lgkmcnt(7)
  v_mfma_f32_32x32x16_bf16 v[36:51], a[48:51], v[144:147], v[36:51]
  ds_read2st64_b32 v[162:163], v173 offset0:120 offset1:122
  v_fmac_f32 v180, v184, v184
  v_fmac_f32 v181, v185, v185
  v_mfma_f32_32x32x16_bf16 v[100:115], a[52:55], v[144:147], v[100:115]
  ds_read2st64_b32 v[164:165], v174 offset0:112 offset1:114
  buffer_load_dwordx4 a[88:91], v132, s[8:11], s26 offen offset:3072
  v_fmac_f32 v180, v186, v186
  v_fmac_f32 v181, v187, v187
  s_waitcnt lgkmcnt(7)
  v_mfma_f32_32x32x16_bf16 v[52:67], a[48:51], v[148:151], v[52:67]
  ds_read2st64_b32 v[166:167], v174 offset0:120 offset1:122
  v_fmac_f32 v180, v188, v188
  v_fmac_f32 v181, v189, v189
  v_mfma_f32_32x32x16_bf16 v[116:131], a[52:55], v[148:151], v[116:131]
  buffer_load_dwordx4 a[92:95], v132, s[8:11], s27 offen offset:3072
  v_fmac_f32 v180, v190, v190
  v_fmac_f32 v181, v191, v191
  s_waitcnt vmcnt(14)
  s_barrier
  s_waitcnt vmcnt(13) lgkmcnt(6)
  v_mfma_f32_32x32x16_bf16 v[4:19], a[56:59], v[152:155], v[4:19]
  ds_read2st64_b32 v[136:137], v171 offset0:128 offset1:130
  ds_read2st64_b32 v[138:139], v171 offset0:136 offset1:138
  v_lshlrev_b32 v184, 16, v152
  v_and_b32 v185, s33, v152
  s_waitcnt vmcnt(12)
  v_mfma_f32_32x32x16_bf16 v[68:83], a[60:63], v[152:155], v[68:83]
  ds_read2st64_b32 v[140:141], v172 offset0:128 offset1:130
  s_add_u32 s26, s26, 4096
  buffer_load_dwordx4 a[96:99], v132, s[8:11], s26 offen offset:0
  v_lshlrev_b32 v186, 16, v153
  v_and_b32 v187, s33, v153
  s_waitcnt lgkmcnt(7)
  v_mfma_f32_32x32x16_bf16 v[20:35], a[56:59], v[156:159], v[20:35]
  ds_read2st64_b32 v[142:143], v172 offset0:136 offset1:138
  v_lshlrev_b32 v188, 16, v154
  v_and_b32 v189, s33, v154
  v_mfma_f32_32x32x16_bf16 v[84:99], a[60:63], v[156:159], v[84:99]
  ds_read2st64_b32 v[144:145], v173 offset0:128 offset1:130
  s_add_u32 s27, s27, 4096
  buffer_load_dwordx4 a[100:103], v132, s[8:11], s27 offen offset:0
  v_lshlrev_b32 v190, 16, v155
  v_and_b32 v191, s33, v155
  s_waitcnt lgkmcnt(7)
  v_mfma_f32_32x32x16_bf16 v[36:51], a[56:59], v[160:163], v[36:51]
  ds_read2st64_b32 v[146:147], v173 offset0:136 offset1:138
  v_fmac_f32 v180, v184, v184
  v_fmac_f32 v181, v185, v185
  v_mfma_f32_32x32x16_bf16 v[100:115], a[60:63], v[160:163], v[100:115]
  ds_read2st64_b32 v[148:149], v174 offset0:128 offset1:130
  buffer_load_dwordx4 a[104:107], v132, s[8:11], s26 offen offset:1024
  v_fmac_f32 v180, v186, v186
  v_fmac_f32 v181, v187, v187
  s_waitcnt lgkmcnt(7)
  v_mfma_f32_32x32x16_bf16 v[52:67], a[56:59], v[164:167], v[52:67]
  ds_read2st64_b32 v[150:151], v174 offset0:136 offset1:138
  v_fmac_f32 v180, v188, v188
  v_fmac_f32 v181, v189, v189
  v_mfma_f32_32x32x16_bf16 v[116:131], a[60:63], v[164:167], v[116:131]
  buffer_load_dwordx4 a[108:111], v132, s[8:11], s27 offen offset:1024
  v_fmac_f32 v180, v190, v190
  v_fmac_f32 v181, v191, v191
  s_waitcnt vmcnt(15) lgkmcnt(6)
  v_mfma_f32_32x32x16_bf16 v[4:19], a[64:67], v[136:139], v[4:19]
  ds_read2st64_b32 v[152:153], v171 offset0:144 offset1:146
  ds_read2st64_b32 v[154:155], v171 offset0:152 offset1:154
  v_lshlrev_b32 v184, 16, v136
  v_and_b32 v185, s33, v136
  s_waitcnt vmcnt(14)
  v_mfma_f32_32x32x16_bf16 v[68:83], a[68:71], v[136:139], v[68:83]
  ds_read2st64_b32 v[156:157], v172 offset0:144 offset1:146
  buffer_load_dwordx4 a[112:115], v132, s[8:11], s26 offen offset:2048
  v_lshlrev_b32 v186, 16, v137
  v_and_b32 v187, s33, v137
  s_waitcnt lgkmcnt(7)
  v_mfma_f32_32x32x16_bf16 v[20:35], a[64:67], v[140:143], v[20:35]
  ds_read2st64_b32 v[158:159], v172 offset0:152 offset1:154
  v_lshlrev_b32 v188, 16, v138
  v_and_b32 v189, s33, v138
  v_mfma_f32_32x32x16_bf16 v[84:99], a[68:71], v[140:143], v[84:99]
  ds_read2st64_b32 v[160:161], v173 offset0:144 offset1:146
  buffer_load_dwordx4 a[116:119], v132, s[8:11], s27 offen offset:2048
  v_lshlrev_b32 v190, 16, v139
  v_and_b32 v191, s33, v139
  s_waitcnt lgkmcnt(7)
  v_mfma_f32_32x32x16_bf16 v[36:51], a[64:67], v[144:147], v[36:51]
  ds_read2st64_b32 v[162:163], v173 offset0:152 offset1:154
  v_fmac_f32 v180, v184, v184
  v_fmac_f32 v181, v185, v185
  v_mfma_f32_32x32x16_bf16 v[100:115], a[68:71], v[144:147], v[100:115]
  ds_read2st64_b32 v[164:165], v174 offset0:144 offset1:146
  s_add_u32 m0, s28, 65536
  s_add_u32 s29, s24, 1048576
  buffer_load_dwordx4 v170, s[12:15], s29 offen lds
  v_fmac_f32 v180, v186, v186
  v_fmac_f32 v181, v187, v187
  s_waitcnt lgkmcnt(7)
  v_mfma_f32_32x32x16_bf16 v[52:67], a[64:67], v[148:151], v[52:67]
  ds_read2st64_b32 v[166:167], v174 offset0:152 offset1:154
  v_fmac_f32 v180, v188, v188
  v_fmac_f32 v181, v189, v189
  v_mfma_f32_32x32x16_bf16 v[116:131], a[68:71], v[148:151], v[116:131]
  s_add_u32 m0, s28, 69632
  s_add_u32 s29, s24, 1114112
  buffer_load_dwordx4 v170, s[12:15], s29 offen lds
  v_fmac_f32 v180, v190, v190
  v_fmac_f32 v181, v191, v191
  s_waitcnt vmcnt(17) lgkmcnt(6)
  v_mfma_f32_32x32x16_bf16 v[4:19], a[72:75], v[152:155], v[4:19]
  ds_read2st64_b32 v[136:137], v171 offset0:160 offset1:162
  ds_read2st64_b32 v[138:139], v171 offset0:168 offset1:170
  v_lshlrev_b32 v184, 16, v152
  v_and_b32 v185, s33, v152
  s_waitcnt vmcnt(16)
  v_mfma_f32_32x32x16_bf16 v[68:83], a[76:79], v[152:155], v[68:83]
  ds_read2st64_b32 v[140:141], v172 offset0:160 offset1:162
  s_add_u32 m0, s28, 73728
  s_add_u32 s29, s24, 1179648
  buffer_load_dwordx4 v170, s[12:15], s29 offen lds
  v_lshlrev_b32 v186, 16, v153
  v_and_b32 v187, s33, v153
  s_waitcnt lgkmcnt(7)
  v_mfma_f32_32x32x16_bf16 v[20:35], a[72:75], v[156:159], v[20:35]
  ds_read2st64_b32 v[142:143], v172 offset0:168 offset1:170
  v_lshlrev_b32 v188, 16, v154
  v_and_b32 v189, s33, v154
  v_mfma_f32_32x32x16_bf16 v[84:99], a[76:79], v[156:159], v[84:99]
  ds_read2st64_b32 v[144:145], v173 offset0:160 offset1:162
  s_add_u32 m0, s28, 77824
  s_add_u32 s29, s24, 1245184
  buffer_load_dwordx4 v170, s[12:15], s29 offen lds
  v_lshlrev_b32 v190, 16, v155
  v_and_b32 v191, s33, v155
  s_waitcnt lgkmcnt(7)
  v_mfma_f32_32x32x16_bf16 v[36:51], a[72:75], v[160:163], v[36:51]
  ds_read2st64_b32 v[146:147], v173 offset0:168 offset1:170
  v_fmac_f32 v180, v184, v184
  v_fmac_f32 v181, v185, v185
  v_mfma_f32_32x32x16_bf16 v[100:115], a[76:79], v[160:163], v[100:115]
  ds_read2st64_b32 v[148:149], v174 offset0:160 offset1:162
  buffer_load_dwordx4 a[120:123], v132, s[8:11], s26 offen offset:3072
  v_fmac_f32 v180, v186, v186
  v_fmac_f32 v181, v187, v187
  s_waitcnt lgkmcnt(7)
  v_mfma_f32_32x32x16_bf16 v[52:67], a[72:75], v[164:167], v[52:67]
  ds_read2st64_b32 v[150:151], v174 offset0:168 offset1:170
  v_fmac_f32 v180, v188, v188
  v_fmac_f32 v181, v189, v189
  v_mfma_f32_32x32x16_bf16 v[116:131], a[76:79], v[164:167], v[116:131]
  buffer_load_dwordx4 a[124:127], v132, s[8:11], s27 offen offset:3072
  v_fmac_f32 v180, v190, v190
  v_fmac_f32 v181, v191, v191
  s_waitcnt vmcnt(19) lgkmcnt(6)
  v_mfma_f32_32x32x16_bf16 v[4:19], a[80:83], v[136:139], v[4:19]
  ds_read2st64_b32 v[152:153], v171 offset0:176 offset1:178
  ds_read2st64_b32 v[154:155], v171 offset0:184 offset1:186
  v_lshlrev_b32 v184, 16, v136
  v_and_b32 v185, s33, v136
  s_waitcnt vmcnt(18)
  v_mfma_f32_32x32x16_bf16 v[68:83], a[84:87], v[136:139], v[68:83]
  ds_read2st64_b32 v[156:157], v172 offset0:176 offset1:178
  s_add_u32 s26, s26, 4096
  buffer_load_dwordx4 a[128:131], v132, s[8:11], s26 offen offset:0
  v_lshlrev_b32 v186, 16, v137
  v_and_b32 v187, s33, v137
  s_waitcnt lgkmcnt(7)
  v_mfma_f32_32x32x16_bf16 v[20:35], a[80:83], v[140:143], v[20:35]
  ds_read2st64_b32 v[158:159], v172 offset0:184 offset1:186
  v_lshlrev_b32 v188, 16, v138
  v_and_b32 v189, s33, v138
  v_mfma_f32_32x32x16_bf16 v[84:99], a[84:87], v[140:143], v[84:99]
  ds_read2st64_b32 v[160:161], v173 offset0:176 offset1:178
  s_add_u32 s27, s27, 4096
  buffer_load_dwordx4 a[132:135], v132, s[8:11], s27 offen offset:0
  v_lshlrev_b32 v190, 16, v139
  v_and_b32 v191, s33, v139
  s_waitcnt lgkmcnt(7)
  v_mfma_f32_32x32x16_bf16 v[36:51], a[80:83], v[144:147], v[36:51]
  ds_read2st64_b32 v[162:163], v173 offset0:184 offset1:186
  v_fmac_f32 v180, v184, v184
  v_fmac_f32 v181, v185, v185
  v_mfma_f32_32x32x16_bf16 v[100:115], a[84:87], v[144:147], v[100:115]
  ds_read2st64_b32 v[164:165], v174 offset0:176 offset1:178
  buffer_load_dwordx4 a[136:139], v132, s[8:11], s26 offen offset:1024
  v_fmac_f32 v180, v186, v186
  v_fmac_f32 v181, v187, v187
  s_waitcnt lgkmcnt(7)
  v_mfma_f32_32x32x16_bf16 v[52:67], a[80:83], v[148:151], v[52:67]
  ds_read2st64_b32 v[166:167], v174 offset0:184 offset1:186
  v_fmac_f32 v180, v188, v188
  v_fmac_f32 v181, v189, v189
  v_mfma_f32_32x32x16_bf16 v[116:131], a[84:87], v[148:151], v[116:131]
  buffer_load_dwordx4 a[140:143], v132, s[8:11], s27 offen offset:1024
  v_fmac_f32 v180, v190, v190
  v_fmac_f32 v181, v191, v191
  s_waitcnt vmcnt(18)
  s_barrier
  s_waitcnt vmcnt(17) lgkmcnt(6)
  v_mfma_f32_32x32x16_bf16 v[4:19], a[88:91], v[152:155], v[4:19]
  ds_read2st64_b32 v[136:137], v171 offset0:192 offset1:194
  ds_read2st64_b32 v[138:139], v171 offset0:200 offset1:202
  v_lshlrev_b32 v184, 16, v152
  v_and_b32 v185, s33, v152
  s_waitcnt vmcnt(16)
  v_mfma_f32_32x32x16_bf16 v[68:83], a[92:95], v[152:155], v[68:83]
  ds_read2st64_b32 v[140:141], v172 offset0:192 offset1:194
  buffer_load_dwordx4 a[144:147], v132, s[8:11], s26 offen offset:2048
  v_lshlrev_b32 v186, 16, v153
  v_and_b32 v187, s33, v153
  s_waitcnt lgkmcnt(7)
  v_mfma_f32_32x32x16_bf16 v[20:35], a[88:91], v[156:159], v[20:35]
  ds_read2st64_b32 v[142:143], v172 offset0:200 offset1:202
  v_lshlrev_b32 v188, 16, v154
  v_and_b32 v189, s33, v154
  v_mfma_f32_32x32x16_bf16 v[84:99], a[92:95], v[156:159], v[84:99]
  ds_read2st64_b32 v[144:145], v173 offset0:192 offset1:194
  buffer_load_dwordx4 a[148:151], v132, s[8:11], s27 offen offset:2048
  v_lshlrev_b32 v190, 16, v155
  v_and_b32 v191, s33, v155
  s_waitcnt lgkmcnt(7)
  v_mfma_f32_32x32x16_bf16 v[36:51], a[88:91], v[160:163], v[36:51]
  ds_read2st64_b32 v[146:147], v173 offset0:200 offset1:202
  v_fmac_f32 v180, v184, v184
  v_fmac_f32 v181, v185, v185
  v_mfma_f32_32x32x16_bf16 v[100:115], a[92:95], v[160:163], v[100:115]
  ds_read2st64_b32 v[148:149], v174 offset0:192 offset1:194
  s_add_u32 m0, s28, 81920
  s_add_u32 s29, s24, 1310720
  buffer_load_dwordx4 v170, s[12:15], s29 offen lds
  v_fmac_f32 v180, v186, v186
  v_fmac_f32 v181, v187, v187
  s_waitcnt lgkmcnt(7)
  v_mfma_f32_32x32x16_bf16 v[52:67], a[88:91], v[164:167], v[52:67]
  ds_read2st64_b32 v[150:151], v174 offset0:200 offset1:202
  v_fmac_f32 v180, v188, v188
  v_fmac_f32 v181, v189, v189
  v_mfma_f32_32x32x16_bf16 v[116:131], a[92:95], v[164:167], v[116:131]
  s_add_u32 m0, s28, 86016
  s_add_u32 s29, s24, 1376256
  buffer_load_dwordx4 v170, s[12:15], s29 offen lds
  v_fmac_f32 v180, v190, v190
  v_fmac_f32 v181, v191, v191
  s_waitcnt vmcnt(19) lgkmcnt(6)
  v_mfma_f32_32x32x16_bf16 v[4:19], a[96:99], v[136:139], v[4:19]
  ds_read2st64_b32 v[152:153], v171 offset0:208 offset1:210
  ds_read2st64_b32 v[154:155], v171 offset0:216 offset1:218
  v_lshlrev_b32 v184, 16, v136
  v_and_b32 v185, s33, v136
  s_waitcnt vmcnt(18)
  v_mfma_f32_32x32x16_bf16 v[68:83], a[100:103], v[136:139], v[68:83]
  ds_read2st64_b32 v[156:157], v172 offset0:208 offset1:210
  s_add_u32 m0, s28, 90112
  s_add_u32 s29, s24, 1441792
  buffer_load_dwordx4 v170, s[12:15], s29 offen lds
  v_lshlrev_b32 v186, 16, v137
  v_and_b32 v187, s33, v137
  s_waitcnt lgkmcnt(7)
  v_mfma_f32_32x32x16_bf16 v[20:35], a[96:99], v[140:143], v[20:35]
  ds_read2st64_b32 v[158:159], v172 offset0:216 offset1:218
  v_lshlrev_b32 v188, 16, v138
  v_and_b32 v189, s33, v138
  v_mfma_f32_32x32x16_bf16 v[84:99], a[100:103], v[140:143], v[84:99]
  ds_read2st64_b32 v[160:161], v173 offset0:208 offset1:210
  s_add_u32 m0, s28, 94208
  s_add_u32 s29, s24, 1507328
  buffer_load_dwordx4 v170, s[12:15], s29 offen lds
  v_lshlrev_b32 v190, 16, v139
  v_and_b32 v191, s33, v139
  s_waitcnt lgkmcnt(7)
  v_mfma_f32_32x32x16_bf16 v[36:51], a[96:99], v[144:147], v[36:51]
  ds_read2st64_b32 v[162:163], v173 offset0:216 offset1:218
  v_fmac_f32 v180, v184, v184
  v_fmac_f32 v181, v185, v185
  v_mfma_f32_32x32x16_bf16 v[100:115], a[100:103], v[144:147], v[100:115]
  ds_read2st64_b32 v[164:165], v174 offset0:208 offset1:210
  buffer_load_dwordx4 a[152:155], v132, s[8:11], s26 offen offset:3072
  v_fmac_f32 v180, v186, v186
  v_fmac_f32 v181, v187, v187
  s_waitcnt lgkmcnt(7)
  v_mfma_f32_32x32x16_bf16 v[52:67], a[96:99], v[148:151], v[52:67]
  ds_read2st64_b32 v[166:167], v174 offset0:216 offset1:218
  v_fmac_f32 v180, v188, v188
  v_fmac_f32 v181, v189, v189
  v_mfma_f32_32x32x16_bf16 v[116:131], a[100:103], v[148:151], v[116:131]
  buffer_load_dwordx4 a[156:159], v132, s[8:11], s27 offen offset:3072
  v_fmac_f32 v180, v190, v190
  v_fmac_f32 v181, v191, v191
  s_waitcnt vmcnt(21) lgkmcnt(6)
  v_mfma_f32_32x32x16_bf16 v[4:19], a[104:107], v[152:155], v[4:19]
  ds_read2st64_b32 v[136:137], v171 offset0:224 offset1:226
  ds_read2st64_b32 v[138:139], v171 offset0:232 offset1:234
  v_lshlrev_b32 v184, 16, v152
  v_and_b32 v185, s33, v152
  s_waitcnt vmcnt(20)
  v_mfma_f32_32x32x16_bf16 v[68:83], a[108:111], v[152:155], v[68:83]
  ds_read2st64_b32 v[140:141], v172 offset0:224 offset1:226
  s_add_u32 m0, s28, 98304
  s_add_u32 s29, s24, 1572864
  buffer_load_dwordx4 v170, s[12:15], s29 offen lds
  v_lshlrev_b32 v186, 16, v153
  v_and_b32 v187, s33, v153
  s_waitcnt lgkmcnt(7)
  v_mfma_f32_32x32x16_bf16 v[20:35], a[104:107], v[156:159], v[20:35]
  ds_read2st64_b32 v[142:143], v172 offset0:232 offset1:234
  v_lshlrev_b32 v188, 16, v154
  v_and_b32 v189, s33, v154
  v_mfma_f32_32x32x16_bf16 v[84:99], a[108:111], v[156:159], v[84:99]
  ds_read2st64_b32 v[144:145], v173 offset0:224 offset1:226
  s_add_u32 m0, s28, 102400
  s_add_u32 s29, s24, 1638400
  buffer_load_dwordx4 v170, s[12:15], s29 offen lds
  v_lshlrev_b32 v190, 16, v155
  v_and_b32 v191, s33, v155
  s_waitcnt lgkmcnt(7)
  v_mfma_f32_32x32x16_bf16 v[36:51], a[104:107], v[160:163], v[36:51]
  ds_read2st64_b32 v[146:147], v173 offset0:232 offset1:234
  v_fmac_f32 v180, v184, v184
  v_fmac_f32 v181, v185, v185
  v_mfma_f32_32x32x16_bf16 v[100:115], a[108:111], v[160:163], v[100:115]
  ds_read2st64_b32 v[148:149], v174 offset0:224 offset1:226
  s_add_u32 m0, s28, 106496
  s_add_u32 s29, s24, 1703936
  buffer_load_dwordx4 v170, s[12:15], s29 offen lds
  v_fmac_f32 v180, v186, v186
  v_fmac_f32 v181, v187, v187
  s_waitcnt lgkmcnt(7)
  v_mfma_f32_32x32x16_bf16 v[52:67], a[104:107], v[164:167], v[52:67]
  ds_read2st64_b32 v[150:151], v174 offset0:232 offset1:234
  v_fmac_f32 v180, v188, v188
  v_fmac_f32 v181, v189, v189
  v_mfma_f32_32x32x16_bf16 v[116:131], a[108:111], v[164:167], v[116:131]
  s_add_u32 m0, s28, 110592
  s_add_u32 s29, s24, 1769472
  buffer_load_dwordx4 v170, s[12:15], s29 offen lds
  v_fmac_f32 v180, v190, v190
  v_fmac_f32 v181, v191, v191
  s_waitcnt vmcnt(23) lgkmcnt(6)
  v_mfma_f32_32x32x16_bf16 v[4:19], a[112:115], v[136:139], v[4:19]
  ds_read2st64_b32 v[152:153], v171 offset0:240 offset1:242
  ds_read2st64_b32 v[154:155], v171 offset0:248 offset1:250
  v_lshlrev_b32 v184, 16, v136
  v_and_b32 v185, s33, v136
  s_waitcnt vmcnt(22)
  v_mfma_f32_32x32x16_bf16 v[68:83], a[116:119], v[136:139], v[68:83]
  ds_read2st64_b32 v[156:157], v172 offset0:240 offset1:242
  s_add_u32 s26, s26, 4096
  buffer_load_dwordx4 a[160:163], v132, s[8:11], s26 offen offset:0
  v_lshlrev_b32 v186, 16, v137
  v_and_b32 v187, s33, v137
  s_waitcnt lgkmcnt(7)
  v_mfma_f32_32x32x16_bf16 v[20:35], a[112:115], v[140:143], v[20:35]
  ds_read2st64_b32 v[158:159], v172 offset0:248 offset1:250
  v_lshlrev_b32 v188, 16, v138
  v_and_b32 v189, s33, v138
  v_mfma_f32_32x32x16_bf16 v[84:99], a[116:119], v[140:143], v[84:99]
  ds_read2st64_b32 v[160:161], v173 offset0:240 offset1:242
  s_add_u32 s27, s27, 4096
  buffer_load_dwordx4 a[164:167], v132, s[8:11], s27 offen offset:0
  v_lshlrev_b32 v190, 16, v139
  v_and_b32 v191, s33, v139
  s_waitcnt lgkmcnt(7)
  v_mfma_f32_32x32x16_bf16 v[36:51], a[112:115], v[144:147], v[36:51]
  ds_read2st64_b32 v[162:163], v173 offset0:248 offset1:250
  v_fmac_f32 v180, v184, v184
  v_fmac_f32 v181, v185, v185
  v_mfma_f32_32x32x16_bf16 v[100:115], a[116:119], v[144:147], v[100:115]
  ds_read2st64_b32 v[164:165], v174 offset0:240 offset1:242
  buffer_load_dwordx4 a[168:171], v132, s[8:11], s26 offen offset:1024
  v_fmac_f32 v180, v186, v186
  v_fmac_f32 v181, v187, v187
  s_waitcnt lgkmcnt(7)
  v_mfma_f32_32x32x16_bf16 v[52:67], a[112:115], v[148:151], v[52:67]
  ds_read2st64_b32 v[166:167], v174 offset0:248 offset1:250
  v_fmac_f32 v180, v188, v188
  v_fmac_f32 v181, v189, v189
  v_mfma_f32_32x32x16_bf16 v[116:131], a[116:119], v[148:151], v[116:131]
  buffer_load_dwordx4 a[172:175], v132, s[8:11], s27 offen offset:1024
  v_fmac_f32 v180, v190, v190
  v_fmac_f32 v181, v191, v191
  s_waitcnt vmcnt(22)
  s_barrier
  s_waitcnt vmcnt(21) lgkmcnt(6)
  v_mfma_f32_32x32x16_bf16 v[4:19], a[120:123], v[152:155], v[4:19]
  ds_read2st64_b32 v[136:137], v175 offset0:0 offset1:2
  ds_read2st64_b32 v[138:139], v175 offset0:8 offset1:10
  v_lshlrev_b32 v184, 16, v152
  v_and_b32 v185, s33, v152
  s_waitcnt vmcnt(20)
  v_mfma_f32_32x32x16_bf16 v[68:83], a[124:127], v[152:155], v[68:83]
  ds_read2st64_b32 v[140:141], v176 offset0:0 offset1:2
  buffer_load_dwordx4 a[176:179], v132, s[8:11], s26 offen offset:2048
  v_lshlrev_b32 v186, 16, v153
  v_and_b32 v187, s33, v153
  s_waitcnt lgkmcnt(7)
  v_mfma_f32_32x32x16_bf16 v[20:35], a[120:123], v[156:159], v[20:35]
  ds_read2st64_b32 v[142:143], v176 offset0:8 offset1:10
  v_lshlrev_b32 v188, 16, v154
  v_and_b32 v189, s33, v154
  v_mfma_f32_32x32x16_bf16 v[84:99], a[124:127], v[156:159], v[84:99]
  ds_read2st64_b32 v[144:145], v177 offset0:0 offset1:2
  buffer_load_dwordx4 a[180:183], v132, s[8:11], s27 offen offset:2048
  v_lshlrev_b32 v190, 16, v155
  v_and_b32 v191, s33, v155
  s_waitcnt lgkmcnt(7)
  v_mfma_f32_32x32x16_bf16 v[36:51], a[120:123], v[160:163], v[36:51]
  ds_read2st64_b32 v[146:147], v177 offset0:8 offset1:10
  v_fmac_f32 v180, v184, v184
  v_fmac_f32 v181, v185, v185
  v_mfma_f32_32x32x16_bf16 v[100:115], a[124:127], v[160:163], v[100:115]
  ds_read2st64_b32 v[148:149], v178 offset0:0 offset1:2
  buffer_load_dwordx4 a[184:187], v132, s[8:11], s26 offen offset:3072
  v_fmac_f32 v180, v186, v186
  v_fmac_f32 v181, v187, v187
  s_waitcnt lgkmcnt(7)
  v_mfma_f32_32x32x16_bf16 v[52:67], a[120:123], v[164:167], v[52:67]
  ds_read2st64_b32 v[150:151], v178 offset0:8 offset1:10
  v_fmac_f32 v180, v188, v188
  v_fmac_f32 v181, v189, v189
  v_mfma_f32_32x32x16_bf16 v[116:131], a[124:127], v[164:167], v[116:131]
  buffer_load_dwordx4 a[188:191], v132, s[8:11], s27 offen offset:3072
  v_fmac_f32 v180, v190, v190
  v_fmac_f32 v181, v191, v191
  s_waitcnt vmcnt(23) lgkmcnt(6)
  v_mfma_f32_32x32x16_bf16 v[4:19], a[128:131], v[136:139], v[4:19]
  ds_read2st64_b32 v[152:153], v175 offset0:16 offset1:18
  ds_read2st64_b32 v[154:155], v175 offset0:24 offset1:26
  v_lshlrev_b32 v184, 16, v136
  v_and_b32 v185, s33, v136
  s_waitcnt vmcnt(22)
  v_mfma_f32_32x32x16_bf16 v[68:83], a[132:135], v[136:139], v[68:83]
  ds_read2st64_b32 v[156:157], v176 offset0:16 offset1:18
  s_add_u32 m0, s28, 114688
  s_add_u32 s29, s24, 1835008
  buffer_load_dwordx4 v170, s[12:15], s29 offen lds
  v_lshlrev_b32 v186, 16, v137
  v_and_b32 v187, s33, v137
  s_waitcnt lgkmcnt(7)
  v_mfma_f32_32x32x16_bf16 v[20:35], a[128:131], v[140:143], v[20:35]
  ds_read2st64_b32 v[158:159], v176 offset0:24 offset1:26
  v_lshlrev_b32 v188, 16, v138
  v_and_b32 v189, s33, v138
  v_mfma_f32_32x32x16_bf16 v[84:99], a[132:135], v[140:143], v[84:99]
  ds_read2st64_b32 v[160:161], v177 offset0:16 offset1:18
  s_add_u32 m0, s28, 118784
  s_add_u32 s29, s24, 1900544
  buffer_load_dwordx4 v170, s[12:15], s29 offen lds
  v_lshlrev_b32 v190, 16, v139
  v_and_b32 v191, s33, v139
  s_waitcnt lgkmcnt(7)
  v_mfma_f32_32x32x16_bf16 v[36:51], a[128:131], v[144:147], v[36:51]
  ds_read2st64_b32 v[162:163], v177 offset0:24 offset1:26
  v_fmac_f32 v180, v184, v184
  v_fmac_f32 v181, v185, v185
  v_mfma_f32_32x32x16_bf16 v[100:115], a[132:135], v[144:147], v[100:115]
  ds_read2st64_b32 v[164:165], v178 offset0:16 offset1:18
  s_add_u32 m0, s28, 122880
  s_add_u32 s29, s24, 1966080
  buffer_load_dwordx4 v170, s[12:15], s29 offen lds
  v_fmac_f32 v180, v186, v186
  v_fmac_f32 v181, v187, v187
  s_waitcnt lgkmcnt(7)
  v_mfma_f32_32x32x16_bf16 v[52:67], a[128:131], v[148:151], v[52:67]
  ds_read2st64_b32 v[166:167], v178 offset0:24 offset1:26
  v_fmac_f32 v180, v188, v188
  v_fmac_f32 v181, v189, v189
  v_mfma_f32_32x32x16_bf16 v[116:131], a[132:135], v[148:151], v[116:131]
  s_add_u32 m0, s28, 126976
  s_add_u32 s29, s24, 2031616
  buffer_load_dwordx4 v170, s[12:15], s29 offen lds
  v_fmac_f32 v180, v190, v190
  v_fmac_f32 v181, v191, v191
  s_waitcnt vmcnt(25) lgkmcnt(6)
  v_mfma_f32_32x32x16_bf16 v[4:19], a[136:139], v[152:155], v[4:19]
  ds_read2st64_b32 v[136:137], v175 offset0:32 offset1:34
  ds_read2st64_b32 v[138:139], v175 offset0:40 offset1:42
  v_lshlrev_b32 v184, 16, v152
  v_and_b32 v185, s33, v152
  s_waitcnt vmcnt(24)
  v_mfma_f32_32x32x16_bf16 v[68:83], a[140:143], v[152:155], v[68:83]
  ds_read2st64_b32 v[140:141], v176 offset0:32 offset1:34
  s_add_u32 s26, s26, 4096
  buffer_load_dwordx4 a[192:195], v132, s[8:11], s26 offen offset:0
  v_lshlrev_b32 v186, 16, v153
  v_and_b32 v187, s33, v153
  s_waitcnt lgkmcnt(7)
  v_mfma_f32_32x32x16_bf16 v[20:35], a[136:139], v[156:159], v[20:35]
  ds_read2st64_b32 v[142:143], v176 offset0:40 offset1:42
  v_lshlrev_b32 v188, 16, v154
  v_and_b32 v189, s33, v154
  v_mfma_f32_32x32x16_bf16 v[84:99], a[140:143], v[156:159], v[84:99]
  ds_read2st64_b32 v[144:145], v177 offset0:32 offset1:34
  s_add_u32 s27, s27, 4096
  buffer_load_dwordx4 a[196:199], v132, s[8:11], s27 offen offset:0
  v_lshlrev_b32 v190, 16, v155
  v_and_b32 v191, s33, v155
  s_waitcnt lgkmcnt(7)
  v_mfma_f32_32x32x16_bf16 v[36:51], a[136:139], v[160:163], v[36:51]
  ds_read2st64_b32 v[146:147], v177 offset0:40 offset1:42
  v_fmac_f32 v180, v184, v184
  v_fmac_f32 v181, v185, v185
  v_mfma_f32_32x32x16_bf16 v[100:115], a[140:143], v[160:163], v[100:115]
  ds_read2st64_b32 v[148:149], v178 offset0:32 offset1:34
  buffer_load_dwordx4 a[200:203], v132, s[8:11], s26 offen offset:1024
  v_fmac_f32 v180, v186, v186
  v_fmac_f32 v181, v187, v187
  s_waitcnt lgkmcnt(7)
  v_mfma_f32_32x32x16_bf16 v[52:67], a[136:139], v[164:167], v[52:67]
  ds_read2st64_b32 v[150:151], v178 offset0:40 offset1:42
  v_fmac_f32 v180, v188, v188
  v_fmac_f32 v181, v189, v189
  v_mfma_f32_32x32x16_bf16 v[116:131], a[140:143], v[164:167], v[116:131]
  buffer_load_dwordx4 a[204:207], v132, s[8:11], s27 offen offset:1024
  v_fmac_f32 v180, v190, v190
  v_fmac_f32 v181, v191, v191
  s_waitcnt vmcnt(27) lgkmcnt(6)
  v_mfma_f32_32x32x16_bf16 v[4:19], a[144:147], v[136:139], v[4:19]
  ds_read2st64_b32 v[152:153], v175 offset0:48 offset1:50
  ds_read2st64_b32 v[154:155], v175 offset0:56 offset1:58
  v_lshlrev_b32 v184, 16, v136
  v_and_b32 v185, s33, v136
  s_waitcnt vmcnt(26)
  v_mfma_f32_32x32x16_bf16 v[68:83], a[148:151], v[136:139], v[68:83]
  ds_read2st64_b32 v[156:157], v176 offset0:48 offset1:50
  buffer_load_dwordx4 a[208:211], v132, s[8:11], s26 offen offset:2048
  v_lshlrev_b32 v186, 16, v137
  v_and_b32 v187, s33, v137
  s_waitcnt lgkmcnt(7)
  v_mfma_f32_32x32x16_bf16 v[20:35], a[144:147], v[140:143], v[20:35]
  ds_read2st64_b32 v[158:159], v176 offset0:56 offset1:58
  v_lshlrev_b32 v188, 16, v138
  v_and_b32 v189, s33, v138
  v_mfma_f32_32x32x16_bf16 v[84:99], a[148:151], v[140:143], v[84:99]
  ds_read2st64_b32 v[160:161], v177 offset0:48 offset1:50
  buffer_load_dwordx4 a[212:215], v132, s[8:11], s27 offen offset:2048
  v_lshlrev_b32 v190, 16, v139
  v_and_b32 v191, s33, v139
  s_waitcnt lgkmcnt(7)
  v_mfma_f32_32x32x16_bf16 v[36:51], a[144:147], v[144:147], v[36:51]
  ds_read2st64_b32 v[162:163], v177 offset0:56 offset1:58
  v_fmac_f32 v180, v184, v184
  v_fmac_f32 v181, v185, v185
  v_mfma_f32_32x32x16_bf16 v[100:115], a[148:151], v[144:147], v[100:115]
  ds_read2st64_b32 v[164:165], v178 offset0:48 offset1:50
  buffer_load_dwordx4 a[216:219], v132, s[8:11], s26 offen offset:3072
  v_fmac_f32 v180, v186, v186
  v_fmac_f32 v181, v187, v187
  s_waitcnt lgkmcnt(7)
  v_mfma_f32_32x32x16_bf16 v[52:67], a[144:147], v[148:151], v[52:67]
  ds_read2st64_b32 v[166:167], v178 offset0:56 offset1:58
  v_fmac_f32 v180, v188, v188
  v_fmac_f32 v181, v189, v189
  v_mfma_f32_32x32x16_bf16 v[116:131], a[148:151], v[148:151], v[116:131]
  buffer_load_dwordx4 a[220:223], v132, s[8:11], s27 offen offset:3072
  v_fmac_f32 v180, v190, v190
  v_fmac_f32 v181, v191, v191
  s_waitcnt vmcnt(26)
  s_barrier
  s_waitcnt vmcnt(25) lgkmcnt(6)
  v_mfma_f32_32x32x16_bf16 v[4:19], a[152:155], v[152:155], v[4:19]
  ds_read2st64_b32 v[136:137], v175 offset0:64 offset1:66
  ds_read2st64_b32 v[138:139], v175 offset0:72 offset1:74
  v_lshlrev_b32 v184, 16, v152
  v_and_b32 v185, s33, v152
  s_waitcnt vmcnt(24)
  v_mfma_f32_32x32x16_bf16 v[68:83], a[156:159], v[152:155], v[68:83]
  ds_read2st64_b32 v[140:141], v175 offset0:80 offset1:82
  s_add_u32 s26, s26, 4096
  buffer_load_dwordx4 a[224:227], v132, s[8:11], s26 offen offset:0
  v_lshlrev_b32 v186, 16, v153
  v_and_b32 v187, s33, v153
  s_waitcnt lgkmcnt(7)
  v_mfma_f32_32x32x16_bf16 v[20:35], a[152:155], v[156:159], v[20:35]
  ds_read2st64_b32 v[142:143], v175 offset0:88 offset1:90
  v_lshlrev_b32 v188, 16, v154
  v_and_b32 v189, s33, v154
  v_mfma_f32_32x32x16_bf16 v[84:99], a[156:159], v[156:159], v[84:99]
  ds_read2st64_b32 v[144:145], v175 offset0:96 offset1:98
  s_add_u32 s27, s27, 4096
  buffer_load_dwordx4 a[228:231], v132, s[8:11], s27 offen offset:0
  v_lshlrev_b32 v190, 16, v155
  v_and_b32 v191, s33, v155
  s_waitcnt lgkmcnt(7)
  v_mfma_f32_32x32x16_bf16 v[36:51], a[152:155], v[160:163], v[36:51]
  ds_read2st64_b32 v[146:147], v175 offset0:104 offset1:106
  v_fmac_f32 v180, v184, v184
  v_fmac_f32 v181, v185, v185
  v_mfma_f32_32x32x16_bf16 v[100:115], a[156:159], v[160:163], v[100:115]
  ds_read2st64_b32 v[148:149], v175 offset0:112 offset1:114
  buffer_load_dwordx4 a[232:235], v132, s[8:11], s26 offen offset:1024
  v_fmac_f32 v180, v186, v186
  v_fmac_f32 v181, v187, v187
  s_waitcnt lgkmcnt(7)
  v_mfma_f32_32x32x16_bf16 v[52:67], a[152:155], v[164:167], v[52:67]
  ds_read2st64_b32 v[150:151], v175 offset0:120 offset1:122
  v_fmac_f32 v180, v188, v188
  v_fmac_f32 v181, v189, v189
  v_mfma_f32_32x32x16_bf16 v[116:131], a[156:159], v[164:167], v[116:131]
  buffer_load_dwordx4 a[236:239], v132, s[8:11], s27 offen offset:1024
  v_fmac_f32 v180, v190, v190
  v_fmac_f32 v181, v191, v191
  v_lshlrev_b32 v168, 2, v133
  s_lshl_b32 s30, s3, 7
  s_add_u32 s30, s30, 131072
  v_add_u32 v210, s30, v168
  s_add_u32 s30, s3, 1
  s_and_b32 s30, s30, 3
  s_lshl_b32 s30, s30, 7
  s_add_u32 s30, s30, 131072
  v_add_u32 v211, s30, v168
  s_add_u32 s30, s3, 2
  s_and_b32 s30, s30, 3
  s_lshl_b32 s30, s30, 7
  s_add_u32 s30, s30, 131072
  v_add_u32 v212, s30, v168
  s_add_u32 s30, s3, 3
  s_and_b32 s30, s30, 3
  s_lshl_b32 s30, s30, 7
  s_add_u32 s30, s30, 131072
  v_add_u32 v213, s30, v168
  s_mov_b32 s30, 0x3b000000
  s_mov_b32 s31, 0xbfb8aa3b
  v_mov_b32 v169, 0x3727c5ac
  s_waitcnt vmcnt(24)
  s_barrier
  s_waitcnt vmcnt(23) lgkmcnt(6)
  v_mfma_f32_32x32x16_bf16 v[4:19], a[160:163], v[136:139], v[4:19]
  ds_read2st64_b32 v[152:153], v175 offset0:128 offset1:130
  buffer_load_dwordx4 a[240:243], v132, s[8:11], s26 offen offset:2048
  buffer_load_dwordx4 a[248:251], v132, s[8:11], s26 offen offset:3072
  v_lshlrev_b32 v184, 16, v136
  v_and_b32 v185, s33, v136
  v_lshlrev_b32 v186, 16, v137
  v_and_b32 v187, s33, v137
  v_lshlrev_b32 v188, 16, v138
  v_and_b32 v189, s33, v138
  v_lshlrev_b32 v190, 16, v139
  v_and_b32 v191, s33, v139
  s_waitcnt vmcnt(24)
  v_mfma_f32_32x32x16_bf16 v[68:83], a[164:167], v[136:139], v[68:83]
  ds_read2st64_b32 v[154:155], v175 offset0:136 offset1:138
  buffer_load_dwordx4 a[244:247], v132, s[8:11], s27 offen offset:2048
  buffer_load_dwordx4 a[252:255], v132, s[8:11], s27 offen offset:3072
  v_fmac_f32 v180, v184, v184
  v_fmac_f32 v181, v185, v185
  v_fmac_f32 v180, v186, v186
  v_fmac_f32 v181, v187, v187
  v_fmac_f32 v180, v188, v188
  v_fmac_f32 v181, v189, v189
  v_fmac_f32 v180, v190, v190
  v_fmac_f32 v181, v191, v191
  s_waitcnt vmcnt(25) lgkmcnt(6)
  v_mfma_f32_32x32x16_bf16 v[4:19], a[168:171], v[140:143], v[4:19]
  ds_read2st64_b32 v[156:157], v175 offset0:144 offset1:146
  v_lshlrev_b32 v184, 16, v140
  v_and_b32 v185, s33, v140
  v_lshlrev_b32 v186, 16, v141
  v_and_b32 v187, s33, v141
  v_lshlrev_b32 v188, 16, v142
  v_and_b32 v189, s33, v142
  v_lshlrev_b32 v190, 16, v143
  v_and_b32 v191, s33, v143
  s_waitcnt vmcnt(24)
  v_mfma_f32_32x32x16_bf16 v[68:83], a[172:175], v[140:143], v[68:83]
  ds_read2st64_b32 v[158:159], v175 offset0:152 offset1:154
  v_fmac_f32 v180, v184, v184
  v_fmac_f32 v181, v185, v185
  v_fmac_f32 v180, v186, v186
  v_fmac_f32 v181, v187, v187
  v_fmac_f32 v180, v188, v188
  v_fmac_f32 v181, v189, v189
  v_fmac_f32 v180, v190, v190
  v_fmac_f32 v181, v191, v191
  s_waitcnt vmcnt(23) lgkmcnt(6)
  v_mfma_f32_32x32x16_bf16 v[4:19], a[176:179], v[144:147], v[4:19]
  ds_read2st64_b32 v[160:161], v175 offset0:160 offset1:162
  v_lshlrev_b32 v184, 16, v144
  v_and_b32 v185, s33, v144
  v_lshlrev_b32 v186, 16, v145
  v_and_b32 v187, s33, v145
  v_lshlrev_b32 v188, 16, v146
  v_and_b32 v189, s33, v146
  v_lshlrev_b32 v190, 16, v147
  v_and_b32 v191, s33, v147
  s_waitcnt vmcnt(22)
  v_mfma_f32_32x32x16_bf16 v[68:83], a[180:183], v[144:147], v[68:83]
  ds_read2st64_b32 v[162:163], v175 offset0:168 offset1:170
  v_fmac_f32 v180, v184, v184
  v_fmac_f32 v181, v185, v185
  v_fmac_f32 v180, v186, v186
  v_fmac_f32 v181, v187, v187
  v_fmac_f32 v180, v188, v188
  v_fmac_f32 v181, v189, v189
  v_fmac_f32 v180, v190, v190
  v_fmac_f32 v181, v191, v191
  s_waitcnt vmcnt(21) lgkmcnt(6)
  v_mfma_f32_32x32x16_bf16 v[4:19], a[184:187], v[148:151], v[4:19]
  ds_read2st64_b32 v[164:165], v175 offset0:176 offset1:178
  v_lshlrev_b32 v184, 16, v148
  v_and_b32 v185, s33, v148
  v_lshlrev_b32 v186, 16, v149
  v_and_b32 v187, s33, v149
  v_lshlrev_b32 v188, 16, v150
  v_and_b32 v189, s33, v150
  v_lshlrev_b32 v190, 16, v151
  v_and_b32 v191, s33, v151
  s_waitcnt vmcnt(20)
  v_mfma_f32_32x32x16_bf16 v[68:83], a[188:191], v[148:151], v[68:83]
  ds_read2st64_b32 v[166:167], v175 offset0:184 offset1:186
  v_fmac_f32 v180, v184, v184
  v_fmac_f32 v181, v185, v185
  v_fmac_f32 v180, v186, v186
  v_fmac_f32 v181, v187, v187
  v_fmac_f32 v180, v188, v188
  v_fmac_f32 v181, v189, v189
  v_fmac_f32 v180, v190, v190
  v_fmac_f32 v181, v191, v191
  s_waitcnt vmcnt(16)
  s_barrier
  s_waitcnt vmcnt(15) lgkmcnt(6)
  v_mfma_f32_32x32x16_bf16 v[4:19], a[192:195], v[152:155], v[4:19]
  ds_read2st64_b32 v[136:137], v175 offset0:192 offset1:194
  v_lshlrev_b32 v184, 16, v152
  v_and_b32 v185, s33, v152
  v_lshlrev_b32 v186, 16, v153
  v_and_b32 v187, s33, v153
  v_lshlrev_b32 v188, 16, v154
  v_and_b32 v189, s33, v154
  v_lshlrev_b32 v190, 16, v155
  v_and_b32 v191, s33, v155
  s_waitcnt vmcnt(14)
  v_mfma_f32_32x32x16_bf16 v[68:83], a[196:199], v[152:155], v[68:83]
  ds_read2st64_b32 v[138:139], v175 offset0:200 offset1:202
  v_fmac_f32 v180, v184, v184
  v_fmac_f32 v181, v185, v185
  v_fmac_f32 v180, v186, v186
  v_fmac_f32 v181, v187, v187
  v_fmac_f32 v180, v188, v188
  v_fmac_f32 v181, v189, v189
  v_fmac_f32 v180, v190, v190
  v_fmac_f32 v181, v191, v191
  s_waitcnt vmcnt(13) lgkmcnt(6)
  v_mfma_f32_32x32x16_bf16 v[4:19], a[200:203], v[156:159], v[4:19]
  ds_read2st64_b32 v[140:141], v175 offset0:208 offset1:210
  v_lshlrev_b32 v184, 16, v156
  v_and_b32 v185, s33, v156
  v_lshlrev_b32 v186, 16, v157
  v_and_b32 v187, s33, v157
  v_lshlrev_b32 v188, 16, v158
  v_and_b32 v189, s33, v158
  v_lshlrev_b32 v190, 16, v159
  v_and_b32 v191, s33, v159
  s_waitcnt vmcnt(12)
  v_mfma_f32_32x32x16_bf16 v[68:83], a[204:207], v[156:159], v[68:83]
  ds_read2st64_b32 v[142:143], v175 offset0:216 offset1:218
  v_fmac_f32 v180, v184, v184
  v_fmac_f32 v181, v185, v185
  v_fmac_f32 v180, v186, v186
  v_fmac_f32 v181, v187, v187
  v_fmac_f32 v180, v188, v188
  v_fmac_f32 v181, v189, v189
  v_fmac_f32 v180, v190, v190
  v_fmac_f32 v181, v191, v191
  s_waitcnt vmcnt(11) lgkmcnt(6)
  v_mfma_f32_32x32x16_bf16 v[4:19], a[208:211], v[160:163], v[4:19]
  ds_read2st64_b32 v[144:145], v175 offset0:224 offset1:226
  v_lshlrev_b32 v184, 16, v160
  v_and_b32 v185, s33, v160
  v_lshlrev_b32 v186, 16, v161
  v_and_b32 v187, s33, v161
  v_lshlrev_b32 v188, 16, v162
  v_and_b32 v189, s33, v162
  v_lshlrev_b32 v190, 16, v163
  v_and_b32 v191, s33, v163
  s_waitcnt vmcnt(10)
  v_mfma_f32_32x32x16_bf16 v[68:83], a[212:215], v[160:163], v[68:83]
  ds_read2st64_b32 v[146:147], v175 offset0:232 offset1:234
  v_fmac_f32 v180, v184, v184
  v_fmac_f32 v181, v185, v185
  v_fmac_f32 v180, v186, v186
  v_fmac_f32 v181, v187, v187
  v_fmac_f32 v180, v188, v188
  v_fmac_f32 v181, v189, v189
  v_fmac_f32 v180, v190, v190
  v_fmac_f32 v181, v191, v191
  s_waitcnt vmcnt(9) lgkmcnt(6)
  v_mfma_f32_32x32x16_bf16 v[4:19], a[216:219], v[164:167], v[4:19]
  ds_read2st64_b32 v[148:149], v175 offset0:240 offset1:242
  v_lshlrev_b32 v184, 16, v164
  v_and_b32 v185, s33, v164
  v_lshlrev_b32 v186, 16, v165
  v_and_b32 v187, s33, v165
  v_lshlrev_b32 v188, 16, v166
  v_and_b32 v189, s33, v166
  v_lshlrev_b32 v190, 16, v167
  v_and_b32 v191, s33, v167
  s_waitcnt vmcnt(8)
  v_mfma_f32_32x32x16_bf16 v[68:83], a[220:223], v[164:167], v[68:83]
  ds_read2st64_b32 v[150:151], v175 offset0:248 offset1:250
  v_fmac_f32 v180, v184, v184
  v_fmac_f32 v181, v185, v185
  v_fmac_f32 v180, v186, v186
  v_fmac_f32 v181, v187, v187
  v_fmac_f32 v180, v188, v188
  v_fmac_f32 v181, v189, v189
  v_fmac_f32 v180, v190, v190
  v_fmac_f32 v181, v191, v191
  s_waitcnt vmcnt(7) lgkmcnt(6)
  v_mfma_f32_32x32x16_bf16 v[4:19], a[224:227], v[136:139], v[4:19]
  ds_read2st64_b32 v[152:153], v176 offset0:64 offset1:66
  v_lshlrev_b32 v184, 16, v136
  v_and_b32 v185, s33, v136
  v_lshlrev_b32 v186, 16, v137
  v_and_b32 v187, s33, v137
  v_lshlrev_b32 v188, 16, v138
  v_and_b32 v189, s33, v138
  v_lshlrev_b32 v190, 16, v139
  v_and_b32 v191, s33, v139
  s_waitcnt vmcnt(6)
  v_mfma_f32_32x32x16_bf16 v[68:83], a[228:231], v[136:139], v[68:83]
  ds_read2st64_b32 v[154:155], v176 offset0:72 offset1:74
  v_fmac_f32 v180, v184, v184
  v_fmac_f32 v181, v185, v185
  v_fmac_f32 v180, v186, v186
  v_fmac_f32 v181, v187, v187
  v_fmac_f32 v180, v188, v188
  v_fmac_f32 v181, v189, v189
  v_fmac_f32 v180, v190, v190
  v_fmac_f32 v181, v191, v191
  s_waitcnt vmcnt(5) lgkmcnt(6)
  v_mfma_f32_32x32x16_bf16 v[4:19], a[232:235], v[140:143], v[4:19]
  ds_read2st64_b32 v[156:157], v176 offset0:80 offset1:82
  v_lshlrev_b32 v184, 16, v140
  v_and_b32 v185, s33, v140
  v_lshlrev_b32 v186, 16, v141
  v_and_b32 v187, s33, v141
  v_lshlrev_b32 v188, 16, v142
  v_and_b32 v189, s33, v142
  v_lshlrev_b32 v190, 16, v143
  v_and_b32 v191, s33, v143
  s_waitcnt vmcnt(4)
  v_mfma_f32_32x32x16_bf16 v[68:83], a[236:239], v[140:143], v[68:83]
  ds_read2st64_b32 v[158:159], v176 offset0:88 offset1:90
  v_fmac_f32 v180, v184, v184
  v_fmac_f32 v181, v185, v185
  v_fmac_f32 v180, v186, v186
  v_fmac_f32 v181, v187, v187
  v_fmac_f32 v180, v188, v188
  v_fmac_f32 v181, v189, v189
  v_fmac_f32 v180, v190, v190
  v_fmac_f32 v181, v191, v191
  s_waitcnt vmcnt(3) lgkmcnt(6)
  v_mfma_f32_32x32x16_bf16 v[4:19], a[240:243], v[144:147], v[4:19]
  ds_read2st64_b32 v[160:161], v176 offset0:96 offset1:98
  v_lshlrev_b32 v184, 16, v144
  v_and_b32 v185, s33, v144
  v_lshlrev_b32 v186, 16, v145
  v_and_b32 v187, s33, v145
  v_lshlrev_b32 v188, 16, v146
  v_and_b32 v189, s33, v146
  v_lshlrev_b32 v190, 16, v147
  v_and_b32 v191, s33, v147
  s_waitcnt vmcnt(1)
  v_mfma_f32_32x32x16_bf16 v[68:83], a[244:247], v[144:147], v[68:83]
  ds_read2st64_b32 v[162:163], v176 offset0:104 offset1:106
  v_fmac_f32 v180, v184, v184
  v_fmac_f32 v181, v185, v185
  v_fmac_f32 v180, v186, v186
  v_fmac_f32 v181, v187, v187
  v_fmac_f32 v180, v188, v188
  v_fmac_f32 v181, v189, v189
  v_fmac_f32 v180, v190, v190
  v_fmac_f32 v181, v191, v191
  s_waitcnt lgkmcnt(6)
  v_mfma_f32_32x32x16_bf16 v[4:19], a[248:251], v[148:151], v[4:19]
  ds_read2st64_b32 v[164:165], v176 offset0:112 offset1:114
  v_lshlrev_b32 v184, 16, v148
  v_and_b32 v185, s33, v148
  v_lshlrev_b32 v186, 16, v149
  v_and_b32 v187, s33, v149
  v_lshlrev_b32 v188, 16, v150
  v_and_b32 v189, s33, v150
  v_lshlrev_b32 v190, 16, v151
  v_and_b32 v191, s33, v151
  s_waitcnt vmcnt(0)
  v_mfma_f32_32x32x16_bf16 v[68:83], a[252:255], v[148:151], v[68:83]
  ds_read2st64_b32 v[166:167], v176 offset0:120 offset1:122
  v_fmac_f32 v180, v184, v184
  v_fmac_f32 v181, v185, v185
  v_fmac_f32 v180, v186, v186
  v_fmac_f32 v181, v187, v187
  v_fmac_f32 v180, v188, v188
  v_fmac_f32 v181, v189, v189
  v_fmac_f32 v180, v190, v190
  v_fmac_f32 v181, v191, v191
  s_waitcnt lgkmcnt(6)
  v_mfma_f32_32x32x16_bf16 v[20:35], a[160:163], v[152:155], v[20:35]
  ds_read2st64_b32 v[136:137], v176 offset0:128 offset1:130
  s_getpc_b64 s[96:97]
pf29:
  s_add_u32 s96, s96, p2_27-pf29
  s_addc_u32 s97, s97, 0
  s_mov_b32 s98, text_end-p2_27
  s_mov_b32 s99, 0x20000
  v_lshlrev_b32 v2, 6, v0
  buffer_load_dword v3, v2, s[96:99], 0 offen
  s_and_b32 s60, s2, 3
  s_lshl_b32 s60, s60, 2
  s_bfe_u32 s61, s2, 0x10002
  s_lshl_b32 s61, s61, 1
  s_add_u32 s60, s60, s61
  s_lshr_b32 s61, s2, 7
  s_add_u32 s60, s60, s61
  s_lshl_b32 s60, s60, 1
  s_bfe_u32 s61, s2, 0x10006
  s_add_u32 s63, s60, s61
  s_bfe_u32 s62, s2, 0x30003
  s_add_u32 s52, s4, 0xe00000
  s_addc_u32 s53, s5, 0
  s_mov_b32 s54, 0x1c0000
  s_mov_b32 s55, 0x20000
  s_mul_i32 s60, s3, 28672
  s_mul_i32 s56, s62, 229376
  s_add_u32 s56, s56, s60
  s_add_u32 s57, s56, 114688
  buffer_load_dwordx4 a[0:3], v132, s[52:55], s56 offen offset:0
  v_add_f32 v180, v180, v181
  v_mov_b32 v181, v180
  s_nop 1
  v_permlane32_swap_b32 v180, v181
  v_add_f32 v180, v180, v181
  v_fma_f32 v194, v180, s30, v169
  ds_write_b32 v210, v194
  v_rsq_f32 v202, v194
  s_nop 0
  v_mul_f32 v202, s31, v202
  v_mfma_f32_32x32x16_bf16 v[84:99], a[164:167], v[152:155], v[84:99]
  ds_read2st64_b32 v[138:139], v176 offset0:136 offset1:138
  s_waitcnt lgkmcnt(7)
  v_mfma_f32_32x32x16_bf16 v[20:35], a[168:171], v[156:159], v[20:35]
  ds_read2st64_b32 v[140:141], v176 offset0:144 offset1:146
  buffer_load_dwordx4 a[4:7], v132, s[52:55], s57 offen offset:0
  v_mfma_f32_32x32x16_bf16 v[84:99], a[172:175], v[156:159], v[84:99]
  ds_read2st64_b32 v[142:143], v176 offset0:152 offset1:154
  v_mul_f32 v68, v4, v68
  v_mul_f32 v4, v4, v202
  v_exp_f32 v4, v4
  v_mul_f32 v69, v5, v69
  v_mul_f32 v5, v5, v202
  s_waitcnt lgkmcnt(7)
  v_mfma_f32_32x32x16_bf16 v[20:35], a[176:179], v[160:163], v[20:35]
  ds_read2st64_b32 v[144:145], v176 offset0:160 offset1:162
  buffer_load_dwordx4 a[8:11], v132, s[52:55], s56 offen offset:1024
  v_exp_f32 v5, v5
  v_fma_f32 v4, v4, v194, v194
  v_rcp_f32 v4, v4
  v_mul_f32 v70, v6, v70
  v_mul_f32 v6, v6, v202
  v_mfma_f32_32x32x16_bf16 v[84:99], a[180:183], v[160:163], v[84:99]
  ds_read2st64_b32 v[146:147], v176 offset0:168 offset1:170
  v_exp_f32 v6, v6
  v_fma_f32 v5, v5, v194, v194
  v_rcp_f32 v5, v5
  v_mul_f32 v68, v68, v4
  s_waitcnt lgkmcnt(7)
  v_mfma_f32_32x32x16_bf16 v[20:35], a[184:187], v[164:167], v[20:35]
  ds_read2st64_b32 v[148:149], v176 offset0:176 offset1:178
  buffer_load_dwordx4 a[12:15], v132, s[52:55], s57 offen offset:1024
  v_mul_f32 v71, v7, v71
  v_mul_f32 v7, v7, v202
  v_exp_f32 v7, v7
  v_fma_f32 v6, v6, v194, v194
  v_rcp_f32 v6, v6
  v_mfma_f32_32x32x16_bf16 v[84:99], a[188:191], v[164:167], v[84:99]
  ds_read2st64_b32 v[150:151], v176 offset0:184 offset1:186
  v_mul_f32 v69, v69, v5
  v_cvt_pk_bf16_f32 v4, v68, v69
  v_mul_f32 v72, v8, v72
  v_mul_f32 v8, v8, v202
  v_exp_f32 v8, v8
  s_waitcnt lgkmcnt(6)
  v_mfma_f32_32x32x16_bf16 v[20:35], a[192:195], v[136:139], v[20:35]
  ds_read2st64_b32 v[152:153], v176 offset0:192 offset1:194
  v_fma_f32 v7, v7, v194, v194
  v_rcp_f32 v7, v7
  v_mul_f32 v70, v70, v6
  v_mul_f32 v73, v9, v73
  v_mul_f32 v9, v9, v202
  v_mfma_f32_32x32x16_bf16 v[84:99], a[196:199], v[136:139], v[84:99]
  ds_read2st64_b32 v[154:155], v176 offset0:200 offset1:202
  buffer_load_dwordx4 a[16:19], v132, s[52:55], s56 offen offset:2048
  v_exp_f32 v9, v9
  v_fma_f32 v8, v8, v194, v194
  v_rcp_f32 v8, v8
  v_mul_f32 v71, v71, v7
  v_cvt_pk_bf16_f32 v5, v70, v71
  s_waitcnt lgkmcnt(6)
  v_mfma_f32_32x32x16_bf16 v[20:35], a[200:203], v[140:143], v[20:35]
  ds_read2st64_b32 v[156:157], v176 offset0:208 offset1:210
  v_mul_f32 v74, v10, v74
  v_mul_f32 v10, v10, v202
  v_exp_f32 v10, v10
  v_fma_f32 v9, v9, v194, v194
  v_rcp_f32 v9, v9
  v_mfma_f32_32x32x16_bf16 v[84:99], a[204:207], v[140:143], v[84:99]
  ds_read2st64_b32 v[158:159], v176 offset0:216 offset1:218
  buffer_load_dwordx4 a[20:23], v132, s[52:55], s57 offen offset:2048
  v_mul_f32 v72, v72, v8
  v_mul_f32 v75, v11, v75
  v_mul_f32 v11, v11, v202
  v_exp_f32 v11, v11
  v_fma_f32 v10, v10, v194, v194
  s_waitcnt lgkmcnt(6)
  v_mfma_f32_32x32x16_bf16 v[20:35], a[208:211], v[144:147], v[20:35]
  ds_read2st64_b32 v[160:161], v176 offset0:224 offset1:226
  s_waitcnt lgkmcnt(0)
  s_barrier
  ds_read_b32 v196, v211
  ds_read_b32 v198, v212
  ds_read_b32 v200, v213
  v_rcp_f32 v10, v10
  v_mul_f32 v73, v73, v9
  v_cvt_pk_bf16_f32 v6, v72, v73
  v_mul_f32 v76, v12, v76
  v_mul_f32 v12, v12, v202
  v_exp_f32 v12, v12
  v_mfma_f32_32x32x16_bf16 v[84:99], a[212:215], v[144:147], v[84:99]
  ds_read2st64_b32 v[162:163], v176 offset0:232 offset1:234
  buffer_load_dwordx4 a[24:27], v132, s[52:55], s56 offen offset:3072
  v_fma_f32 v11, v11, v194, v194
  v_rcp_f32 v11, v11
  v_mul_f32 v74, v74, v10
  v_mul_f32 v77, v13, v77
  v_mul_f32 v13, v13, v202
  v_mfma_f32_32x32x16_bf16 v[20:35], a[216:219], v[148:151], v[20:35]
  ds_read2st64_b32 v[164:165], v176 offset0:240 offset1:242
  v_exp_f32 v13, v13
  v_fma_f32 v12, v12, v194, v194
  v_rcp_f32 v12, v12
  v_mfma_f32_32x32x16_bf16 v[84:99], a[220:223], v[148:151], v[84:99]
  ds_read2st64_b32 v[166:167], v176 offset0:248 offset1:250
  buffer_load_dwordx4 a[28:31], v132, s[52:55], s57 offen offset:3072
  v_mul_f32 v75, v75, v11
  v_cvt_pk_bf16_f32 v7, v74, v75
  buffer_store_dwordx4 v[4:7], v132, s[16:19], s36 offen sc0 sc1
  v_mul_f32 v78, v14, v78
  v_mul_f32 v14, v14, v202
  v_exp_f32 v14, v14
  v_fma_f32 v13, v13, v194, v194
  v_mfma_f32_32x32x16_bf16 v[20:35], a[224:227], v[152:155], v[20:35]
  ds_read2st64_b32 v[136:137], v177 offset0:64 offset1:66
  v_rcp_f32 v13, v13
  v_mul_f32 v76, v76, v12
  v_mul_f32 v79, v15, v79
  v_mul_f32 v15, v15, v202
  v_exp_f32 v15, v15
  v_mfma_f32_32x32x16_bf16 v[84:99], a[228:231], v[152:155], v[84:99]
  ds_read2st64_b32 v[138:139], v177 offset0:72 offset1:74
  v_fma_f32 v14, v14, v194, v194
  v_rcp_f32 v14, v14
  v_mul_f32 v77, v77, v13
  v_cvt_pk_bf16_f32 v8, v76, v77
  v_mul_f32 v80, v16, v80
  v_mfma_f32_32x32x16_bf16 v[20:35], a[232:235], v[156:159], v[20:35]
  ds_read2st64_b32 v[140:141], v177 offset0:80 offset1:82
  s_add_u32 s56, s56, 4096
  buffer_load_dwordx4 a[32:35], v132, s[52:55], s56 offen offset:0
  v_mul_f32 v16, v16, v202
  v_exp_f32 v16, v16
  v_fma_f32 v15, v15, v194, v194
  v_rcp_f32 v15, v15
  v_mfma_f32_32x32x16_bf16 v[84:99], a[236:239], v[156:159], v[84:99]
  ds_read2st64_b32 v[142:143], v177 offset0:88 offset1:90
  v_mul_f32 v78, v78, v14
  v_mul_f32 v81, v17, v81
  v_mul_f32 v17, v17, v202
  v_exp_f32 v17, v17
  v_fma_f32 v16, v16, v194, v194
  s_waitcnt lgkmcnt(6)
  v_mfma_f32_32x32x16_bf16 v[20:35], a[240:243], v[160:163], v[20:35]
  ds_read2st64_b32 v[144:145], v177 offset0:96 offset1:98
  s_add_u32 s57, s57, 4096
  buffer_load_dwordx4 a[36:39], v132, s[52:55], s57 offen offset:0
  v_rsq_f32 v204, v196
  s_nop 0
  v_mul_f32 v204, s31, v204
  v_rsq_f32 v206, v198
  s_nop 0
  v_mul_f32 v206, s31, v206
  v_rsq_f32 v208, v200
  s_nop 0
  v_mul_f32 v208, s31, v208
  v_rcp_f32 v16, v16
  v_mul_f32 v79, v79, v15
  v_cvt_pk_bf16_f32 v9, v78, v79
  v_mul_f32 v82, v18, v82
  v_mul_f32 v18, v18, v202
  v_exp_f32 v18, v18
  v_mfma_f32_32x32x16_bf16 v[84:99], a[244:247], v[160:163], v[84:99]
  ds_read2st64_b32 v[146:147], v177 offset0:104 offset1:106
  v_fma_f32 v17, v17, v194, v194
  v_rcp_f32 v17, v17
  v_mul_f32 v80, v80, v16
  v_mul_f32 v83, v19, v83
  v_mul_f32 v19, v19, v202
  s_waitcnt lgkmcnt(6)
  v_mfma_f32_32x32x16_bf16 v[20:35], a[248:251], v[164:167], v[20:35]
  ds_read2st64_b32 v[148:149], v177 offset0:112 offset1:114
  buffer_load_dwordx4 a[40:43], v132, s[52:55], s56 offen offset:1024
  v_exp_f32 v19, v19
  v_fma_f32 v18, v18, v194, v194
  v_rcp_f32 v18, v18
  v_mul_f32 v81, v81, v17
  v_mfma_f32_32x32x16_bf16 v[84:99], a[252:255], v[164:167], v[84:99]
  ds_read2st64_b32 v[150:151], v177 offset0:120 offset1:122
  v_cvt_pk_bf16_f32 v10, v80, v81
  v_fma_f32 v19, v19, v194, v194
  v_rcp_f32 v19, v19
  v_mul_f32 v82, v82, v18
  v_mul_f32 v83, v83, v19
  v_cvt_pk_bf16_f32 v11, v82, v83
  buffer_store_dwordx4 v[8:11], v132, s[16:19], s36 offen offset:1024 sc0 sc1
  s_waitcnt lgkmcnt(6)
  v_mfma_f32_32x32x16_bf16 v[36:51], a[160:163], v[136:139], v[36:51]
  ds_read2st64_b32 v[152:153], v177 offset0:128 offset1:130
  buffer_load_dwordx4 a[44:47], v132, s[52:55], s57 offen offset:1024
  v_mfma_f32_32x32x16_bf16 v[100:115], a[164:167], v[136:139], v[100:115]
  ds_read2st64_b32 v[154:155], v177 offset0:136 offset1:138
  s_waitcnt lgkmcnt(6)
  v_mfma_f32_32x32x16_bf16 v[36:51], a[168:171], v[140:143], v[36:51]
  ds_read2st64_b32 v[156:157], v177 offset0:144 offset1:146
  v_mfma_f32_32x32x16_bf16 v[100:115], a[172:175], v[140:143], v[100:115]
  ds_read2st64_b32 v[158:159], v177 offset0:152 offset1:154
  buffer_load_dwordx4 a[48:51], v132, s[52:55], s56 offen offset:2048
  v_mul_f32 v84, v20, v84
  v_mul_f32 v20, v20, v204
  v_exp_f32 v20, v20
  v_mul_f32 v85, v21, v85
  v_mul_f32 v21, v21, v204
  s_waitcnt lgkmcnt(6)
  v_mfma_f32_32x32x16_bf16 v[36:51], a[176:179], v[144:147], v[36:51]
  ds_read2st64_b32 v[160:161], v177 offset0:160 offset1:162
  v_exp_f32 v21, v21
  v_fma_f32 v20, v20, v196, v196
  v_rcp_f32 v20, v20
  v_mul_f32 v86, v22, v86
  v_mul_f32 v22, v22, v204
  v_mfma_f32_32x32x16_bf16 v[100:115], a[180:183], v[144:147], v[100:115]
  ds_read2st64_b32 v[162:163], v177 offset0:168 offset1:170
  buffer_load_dwordx4 a[52:55], v132, s[52:55], s57 offen offset:2048
  v_exp_f32 v22, v22
  v_fma_f32 v21, v21, v196, v196
  v_rcp_f32 v21, v21
  v_mul_f32 v84, v84, v20
  s_waitcnt lgkmcnt(6)
  v_mfma_f32_32x32x16_bf16 v[36:51], a[184:187], v[148:151], v[36:51]
  ds_read2st64_b32 v[164:165], v177 offset0:176 offset1:178
  v_mul_f32 v87, v23, v87
  v_mul_f32 v23, v23, v204
  v_exp_f32 v23, v23
  v_fma_f32 v22, v22, v196, v196
  v_rcp_f32 v22, v22
  v_mfma_f32_32x32x16_bf16 v[100:115], a[188:191], v[148:151], v[100:115]
  ds_read2st64_b32 v[166:167], v177 offset0:184 offset1:186
  buffer_load_dwordx4 a[56:59], v132, s[52:55], s56 offen offset:3072
  v_mul_f32 v85, v85, v21
  v_cvt_pk_bf16_f32 v20, v84, v85
  v_mul_f32 v88, v24, v88
  v_mul_f32 v24, v24, v204
  v_exp_f32 v24, v24
  s_waitcnt lgkmcnt(6)
  v_mfma_f32_32x32x16_bf16 v[36:51], a[192:195], v[152:155], v[36:51]
  ds_read2st64_b32 v[136:137], v177 offset0:192 offset1:194
  v_fma_f32 v23, v23, v196, v196
  v_rcp_f32 v23, v23
  v_mul_f32 v86, v86, v22
  v_mul_f32 v89, v25, v89
  v_mul_f32 v25, v25, v204
  v_mfma_f32_32x32x16_bf16 v[100:115], a[196:199], v[152:155], v[100:115]
  ds_read2st64_b32 v[138:139], v177 offset0:200 offset1:202
  buffer_load_dwordx4 a[60:63], v132, s[52:55], s57 offen offset:3072
  v_exp_f32 v25, v25
  v_fma_f32 v24, v24, v196, v196
  v_rcp_f32 v24, v24
  v_mul_f32 v87, v87, v23
  v_cvt_pk_bf16_f32 v21, v86, v87
  s_waitcnt lgkmcnt(6)
  v_mfma_f32_32x32x16_bf16 v[36:51], a[200:203], v[156:159], v[36:51]
  ds_read2st64_b32 v[140:141], v177 offset0:208 offset1:210
  v_mul_f32 v90, v26, v90
  v_mul_f32 v26, v26, v204
  v_exp_f32 v26, v26
  v_fma_f32 v25, v25, v196, v196
  v_rcp_f32 v25, v25
  v_mfma_f32_32x32x16_bf16 v[100:115], a[204:207], v[156:159], v[100:115]
  ds_read2st64_b32 v[142:143], v177 offset0:216 offset1:218
  v_mul_f32 v88, v88, v24
  v_mul_f32 v91, v27, v91
  v_mul_f32 v27, v27, v204
  v_exp_f32 v27, v27
  v_fma_f32 v26, v26, v196, v196
  s_waitcnt lgkmcnt(6)
  v_mfma_f32_32x32x16_bf16 v[36:51], a[208:211], v[160:163], v[36:51]
  ds_read2st64_b32 v[144:145], v177 offset0:224 offset1:226
  s_add_u32 s56, s56, 4096
  buffer_load_dwordx4 a[64:67], v132, s[52:55], s56 offen offset:0
  v_rcp_f32 v26, v26
  v_mul_f32 v89, v89, v25
  v_cvt_pk_bf16_f32 v22, v88, v89
  v_mul_f32 v92, v28, v92
  v_mul_f32 v28, v28, v204
  v_exp_f32 v28, v28
  v_mfma_f32_32x32x16_bf16 v[100:115], a[212:215], v[160:163], v[100:115]
  ds_read2st64_b32 v[146:147], v177 offset0:232 offset1:234
  v_fma_f32 v27, v27, v196, v196
  v_rcp_f32 v27, v27
  v_mul_f32 v90, v90, v26
  v_mul_f32 v93, v29, v93
  v_mul_f32 v29, v29, v204
  s_waitcnt lgkmcnt(6)
  v_mfma_f32_32x32x16_bf16 v[36:51], a[216:219], v[164:167], v[36:51]
  ds_read2st64_b32 v[148:149], v177 offset0:240 offset1:242
  s_add_u32 s57, s57, 4096
  buffer_load_dwordx4 a[68:71], v132, s[52:55], s57 offen offset:0
  v_exp_f32 v29, v29
  v_fma_f32 v28, v28, v196, v196
  v_rcp_f32 v28, v28
  v_mfma_f32_32x32x16_bf16 v[100:115], a[220:223], v[164:167], v[100:115]
  ds_read2st64_b32 v[150:151], v177 offset0:248 offset1:250
  v_mul_f32 v91, v91, v27
  v_cvt_pk_bf16_f32 v23, v90, v91
  buffer_store_dwordx4 v[20:23], v132, s[16:19], s37 offen sc0 sc1
  v_mul_f32 v94, v30, v94
  v_mul_f32 v30, v30, v204
  v_exp_f32 v30, v30
  v_fma_f32 v29, v29, v196, v196
  s_waitcnt lgkmcnt(6)
  v_mfma_f32_32x32x16_bf16 v[36:51], a[224:227], v[136:139], v[36:51]
  ds_read2st64_b32 v[152:153], v178 offset0:64 offset1:66
  buffer_load_dwordx4 a[72:75], v132, s[52:55], s56 offen offset:1024
  v_rcp_f32 v29, v29
  v_mul_f32 v92, v92, v28
  v_mul_f32 v95, v31, v95
  v_mul_f32 v31, v31, v204
  v_exp_f32 v31, v31
  v_mfma_f32_32x32x16_bf16 v[100:115], a[228:231], v[136:139], v[100:115]
  ds_read2st64_b32 v[154:155], v178 offset0:72 offset1:74
  v_fma_f32 v30, v30, v196, v196
  v_rcp_f32 v30, v30
  v_mul_f32 v93, v93, v29
  v_cvt_pk_bf16_f32 v24, v92, v93
  v_mul_f32 v96, v32, v96
  s_waitcnt lgkmcnt(6)
  v_mfma_f32_32x32x16_bf16 v[36:51], a[232:235], v[140:143], v[36:51]
  ds_read2st64_b32 v[156:157], v178 offset0:80 offset1:82
  buffer_load_dwordx4 a[76:79], v132, s[52:55], s57 offen offset:1024
  v_mul_f32 v32, v32, v204
  v_exp_f32 v32, v32
  v_fma_f32 v31, v31, v196, v196
  v_rcp_f32 v31, v31
  v_mfma_f32_32x32x16_bf16 v[100:115], a[236:239], v[140:143], v[100:115]
  ds_read2st64_b32 v[158:159], v178 offset0:88 offset1:90
  v_mul_f32 v94, v94, v30
  v_mul_f32 v97, v33, v97
  v_mul_f32 v33, v33, v204
  v_exp_f32 v33, v33
  v_fma_f32 v32, v32, v196, v196
  s_waitcnt lgkmcnt(6)
  v_mfma_f32_32x32x16_bf16 v[36:51], a[240:243], v[144:147], v[36:51]
  ds_read2st64_b32 v[160:161], v178 offset0:96 offset1:98
  v_rcp_f32 v32, v32
  v_mul_f32 v95, v95, v31
  v_cvt_pk_bf16_f32 v25, v94, v95
  v_mul_f32 v98, v34, v98
  v_mul_f32 v34, v34, v204
  v_exp_f32 v34, v34
  v_mfma_f32_32x32x16_bf16 v[100:115], a[244:247], v[144:147], v[100:115]
  ds_read2st64_b32 v[162:163], v178 offset0:104 offset1:106
  buffer_load_dwordx4 a[80:83], v132, s[52:55], s56 offen offset:2048
  v_fma_f32 v33, v33, v196, v196
  v_rcp_f32 v33, v33
  v_mul_f32 v96, v96, v32
  v_mul_f32 v99, v35, v99
  v_mul_f32 v35, v35, v204
  s_waitcnt lgkmcnt(6)
  v_mfma_f32_32x32x16_bf16 v[36:51], a[248:251], v[148:151], v[36:51]
  ds_read2st64_b32 v[164:165], v178 offset0:112 offset1:114
  v_exp_f32 v35, v35
  v_fma_f32 v34, v34, v196, v196
  v_rcp_f32 v34, v34
  v_mul_f32 v97, v97, v33
  v_mfma_f32_32x32x16_bf16 v[100:115], a[252:255], v[148:151], v[100:115]
  ds_read2st64_b32 v[166:167], v178 offset0:120 offset1:122
  buffer_load_dwordx4 a[84:87], v132, s[52:55], s57 offen offset:2048
  v_cvt_pk_bf16_f32 v26, v96, v97
  v_fma_f32 v35, v35, v196, v196
  v_rcp_f32 v35, v35
  v_mul_f32 v98, v98, v34
  v_mul_f32 v99, v99, v35
  v_cvt_pk_bf16_f32 v27, v98, v99
  buffer_store_dwordx4 v[24:27], v132, s[16:19], s37 offen offset:1024 sc0 sc1
  s_waitcnt lgkmcnt(6)
  v_mfma_f32_32x32x16_bf16 v[52:67], a[160:163], v[152:155], v[52:67]
  ds_read2st64_b32 v[136:137], v178 offset0:128 offset1:130
  v_mfma_f32_32x32x16_bf16 v[116:131], a[164:167], v[152:155], v[116:131]
  ds_read2st64_b32 v[138:139], v178 offset0:136 offset1:138
  buffer_load_dwordx4 a[88:91], v132, s[52:55], s56 offen offset:3072
  s_waitcnt lgkmcnt(6)
  v_mfma_f32_32x32x16_bf16 v[52:67], a[168:171], v[156:159], v[52:67]
  ds_read2st64_b32 v[140:141], v178 offset0:144 offset1:146
  v_mfma_f32_32x32x16_bf16 v[116:131], a[172:175], v[156:159], v[116:131]
  ds_read2st64_b32 v[142:143], v178 offset0:152 offset1:154
  buffer_load_dwordx4 a[92:95], v132, s[52:55], s57 offen offset:3072
  v_mul_f32 v100, v36, v100
  v_mul_f32 v36, v36, v206
  v_exp_f32 v36, v36
  v_mul_f32 v101, v37, v101
  v_mul_f32 v37, v37, v206
  s_waitcnt lgkmcnt(6)
  v_mfma_f32_32x32x16_bf16 v[52:67], a[176:179], v[160:163], v[52:67]
  ds_read2st64_b32 v[144:145], v178 offset0:160 offset1:162
  v_exp_f32 v37, v37
  v_fma_f32 v36, v36, v198, v198
  v_rcp_f32 v36, v36
  v_mul_f32 v102, v38, v102
  v_mul_f32 v38, v38, v206
  v_mfma_f32_32x32x16_bf16 v[116:131], a[180:183], v[160:163], v[116:131]
  ds_read2st64_b32 v[146:147], v178 offset0:168 offset1:170
  v_exp_f32 v38, v38
  v_fma_f32 v37, v37, v198, v198
  v_rcp_f32 v37, v37
  v_mul_f32 v100, v100, v36
  s_waitcnt lgkmcnt(6)
  v_mfma_f32_32x32x16_bf16 v[52:67], a[184:187], v[164:167], v[52:67]
  ds_read2st64_b32 v[148:149], v178 offset0:176 offset1:178
  s_add_u32 s56, s56, 4096
  buffer_load_dwordx4 a[96:99], v132, s[52:55], s56 offen offset:0
  v_mul_f32 v103, v39, v103
  v_mul_f32 v39, v39, v206
  v_exp_f32 v39, v39
  v_fma_f32 v38, v38, v198, v198
  v_rcp_f32 v38, v38
  v_mfma_f32_32x32x16_bf16 v[116:131], a[188:191], v[164:167], v[116:131]
  ds_read2st64_b32 v[150:151], v178 offset0:184 offset1:186
  v_mul_f32 v101, v101, v37
  v_cvt_pk_bf16_f32 v36, v100, v101
  v_mul_f32 v104, v40, v104
  v_mul_f32 v40, v40, v206
  v_exp_f32 v40, v40
  s_waitcnt lgkmcnt(6)
  v_mfma_f32_32x32x16_bf16 v[52:67], a[192:195], v[136:139], v[52:67]
  ds_read2st64_b32 v[152:153], v178 offset0:192 offset1:194
  s_add_u32 s57, s57, 4096
  buffer_load_dwordx4 a[100:103], v132, s[52:55], s57 offen offset:0
  v_fma_f32 v39, v39, v198, v198
  v_rcp_f32 v39, v39
  v_mul_f32 v102, v102, v38
  v_mul_f32 v105, v41, v105
  v_mul_f32 v41, v41, v206
  v_mfma_f32_32x32x16_bf16 v[116:131], a[196:199], v[136:139], v[116:131]
  ds_read2st64_b32 v[154:155], v178 offset0:200 offset1:202
  v_exp_f32 v41, v41
  v_fma_f32 v40, v40, v198, v198
  v_rcp_f32 v40, v40
  v_mul_f32 v103, v103, v39
  v_cvt_pk_bf16_f32 v37, v102, v103
  s_waitcnt lgkmcnt(6)
  v_mfma_f32_32x32x16_bf16 v[52:67], a[200:203], v[140:143], v[52:67]
  ds_read2st64_b32 v[156:157], v178 offset0:208 offset1:210
  buffer_load_dwordx4 a[104:107], v132, s[52:55], s56 offen offset:1024
  v_mul_f32 v106, v42, v106
  v_mul_f32 v42, v42, v206
  v_exp_f32 v42, v42
  v_fma_f32 v41, v41, v198, v198
  v_rcp_f32 v41, v41
  v_mfma_f32_32x32x16_bf16 v[116:131], a[204:207], v[140:143], v[116:131]
  ds_read2st64_b32 v[158:159], v178 offset0:216 offset1:218
  v_mul_f32 v104, v104, v40
  v_mul_f32 v107, v43, v107
  v_mul_f32 v43, v43, v206
  v_exp_f32 v43, v43
  v_fma_f32 v42, v42, v198, v198
  s_waitcnt lgkmcnt(6)
  v_mfma_f32_32x32x16_bf16 v[52:67], a[208:211], v[144:147], v[52:67]
  ds_read2st64_b32 v[160:161], v178 offset0:224 offset1:226
  buffer_load_dwordx4 a[108:111], v132, s[52:55], s57 offen offset:1024
  v_rcp_f32 v42, v42
  v_mul_f32 v105, v105, v41
  v_cvt_pk_bf16_f32 v38, v104, v105
  v_mul_f32 v108, v44, v108
  v_mul_f32 v44, v44, v206
  v_exp_f32 v44, v44
  v_mfma_f32_32x32x16_bf16 v[116:131], a[212:215], v[144:147], v[116:131]
  ds_read2st64_b32 v[162:163], v178 offset0:232 offset1:234
  v_fma_f32 v43, v43, v198, v198
  v_rcp_f32 v43, v43
  v_mul_f32 v106, v106, v42
  v_mul_f32 v109, v45, v109
  v_mul_f32 v45, v45, v206
  s_waitcnt lgkmcnt(6)
  v_mfma_f32_32x32x16_bf16 v[52:67], a[216:219], v[148:151], v[52:67]
  ds_read2st64_b32 v[164:165], v178 offset0:240 offset1:242
  v_exp_f32 v45, v45
  v_fma_f32 v44, v44, v198, v198
  v_rcp_f32 v44, v44
  v_mfma_f32_32x32x16_bf16 v[116:131], a[220:223], v[148:151], v[116:131]
  ds_read2st64_b32 v[166:167], v178 offset0:248 offset1:250
  buffer_load_dwordx4 a[112:115], v132, s[52:55], s56 offen offset:2048
  v_mul_f32 v107, v107, v43
  v_cvt_pk_bf16_f32 v39, v106, v107
  buffer_store_dwordx4 v[36:39], v132, s[16:19], s38 offen sc0 sc1
  v_mul_f32 v110, v46, v110
  v_mul_f32 v46, v46, v206
  v_exp_f32 v46, v46
  v_fma_f32 v45, v45, v198, v198
  s_waitcnt lgkmcnt(6)
  v_mfma_f32_32x32x16_bf16 v[52:67], a[224:227], v[152:155], v[52:67]
  v_rcp_f32 v45, v45
  v_mul_f32 v108, v108, v44
  v_mul_f32 v111, v47, v111
  v_mul_f32 v47, v47, v206
  v_exp_f32 v47, v47
  v_mfma_f32_32x32x16_bf16 v[116:131], a[228:231], v[152:155], v[116:131]
  buffer_load_dwordx4 a[116:119], v132, s[52:55], s57 offen offset:2048
  v_fma_f32 v46, v46, v198, v198
  v_rcp_f32 v46, v46
  v_mul_f32 v109, v109, v45
  v_cvt_pk_bf16_f32 v40, v108, v109
  v_mul_f32 v112, v48, v112
  s_waitcnt lgkmcnt(4)
  v_mfma_f32_32x32x16_bf16 v[52:67], a[232:235], v[156:159], v[52:67]
  v_mul_f32 v48, v48, v206
  v_exp_f32 v48, v48
  v_fma_f32 v47, v47, v198, v198
  v_rcp_f32 v47, v47
  v_mfma_f32_32x32x16_bf16 v[116:131], a[236:239], v[156:159], v[116:131]
  buffer_load_dwordx4 a[120:123], v132, s[52:55], s56 offen offset:3072
  v_mul_f32 v110, v110, v46
  v_mul_f32 v113, v49, v113
  v_mul_f32 v49, v49, v206
  v_exp_f32 v49, v49
  v_fma_f32 v48, v48, v198, v198
  s_waitcnt lgkmcnt(2)
  v_mfma_f32_32x32x16_bf16 v[52:67], a[240:243], v[160:163], v[52:67]
  v_rcp_f32 v48, v48
  v_mul_f32 v111, v111, v47
  v_cvt_pk_bf16_f32 v41, v110, v111
  v_mul_f32 v114, v50, v114
  v_mul_f32 v50, v50, v206
  v_exp_f32 v50, v50
  v_mfma_f32_32x32x16_bf16 v[116:131], a[244:247], v[160:163], v[116:131]
  buffer_load_dwordx4 a[124:127], v132, s[52:55], s57 offen offset:3072
  v_fma_f32 v49, v49, v198, v198
  v_rcp_f32 v49, v49
  v_mul_f32 v112, v112, v48
  v_mul_f32 v115, v51, v115
  v_mul_f32 v51, v51, v206
  s_waitcnt lgkmcnt(0)
  v_mfma_f32_32x32x16_bf16 v[52:67], a[248:251], v[164:167], v[52:67]
  v_exp_f32 v51, v51
  v_fma_f32 v50, v50, v198, v198
  v_rcp_f32 v50, v50
  v_mul_f32 v113, v113, v49
  v_mfma_f32_32x32x16_bf16 v[116:131], a[252:255], v[164:167], v[116:131]
  v_cvt_pk_bf16_f32 v42, v112, v113
  v_fma_f32 v51, v51, v198, v198
  v_rcp_f32 v51, v51
  v_mul_f32 v114, v114, v50
  v_mul_f32 v115, v115, v51
  v_cvt_pk_bf16_f32 v43, v114, v115
  buffer_store_dwordx4 v[40:43], v132, s[16:19], s38 offen offset:1024 sc0 sc1
  s_nop 4
  v_mul_f32 v116, v52, v116
  v_mul_f32 v52, v52, v208
  v_exp_f32 v52, v52
  v_mul_f32 v117, v53, v117
  v_mul_f32 v53, v53, v208
  v_exp_f32 v53, v53
  v_fma_f32 v52, v52, v200, v200
  v_rcp_f32 v52, v52
  v_mul_f32 v118, v54, v118
  v_mul_f32 v54, v54, v208
  v_exp_f32 v54, v54
  v_fma_f32 v53, v53, v200, v200
  v_rcp_f32 v53, v53
  v_mul_f32 v116, v116, v52
  v_mul_f32 v119, v55, v119
  v_mul_f32 v55, v55, v208
  v_exp_f32 v55, v55
  v_fma_f32 v54, v54, v200, v200
  v_rcp_f32 v54, v54
  v_mul_f32 v117, v117, v53
  v_cvt_pk_bf16_f32 v52, v116, v117
  v_mul_f32 v120, v56, v120
  v_mul_f32 v56, v56, v208
  v_exp_f32 v56, v56
  v_fma_f32 v55, v55, v200, v200
  v_rcp_f32 v55, v55
  v_mul_f32 v118, v118, v54
  v_mul_f32 v121, v57, v121
  v_mul_f32 v57, v57, v208
  v_exp_f32 v57, v57
  v_fma_f32 v56, v56, v200, v200
  v_rcp_f32 v56, v56
  v_mul_f32 v119, v119, v55
  v_cvt_pk_bf16_f32 v53, v118, v119
  v_mul_f32 v122, v58, v122
  v_mul_f32 v58, v58, v208
  v_exp_f32 v58, v58
  v_fma_f32 v57, v57, v200, v200
  v_rcp_f32 v57, v57
  v_mul_f32 v120, v120, v56
  v_mul_f32 v123, v59, v123
  v_mul_f32 v59, v59, v208
  v_exp_f32 v59, v59
  v_fma_f32 v58, v58, v200, v200
  v_rcp_f32 v58, v58
  v_mul_f32 v121, v121, v57
  v_cvt_pk_bf16_f32 v54, v120, v121
  v_mul_f32 v124, v60, v124
  v_mul_f32 v60, v60, v208
  v_exp_f32 v60, v60
  v_fma_f32 v59, v59, v200, v200
  v_rcp_f32 v59, v59
  v_mul_f32 v122, v122, v58
  v_mul_f32 v125, v61, v125
  v_mul_f32 v61, v61, v208
  v_exp_f32 v61, v61
  v_fma_f32 v60, v60, v200, v200
  v_rcp_f32 v60, v60
  v_mul_f32 v123, v123, v59
  v_cvt_pk_bf16_f32 v55, v122, v123
  buffer_store_dwordx4 v[52:55], v132, s[16:19], s39 offen sc0 sc1
  v_mul_f32 v126, v62, v126
  v_mul_f32 v62, v62, v208
  v_exp_f32 v62, v62
  v_fma_f32 v61, v61, v200, v200
  v_rcp_f32 v61, v61
  v_mul_f32 v124, v124, v60
  v_mul_f32 v127, v63, v127
  v_mul_f32 v63, v63, v208
  v_exp_f32 v63, v63
  v_fma_f32 v62, v62, v200, v200
  v_rcp_f32 v62, v62
  v_mul_f32 v125, v125, v61
  v_cvt_pk_bf16_f32 v56, v124, v125
  v_mul_f32 v128, v64, v128
  v_mul_f32 v64, v64, v208
  v_exp_f32 v64, v64
  v_fma_f32 v63, v63, v200, v200
  v_rcp_f32 v63, v63
  v_mul_f32 v126, v126, v62
  v_mul_f32 v129, v65, v129
  v_mul_f32 v65, v65, v208
  v_exp_f32 v65, v65
  v_fma_f32 v64, v64, v200, v200
  v_rcp_f32 v64, v64
  v_mul_f32 v127, v127, v63
  v_cvt_pk_bf16_f32 v57, v126, v127
  v_mul_f32 v130, v66, v130
  v_mul_f32 v66, v66, v208
  v_exp_f32 v66, v66
  v_fma_f32 v65, v65, v200, v200
  v_rcp_f32 v65, v65
  v_mul_f32 v128, v128, v64
  v_mul_f32 v131, v67, v131
  v_mul_f32 v67, v67, v208
  v_exp_f32 v67, v67
  v_fma_f32 v66, v66, v200, v200
  v_rcp_f32 v66, v66
  v_mul_f32 v129, v129, v65
  v_cvt_pk_bf16_f32 v58, v128, v129
  v_fma_f32 v67, v67, v200, v200
  v_rcp_f32 v67, v67
  v_mul_f32 v130, v130, v66
  v_mul_f32 v131, v131, v67
  v_cvt_pk_bf16_f32 v59, v130, v131
  buffer_store_dwordx4 v[56:59], v132, s[16:19], s39 offen offset:1024 sc0 sc1
  s_add_u32 s56, s56, 4096
  buffer_load_dwordx4 a[128:131], v132, s[52:55], s56 offen offset:0
  s_add_u32 s57, s57, 4096
  buffer_load_dwordx4 a[132:135], v132, s[52:55], s57 offen offset:0
  buffer_load_dwordx4 a[136:139], v132, s[52:55], s56 offen offset:1024
  buffer_load_dwordx4 a[140:143], v132, s[52:55], s57 offen offset:1024
  buffer_load_dwordx4 a[144:147], v132, s[52:55], s56 offen offset:2048
  buffer_load_dwordx4 a[148:151], v132, s[52:55], s57 offen offset:2048
  buffer_load_dwordx4 a[152:155], v132, s[52:55], s56 offen offset:3072
  buffer_load_dwordx4 a[156:159], v132, s[52:55], s57 offen offset:3072
  s_add_u32 s40, s4, 0x1a10000
  s_addc_u32 s41, s5, 0
  s_mov_b32 s42, 0x10000
  s_mov_b32 s43, 0x20000
  s_mul_i32 s44, s22, 4352
  v_mov_b32 v2, s44
  v_mov_b32 v1, 1
  s_waitcnt vmcnt(8)
  s_barrier
  s_lshr_b32 s47, s63, 1
  s_mul_i32 s47, s47, 4352
  s_cmp_eq_u32 s3, 0
  s_cselect_b32 exec_lo, 1, 0
  s_mov_b32 exec_hi, 0
  buffer_atomic_add v1, v2, s[40:43], 0 offen
  s_mov_b64 exec, -1
  s_add_u32 s56, s56, 4096
  buffer_load_dwordx4 a[160:163], v132, s[52:55], s56 offen offset:0
  s_add_u32 s57, s57, 4096
  buffer_load_dwordx4 a[164:167], v132, s[52:55], s57 offen offset:0
  buffer_load_dwordx4 a[168:171], v132, s[52:55], s56 offen offset:1024
  buffer_load_dwordx4 a[172:175], v132, s[52:55], s57 offen offset:1024
  buffer_load_dwordx4 a[176:179], v132, s[52:55], s56 offen offset:2048
  buffer_load_dwordx4 a[180:183], v132, s[52:55], s57 offen offset:2048
  buffer_load_dwordx4 a[184:187], v132, s[52:55], s56 offen offset:3072
  buffer_load_dwordx4 a[188:191], v132, s[52:55], s57 offen offset:3072
  s_add_u32 s56, s56, 4096
  buffer_load_dwordx4 a[192:195], v132, s[52:55], s56 offen offset:0
  s_add_u32 s57, s57, 4096
  buffer_load_dwordx4 a[196:199], v132, s[52:55], s57 offen offset:0
  buffer_load_dwordx4 a[200:203], v132, s[52:55], s56 offen offset:1024
  buffer_load_dwordx4 a[204:207], v132, s[52:55], s57 offen offset:1024
  buffer_load_dwordx4 a[208:211], v132, s[52:55], s56 offen offset:2048
  buffer_load_dwordx4 a[212:215], v132, s[52:55], s57 offen offset:2048
  buffer_load_dwordx4 a[216:219], v132, s[52:55], s56 offen offset:3072
  buffer_load_dwordx4 a[220:223], v132, s[52:55], s57 offen offset:3072
  s_branch p2_27
gs26:
  s_getpc_b64 s[96:97]
pf30:
  s_mov_b32 s98, text_end-pf30
  s_mov_b32 s99, 0x20000
  v_lshlrev_b32 v2, 6, v0
  buffer_load_dword v3, v2, s[96:99], 0 offen
  s_sub_u32 s20, s2, 224
  s_and_b32 s22, s20, 3
  s_lshl_b32 s22, s22, 2
  s_lshr_b32 s23, s20, 3
  s_add_u32 s22, s22, s23
  s_bfe_u32 s23, s20, 0x10002
  s_getpc_b64 s[34:35]
  s_add_u32 s34, s34, RT@rel32@lo+4
  s_addc_u32 s35, s35, RT@rel32@hi+12
  s_mov_b32 s8, s34
  s_mov_b32 s9, s35
  s_mov_b32 s10, 0x80000
  s_mov_b32 s11, 0x20000
  s_waitcnt lgkmcnt(0)
  s_add_u32 s12, s4, 0x600000
  s_addc_u32 s13, s5, 0
  s_mov_b32 s14, 0x200000
  s_mov_b32 s15, 0x20000
  s_add_u32 s16, s4, 0x1c00000
  s_addc_u32 s17, s5, 0
  s_mov_b32 s18, 0x200000
  s_mov_b32 s19, 0x20000
  s_lshl_b32 s24, s3, 14
  s_lshl_b32 s25, s22, 9
  s_add_u32 s24, s24, s25
  s_lshl_b32 s25, s23, 3
  s_lshl_b32 s26, s3, 1
  s_add_u32 s25, s25, s26
  s_lshl_b32 s26, s25, 15
  s_add_u32 s27, s26, 32768
  s_lshl_b32 s30, s25, 17
  s_lshl_b32 s31, s22, 13
  s_add_u32 s30, s30, s31
  s_add_u32 s36, s30, 0
  s_add_u32 s37, s30, 2048
  s_add_u32 s38, s30, 4096
  s_add_u32 s39, s30, 6144
  s_add_u32 s40, s30, 131072
  s_add_u32 s41, s30, 133120
  s_add_u32 s42, s30, 135168
  s_add_u32 s43, s30, 137216
  s_lshr_b32 s50, s20, 3
  s_lshl_b32 s50, s50, 1
  s_and_b32 s50, s50, 7
  v_and_b32 v135, 63, v0
  v_lshlrev_b32 v132, 4, v135
  v_and_b32 v133, 31, v135
  v_lshrrev_b32 v134, 5, v135
  v_lshlrev_b32 v168, 4, v133
  v_lshl_or_b32 v170, v134, 13, v168
  s_lshl_b32 s28, s3, 10
  s_add_u32 m0, s28, 0
  s_add_u32 s29, s24, 0
  buffer_load_dwordx4 v170, s[12:15], s29 offen lds
  s_add_u32 m0, s28, 4096
  s_add_u32 s29, s24, 65536
  buffer_load_dwordx4 v170, s[12:15], s29 offen lds
  buffer_load_dwordx4 a[0:3], v132, s[8:11], s26 offen offset:0
  buffer_load_dwordx4 a[4:7], v132, s[8:11], s27 offen offset:0
  s_add_u32 m0, s28, 8192
  s_add_u32 s29, s24, 131072
  buffer_load_dwordx4 v170, s[12:15], s29 offen lds
  s_add_u32 m0, s28, 12288
  s_add_u32 s29, s24, 196608
  buffer_load_dwordx4 v170, s[12:15], s29 offen lds
  buffer_load_dwordx4 a[8:11], v132, s[8:11], s26 offen offset:1024
  buffer_load_dwordx4 a[12:15], v132, s[8:11], s27 offen offset:1024
  buffer_load_dwordx4 a[16:19], v132, s[8:11], s26 offen offset:2048
  buffer_load_dwordx4 a[20:23], v132, s[8:11], s27 offen offset:2048
  s_add_u32 m0, s28, 16384
  s_add_u32 s29, s24, 262144
  buffer_load_dwordx4 v170, s[12:15], s29 offen lds
  s_add_u32 m0, s28, 20480
  s_add_u32 s29, s24, 327680
  buffer_load_dwordx4 v170, s[12:15], s29 offen lds
  v_lshlrev_b32 v168, 2, v133
  v_lshl_or_b32 v168, v134, 10, v168
  v_add_u32 v171, 0, v168
  v_add_u32 v175, 0x10000, v171
  v_add_u32 v172, 128, v168
  v_add_u32 v176, 0x10000, v172
  v_add_u32 v173, 256, v168
  v_add_u32 v177, 0x10000, v173
  v_add_u32 v174, 384, v168
  v_add_u32 v178, 0x10000, v174
  s_waitcnt vmcnt(11)
  s_barrier
  ds_read2st64_b32 v[136:137], v171 offset0:0 offset1:2
  ds_read2st64_b32 v[138:139], v171 offset0:8 offset1:10
  ds_read2st64_b32 v[140:141], v172 offset0:0 offset1:2
  ds_read2st64_b32 v[142:143], v172 offset0:8 offset1:10
  ds_read2st64_b32 v[144:145], v173 offset0:0 offset1:2
  ds_read2st64_b32 v[146:147], v173 offset0:8 offset1:10
  ds_read2st64_b32 v[148:149], v174 offset0:0 offset1:2
  ds_read2st64_b32 v[150:151], v174 offset0:8 offset1:10
  s_waitcnt vmcnt(10)
  s_barrier
  s_waitcnt vmcnt(9) lgkmcnt(6)
  v_mfma_f32_32x32x16_bf16 v[4:19], a[0:3], v[136:139], 0
  ds_read2st64_b32 v[152:153], v171 offset0:16 offset1:18
  ds_read2st64_b32 v[154:155], v171 offset0:24 offset1:26
  s_waitcnt vmcnt(8)
  v_mfma_f32_32x32x16_bf16 v[68:83], a[4:7], v[136:139], 0
  ds_read2st64_b32 v[156:157], v172 offset0:16 offset1:18
  s_add_u32 m0, s28, 24576
  s_add_u32 s29, s24, 393216
  buffer_load_dwordx4 v170, s[12:15], s29 offen lds
  s_waitcnt lgkmcnt(7)
  v_mfma_f32_32x32x16_bf16 v[20:35], a[0:3], v[140:143], 0
  ds_read2st64_b32 v[158:159], v172 offset0:24 offset1:26
  v_mfma_f32_32x32x16_bf16 v[84:99], a[4:7], v[140:143], 0
  ds_read2st64_b32 v[160:161], v173 offset0:16 offset1:18
  s_add_u32 m0, s28, 28672
  s_add_u32 s29, s24, 458752
  buffer_load_dwordx4 v170, s[12:15], s29 offen lds
  s_waitcnt lgkmcnt(7)
  v_mfma_f32_32x32x16_bf16 v[36:51], a[0:3], v[144:147], 0
  ds_read2st64_b32 v[162:163], v173 offset0:24 offset1:26
  v_mfma_f32_32x32x16_bf16 v[100:115], a[4:7], v[144:147], 0
  ds_read2st64_b32 v[164:165], v174 offset0:16 offset1:18
  buffer_load_dwordx4 a[24:27], v132, s[8:11], s26 offen offset:3072
  s_waitcnt lgkmcnt(7)
  v_mfma_f32_32x32x16_bf16 v[52:67], a[0:3], v[148:151], 0
  ds_read2st64_b32 v[166:167], v174 offset0:24 offset1:26
  v_mfma_f32_32x32x16_bf16 v[116:131], a[4:7], v[148:151], 0
  buffer_load_dwordx4 a[28:31], v132, s[8:11], s27 offen offset:3072
  s_waitcnt vmcnt(10)
  s_barrier
  s_waitcnt vmcnt(9) lgkmcnt(6)
  v_mfma_f32_32x32x16_bf16 v[4:19], a[8:11], v[152:155], v[4:19]
  ds_read2st64_b32 v[136:137], v171 offset0:32 offset1:34
  ds_read2st64_b32 v[138:139], v171 offset0:40 offset1:42
  s_waitcnt vmcnt(8)
  v_mfma_f32_32x32x16_bf16 v[68:83], a[12:15], v[152:155], v[68:83]
  ds_read2st64_b32 v[140:141], v172 offset0:32 offset1:34
  s_add_u32 s26, s26, 4096
  buffer_load_dwordx4 a[32:35], v132, s[8:11], s26 offen offset:0
  s_waitcnt lgkmcnt(7)
  v_mfma_f32_32x32x16_bf16 v[20:35], a[8:11], v[156:159], v[20:35]
  ds_read2st64_b32 v[142:143], v172 offset0:40 offset1:42
  v_mfma_f32_32x32x16_bf16 v[84:99], a[12:15], v[156:159], v[84:99]
  ds_read2st64_b32 v[144:145], v173 offset0:32 offset1:34
  s_add_u32 s27, s27, 4096
  buffer_load_dwordx4 a[36:39], v132, s[8:11], s27 offen offset:0
  s_waitcnt lgkmcnt(7)
  v_mfma_f32_32x32x16_bf16 v[36:51], a[8:11], v[160:163], v[36:51]
  ds_read2st64_b32 v[146:147], v173 offset0:40 offset1:42
  v_mfma_f32_32x32x16_bf16 v[100:115], a[12:15], v[160:163], v[100:115]
  ds_read2st64_b32 v[148:149], v174 offset0:32 offset1:34
  buffer_load_dwordx4 a[40:43], v132, s[8:11], s26 offen offset:1024
  s_waitcnt lgkmcnt(7)
  v_mfma_f32_32x32x16_bf16 v[52:67], a[8:11], v[164:167], v[52:67]
  ds_read2st64_b32 v[150:151], v174 offset0:40 offset1:42
  v_mfma_f32_32x32x16_bf16 v[116:131], a[12:15], v[164:167], v[116:131]
  buffer_load_dwordx4 a[44:47], v132, s[8:11], s27 offen offset:1024
  s_waitcnt vmcnt(11) lgkmcnt(6)
  v_mfma_f32_32x32x16_bf16 v[4:19], a[16:19], v[136:139], v[4:19]
  ds_read2st64_b32 v[152:153], v171 offset0:48 offset1:50
  ds_read2st64_b32 v[154:155], v171 offset0:56 offset1:58
  s_waitcnt vmcnt(10)
  v_mfma_f32_32x32x16_bf16 v[68:83], a[20:23], v[136:139], v[68:83]
  ds_read2st64_b32 v[156:157], v172 offset0:48 offset1:50
  buffer_load_dwordx4 a[48:51], v132, s[8:11], s26 offen offset:2048
  s_waitcnt lgkmcnt(7)
  v_mfma_f32_32x32x16_bf16 v[20:35], a[16:19], v[140:143], v[20:35]
  ds_read2st64_b32 v[158:159], v172 offset0:56 offset1:58
  v_mfma_f32_32x32x16_bf16 v[84:99], a[20:23], v[140:143], v[84:99]
  ds_read2st64_b32 v[160:161], v173 offset0:48 offset1:50
  buffer_load_dwordx4 a[52:55], v132, s[8:11], s27 offen offset:2048
  s_waitcnt lgkmcnt(7)
  v_mfma_f32_32x32x16_bf16 v[36:51], a[16:19], v[144:147], v[36:51]
  ds_read2st64_b32 v[162:163], v173 offset0:56 offset1:58
  v_mfma_f32_32x32x16_bf16 v[100:115], a[20:23], v[144:147], v[100:115]
  ds_read2st64_b32 v[164:165], v174 offset0:48 offset1:50
  s_add_u32 m0, s28, 32768
  s_add_u32 s29, s24, 524288
  buffer_load_dwordx4 v170, s[12:15], s29 offen lds
  s_waitcnt lgkmcnt(7)
  v_mfma_f32_32x32x16_bf16 v[52:67], a[16:19], v[148:151], v[52:67]
  ds_read2st64_b32 v[166:167], v174 offset0:56 offset1:58
  v_mfma_f32_32x32x16_bf16 v[116:131], a[20:23], v[148:151], v[116:131]
  s_add_u32 m0, s28, 36864
  s_add_u32 s29, s24, 589824
  buffer_load_dwordx4 v170, s[12:15], s29 offen lds
  s_waitcnt vmcnt(10)
  s_barrier
  s_waitcnt vmcnt(9) lgkmcnt(6)
  v_mfma_f32_32x32x16_bf16 v[4:19], a[24:27], v[152:155], v[4:19]
  ds_read2st64_b32 v[136:137], v171 offset0:64 offset1:66
  ds_read2st64_b32 v[138:139], v171 offset0:72 offset1:74
  s_waitcnt vmcnt(8)
  v_mfma_f32_32x32x16_bf16 v[68:83], a[28:31], v[152:155], v[68:83]
  ds_read2st64_b32 v[140:141], v172 offset0:64 offset1:66
  s_add_u32 m0, s28, 40960
  s_add_u32 s29, s24, 655360
  buffer_load_dwordx4 v170, s[12:15], s29 offen lds
  s_waitcnt lgkmcnt(7)
  v_mfma_f32_32x32x16_bf16 v[20:35], a[24:27], v[156:159], v[20:35]
  ds_read2st64_b32 v[142:143], v172 offset0:72 offset1:74
  v_mfma_f32_32x32x16_bf16 v[84:99], a[28:31], v[156:159], v[84:99]
  ds_read2st64_b32 v[144:145], v173 offset0:64 offset1:66
  s_add_u32 m0, s28, 45056
  s_add_u32 s29, s24, 720896
  buffer_load_dwordx4 v170, s[12:15], s29 offen lds
  s_waitcnt lgkmcnt(7)
  v_mfma_f32_32x32x16_bf16 v[36:51], a[24:27], v[160:163], v[36:51]
  ds_read2st64_b32 v[146:147], v173 offset0:72 offset1:74
  v_mfma_f32_32x32x16_bf16 v[100:115], a[28:31], v[160:163], v[100:115]
  ds_read2st64_b32 v[148:149], v174 offset0:64 offset1:66
  buffer_load_dwordx4 a[56:59], v132, s[8:11], s26 offen offset:3072
  s_waitcnt lgkmcnt(7)
  v_mfma_f32_32x32x16_bf16 v[52:67], a[24:27], v[164:167], v[52:67]
  ds_read2st64_b32 v[150:151], v174 offset0:72 offset1:74
  v_mfma_f32_32x32x16_bf16 v[116:131], a[28:31], v[164:167], v[116:131]
  buffer_load_dwordx4 a[60:63], v132, s[8:11], s27 offen offset:3072
  s_waitcnt vmcnt(11) lgkmcnt(6)
  v_mfma_f32_32x32x16_bf16 v[4:19], a[32:35], v[136:139], v[4:19]
  ds_read2st64_b32 v[152:153], v171 offset0:80 offset1:82
  ds_read2st64_b32 v[154:155], v171 offset0:88 offset1:90
  s_waitcnt vmcnt(10)
  v_mfma_f32_32x32x16_bf16 v[68:83], a[36:39], v[136:139], v[68:83]
  ds_read2st64_b32 v[156:157], v172 offset0:80 offset1:82
  s_add_u32 s26, s26, 4096
  buffer_load_dwordx4 a[64:67], v132, s[8:11], s26 offen offset:0
  s_waitcnt lgkmcnt(7)
  v_mfma_f32_32x32x16_bf16 v[20:35], a[32:35], v[140:143], v[20:35]
  ds_read2st64_b32 v[158:159], v172 offset0:88 offset1:90
  v_mfma_f32_32x32x16_bf16 v[84:99], a[36:39], v[140:143], v[84:99]
  ds_read2st64_b32 v[160:161], v173 offset0:80 offset1:82
  s_add_u32 s27, s27, 4096
  buffer_load_dwordx4 a[68:71], v132, s[8:11], s27 offen offset:0
  s_waitcnt lgkmcnt(7)
  v_mfma_f32_32x32x16_bf16 v[36:51], a[32:35], v[144:147], v[36:51]
  ds_read2st64_b32 v[162:163], v173 offset0:88 offset1:90
  v_mfma_f32_32x32x16_bf16 v[100:115], a[36:39], v[144:147], v[100:115]
  ds_read2st64_b32 v[164:165], v174 offset0:80 offset1:82
  buffer_load_dwordx4 a[72:75], v132, s[8:11], s26 offen offset:1024
  s_waitcnt lgkmcnt(7)
  v_mfma_f32_32x32x16_bf16 v[52:67], a[32:35], v[148:151], v[52:67]
  ds_read2st64_b32 v[166:167], v174 offset0:88 offset1:90
  v_mfma_f32_32x32x16_bf16 v[116:131], a[36:39], v[148:151], v[116:131]
  buffer_load_dwordx4 a[76:79], v132, s[8:11], s27 offen offset:1024
  s_waitcnt vmcnt(13) lgkmcnt(6)
  v_mfma_f32_32x32x16_bf16 v[4:19], a[40:43], v[152:155], v[4:19]
  ds_read2st64_b32 v[136:137], v171 offset0:96 offset1:98
  ds_read2st64_b32 v[138:139], v171 offset0:104 offset1:106
  s_waitcnt vmcnt(12)
  v_mfma_f32_32x32x16_bf16 v[68:83], a[44:47], v[152:155], v[68:83]
  ds_read2st64_b32 v[140:141], v172 offset0:96 offset1:98
  buffer_load_dwordx4 a[80:83], v132, s[8:11], s26 offen offset:2048
  s_waitcnt lgkmcnt(7)
  v_mfma_f32_32x32x16_bf16 v[20:35], a[40:43], v[156:159], v[20:35]
  ds_read2st64_b32 v[142:143], v172 offset0:104 offset1:106
  v_mfma_f32_32x32x16_bf16 v[84:99], a[44:47], v[156:159], v[84:99]
  ds_read2st64_b32 v[144:145], v173 offset0:96 offset1:98
  buffer_load_dwordx4 a[84:87], v132, s[8:11], s27 offen offset:2048
  s_waitcnt lgkmcnt(7)
  v_mfma_f32_32x32x16_bf16 v[36:51], a[40:43], v[160:163], v[36:51]
  ds_read2st64_b32 v[146:147], v173 offset0:104 offset1:106
  v_mfma_f32_32x32x16_bf16 v[100:115], a[44:47], v[160:163], v[100:115]
  ds_read2st64_b32 v[148:149], v174 offset0:96 offset1:98
  s_add_u32 m0, s28, 49152
  s_add_u32 s29, s24, 786432
  buffer_load_dwordx4 v170, s[12:15], s29 offen lds
  s_waitcnt lgkmcnt(7)
  v_mfma_f32_32x32x16_bf16 v[52:67], a[40:43], v[164:167], v[52:67]
  ds_read2st64_b32 v[150:151], v174 offset0:104 offset1:106
  v_mfma_f32_32x32x16_bf16 v[116:131], a[44:47], v[164:167], v[116:131]
  s_add_u32 m0, s28, 53248
  s_add_u32 s29, s24, 851968
  buffer_load_dwordx4 v170, s[12:15], s29 offen lds
  s_waitcnt vmcnt(15) lgkmcnt(6)
  v_mfma_f32_32x32x16_bf16 v[4:19], a[48:51], v[136:139], v[4:19]
  ds_read2st64_b32 v[152:153], v171 offset0:112 offset1:114
  ds_read2st64_b32 v[154:155], v171 offset0:120 offset1:122
  s_waitcnt vmcnt(14)
  v_mfma_f32_32x32x16_bf16 v[68:83], a[52:55], v[136:139], v[68:83]
  ds_read2st64_b32 v[156:157], v172 offset0:112 offset1:114
  s_add_u32 m0, s28, 57344
  s_add_u32 s29, s24, 917504
  buffer_load_dwordx4 v170, s[12:15], s29 offen lds
  s_waitcnt lgkmcnt(7)
  v_mfma_f32_32x32x16_bf16 v[20:35], a[48:51], v[140:143], v[20:35]
  ds_read2st64_b32 v[158:159], v172 offset0:120 offset1:122
  v_mfma_f32_32x32x16_bf16 v[84:99], a[52:55], v[140:143], v[84:99]
  ds_read2st64_b32 v[160:161], v173 offset0:112 offset1:114
  s_add_u32 m0, s28, 61440
  s_add_u32 s29, s24, 983040
  buffer_load_dwordx4 v170, s[12:15], s29 offen lds
  s_waitcnt lgkmcnt(7)
  v_mfma_f32_32x32x16_bf16 v[36:51], a[48:51], v[144:147], v[36:51]
  ds_read2st64_b32 v[162:163], v173 offset0:120 offset1:122
  v_mfma_f32_32x32x16_bf16 v[100:115], a[52:55], v[144:147], v[100:115]
  ds_read2st64_b32 v[164:165], v174 offset0:112 offset1:114
  buffer_load_dwordx4 a[88:91], v132, s[8:11], s26 offen offset:3072
  s_waitcnt lgkmcnt(7)
  v_mfma_f32_32x32x16_bf16 v[52:67], a[48:51], v[148:151], v[52:67]
  ds_read2st64_b32 v[166:167], v174 offset0:120 offset1:122
  v_mfma_f32_32x32x16_bf16 v[116:131], a[52:55], v[148:151], v[116:131]
  buffer_load_dwordx4 a[92:95], v132, s[8:11], s27 offen offset:3072
  s_waitcnt vmcnt(14)
  s_barrier
  s_waitcnt vmcnt(13) lgkmcnt(6)
  v_mfma_f32_32x32x16_bf16 v[4:19], a[56:59], v[152:155], v[4:19]
  ds_read2st64_b32 v[136:137], v171 offset0:128 offset1:130
  ds_read2st64_b32 v[138:139], v171 offset0:136 offset1:138
  s_waitcnt vmcnt(12)
  v_mfma_f32_32x32x16_bf16 v[68:83], a[60:63], v[152:155], v[68:83]
  ds_read2st64_b32 v[140:141], v172 offset0:128 offset1:130
  s_add_u32 s26, s26, 4096
  buffer_load_dwordx4 a[96:99], v132, s[8:11], s26 offen offset:0
  s_waitcnt lgkmcnt(7)
  v_mfma_f32_32x32x16_bf16 v[20:35], a[56:59], v[156:159], v[20:35]
  ds_read2st64_b32 v[142:143], v172 offset0:136 offset1:138
  v_mfma_f32_32x32x16_bf16 v[84:99], a[60:63], v[156:159], v[84:99]
  ds_read2st64_b32 v[144:145], v173 offset0:128 offset1:130
  s_add_u32 s27, s27, 4096
  buffer_load_dwordx4 a[100:103], v132, s[8:11], s27 offen offset:0
  s_waitcnt lgkmcnt(7)
  v_mfma_f32_32x32x16_bf16 v[36:51], a[56:59], v[160:163], v[36:51]
  ds_read2st64_b32 v[146:147], v173 offset0:136 offset1:138
  v_mfma_f32_32x32x16_bf16 v[100:115], a[60:63], v[160:163], v[100:115]
  ds_read2st64_b32 v[148:149], v174 offset0:128 offset1:130
  buffer_load_dwordx4 a[104:107], v132, s[8:11], s26 offen offset:1024
  s_waitcnt lgkmcnt(7)
  v_mfma_f32_32x32x16_bf16 v[52:67], a[56:59], v[164:167], v[52:67]
  ds_read2st64_b32 v[150:151], v174 offset0:136 offset1:138
  v_mfma_f32_32x32x16_bf16 v[116:131], a[60:63], v[164:167], v[116:131]
  buffer_load_dwordx4 a[108:111], v132, s[8:11], s27 offen offset:1024
  s_waitcnt vmcnt(15) lgkmcnt(6)
  v_mfma_f32_32x32x16_bf16 v[4:19], a[64:67], v[136:139], v[4:19]
  ds_read2st64_b32 v[152:153], v171 offset0:144 offset1:146
  ds_read2st64_b32 v[154:155], v171 offset0:152 offset1:154
  s_waitcnt vmcnt(14)
  v_mfma_f32_32x32x16_bf16 v[68:83], a[68:71], v[136:139], v[68:83]
  ds_read2st64_b32 v[156:157], v172 offset0:144 offset1:146
  buffer_load_dwordx4 a[112:115], v132, s[8:11], s26 offen offset:2048
  s_waitcnt lgkmcnt(7)
  v_mfma_f32_32x32x16_bf16 v[20:35], a[64:67], v[140:143], v[20:35]
  ds_read2st64_b32 v[158:159], v172 offset0:152 offset1:154
  v_mfma_f32_32x32x16_bf16 v[84:99], a[68:71], v[140:143], v[84:99]
  ds_read2st64_b32 v[160:161], v173 offset0:144 offset1:146
  buffer_load_dwordx4 a[116:119], v132, s[8:11], s27 offen offset:2048
  s_waitcnt lgkmcnt(7)
  v_mfma_f32_32x32x16_bf16 v[36:51], a[64:67], v[144:147], v[36:51]
  ds_read2st64_b32 v[162:163], v173 offset0:152 offset1:154
  v_mfma_f32_32x32x16_bf16 v[100:115], a[68:71], v[144:147], v[100:115]
  ds_read2st64_b32 v[164:165], v174 offset0:144 offset1:146
  s_add_u32 m0, s28, 65536
  s_add_u32 s29, s24, 1048576
  buffer_load_dwordx4 v170, s[12:15], s29 offen lds
  s_waitcnt lgkmcnt(7)
  v_mfma_f32_32x32x16_bf16 v[52:67], a[64:67], v[148:151], v[52:67]
  ds_read2st64_b32 v[166:167], v174 offset0:152 offset1:154
  v_mfma_f32_32x32x16_bf16 v[116:131], a[68:71], v[148:151], v[116:131]
  s_add_u32 m0, s28, 69632
  s_add_u32 s29, s24, 1114112
  buffer_load_dwordx4 v170, s[12:15], s29 offen lds
  s_waitcnt vmcnt(17) lgkmcnt(6)
  v_mfma_f32_32x32x16_bf16 v[4:19], a[72:75], v[152:155], v[4:19]
  ds_read2st64_b32 v[136:137], v171 offset0:160 offset1:162
  ds_read2st64_b32 v[138:139], v171 offset0:168 offset1:170
  s_waitcnt vmcnt(16)
  v_mfma_f32_32x32x16_bf16 v[68:83], a[76:79], v[152:155], v[68:83]
  ds_read2st64_b32 v[140:141], v172 offset0:160 offset1:162
  s_add_u32 m0, s28, 73728
  s_add_u32 s29, s24, 1179648
  buffer_load_dwordx4 v170, s[12:15], s29 offen lds
  s_waitcnt lgkmcnt(7)
  v_mfma_f32_32x32x16_bf16 v[20:35], a[72:75], v[156:159], v[20:35]
  ds_read2st64_b32 v[142:143], v172 offset0:168 offset1:170
  v_mfma_f32_32x32x16_bf16 v[84:99], a[76:79], v[156:159], v[84:99]
  ds_read2st64_b32 v[144:145], v173 offset0:160 offset1:162
  s_add_u32 m0, s28, 77824
  s_add_u32 s29, s24, 1245184
  buffer_load_dwordx4 v170, s[12:15], s29 offen lds
  s_waitcnt lgkmcnt(7)
  v_mfma_f32_32x32x16_bf16 v[36:51], a[72:75], v[160:163], v[36:51]
  ds_read2st64_b32 v[146:147], v173 offset0:168 offset1:170
  v_mfma_f32_32x32x16_bf16 v[100:115], a[76:79], v[160:163], v[100:115]
  ds_read2st64_b32 v[148:149], v174 offset0:160 offset1:162
  buffer_load_dwordx4 a[120:123], v132, s[8:11], s26 offen offset:3072
  s_waitcnt lgkmcnt(7)
  v_mfma_f32_32x32x16_bf16 v[52:67], a[72:75], v[164:167], v[52:67]
  ds_read2st64_b32 v[150:151], v174 offset0:168 offset1:170
  v_mfma_f32_32x32x16_bf16 v[116:131], a[76:79], v[164:167], v[116:131]
  buffer_load_dwordx4 a[124:127], v132, s[8:11], s27 offen offset:3072
  s_waitcnt vmcnt(19) lgkmcnt(6)
  v_mfma_f32_32x32x16_bf16 v[4:19], a[80:83], v[136:139], v[4:19]
  ds_read2st64_b32 v[152:153], v171 offset0:176 offset1:178
  ds_read2st64_b32 v[154:155], v171 offset0:184 offset1:186
  s_waitcnt vmcnt(18)
  v_mfma_f32_32x32x16_bf16 v[68:83], a[84:87], v[136:139], v[68:83]
  ds_read2st64_b32 v[156:157], v172 offset0:176 offset1:178
  s_add_u32 s26, s26, 4096
  buffer_load_dwordx4 a[128:131], v132, s[8:11], s26 offen offset:0
  s_waitcnt lgkmcnt(7)
  v_mfma_f32_32x32x16_bf16 v[20:35], a[80:83], v[140:143], v[20:35]
  ds_read2st64_b32 v[158:159], v172 offset0:184 offset1:186
  v_mfma_f32_32x32x16_bf16 v[84:99], a[84:87], v[140:143], v[84:99]
  ds_read2st64_b32 v[160:161], v173 offset0:176 offset1:178
  s_add_u32 s27, s27, 4096
  buffer_load_dwordx4 a[132:135], v132, s[8:11], s27 offen offset:0
  s_waitcnt lgkmcnt(7)
  v_mfma_f32_32x32x16_bf16 v[36:51], a[80:83], v[144:147], v[36:51]
  ds_read2st64_b32 v[162:163], v173 offset0:184 offset1:186
  v_mfma_f32_32x32x16_bf16 v[100:115], a[84:87], v[144:147], v[100:115]
  ds_read2st64_b32 v[164:165], v174 offset0:176 offset1:178
  buffer_load_dwordx4 a[136:139], v132, s[8:11], s26 offen offset:1024
  s_waitcnt lgkmcnt(7)
  v_mfma_f32_32x32x16_bf16 v[52:67], a[80:83], v[148:151], v[52:67]
  ds_read2st64_b32 v[166:167], v174 offset0:184 offset1:186
  v_mfma_f32_32x32x16_bf16 v[116:131], a[84:87], v[148:151], v[116:131]
  buffer_load_dwordx4 a[140:143], v132, s[8:11], s27 offen offset:1024
  s_waitcnt vmcnt(18)
  s_barrier
  s_waitcnt vmcnt(17) lgkmcnt(6)
  v_mfma_f32_32x32x16_bf16 v[4:19], a[88:91], v[152:155], v[4:19]
  ds_read2st64_b32 v[136:137], v171 offset0:192 offset1:194
  ds_read2st64_b32 v[138:139], v171 offset0:200 offset1:202
  s_waitcnt vmcnt(16)
  v_mfma_f32_32x32x16_bf16 v[68:83], a[92:95], v[152:155], v[68:83]
  ds_read2st64_b32 v[140:141], v172 offset0:192 offset1:194
  buffer_load_dwordx4 a[144:147], v132, s[8:11], s26 offen offset:2048
  s_waitcnt lgkmcnt(7)
  v_mfma_f32_32x32x16_bf16 v[20:35], a[88:91], v[156:159], v[20:35]
  ds_read2st64_b32 v[142:143], v172 offset0:200 offset1:202
  v_mfma_f32_32x32x16_bf16 v[84:99], a[92:95], v[156:159], v[84:99]
  ds_read2st64_b32 v[144:145], v173 offset0:192 offset1:194
  buffer_load_dwordx4 a[148:151], v132, s[8:11], s27 offen offset:2048
  s_waitcnt lgkmcnt(7)
  v_mfma_f32_32x32x16_bf16 v[36:51], a[88:91], v[160:163], v[36:51]
  ds_read2st64_b32 v[146:147], v173 offset0:200 offset1:202
  v_mfma_f32_32x32x16_bf16 v[100:115], a[92:95], v[160:163], v[100:115]
  ds_read2st64_b32 v[148:149], v174 offset0:192 offset1:194
  s_add_u32 m0, s28, 81920
  s_add_u32 s29, s24, 1310720
  buffer_load_dwordx4 v170, s[12:15], s29 offen lds
  s_waitcnt lgkmcnt(7)
  v_mfma_f32_32x32x16_bf16 v[52:67], a[88:91], v[164:167], v[52:67]
  ds_read2st64_b32 v[150:151], v174 offset0:200 offset1:202
  v_mfma_f32_32x32x16_bf16 v[116:131], a[92:95], v[164:167], v[116:131]
  s_add_u32 m0, s28, 86016
  s_add_u32 s29, s24, 1376256
  buffer_load_dwordx4 v170, s[12:15], s29 offen lds
  s_waitcnt vmcnt(19) lgkmcnt(6)
  v_mfma_f32_32x32x16_bf16 v[4:19], a[96:99], v[136:139], v[4:19]
  ds_read2st64_b32 v[152:153], v171 offset0:208 offset1:210
  ds_read2st64_b32 v[154:155], v171 offset0:216 offset1:218
  s_waitcnt vmcnt(18)
  v_mfma_f32_32x32x16_bf16 v[68:83], a[100:103], v[136:139], v[68:83]
  ds_read2st64_b32 v[156:157], v172 offset0:208 offset1:210
  s_add_u32 m0, s28, 90112
  s_add_u32 s29, s24, 1441792
  buffer_load_dwordx4 v170, s[12:15], s29 offen lds
  s_waitcnt lgkmcnt(7)
  v_mfma_f32_32x32x16_bf16 v[20:35], a[96:99], v[140:143], v[20:35]
  ds_read2st64_b32 v[158:159], v172 offset0:216 offset1:218
  v_mfma_f32_32x32x16_bf16 v[84:99], a[100:103], v[140:143], v[84:99]
  ds_read2st64_b32 v[160:161], v173 offset0:208 offset1:210
  s_add_u32 m0, s28, 94208
  s_add_u32 s29, s24, 1507328
  buffer_load_dwordx4 v170, s[12:15], s29 offen lds
  s_waitcnt lgkmcnt(7)
  v_mfma_f32_32x32x16_bf16 v[36:51], a[96:99], v[144:147], v[36:51]
  ds_read2st64_b32 v[162:163], v173 offset0:216 offset1:218
  v_mfma_f32_32x32x16_bf16 v[100:115], a[100:103], v[144:147], v[100:115]
  ds_read2st64_b32 v[164:165], v174 offset0:208 offset1:210
  buffer_load_dwordx4 a[152:155], v132, s[8:11], s26 offen offset:3072
  s_waitcnt lgkmcnt(7)
  v_mfma_f32_32x32x16_bf16 v[52:67], a[96:99], v[148:151], v[52:67]
  ds_read2st64_b32 v[166:167], v174 offset0:216 offset1:218
  v_mfma_f32_32x32x16_bf16 v[116:131], a[100:103], v[148:151], v[116:131]
  buffer_load_dwordx4 a[156:159], v132, s[8:11], s27 offen offset:3072
  s_waitcnt vmcnt(21) lgkmcnt(6)
  v_mfma_f32_32x32x16_bf16 v[4:19], a[104:107], v[152:155], v[4:19]
  ds_read2st64_b32 v[136:137], v171 offset0:224 offset1:226
  ds_read2st64_b32 v[138:139], v171 offset0:232 offset1:234
  s_waitcnt vmcnt(20)
  v_mfma_f32_32x32x16_bf16 v[68:83], a[108:111], v[152:155], v[68:83]
  ds_read2st64_b32 v[140:141], v172 offset0:224 offset1:226
  s_add_u32 s26, s26, 4096
  buffer_load_dwordx4 a[160:163], v132, s[8:11], s26 offen offset:0
  s_waitcnt lgkmcnt(7)
  v_mfma_f32_32x32x16_bf16 v[20:35], a[104:107], v[156:159], v[20:35]
  ds_read2st64_b32 v[142:143], v172 offset0:232 offset1:234
  v_mfma_f32_32x32x16_bf16 v[84:99], a[108:111], v[156:159], v[84:99]
  ds_read2st64_b32 v[144:145], v173 offset0:224 offset1:226
  s_add_u32 s27, s27, 4096
  buffer_load_dwordx4 a[164:167], v132, s[8:11], s27 offen offset:0
  s_waitcnt lgkmcnt(7)
  v_mfma_f32_32x32x16_bf16 v[36:51], a[104:107], v[160:163], v[36:51]
  ds_read2st64_b32 v[146:147], v173 offset0:232 offset1:234
  v_mfma_f32_32x32x16_bf16 v[100:115], a[108:111], v[160:163], v[100:115]
  ds_read2st64_b32 v[148:149], v174 offset0:224 offset1:226
  buffer_load_dwordx4 a[168:171], v132, s[8:11], s26 offen offset:1024
  s_waitcnt lgkmcnt(7)
  v_mfma_f32_32x32x16_bf16 v[52:67], a[104:107], v[164:167], v[52:67]
  ds_read2st64_b32 v[150:151], v174 offset0:232 offset1:234
  v_mfma_f32_32x32x16_bf16 v[116:131], a[108:111], v[164:167], v[116:131]
  buffer_load_dwordx4 a[172:175], v132, s[8:11], s27 offen offset:1024
  s_waitcnt vmcnt(23) lgkmcnt(6)
  v_mfma_f32_32x32x16_bf16 v[4:19], a[112:115], v[136:139], v[4:19]
  ds_read2st64_b32 v[152:153], v171 offset0:240 offset1:242
  ds_read2st64_b32 v[154:155], v171 offset0:248 offset1:250
  s_waitcnt vmcnt(22)
  v_mfma_f32_32x32x16_bf16 v[68:83], a[116:119], v[136:139], v[68:83]
  ds_read2st64_b32 v[156:157], v172 offset0:240 offset1:242
  buffer_load_dwordx4 a[176:179], v132, s[8:11], s26 offen offset:2048
  s_waitcnt lgkmcnt(7)
  v_mfma_f32_32x32x16_bf16 v[20:35], a[112:115], v[140:143], v[20:35]
  ds_read2st64_b32 v[158:159], v172 offset0:248 offset1:250
  v_mfma_f32_32x32x16_bf16 v[84:99], a[116:119], v[140:143], v[84:99]
  ds_read2st64_b32 v[160:161], v173 offset0:240 offset1:242
  buffer_load_dwordx4 a[180:183], v132, s[8:11], s27 offen offset:2048
  s_waitcnt lgkmcnt(7)
  v_mfma_f32_32x32x16_bf16 v[36:51], a[112:115], v[144:147], v[36:51]
  ds_read2st64_b32 v[162:163], v173 offset0:248 offset1:250
  v_mfma_f32_32x32x16_bf16 v[100:115], a[116:119], v[144:147], v[100:115]
  ds_read2st64_b32 v[164:165], v174 offset0:240 offset1:242
  s_add_u32 m0, s28, 98304
  s_add_u32 s29, s24, 1572864
  buffer_load_dwordx4 v170, s[12:15], s29 offen lds
  s_waitcnt lgkmcnt(7)
  v_mfma_f32_32x32x16_bf16 v[52:67], a[112:115], v[148:151], v[52:67]
  ds_read2st64_b32 v[166:167], v174 offset0:248 offset1:250
  v_mfma_f32_32x32x16_bf16 v[116:131], a[116:119], v[148:151], v[116:131]
  s_add_u32 m0, s28, 102400
  s_add_u32 s29, s24, 1638400
  buffer_load_dwordx4 v170, s[12:15], s29 offen lds
  s_waitcnt vmcnt(22)
  s_barrier
  s_waitcnt vmcnt(21) lgkmcnt(6)
  v_mfma_f32_32x32x16_bf16 v[4:19], a[120:123], v[152:155], v[4:19]
  ds_read2st64_b32 v[136:137], v175 offset0:0 offset1:2
  ds_read2st64_b32 v[138:139], v175 offset0:8 offset1:10
  s_waitcnt vmcnt(20)
  v_mfma_f32_32x32x16_bf16 v[68:83], a[124:127], v[152:155], v[68:83]
  ds_read2st64_b32 v[140:141], v176 offset0:0 offset1:2
  s_add_u32 m0, s28, 106496
  s_add_u32 s29, s24, 1703936
  buffer_load_dwordx4 v170, s[12:15], s29 offen lds
  s_waitcnt lgkmcnt(7)
  v_mfma_f32_32x32x16_bf16 v[20:35], a[120:123], v[156:159], v[20:35]
  ds_read2st64_b32 v[142:143], v176 offset0:8 offset1:10
  v_mfma_f32_32x32x16_bf16 v[84:99], a[124:127], v[156:159], v[84:99]
  ds_read2st64_b32 v[144:145], v177 offset0:0 offset1:2
  s_add_u32 m0, s28, 110592
  s_add_u32 s29, s24, 1769472
  buffer_load_dwordx4 v170, s[12:15], s29 offen lds
  s_waitcnt lgkmcnt(7)
  v_mfma_f32_32x32x16_bf16 v[36:51], a[120:123], v[160:163], v[36:51]
  ds_read2st64_b32 v[146:147], v177 offset0:8 offset1:10
  v_mfma_f32_32x32x16_bf16 v[100:115], a[124:127], v[160:163], v[100:115]
  ds_read2st64_b32 v[148:149], v178 offset0:0 offset1:2
  buffer_load_dwordx4 a[184:187], v132, s[8:11], s26 offen offset:3072
  s_waitcnt lgkmcnt(7)
  v_mfma_f32_32x32x16_bf16 v[52:67], a[120:123], v[164:167], v[52:67]
  ds_read2st64_b32 v[150:151], v178 offset0:8 offset1:10
  v_mfma_f32_32x32x16_bf16 v[116:131], a[124:127], v[164:167], v[116:131]
  buffer_load_dwordx4 a[188:191], v132, s[8:11], s27 offen offset:3072
  s_waitcnt vmcnt(23) lgkmcnt(6)
  v_mfma_f32_32x32x16_bf16 v[4:19], a[128:131], v[136:139], v[4:19]
  ds_read2st64_b32 v[152:153], v175 offset0:16 offset1:18
  ds_read2st64_b32 v[154:155], v175 offset0:24 offset1:26
  s_waitcnt vmcnt(22)
  v_mfma_f32_32x32x16_bf16 v[68:83], a[132:135], v[136:139], v[68:83]
  ds_read2st64_b32 v[156:157], v176 offset0:16 offset1:18
  s_add_u32 s26, s26, 4096
  buffer_load_dwordx4 a[192:195], v132, s[8:11], s26 offen offset:0
  s_waitcnt lgkmcnt(7)
  v_mfma_f32_32x32x16_bf16 v[20:35], a[128:131], v[140:143], v[20:35]
  ds_read2st64_b32 v[158:159], v176 offset0:24 offset1:26
  v_mfma_f32_32x32x16_bf16 v[84:99], a[132:135], v[140:143], v[84:99]
  ds_read2st64_b32 v[160:161], v177 offset0:16 offset1:18
  s_add_u32 s27, s27, 4096
  buffer_load_dwordx4 a[196:199], v132, s[8:11], s27 offen offset:0
  s_waitcnt lgkmcnt(7)
  v_mfma_f32_32x32x16_bf16 v[36:51], a[128:131], v[144:147], v[36:51]
  ds_read2st64_b32 v[162:163], v177 offset0:24 offset1:26
  v_mfma_f32_32x32x16_bf16 v[100:115], a[132:135], v[144:147], v[100:115]
  ds_read2st64_b32 v[164:165], v178 offset0:16 offset1:18
  buffer_load_dwordx4 a[200:203], v132, s[8:11], s26 offen offset:1024
  s_waitcnt lgkmcnt(7)
  v_mfma_f32_32x32x16_bf16 v[52:67], a[128:131], v[148:151], v[52:67]
  ds_read2st64_b32 v[166:167], v178 offset0:24 offset1:26
  v_mfma_f32_32x32x16_bf16 v[116:131], a[132:135], v[148:151], v[116:131]
  buffer_load_dwordx4 a[204:207], v132, s[8:11], s27 offen offset:1024
  s_waitcnt vmcnt(25) lgkmcnt(6)
  v_mfma_f32_32x32x16_bf16 v[4:19], a[136:139], v[152:155], v[4:19]
  ds_read2st64_b32 v[136:137], v175 offset0:32 offset1:34
  ds_read2st64_b32 v[138:139], v175 offset0:40 offset1:42
  s_waitcnt vmcnt(24)
  v_mfma_f32_32x32x16_bf16 v[68:83], a[140:143], v[152:155], v[68:83]
  ds_read2st64_b32 v[140:141], v176 offset0:32 offset1:34
  buffer_load_dwordx4 a[208:211], v132, s[8:11], s26 offen offset:2048
  s_waitcnt lgkmcnt(7)
  v_mfma_f32_32x32x16_bf16 v[20:35], a[136:139], v[156:159], v[20:35]
  ds_read2st64_b32 v[142:143], v176 offset0:40 offset1:42
  v_mfma_f32_32x32x16_bf16 v[84:99], a[140:143], v[156:159], v[84:99]
  ds_read2st64_b32 v[144:145], v177 offset0:32 offset1:34
  buffer_load_dwordx4 a[212:215], v132, s[8:11], s27 offen offset:2048
  s_waitcnt lgkmcnt(7)
  v_mfma_f32_32x32x16_bf16 v[36:51], a[136:139], v[160:163], v[36:51]
  ds_read2st64_b32 v[146:147], v177 offset0:40 offset1:42
  v_mfma_f32_32x32x16_bf16 v[100:115], a[140:143], v[160:163], v[100:115]
  ds_read2st64_b32 v[148:149], v178 offset0:32 offset1:34
  s_add_u32 m0, s28, 114688
  s_add_u32 s29, s24, 1835008
  buffer_load_dwordx4 v170, s[12:15], s29 offen lds
  s_waitcnt lgkmcnt(7)
  v_mfma_f32_32x32x16_bf16 v[52:67], a[136:139], v[164:167], v[52:67]
  ds_read2st64_b32 v[150:151], v178 offset0:40 offset1:42
  v_mfma_f32_32x32x16_bf16 v[116:131], a[140:143], v[164:167], v[116:131]
  s_add_u32 m0, s28, 118784
  s_add_u32 s29, s24, 1900544
  buffer_load_dwordx4 v170, s[12:15], s29 offen lds
  s_waitcnt vmcnt(27) lgkmcnt(6)
  v_mfma_f32_32x32x16_bf16 v[4:19], a[144:147], v[136:139], v[4:19]
  ds_read2st64_b32 v[152:153], v175 offset0:48 offset1:50
  ds_read2st64_b32 v[154:155], v175 offset0:56 offset1:58
  s_waitcnt vmcnt(26)
  v_mfma_f32_32x32x16_bf16 v[68:83], a[148:151], v[136:139], v[68:83]
  ds_read2st64_b32 v[156:157], v176 offset0:48 offset1:50
  s_add_u32 m0, s28, 122880
  s_add_u32 s29, s24, 1966080
  buffer_load_dwordx4 v170, s[12:15], s29 offen lds
  s_waitcnt lgkmcnt(7)
  v_mfma_f32_32x32x16_bf16 v[20:35], a[144:147], v[140:143], v[20:35]
  ds_read2st64_b32 v[158:159], v176 offset0:56 offset1:58
  v_mfma_f32_32x32x16_bf16 v[84:99], a[148:151], v[140:143], v[84:99]
  ds_read2st64_b32 v[160:161], v177 offset0:48 offset1:50
  s_add_u32 m0, s28, 126976
  s_add_u32 s29, s24, 2031616
  buffer_load_dwordx4 v170, s[12:15], s29 offen lds
  s_waitcnt lgkmcnt(7)
  v_mfma_f32_32x32x16_bf16 v[36:51], a[144:147], v[144:147], v[36:51]
  ds_read2st64_b32 v[162:163], v177 offset0:56 offset1:58
  v_mfma_f32_32x32x16_bf16 v[100:115], a[148:151], v[144:147], v[100:115]
  ds_read2st64_b32 v[164:165], v178 offset0:48 offset1:50
  buffer_load_dwordx4 a[216:219], v132, s[8:11], s26 offen offset:3072
  s_waitcnt lgkmcnt(7)
  v_mfma_f32_32x32x16_bf16 v[52:67], a[144:147], v[148:151], v[52:67]
  ds_read2st64_b32 v[166:167], v178 offset0:56 offset1:58
  v_mfma_f32_32x32x16_bf16 v[116:131], a[148:151], v[148:151], v[116:131]
  buffer_load_dwordx4 a[220:223], v132, s[8:11], s27 offen offset:3072
  s_waitcnt vmcnt(26)
  s_barrier
  s_waitcnt vmcnt(25) lgkmcnt(6)
  v_mfma_f32_32x32x16_bf16 v[4:19], a[152:155], v[152:155], v[4:19]
  ds_read2st64_b32 v[136:137], v175 offset0:64 offset1:66
  ds_read2st64_b32 v[138:139], v175 offset0:72 offset1:74
  s_waitcnt vmcnt(24)
  v_mfma_f32_32x32x16_bf16 v[68:83], a[156:159], v[152:155], v[68:83]
  ds_read2st64_b32 v[140:141], v176 offset0:64 offset1:66
  s_add_u32 s26, s26, 4096
  buffer_load_dwordx4 a[224:227], v132, s[8:11], s26 offen offset:0
  s_waitcnt lgkmcnt(7)
  v_mfma_f32_32x32x16_bf16 v[20:35], a[152:155], v[156:159], v[20:35]
  ds_read2st64_b32 v[142:143], v176 offset0:72 offset1:74
  v_mfma_f32_32x32x16_bf16 v[84:99], a[156:159], v[156:159], v[84:99]
  ds_read2st64_b32 v[144:145], v177 offset0:64 offset1:66
  s_add_u32 s27, s27, 4096
  buffer_load_dwordx4 a[228:231], v132, s[8:11], s27 offen offset:0
  s_waitcnt lgkmcnt(7)
  v_mfma_f32_32x32x16_bf16 v[36:51], a[152:155], v[160:163], v[36:51]
  ds_read2st64_b32 v[146:147], v177 offset0:72 offset1:74
  v_mfma_f32_32x32x16_bf16 v[100:115], a[156:159], v[160:163], v[100:115]
  ds_read2st64_b32 v[148:149], v178 offset0:64 offset1:66
  buffer_load_dwordx4 a[232:235], v132, s[8:11], s26 offen offset:1024
  s_waitcnt lgkmcnt(7)
  v_mfma_f32_32x32x16_bf16 v[52:67], a[152:155], v[164:167], v[52:67]
  ds_read2st64_b32 v[150:151], v178 offset0:72 offset1:74
  v_mfma_f32_32x32x16_bf16 v[116:131], a[156:159], v[164:167], v[116:131]
  buffer_load_dwordx4 a[236:239], v132, s[8:11], s27 offen offset:1024
  s_waitcnt vmcnt(27) lgkmcnt(6)
  v_mfma_f32_32x32x16_bf16 v[4:19], a[160:163], v[136:139], v[4:19]
  ds_read2st64_b32 v[152:153], v175 offset0:80 offset1:82
  ds_read2st64_b32 v[154:155], v175 offset0:88 offset1:90
  s_waitcnt vmcnt(26)
  v_mfma_f32_32x32x16_bf16 v[68:83], a[164:167], v[136:139], v[68:83]
  ds_read2st64_b32 v[156:157], v176 offset0:80 offset1:82
  buffer_load_dwordx4 a[240:243], v132, s[8:11], s26 offen offset:2048
  s_waitcnt lgkmcnt(7)
  v_mfma_f32_32x32x16_bf16 v[20:35], a[160:163], v[140:143], v[20:35]
  ds_read2st64_b32 v[158:159], v176 offset0:88 offset1:90
  v_mfma_f32_32x32x16_bf16 v[84:99], a[164:167], v[140:143], v[84:99]
  ds_read2st64_b32 v[160:161], v177 offset0:80 offset1:82
  buffer_load_dwordx4 a[244:247], v132, s[8:11], s27 offen offset:2048
  s_waitcnt lgkmcnt(7)
  v_mfma_f32_32x32x16_bf16 v[36:51], a[160:163], v[144:147], v[36:51]
  ds_read2st64_b32 v[162:163], v177 offset0:88 offset1:90
  v_mfma_f32_32x32x16_bf16 v[100:115], a[164:167], v[144:147], v[100:115]
  ds_read2st64_b32 v[164:165], v178 offset0:80 offset1:82
  buffer_load_dwordx4 a[248:251], v132, s[8:11], s26 offen offset:3072
  s_waitcnt lgkmcnt(7)
  v_mfma_f32_32x32x16_bf16 v[52:67], a[160:163], v[148:151], v[52:67]
  ds_read2st64_b32 v[166:167], v178 offset0:88 offset1:90
  v_mfma_f32_32x32x16_bf16 v[116:131], a[164:167], v[148:151], v[116:131]
  buffer_load_dwordx4 a[252:255], v132, s[8:11], s27 offen offset:3072
  s_waitcnt vmcnt(29) lgkmcnt(6)
  v_mfma_f32_32x32x16_bf16 v[4:19], a[168:171], v[152:155], v[4:19]
  ds_read2st64_b32 v[136:137], v175 offset0:96 offset1:98
  ds_read2st64_b32 v[138:139], v175 offset0:104 offset1:106
  s_waitcnt vmcnt(28)
  v_mfma_f32_32x32x16_bf16 v[68:83], a[172:175], v[152:155], v[68:83]
  ds_read2st64_b32 v[140:141], v176 offset0:96 offset1:98
  s_waitcnt lgkmcnt(7)
  v_mfma_f32_32x32x16_bf16 v[20:35], a[168:171], v[156:159], v[20:35]
  ds_read2st64_b32 v[142:143], v176 offset0:104 offset1:106
  v_mfma_f32_32x32x16_bf16 v[84:99], a[172:175], v[156:159], v[84:99]
  ds_read2st64_b32 v[144:145], v177 offset0:96 offset1:98
  s_waitcnt lgkmcnt(7)
  v_mfma_f32_32x32x16_bf16 v[36:51], a[168:171], v[160:163], v[36:51]
  ds_read2st64_b32 v[146:147], v177 offset0:104 offset1:106
  v_mfma_f32_32x32x16_bf16 v[100:115], a[172:175], v[160:163], v[100:115]
  ds_read2st64_b32 v[148:149], v178 offset0:96 offset1:98
  s_waitcnt lgkmcnt(7)
  v_mfma_f32_32x32x16_bf16 v[52:67], a[168:171], v[164:167], v[52:67]
  ds_read2st64_b32 v[150:151], v178 offset0:104 offset1:106
  v_mfma_f32_32x32x16_bf16 v[116:131], a[172:175], v[164:167], v[116:131]
  s_waitcnt vmcnt(27) lgkmcnt(6)
  v_mfma_f32_32x32x16_bf16 v[4:19], a[176:179], v[136:139], v[4:19]
  ds_read2st64_b32 v[152:153], v175 offset0:112 offset1:114
  ds_read2st64_b32 v[154:155], v175 offset0:120 offset1:122
  s_waitcnt vmcnt(26)
  v_mfma_f32_32x32x16_bf16 v[68:83], a[180:183], v[136:139], v[68:83]
  ds_read2st64_b32 v[156:157], v176 offset0:112 offset1:114
  s_waitcnt lgkmcnt(7)
  v_mfma_f32_32x32x16_bf16 v[20:35], a[176:179], v[140:143], v[20:35]
  ds_read2st64_b32 v[158:159], v176 offset0:120 offset1:122
  v_mfma_f32_32x32x16_bf16 v[84:99], a[180:183], v[140:143], v[84:99]
  ds_read2st64_b32 v[160:161], v177 offset0:112 offset1:114
  s_waitcnt lgkmcnt(7)
  v_mfma_f32_32x32x16_bf16 v[36:51], a[176:179], v[144:147], v[36:51]
  ds_read2st64_b32 v[162:163], v177 offset0:120 offset1:122
  v_mfma_f32_32x32x16_bf16 v[100:115], a[180:183], v[144:147], v[100:115]
  ds_read2st64_b32 v[164:165], v178 offset0:112 offset1:114
  s_waitcnt lgkmcnt(7)
  v_mfma_f32_32x32x16_bf16 v[52:67], a[176:179], v[148:151], v[52:67]
  ds_read2st64_b32 v[166:167], v178 offset0:120 offset1:122
  v_mfma_f32_32x32x16_bf16 v[116:131], a[180:183], v[148:151], v[116:131]
  s_waitcnt vmcnt(22)
  s_barrier
  s_waitcnt vmcnt(21) lgkmcnt(6)
  v_mfma_f32_32x32x16_bf16 v[4:19], a[184:187], v[152:155], v[4:19]
  ds_read2st64_b32 v[136:137], v175 offset0:128 offset1:130
  ds_read2st64_b32 v[138:139], v175 offset0:136 offset1:138
  s_waitcnt vmcnt(20)
  v_mfma_f32_32x32x16_bf16 v[68:83], a[188:191], v[152:155], v[68:83]
  ds_read2st64_b32 v[140:141], v176 offset0:128 offset1:130
  s_waitcnt lgkmcnt(7)
  v_mfma_f32_32x32x16_bf16 v[20:35], a[184:187], v[156:159], v[20:35]
  ds_read2st64_b32 v[142:143], v176 offset0:136 offset1:138
  v_mfma_f32_32x32x16_bf16 v[84:99], a[188:191], v[156:159], v[84:99]
  ds_read2st64_b32 v[144:145], v177 offset0:128 offset1:130
  s_waitcnt lgkmcnt(7)
  v_mfma_f32_32x32x16_bf16 v[36:51], a[184:187], v[160:163], v[36:51]
  ds_read2st64_b32 v[146:147], v177 offset0:136 offset1:138
  v_mfma_f32_32x32x16_bf16 v[100:115], a[188:191], v[160:163], v[100:115]
  ds_read2st64_b32 v[148:149], v178 offset0:128 offset1:130
  s_waitcnt lgkmcnt(7)
  v_mfma_f32_32x32x16_bf16 v[52:67], a[184:187], v[164:167], v[52:67]
  ds_read2st64_b32 v[150:151], v178 offset0:136 offset1:138
  v_mfma_f32_32x32x16_bf16 v[116:131], a[188:191], v[164:167], v[116:131]
  s_waitcnt vmcnt(19) lgkmcnt(6)
  v_mfma_f32_32x32x16_bf16 v[4:19], a[192:195], v[136:139], v[4:19]
  ds_read2st64_b32 v[152:153], v175 offset0:144 offset1:146
  ds_read2st64_b32 v[154:155], v175 offset0:152 offset1:154
  s_waitcnt vmcnt(18)
  v_mfma_f32_32x32x16_bf16 v[68:83], a[196:199], v[136:139], v[68:83]
  ds_read2st64_b32 v[156:157], v176 offset0:144 offset1:146
  s_waitcnt lgkmcnt(7)
  v_mfma_f32_32x32x16_bf16 v[20:35], a[192:195], v[140:143], v[20:35]
  ds_read2st64_b32 v[158:159], v176 offset0:152 offset1:154
  v_mfma_f32_32x32x16_bf16 v[84:99], a[196:199], v[140:143], v[84:99]
  ds_read2st64_b32 v[160:161], v177 offset0:144 offset1:146
  s_waitcnt lgkmcnt(7)
  v_mfma_f32_32x32x16_bf16 v[36:51], a[192:195], v[144:147], v[36:51]
  ds_read2st64_b32 v[162:163], v177 offset0:152 offset1:154
  v_mfma_f32_32x32x16_bf16 v[100:115], a[196:199], v[144:147], v[100:115]
  ds_read2st64_b32 v[164:165], v178 offset0:144 offset1:146
  s_waitcnt lgkmcnt(7)
  v_mfma_f32_32x32x16_bf16 v[52:67], a[192:195], v[148:151], v[52:67]
  ds_read2st64_b32 v[166:167], v178 offset0:152 offset1:154
  v_mfma_f32_32x32x16_bf16 v[116:131], a[196:199], v[148:151], v[116:131]
  s_waitcnt vmcnt(17) lgkmcnt(6)
  v_mfma_f32_32x32x16_bf16 v[4:19], a[200:203], v[152:155], v[4:19]
  ds_read2st64_b32 v[136:137], v175 offset0:160 offset1:162
  ds_read2st64_b32 v[138:139], v175 offset0:168 offset1:170
  s_waitcnt vmcnt(16)
  v_mfma_f32_32x32x16_bf16 v[68:83], a[204:207], v[152:155], v[68:83]
  ds_read2st64_b32 v[140:141], v176 offset0:160 offset1:162
  s_waitcnt lgkmcnt(7)
  v_mfma_f32_32x32x16_bf16 v[20:35], a[200:203], v[156:159], v[20:35]
  ds_read2st64_b32 v[142:143], v176 offset0:168 offset1:170
  v_mfma_f32_32x32x16_bf16 v[84:99], a[204:207], v[156:159], v[84:99]
  ds_read2st64_b32 v[144:145], v177 offset0:160 offset1:162
  s_waitcnt lgkmcnt(7)
  v_mfma_f32_32x32x16_bf16 v[36:51], a[200:203], v[160:163], v[36:51]
  ds_read2st64_b32 v[146:147], v177 offset0:168 offset1:170
  v_mfma_f32_32x32x16_bf16 v[100:115], a[204:207], v[160:163], v[100:115]
  ds_read2st64_b32 v[148:149], v178 offset0:160 offset1:162
  s_waitcnt lgkmcnt(7)
  v_mfma_f32_32x32x16_bf16 v[52:67], a[200:203], v[164:167], v[52:67]
  ds_read2st64_b32 v[150:151], v178 offset0:168 offset1:170
  v_mfma_f32_32x32x16_bf16 v[116:131], a[204:207], v[164:167], v[116:131]
  s_waitcnt vmcnt(15) lgkmcnt(6)
  v_mfma_f32_32x32x16_bf16 v[4:19], a[208:211], v[136:139], v[4:19]
  ds_read2st64_b32 v[152:153], v175 offset0:176 offset1:178
  ds_read2st64_b32 v[154:155], v175 offset0:184 offset1:186
  s_waitcnt vmcnt(14)
  v_mfma_f32_32x32x16_bf16 v[68:83], a[212:215], v[136:139], v[68:83]
  ds_read2st64_b32 v[156:157], v176 offset0:176 offset1:178
  s_waitcnt lgkmcnt(7)
  v_mfma_f32_32x32x16_bf16 v[20:35], a[208:211], v[140:143], v[20:35]
  ds_read2st64_b32 v[158:159], v176 offset0:184 offset1:186
  v_mfma_f32_32x32x16_bf16 v[84:99], a[212:215], v[140:143], v[84:99]
  ds_read2st64_b32 v[160:161], v177 offset0:176 offset1:178
  s_waitcnt lgkmcnt(7)
  v_mfma_f32_32x32x16_bf16 v[36:51], a[208:211], v[144:147], v[36:51]
  ds_read2st64_b32 v[162:163], v177 offset0:184 offset1:186
  v_mfma_f32_32x32x16_bf16 v[100:115], a[212:215], v[144:147], v[100:115]
  ds_read2st64_b32 v[164:165], v178 offset0:176 offset1:178
  s_waitcnt lgkmcnt(7)
  v_mfma_f32_32x32x16_bf16 v[52:67], a[208:211], v[148:151], v[52:67]
  ds_read2st64_b32 v[166:167], v178 offset0:184 offset1:186
  v_mfma_f32_32x32x16_bf16 v[116:131], a[212:215], v[148:151], v[116:131]
  s_waitcnt vmcnt(10)
  s_barrier
  s_waitcnt vmcnt(9) lgkmcnt(6)
  v_mfma_f32_32x32x16_bf16 v[4:19], a[216:219], v[152:155], v[4:19]
  ds_read2st64_b32 v[136:137], v175 offset0:192 offset1:194
  ds_read2st64_b32 v[138:139], v175 offset0:200 offset1:202
  s_waitcnt vmcnt(8)
  v_mfma_f32_32x32x16_bf16 v[68:83], a[220:223], v[152:155], v[68:83]
  ds_read2st64_b32 v[140:141], v175 offset0:208 offset1:210
  s_waitcnt lgkmcnt(7)
  v_mfma_f32_32x32x16_bf16 v[20:35], a[216:219], v[156:159], v[20:35]
  ds_read2st64_b32 v[142:143], v175 offset0:216 offset1:218
  v_mfma_f32_32x32x16_bf16 v[84:99], a[220:223], v[156:159], v[84:99]
  ds_read2st64_b32 v[144:145], v175 offset0:224 offset1:226
  s_waitcnt lgkmcnt(7)
  v_mfma_f32_32x32x16_bf16 v[36:51], a[216:219], v[160:163], v[36:51]
  ds_read2st64_b32 v[146:147], v175 offset0:232 offset1:234
  v_mfma_f32_32x32x16_bf16 v[100:115], a[220:223], v[160:163], v[100:115]
  ds_read2st64_b32 v[148:149], v175 offset0:240 offset1:242
  s_waitcnt lgkmcnt(7)
  v_mfma_f32_32x32x16_bf16 v[52:67], a[216:219], v[164:167], v[52:67]
  ds_read2st64_b32 v[150:151], v175 offset0:248 offset1:250
  v_mfma_f32_32x32x16_bf16 v[116:131], a[220:223], v[164:167], v[116:131]
  s_waitcnt vmcnt(7) lgkmcnt(6)
  v_mfma_f32_32x32x16_bf16 v[4:19], a[224:227], v[136:139], v[4:19]
  ds_read2st64_b32 v[152:153], v176 offset0:192 offset1:194
  s_waitcnt vmcnt(6)
  v_mfma_f32_32x32x16_bf16 v[68:83], a[228:231], v[136:139], v[68:83]
  ds_read2st64_b32 v[154:155], v176 offset0:200 offset1:202
  s_waitcnt vmcnt(5) lgkmcnt(6)
  v_mfma_f32_32x32x16_bf16 v[4:19], a[232:235], v[140:143], v[4:19]
  ds_read2st64_b32 v[156:157], v176 offset0:208 offset1:210
  s_waitcnt vmcnt(4)
  v_mfma_f32_32x32x16_bf16 v[68:83], a[236:239], v[140:143], v[68:83]
  ds_read2st64_b32 v[158:159], v176 offset0:216 offset1:218
  s_waitcnt vmcnt(3) lgkmcnt(6)
  v_mfma_f32_32x32x16_bf16 v[4:19], a[240:243], v[144:147], v[4:19]
  ds_read2st64_b32 v[160:161], v176 offset0:224 offset1:226
  s_waitcnt vmcnt(2)
  v_mfma_f32_32x32x16_bf16 v[68:83], a[244:247], v[144:147], v[68:83]
  ds_read2st64_b32 v[162:163], v176 offset0:232 offset1:234
  s_waitcnt vmcnt(1) lgkmcnt(6)
  v_mfma_f32_32x32x16_bf16 v[4:19], a[248:251], v[148:151], v[4:19]
  ds_read2st64_b32 v[164:165], v176 offset0:240 offset1:242
  s_waitcnt vmcnt(0)
  v_mfma_f32_32x32x16_bf16 v[68:83], a[252:255], v[148:151], v[68:83]
  ds_read2st64_b32 v[166:167], v176 offset0:248 offset1:250
  s_waitcnt lgkmcnt(6)
  v_mfma_f32_32x32x16_bf16 v[20:35], a[224:227], v[152:155], v[20:35]
  ds_read2st64_b32 v[136:137], v177 offset0:192 offset1:194
  s_getpc_b64 s[96:97]
pf31:
  s_add_u32 s96, s96, p2_27-pf31
  s_addc_u32 s97, s97, 0
  s_mov_b32 s98, text_end-p2_27
  s_mov_b32 s99, 0x20000
  v_lshlrev_b32 v2, 6, v0
  buffer_load_dword v3, v2, s[96:99], 0 offen
  s_and_b32 s60, s2, 3
  s_lshl_b32 s60, s60, 2
  s_bfe_u32 s61, s2, 0x10002
  s_lshl_b32 s61, s61, 1
  s_add_u32 s60, s60, s61
  s_lshr_b32 s61, s2, 7
  s_add_u32 s60, s60, s61
  s_lshl_b32 s60, s60, 1
  s_bfe_u32 s61, s2, 0x10006
  s_add_u32 s63, s60, s61
  s_bfe_u32 s62, s2, 0x30003
  s_add_u32 s52, s4, 0xe00000
  s_addc_u32 s53, s5, 0
  s_mov_b32 s54, 0x1c0000
  s_mov_b32 s55, 0x20000
  s_mul_i32 s60, s3, 28672
  s_mul_i32 s56, s62, 229376
  s_add_u32 s56, s56, s60
  s_add_u32 s57, s56, 114688
  buffer_load_dwordx4 a[0:3], v132, s[52:55], s56 offen offset:0
  v_mfma_f32_32x32x16_bf16 v[84:99], a[228:231], v[152:155], v[84:99]
  ds_read2st64_b32 v[138:139], v177 offset0:200 offset1:202
  buffer_load_dwordx4 a[4:7], v132, s[52:55], s57 offen offset:0
  s_waitcnt lgkmcnt(6)
  v_mfma_f32_32x32x16_bf16 v[20:35], a[232:235], v[156:159], v[20:35]
  ds_read2st64_b32 v[140:141], v177 offset0:208 offset1:210
  v_mfma_f32_32x32x16_bf16 v[84:99], a[236:239], v[156:159], v[84:99]
  ds_read2st64_b32 v[142:143], v177 offset0:216 offset1:218
  buffer_load_dwordx4 a[8:11], v132, s[52:55], s56 offen offset:1024
  s_waitcnt lgkmcnt(6)
  v_mfma_f32_32x32x16_bf16 v[20:35], a[240:243], v[160:163], v[20:35]
  ds_read2st64_b32 v[144:145], v177 offset0:224 offset1:226
  buffer_load_dwordx4 a[12:15], v132, s[52:55], s57 offen offset:1024
  v_mfma_f32_32x32x16_bf16 v[84:99], a[244:247], v[160:163], v[84:99]
  ds_read2st64_b32 v[146:147], v177 offset0:232 offset1:234
  v_cvt_pk_bf16_f32 v4, v4, v5
  v_cvt_pk_bf16_f32 v5, v6, v7
  v_cvt_pk_bf16_f32 v6, v8, v9
  v_cvt_pk_bf16_f32 v7, v10, v11
  buffer_store_dwordx4 v[4:7], v132, s[16:19], s36 offen sc0 sc1
  v_cvt_pk_bf16_f32 v8, v12, v13
  v_cvt_pk_bf16_f32 v9, v14, v15
  s_waitcnt lgkmcnt(6)
  v_mfma_f32_32x32x16_bf16 v[20:35], a[248:251], v[164:167], v[20:35]
  ds_read2st64_b32 v[148:149], v177 offset0:240 offset1:242
  buffer_load_dwordx4 a[16:19], v132, s[52:55], s56 offen offset:2048
  v_cvt_pk_bf16_f32 v10, v16, v17
  v_cvt_pk_bf16_f32 v11, v18, v19
  buffer_store_dwordx4 v[8:11], v132, s[16:19], s36 offen offset:1024 sc0 sc1
  v_cvt_pk_bf16_f32 v68, v68, v69
  v_cvt_pk_bf16_f32 v69, v70, v71
  v_cvt_pk_bf16_f32 v70, v72, v73
  v_cvt_pk_bf16_f32 v71, v74, v75
  v_mfma_f32_32x32x16_bf16 v[84:99], a[252:255], v[164:167], v[84:99]
  ds_read2st64_b32 v[150:151], v177 offset0:248 offset1:250
  buffer_load_dwordx4 a[20:23], v132, s[52:55], s57 offen offset:2048
  buffer_store_dwordx4 v[68:71], v132, s[16:19], s40 offen sc0 sc1
  v_cvt_pk_bf16_f32 v72, v76, v77
  v_cvt_pk_bf16_f32 v73, v78, v79
  v_cvt_pk_bf16_f32 v74, v80, v81
  v_cvt_pk_bf16_f32 v75, v82, v83
  buffer_store_dwordx4 v[72:75], v132, s[16:19], s40 offen offset:1024 sc0 sc1
  s_waitcnt lgkmcnt(6)
  v_mfma_f32_32x32x16_bf16 v[36:51], a[224:227], v[136:139], v[36:51]
  ds_read2st64_b32 v[152:153], v178 offset0:192 offset1:194
  v_mfma_f32_32x32x16_bf16 v[100:115], a[228:231], v[136:139], v[100:115]
  ds_read2st64_b32 v[154:155], v178 offset0:200 offset1:202
  buffer_load_dwordx4 a[24:27], v132, s[52:55], s56 offen offset:3072
  s_waitcnt lgkmcnt(6)
  v_mfma_f32_32x32x16_bf16 v[36:51], a[232:235], v[140:143], v[36:51]
  ds_read2st64_b32 v[156:157], v178 offset0:208 offset1:210
  buffer_load_dwordx4 a[28:31], v132, s[52:55], s57 offen offset:3072
  v_mfma_f32_32x32x16_bf16 v[100:115], a[236:239], v[140:143], v[100:115]
  ds_read2st64_b32 v[158:159], v178 offset0:216 offset1:218
  s_waitcnt lgkmcnt(6)
  v_mfma_f32_32x32x16_bf16 v[36:51], a[240:243], v[144:147], v[36:51]
  ds_read2st64_b32 v[160:161], v178 offset0:224 offset1:226
  s_add_u32 s56, s56, 4096
  buffer_load_dwordx4 a[32:35], v132, s[52:55], s56 offen offset:0
  v_mfma_f32_32x32x16_bf16 v[100:115], a[244:247], v[144:147], v[100:115]
  ds_read2st64_b32 v[162:163], v178 offset0:232 offset1:234
  s_add_u32 s57, s57, 4096
  buffer_load_dwordx4 a[36:39], v132, s[52:55], s57 offen offset:0
  v_cvt_pk_bf16_f32 v20, v20, v21
  v_cvt_pk_bf16_f32 v21, v22, v23
  v_cvt_pk_bf16_f32 v22, v24, v25
  v_cvt_pk_bf16_f32 v23, v26, v27
  buffer_store_dwordx4 v[20:23], v132, s[16:19], s37 offen sc0 sc1
  v_cvt_pk_bf16_f32 v24, v28, v29
  v_cvt_pk_bf16_f32 v25, v30, v31
  s_waitcnt lgkmcnt(6)
  v_mfma_f32_32x32x16_bf16 v[36:51], a[248:251], v[148:151], v[36:51]
  ds_read2st64_b32 v[164:165], v178 offset0:240 offset1:242
  v_cvt_pk_bf16_f32 v26, v32, v33
  v_cvt_pk_bf16_f32 v27, v34, v35
  buffer_store_dwordx4 v[24:27], v132, s[16:19], s37 offen offset:1024 sc0 sc1
  v_cvt_pk_bf16_f32 v84, v84, v85
  v_cvt_pk_bf16_f32 v85, v86, v87
  v_cvt_pk_bf16_f32 v86, v88, v89
  v_cvt_pk_bf16_f32 v87, v90, v91
  v_mfma_f32_32x32x16_bf16 v[100:115], a[252:255], v[148:151], v[100:115]
  ds_read2st64_b32 v[166:167], v178 offset0:248 offset1:250
  buffer_load_dwordx4 a[40:43], v132, s[52:55], s56 offen offset:1024
  buffer_store_dwordx4 v[84:87], v132, s[16:19], s41 offen sc0 sc1
  v_cvt_pk_bf16_f32 v88, v92, v93
  v_cvt_pk_bf16_f32 v89, v94, v95
  v_cvt_pk_bf16_f32 v90, v96, v97
  v_cvt_pk_bf16_f32 v91, v98, v99
  buffer_store_dwordx4 v[88:91], v132, s[16:19], s41 offen offset:1024 sc0 sc1
  s_waitcnt lgkmcnt(6)
  v_mfma_f32_32x32x16_bf16 v[52:67], a[224:227], v[152:155], v[52:67]
  buffer_load_dwordx4 a[44:47], v132, s[52:55], s57 offen offset:1024
  v_mfma_f32_32x32x16_bf16 v[116:131], a[228:231], v[152:155], v[116:131]
  s_waitcnt lgkmcnt(4)
  v_mfma_f32_32x32x16_bf16 v[52:67], a[232:235], v[156:159], v[52:67]
  buffer_load_dwordx4 a[48:51], v132, s[52:55], s56 offen offset:2048
  v_mfma_f32_32x32x16_bf16 v[116:131], a[236:239], v[156:159], v[116:131]
  buffer_load_dwordx4 a[52:55], v132, s[52:55], s57 offen offset:2048
  s_waitcnt lgkmcnt(2)
  v_mfma_f32_32x32x16_bf16 v[52:67], a[240:243], v[160:163], v[52:67]
  v_mfma_f32_32x32x16_bf16 v[116:131], a[244:247], v[160:163], v[116:131]
  buffer_load_dwordx4 a[56:59], v132, s[52:55], s56 offen offset:3072
  v_cvt_pk_bf16_f32 v36, v36, v37
  v_cvt_pk_bf16_f32 v37, v38, v39
  v_cvt_pk_bf16_f32 v38, v40, v41
  v_cvt_pk_bf16_f32 v39, v42, v43
  buffer_store_dwordx4 v[36:39], v132, s[16:19], s38 offen sc0 sc1
  v_cvt_pk_bf16_f32 v40, v44, v45
  v_cvt_pk_bf16_f32 v41, v46, v47
  s_waitcnt lgkmcnt(0)
  v_mfma_f32_32x32x16_bf16 v[52:67], a[248:251], v[164:167], v[52:67]
  buffer_load_dwordx4 a[60:63], v132, s[52:55], s57 offen offset:3072
  v_cvt_pk_bf16_f32 v42, v48, v49
  v_cvt_pk_bf16_f32 v43, v50, v51
  buffer_store_dwordx4 v[40:43], v132, s[16:19], s38 offen offset:1024 sc0 sc1
  v_cvt_pk_bf16_f32 v100, v100, v101
  v_cvt_pk_bf16_f32 v101, v102, v103
  v_cvt_pk_bf16_f32 v102, v104, v105
  v_cvt_pk_bf16_f32 v103, v106, v107
  v_mfma_f32_32x32x16_bf16 v[116:131], a[252:255], v[164:167], v[116:131]
  buffer_store_dwordx4 v[100:103], v132, s[16:19], s42 offen sc0 sc1
  v_cvt_pk_bf16_f32 v104, v108, v109
  v_cvt_pk_bf16_f32 v105, v110, v111
  v_cvt_pk_bf16_f32 v106, v112, v113
  v_cvt_pk_bf16_f32 v107, v114, v115
  buffer_store_dwordx4 v[104:107], v132, s[16:19], s42 offen offset:1024 sc0 sc1
  v_cvt_pk_bf16_f32 v52, v52, v53
  v_cvt_pk_bf16_f32 v53, v54, v55
  v_cvt_pk_bf16_f32 v54, v56, v57
  v_cvt_pk_bf16_f32 v55, v58, v59
  buffer_store_dwordx4 v[52:55], v132, s[16:19], s39 offen sc0 sc1
  v_cvt_pk_bf16_f32 v56, v60, v61
  v_cvt_pk_bf16_f32 v57, v62, v63
  v_cvt_pk_bf16_f32 v58, v64, v65
  v_cvt_pk_bf16_f32 v59, v66, v67
  buffer_store_dwordx4 v[56:59], v132, s[16:19], s39 offen offset:1024 sc0 sc1
  v_cvt_pk_bf16_f32 v116, v116, v117
  v_cvt_pk_bf16_f32 v117, v118, v119
  v_cvt_pk_bf16_f32 v118, v120, v121
  v_cvt_pk_bf16_f32 v119, v122, v123
  buffer_store_dwordx4 v[116:119], v132, s[16:19], s43 offen sc0 sc1
  v_cvt_pk_bf16_f32 v120, v124, v125
  v_cvt_pk_bf16_f32 v121, v126, v127
  v_cvt_pk_bf16_f32 v122, v128, v129
  v_cvt_pk_bf16_f32 v123, v130, v131
  buffer_store_dwordx4 v[120:123], v132, s[16:19], s43 offen offset:1024 sc0 sc1
  s_add_u32 s40, s4, 0x1a10000
  s_addc_u32 s41, s5, 0
  s_mov_b32 s42, 0x10000
  s_mov_b32 s43, 0x20000
  s_mul_i32 s44, s22, 4352
  v_mov_b32 v2, s44
  v_mov_b32 v1, 1
  s_waitcnt vmcnt(0)
  s_barrier
  s_lshr_b32 s47, s63, 1
  s_mul_i32 s47, s47, 4352
  s_cmp_eq_u32 s3, 0
  s_cselect_b32 exec_lo, 1, 0
  s_mov_b32 exec_hi, 0
  buffer_atomic_add v1, v2, s[40:43], 0 offen
  s_mov_b64 exec, -1
  s_add_u32 s56, s56, 4096
  buffer_load_dwordx4 a[64:67], v132, s[52:55], s56 offen offset:0
  s_add_u32 s57, s57, 4096
  buffer_load_dwordx4 a[68:71], v132, s[52:55], s57 offen offset:0
  buffer_load_dwordx4 a[72:75], v132, s[52:55], s56 offen offset:1024
  buffer_load_dwordx4 a[76:79], v132, s[52:55], s57 offen offset:1024
  buffer_load_dwordx4 a[80:83], v132, s[52:55], s56 offen offset:2048
  buffer_load_dwordx4 a[84:87], v132, s[52:55], s57 offen offset:2048
  buffer_load_dwordx4 a[88:91], v132, s[52:55], s56 offen offset:3072
  buffer_load_dwordx4 a[92:95], v132, s[52:55], s57 offen offset:3072
  s_add_u32 s56, s56, 4096
  buffer_load_dwordx4 a[96:99], v132, s[52:55], s56 offen offset:0
  s_add_u32 s57, s57, 4096
  buffer_load_dwordx4 a[100:103], v132, s[52:55], s57 offen offset:0
  buffer_load_dwordx4 a[104:107], v132, s[52:55], s56 offen offset:1024
  buffer_load_dwordx4 a[108:111], v132, s[52:55], s57 offen offset:1024
  buffer_load_dwordx4 a[112:115], v132, s[52:55], s56 offen offset:2048
  buffer_load_dwordx4 a[116:119], v132, s[52:55], s57 offen offset:2048
  buffer_load_dwordx4 a[120:123], v132, s[52:55], s56 offen offset:3072
  buffer_load_dwordx4 a[124:127], v132, s[52:55], s57 offen offset:3072
  s_add_u32 s56, s56, 4096
  buffer_load_dwordx4 a[128:131], v132, s[52:55], s56 offen offset:0
  s_add_u32 s57, s57, 4096
  buffer_load_dwordx4 a[132:135], v132, s[52:55], s57 offen offset:0
  buffer_load_dwordx4 a[136:139], v132, s[52:55], s56 offen offset:1024
  buffer_load_dwordx4 a[140:143], v132, s[52:55], s57 offen offset:1024
  buffer_load_dwordx4 a[144:147], v132, s[52:55], s56 offen offset:2048
  buffer_load_dwordx4 a[148:151], v132, s[52:55], s57 offen offset:2048
  buffer_load_dwordx4 a[152:155], v132, s[52:55], s56 offen offset:3072
  buffer_load_dwordx4 a[156:159], v132, s[52:55], s57 offen offset:3072
  s_add_u32 s56, s56, 4096
  buffer_load_dwordx4 a[160:163], v132, s[52:55], s56 offen offset:0
  s_add_u32 s57, s57, 4096
  buffer_load_dwordx4 a[164:167], v132, s[52:55], s57 offen offset:0
  buffer_load_dwordx4 a[168:171], v132, s[52:55], s56 offen offset:1024
  buffer_load_dwordx4 a[172:175], v132, s[52:55], s57 offen offset:1024
  buffer_load_dwordx4 a[176:179], v132, s[52:55], s56 offen offset:2048
  buffer_load_dwordx4 a[180:183], v132, s[52:55], s57 offen offset:2048
  buffer_load_dwordx4 a[184:187], v132, s[52:55], s56 offen offset:3072
  buffer_load_dwordx4 a[188:191], v132, s[52:55], s57 offen offset:3072
  s_add_u32 s56, s56, 4096
  buffer_load_dwordx4 a[192:195], v132, s[52:55], s56 offen offset:0
  s_add_u32 s57, s57, 4096
  buffer_load_dwordx4 a[196:199], v132, s[52:55], s57 offen offset:0
  buffer_load_dwordx4 a[200:203], v132, s[52:55], s56 offen offset:1024
  buffer_load_dwordx4 a[204:207], v132, s[52:55], s57 offen offset:1024
  buffer_load_dwordx4 a[208:211], v132, s[52:55], s56 offen offset:2048
  buffer_load_dwordx4 a[212:215], v132, s[52:55], s57 offen offset:2048
  buffer_load_dwordx4 a[216:219], v132, s[52:55], s56 offen offset:3072
  buffer_load_dwordx4 a[220:223], v132, s[52:55], s57 offen offset:3072
p2_27:
  v_and_b32 v4, 63, v0
  v_lshlrev_b32 v5, 4, v4
  v_and_b32 v6, 31, v4
  v_lshrrev_b32 v7, 5, v4
  s_add_u32 s12, s4, 0x1000000
  s_addc_u32 s13, s5, 0
  s_mov_b32 s14, 0x700000
  s_mov_b32 s15, 0x20000
  s_mul_i32 s24, s3, 28672
  s_mul_i32 s28, s63, 229376
  s_add_u32 s28, s28, s24
  s_add_u32 s29, s28, 114688
  s_lshr_b32 s30, s3, 1
  s_and_b32 s31, s3, 1
  s_lshl_b32 s32, s62, 1
  s_add_u32 s32, s32, s30
  s_lshl_b32 s33, s63, 1
  s_add_u32 s33, s33, s31
  s_add_u32 s8, s4, 0x1c00000
  s_addc_u32 s9, s5, 0
  s_mov_b32 s10, 0x200000
  s_mov_b32 s11, 0x20000
  s_mov_b32 s36, s6
  s_mov_b32 s37, s7
  s_mov_b32 s38, 0x200000
  s_mov_b32 s39, 0x20000
  s_lshl_b32 s34, s32, 17
  s_lshl_b32 s35, s33, 11
  s_add_u32 s34, s34, s35
  s_cmp_lg_u32 s3, 0
  s_cbranch_scc1 pskip34
  s_mov_b64 exec, 1
  v_mov_b32 v2, s47
  s_mov_b32 s45, 0x4000
  buffer_load_dword v244, v2, s[40:43], 0 offen sc1
  buffer_load_dword v245, v2, s[40:43], 0 offen sc1
poll32:
  buffer_load_dword v246, v2, s[40:43], 0 offen sc1
  s_waitcnt vmcnt(2)
  v_readfirstlane_b32 s46, v244
  s_nop 1
  s_cmp_ge_u32 s46, 16
  s_cbranch_scc1 pdone33
  buffer_load_dword v244, v2, s[40:43], 0 offen sc1
  s_waitcnt vmcnt(2)
  v_readfirstlane_b32 s46, v245
  s_nop 1
  s_cmp_ge_u32 s46, 16
  s_cbranch_scc1 pdone33
  buffer_load_dword v245, v2, s[40:43], 0 offen sc1
  s_waitcnt vmcnt(2)
  v_readfirstlane_b32 s46, v246
  s_nop 1
  s_cmp_ge_u32 s46, 16
  s_cbranch_scc1 pdone33
  s_sub_u32 s45, s45, 1
  s_cbranch_scc0 poll32
pdone33:
  s_mov_b64 exec, -1
pskip34:
  s_barrier
  buffer_load_dwordx4 v[84:87], v5, s[12:15], s28 offen offset:0 sc1
  buffer_load_dwordx4 v[88:91], v5, s[12:15], s29 offen offset:0 sc1
  buffer_load_dwordx4 v[92:95], v5, s[12:15], s28 offen offset:1024 sc1
  buffer_load_dwordx4 v[96:99], v5, s[12:15], s29 offen offset:1024 sc1
  buffer_load_dwordx4 v[100:103], v5, s[12:15], s28 offen offset:2048 sc1
  buffer_load_dwordx4 v[104:107], v5, s[12:15], s29 offen offset:2048 sc1
  buffer_load_dwordx4 v[108:111], v5, s[12:15], s28 offen offset:3072 sc1
  buffer_load_dwordx4 v[112:115], v5, s[12:15], s29 offen offset:3072 sc1
  s_add_u32 s28, s28, 4096
  buffer_load_dwordx4 v[116:119], v5, s[12:15], s28 offen offset:0 sc1
  s_add_u32 s29, s29, 4096
  buffer_load_dwordx4 v[120:123], v5, s[12:15], s29 offen offset:0 sc1
  buffer_load_dwordx4 v[124:127], v5, s[12:15], s28 offen offset:1024 sc1
  buffer_load_dwordx4 v[128:131], v5, s[12:15], s29 offen offset:1024 sc1
  buffer_load_dwordx4 v[132:135], v5, s[12:15], s28 offen offset:2048 sc1
  buffer_load_dwordx4 v[136:139], v5, s[12:15], s29 offen offset:2048 sc1
  buffer_load_dwordx4 v[140:143], v5, s[12:15], s28 offen offset:3072 sc1
  buffer_load_dwordx4 v[144:147], v5, s[12:15], s29 offen offset:3072 sc1
  s_add_u32 s28, s28, 4096
  buffer_load_dwordx4 v[148:151], v5, s[12:15], s28 offen offset:0 sc1
  s_add_u32 s29, s29, 4096
  buffer_load_dwordx4 v[152:155], v5, s[12:15], s29 offen offset:0 sc1
  buffer_load_dwordx4 v[156:159], v5, s[12:15], s28 offen offset:1024 sc1
  buffer_load_dwordx4 v[160:163], v5, s[12:15], s29 offen offset:1024 sc1
  buffer_load_dwordx4 v[164:167], v5, s[12:15], s28 offen offset:2048 sc1
  buffer_load_dwordx4 v[168:171], v5, s[12:15], s29 offen offset:2048 sc1
  buffer_load_dwordx4 v[172:175], v5, s[12:15], s28 offen offset:3072 sc1
  buffer_load_dwordx4 v[176:179], v5, s[12:15], s29 offen offset:3072 sc1
  s_add_u32 s28, s28, 4096
  buffer_load_dwordx4 v[180:183], v5, s[12:15], s28 offen offset:0 sc1
  s_add_u32 s29, s29, 4096
  buffer_load_dwordx4 v[184:187], v5, s[12:15], s29 offen offset:0 sc1
  buffer_load_dwordx4 v[188:191], v5, s[12:15], s28 offen offset:1024 sc1
  buffer_load_dwordx4 v[192:195], v5, s[12:15], s29 offen offset:1024 sc1
  buffer_load_dwordx4 v[196:199], v5, s[12:15], s28 offen offset:2048 sc1
  buffer_load_dwordx4 v[200:203], v5, s[12:15], s29 offen offset:2048 sc1
  buffer_load_dwordx4 v[204:207], v5, s[12:15], s28 offen offset:3072 sc1
  buffer_load_dwordx4 v[208:211], v5, s[12:15], s29 offen offset:3072 sc1
  s_add_u32 s28, s28, 4096
  buffer_load_dwordx4 v[212:215], v5, s[12:15], s28 offen offset:0 sc1
  s_add_u32 s29, s29, 4096
  buffer_load_dwordx4 v[216:219], v5, s[12:15], s29 offen offset:0 sc1
  buffer_load_dwordx4 v[220:223], v5, s[12:15], s28 offen offset:1024 sc1
  buffer_load_dwordx4 v[224:227], v5, s[12:15], s29 offen offset:1024 sc1
  buffer_load_dwordx4 v[228:231], v5, s[12:15], s28 offen offset:2048 sc1
  buffer_load_dwordx4 v[232:235], v5, s[12:15], s29 offen offset:2048 sc1
  buffer_load_dwordx4 v[236:239], v5, s[12:15], s28 offen offset:3072 sc1
  buffer_load_dwordx4 v[240:243], v5, s[12:15], s29 offen offset:3072 sc1
  s_waitcnt vmcnt(39)
  v_mfma_f32_32x32x16_bf16 v[12:27], a[0:3], v[84:87], 0
  s_waitcnt vmcnt(38)
  v_mfma_f32_32x32x16_bf16 v[28:43], a[0:3], v[88:91], 0
  v_mfma_f32_32x32x16_bf16 v[44:59], a[4:7], v[84:87], 0
  v_mfma_f32_32x32x16_bf16 v[60:75], a[4:7], v[88:91], 0
  s_waitcnt vmcnt(37)
  v_mfma_f32_32x32x16_bf16 v[12:27], a[8:11], v[92:95], v[12:27]
  s_add_u32 s28, s28, 4096
  buffer_load_dwordx4 v[84:87], v5, s[12:15], s28 offen offset:0 sc1
  s_waitcnt vmcnt(37)
  v_mfma_f32_32x32x16_bf16 v[28:43], a[8:11], v[96:99], v[28:43]
  v_mfma_f32_32x32x16_bf16 v[44:59], a[12:15], v[92:95], v[44:59]
  s_add_u32 s29, s29, 4096
  buffer_load_dwordx4 v[88:91], v5, s[12:15], s29 offen offset:0 sc1
  v_mfma_f32_32x32x16_bf16 v[60:75], a[12:15], v[96:99], v[60:75]
  s_waitcnt vmcnt(37)
  v_mfma_f32_32x32x16_bf16 v[12:27], a[16:19], v[100:103], v[12:27]
  buffer_load_dwordx4 v[92:95], v5, s[12:15], s28 offen offset:1024 sc1
  s_waitcnt vmcnt(37)
  v_mfma_f32_32x32x16_bf16 v[28:43], a[16:19], v[104:107], v[28:43]
  v_mfma_f32_32x32x16_bf16 v[44:59], a[20:23], v[100:103], v[44:59]
  buffer_load_dwordx4 v[96:99], v5, s[12:15], s29 offen offset:1024 sc1
  v_mfma_f32_32x32x16_bf16 v[60:75], a[20:23], v[104:107], v[60:75]
  s_waitcnt vmcnt(37)
  v_mfma_f32_32x32x16_bf16 v[12:27], a[24:27], v[108:111], v[12:27]
  buffer_load_dwordx4 v[100:103], v5, s[12:15], s28 offen offset:2048 sc1
  s_waitcnt vmcnt(37)
  v_mfma_f32_32x32x16_bf16 v[28:43], a[24:27], v[112:115], v[28:43]
  v_mfma_f32_32x32x16_bf16 v[44:59], a[28:31], v[108:111], v[44:59]
  buffer_load_dwordx4 v[104:107], v5, s[12:15], s29 offen offset:2048 sc1
  v_mfma_f32_32x32x16_bf16 v[60:75], a[28:31], v[112:115], v[60:75]
  s_waitcnt vmcnt(37)
  v_mfma_f32_32x32x16_bf16 v[12:27], a[32:35], v[116:119], v[12:27]
  buffer_load_dwordx4 v[108:111], v5, s[12:15], s28 offen offset:3072 sc1
  s_waitcnt vmcnt(37)
  v_mfma_f32_32x32x16_bf16 v[28:43], a[32:35], v[120:123], v[28:43]
  v_mfma_f32_32x32x16_bf16 v[44:59], a[36:39], v[116:119], v[44:59]
  buffer_load_dwordx4 v[112:115], v5, s[12:15], s29 offen offset:3072 sc1
  v_mfma_f32_32x32x16_bf16 v[60:75], a[36:39], v[120:123], v[60:75]
  s_waitcnt vmcnt(37)
  v_mfma_f32_32x32x16_bf16 v[12:27], a[40:43], v[124:127], v[12:27]
  s_add_u32 s28, s28, 4096
  buffer_load_dwordx4 v[116:119], v5, s[12:15], s28 offen offset:0 sc1
  s_waitcnt vmcnt(37)
  v_mfma_f32_32x32x16_bf16 v[28:43], a[40:43], v[128:131], v[28:43]
  v_mfma_f32_32x32x16_bf16 v[44:59], a[44:47], v[124:127], v[44:59]
  s_add_u32 s29, s29, 4096
  buffer_load_dwordx4 v[120:123], v5, s[12:15], s29 offen offset:0 sc1
  v_mfma_f32_32x32x16_bf16 v[60:75], a[44:47], v[128:131], v[60:75]
  s_waitcnt vmcnt(37)
  v_mfma_f32_32x32x16_bf16 v[12:27], a[48:51], v[132:135], v[12:27]
  buffer_load_dwordx4 v[124:127], v5, s[12:15], s28 offen offset:1024 sc1
  s_waitcnt vmcnt(37)
  v_mfma_f32_32x32x16_bf16 v[28:43], a[48:51], v[136:139], v[28:43]
  v_mfma_f32_32x32x16_bf16 v[44:59], a[52:55], v[132:135], v[44:59]
  buffer_load_dwordx4 v[128:131], v5, s[12:15], s29 offen offset:1024 sc1
  v_mfma_f32_32x32x16_bf16 v[60:75], a[52:55], v[136:139], v[60:75]
  s_waitcnt vmcnt(37)
  v_mfma_f32_32x32x16_bf16 v[12:27], a[56:59], v[140:143], v[12:27]
  buffer_load_dwordx4 v[132:135], v5, s[12:15], s28 offen offset:2048 sc1
  s_waitcnt vmcnt(37)
  v_mfma_f32_32x32x16_bf16 v[28:43], a[56:59], v[144:147], v[28:43]
  v_mfma_f32_32x32x16_bf16 v[44:59], a[60:63], v[140:143], v[44:59]
  buffer_load_dwordx4 v[136:139], v5, s[12:15], s29 offen offset:2048 sc1
  v_mfma_f32_32x32x16_bf16 v[60:75], a[60:63], v[144:147], v[60:75]
  s_waitcnt vmcnt(37)
  v_mfma_f32_32x32x16_bf16 v[12:27], a[64:67], v[148:151], v[12:27]
  buffer_load_dwordx4 v[140:143], v5, s[12:15], s28 offen offset:3072 sc1
  s_waitcnt vmcnt(37)
  v_mfma_f32_32x32x16_bf16 v[28:43], a[64:67], v[152:155], v[28:43]
  v_mfma_f32_32x32x16_bf16 v[44:59], a[68:71], v[148:151], v[44:59]
  buffer_load_dwordx4 v[144:147], v5, s[12:15], s29 offen offset:3072 sc1
  v_mfma_f32_32x32x16_bf16 v[60:75], a[68:71], v[152:155], v[60:75]
  s_waitcnt vmcnt(37)
  v_mfma_f32_32x32x16_bf16 v[12:27], a[72:75], v[156:159], v[12:27]
  buffer_load_dwordx4 v[76:79], v5, s[8:11], s34 offen sc1
  buffer_load_dwordx4 v[80:83], v5, s[8:11], s34 offen offset:1024 sc1
  s_waitcnt vmcnt(38)
  v_mfma_f32_32x32x16_bf16 v[28:43], a[72:75], v[160:163], v[28:43]
  v_mfma_f32_32x32x16_bf16 v[44:59], a[76:79], v[156:159], v[44:59]
  v_mfma_f32_32x32x16_bf16 v[60:75], a[76:79], v[160:163], v[60:75]
  s_waitcnt vmcnt(37)
  v_mfma_f32_32x32x16_bf16 v[12:27], a[80:83], v[164:167], v[12:27]
  s_waitcnt vmcnt(36)
  v_mfma_f32_32x32x16_bf16 v[28:43], a[80:83], v[168:171], v[28:43]
  v_mfma_f32_32x32x16_bf16 v[44:59], a[84:87], v[164:167], v[44:59]
  v_mfma_f32_32x32x16_bf16 v[60:75], a[84:87], v[168:171], v[60:75]
  s_waitcnt vmcnt(35)
  v_mfma_f32_32x32x16_bf16 v[12:27], a[88:91], v[172:175], v[12:27]
  s_waitcnt vmcnt(34)
  v_mfma_f32_32x32x16_bf16 v[28:43], a[88:91], v[176:179], v[28:43]
  v_mfma_f32_32x32x16_bf16 v[44:59], a[92:95], v[172:175], v[44:59]
  v_mfma_f32_32x32x16_bf16 v[60:75], a[92:95], v[176:179], v[60:75]
  s_waitcnt vmcnt(33)
  v_mfma_f32_32x32x16_bf16 v[12:27], a[96:99], v[180:183], v[12:27]
  s_waitcnt vmcnt(32)
  v_mfma_f32_32x32x16_bf16 v[28:43], a[96:99], v[184:187], v[28:43]
  v_mfma_f32_32x32x16_bf16 v[44:59], a[100:103], v[180:183], v[44:59]
  v_mfma_f32_32x32x16_bf16 v[60:75], a[100:103], v[184:187], v[60:75]
  s_waitcnt vmcnt(31)
  v_mfma_f32_32x32x16_bf16 v[12:27], a[104:107], v[188:191], v[12:27]
  s_waitcnt vmcnt(30)
  v_mfma_f32_32x32x16_bf16 v[28:43], a[104:107], v[192:195], v[28:43]
  v_mfma_f32_32x32x16_bf16 v[44:59], a[108:111], v[188:191], v[44:59]
  v_mfma_f32_32x32x16_bf16 v[60:75], a[108:111], v[192:195], v[60:75]
  s_waitcnt vmcnt(29)
  v_mfma_f32_32x32x16_bf16 v[12:27], a[112:115], v[196:199], v[12:27]
  s_waitcnt vmcnt(28)
  v_mfma_f32_32x32x16_bf16 v[28:43], a[112:115], v[200:203], v[28:43]
  v_mfma_f32_32x32x16_bf16 v[44:59], a[116:119], v[196:199], v[44:59]
  v_mfma_f32_32x32x16_bf16 v[60:75], a[116:119], v[200:203], v[60:75]
  s_waitcnt vmcnt(27)
  v_mfma_f32_32x32x16_bf16 v[12:27], a[120:123], v[204:207], v[12:27]
  s_waitcnt vmcnt(26)
  v_mfma_f32_32x32x16_bf16 v[28:43], a[120:123], v[208:211], v[28:43]
  v_mfma_f32_32x32x16_bf16 v[44:59], a[124:127], v[204:207], v[44:59]
  v_mfma_f32_32x32x16_bf16 v[60:75], a[124:127], v[208:211], v[60:75]
  s_waitcnt vmcnt(25)
  v_mfma_f32_32x32x16_bf16 v[12:27], a[128:131], v[212:215], v[12:27]
  s_waitcnt vmcnt(24)
  v_mfma_f32_32x32x16_bf16 v[28:43], a[128:131], v[216:219], v[28:43]
  v_mfma_f32_32x32x16_bf16 v[44:59], a[132:135], v[212:215], v[44:59]
  v_mfma_f32_32x32x16_bf16 v[60:75], a[132:135], v[216:219], v[60:75]
  s_waitcnt vmcnt(23)
  v_mfma_f32_32x32x16_bf16 v[12:27], a[136:139], v[220:223], v[12:27]
  s_waitcnt vmcnt(22)
  v_mfma_f32_32x32x16_bf16 v[28:43], a[136:139], v[224:227], v[28:43]
  v_mfma_f32_32x32x16_bf16 v[44:59], a[140:143], v[220:223], v[44:59]
  v_mfma_f32_32x32x16_bf16 v[60:75], a[140:143], v[224:227], v[60:75]
  s_waitcnt vmcnt(21)
  v_mfma_f32_32x32x16_bf16 v[12:27], a[144:147], v[228:231], v[12:27]
  s_waitcnt vmcnt(20)
  v_mfma_f32_32x32x16_bf16 v[28:43], a[144:147], v[232:235], v[28:43]
  v_mfma_f32_32x32x16_bf16 v[44:59], a[148:151], v[228:231], v[44:59]
  v_mfma_f32_32x32x16_bf16 v[60:75], a[148:151], v[232:235], v[60:75]
  s_waitcnt vmcnt(19)
  v_mfma_f32_32x32x16_bf16 v[12:27], a[152:155], v[236:239], v[12:27]
  s_waitcnt vmcnt(18)
  v_mfma_f32_32x32x16_bf16 v[28:43], a[152:155], v[240:243], v[28:43]
  v_mfma_f32_32x32x16_bf16 v[44:59], a[156:159], v[236:239], v[44:59]
  v_mfma_f32_32x32x16_bf16 v[60:75], a[156:159], v[240:243], v[60:75]
  s_waitcnt vmcnt(17)
  v_mfma_f32_32x32x16_bf16 v[12:27], a[160:163], v[84:87], v[12:27]
  s_waitcnt vmcnt(16)
  v_mfma_f32_32x32x16_bf16 v[28:43], a[160:163], v[88:91], v[28:43]
  v_mfma_f32_32x32x16_bf16 v[44:59], a[164:167], v[84:87], v[44:59]
  v_mfma_f32_32x32x16_bf16 v[60:75], a[164:167], v[88:91], v[60:75]
  s_waitcnt vmcnt(15)
  v_mfma_f32_32x32x16_bf16 v[12:27], a[168:171], v[92:95], v[12:27]
  s_waitcnt vmcnt(14)
  v_mfma_f32_32x32x16_bf16 v[28:43], a[168:171], v[96:99], v[28:43]
  v_mfma_f32_32x32x16_bf16 v[44:59], a[172:175], v[92:95], v[44:59]
  v_mfma_f32_32x32x16_bf16 v[60:75], a[172:175], v[96:99], v[60:75]
  s_waitcnt vmcnt(13)
  v_mfma_f32_32x32x16_bf16 v[12:27], a[176:179], v[100:103], v[12:27]
  s_waitcnt vmcnt(12)
  v_mfma_f32_32x32x16_bf16 v[28:43], a[176:179], v[104:107], v[28:43]
  v_mfma_f32_32x32x16_bf16 v[44:59], a[180:183], v[100:103], v[44:59]
  v_mfma_f32_32x32x16_bf16 v[60:75], a[180:183], v[104:107], v[60:75]
  s_waitcnt vmcnt(11)
  v_mfma_f32_32x32x16_bf16 v[12:27], a[184:187], v[108:111], v[12:27]
  s_waitcnt vmcnt(10)
  v_mfma_f32_32x32x16_bf16 v[28:43], a[184:187], v[112:115], v[28:43]
  v_mfma_f32_32x32x16_bf16 v[44:59], a[188:191], v[108:111], v[44:59]
  v_mfma_f32_32x32x16_bf16 v[60:75], a[188:191], v[112:115], v[60:75]
  s_waitcnt vmcnt(9)
  v_mfma_f32_32x32x16_bf16 v[12:27], a[192:195], v[116:119], v[12:27]
  s_waitcnt vmcnt(8)
  v_mfma_f32_32x32x16_bf16 v[28:43], a[192:195], v[120:123], v[28:43]
  v_mfma_f32_32x32x16_bf16 v[44:59], a[196:199], v[116:119], v[44:59]
  v_mfma_f32_32x32x16_bf16 v[60:75], a[196:199], v[120:123], v[60:75]
  s_waitcnt vmcnt(7)
  v_mfma_f32_32x32x16_bf16 v[12:27], a[200:203], v[124:127], v[12:27]
  s_waitcnt vmcnt(6)
  v_mfma_f32_32x32x16_bf16 v[28:43], a[200:203], v[128:131], v[28:43]
  v_mfma_f32_32x32x16_bf16 v[44:59], a[204:207], v[124:127], v[44:59]
  v_mfma_f32_32x32x16_bf16 v[60:75], a[204:207], v[128:131], v[60:75]
  s_waitcnt vmcnt(5)
  v_mfma_f32_32x32x16_bf16 v[12:27], a[208:211], v[132:135], v[12:27]
  s_waitcnt vmcnt(4)
  v_mfma_f32_32x32x16_bf16 v[28:43], a[208:211], v[136:139], v[28:43]
  v_mfma_f32_32x32x16_bf16 v[44:59], a[212:215], v[132:135], v[44:59]
  v_mfma_f32_32x32x16_bf16 v[60:75], a[212:215], v[136:139], v[60:75]
  s_waitcnt vmcnt(3)
  v_mfma_f32_32x32x16_bf16 v[12:27], a[216:219], v[140:143], v[12:27]
  s_waitcnt vmcnt(2)
  v_mfma_f32_32x32x16_bf16 v[28:43], a[216:219], v[144:147], v[28:43]
  v_mfma_f32_32x32x16_bf16 v[44:59], a[220:223], v[140:143], v[44:59]
  v_mfma_f32_32x32x16_bf16 v[60:75], a[220:223], v[144:147], v[60:75]
  s_cmp_lg_u32 s3, 0
  s_cbranch_scc1 rq36
  s_nop 7
  ds_write_b128 v5, v[28:31] offset:20480
  ds_write_b128 v5, v[32:35] offset:21504
  ds_write_b128 v5, v[36:39] offset:22528
  ds_write_b128 v5, v[40:43] offset:23552
  ds_write_b128 v5, v[44:47] offset:28672
  ds_write_b128 v5, v[48:51] offset:29696
  ds_write_b128 v5, v[52:55] offset:30720
  ds_write_b128 v5, v[56:59] offset:31744
  ds_write_b128 v5, v[60:63] offset:36864
  ds_write_b128 v5, v[64:67] offset:37888
  ds_write_b128 v5, v[68:71] offset:38912
  ds_write_b128 v5, v[72:75] offset:39936
  s_waitcnt lgkmcnt(0)
  s_barrier
  ds_read_b128 v[84:87], v5 offset:0
  ds_read_b128 v[88:91], v5 offset:1024
  ds_read_b128 v[92:95], v5 offset:2048
  ds_read_b128 v[96:99], v5 offset:3072
  ds_read_b128 v[100:103], v5 offset:4096
  ds_read_b128 v[104:107], v5 offset:5120
  ds_read_b128 v[108:111], v5 offset:6144
  ds_read_b128 v[112:115], v5 offset:7168
  ds_read_b128 v[116:119], v5 offset:8192
  ds_read_b128 v[120:123], v5 offset:9216
  ds_read_b128 v[124:127], v5 offset:10240
  ds_read_b128 v[128:131], v5 offset:11264
  s_waitcnt lgkmcnt(11)
  v_add_f32 v132, v12, v84
  v_add_f32 v133, v13, v85
  v_add_f32 v134, v14, v86
  v_add_f32 v135, v15, v87
  s_waitcnt lgkmcnt(10)
  v_add_f32 v136, v16, v88
  v_add_f32 v137, v17, v89
  v_add_f32 v138, v18, v90
  v_add_f32 v139, v19, v91
  s_waitcnt lgkmcnt(9)
  v_add_f32 v140, v20, v92
  v_add_f32 v141, v21, v93
  v_add_f32 v142, v22, v94
  v_add_f32 v143, v23, v95
  s_waitcnt lgkmcnt(8)
  v_add_f32 v144, v24, v96
  v_add_f32 v145, v25, v97
  v_add_f32 v146, v26, v98
  v_add_f32 v147, v27, v99
  s_waitcnt lgkmcnt(3)
  v_add_f32 v100, v100, v116
  v_add_f32 v101, v101, v117
  v_add_f32 v102, v102, v118
  v_add_f32 v103, v103, v119
  s_waitcnt lgkmcnt(2)
  v_add_f32 v104, v104, v120
  v_add_f32 v105, v105, v121
  v_add_f32 v106, v106, v122
  v_add_f32 v107, v107, v123
  s_waitcnt lgkmcnt(1)
  v_add_f32 v108, v108, v124
  v_add_f32 v109, v109, v125
  v_add_f32 v110, v110, v126
  v_add_f32 v111, v111, v127
  s_waitcnt lgkmcnt(0)
  v_add_f32 v112, v112, v128
  v_add_f32 v113, v113, v129
  v_add_f32 v114, v114, v130
  v_add_f32 v115, v115, v131
  v_add_f32 v132, v132, v100
  v_add_f32 v133, v133, v101
  v_add_f32 v134, v134, v102
  v_add_f32 v135, v135, v103
  v_add_f32 v136, v136, v104
  v_add_f32 v137, v137, v105
  v_add_f32 v138, v138, v106
  v_add_f32 v139, v139, v107
  v_add_f32 v140, v140, v108
  v_add_f32 v141, v141, v109
  v_add_f32 v142, v142, v110
  v_add_f32 v143, v143, v111
  v_add_f32 v144, v144, v112
  v_add_f32 v145, v145, v113
  v_add_f32 v146, v146, v114
  v_add_f32 v147, v147, v115
  s_branch rd39
rq36:
  s_cmp_lg_u32 s3, 1
  s_cbranch_scc1 rq37
  s_nop 6
  ds_write_b128 v5, v[44:47] offset:32768
  ds_write_b128 v5, v[48:51] offset:33792
  ds_write_b128 v5, v[52:55] offset:34816
  ds_write_b128 v5, v[56:59] offset:35840
  ds_write_b128 v5, v[60:63] offset:40960
  ds_write_b128 v5, v[64:67] offset:41984
  ds_write_b128 v5, v[68:71] offset:43008
  ds_write_b128 v5, v[72:75] offset:44032
  ds_write_b128 v5, v[12:15] offset:0
  ds_write_b128 v5, v[16:19] offset:1024
  ds_write_b128 v5, v[20:23] offset:2048
  ds_write_b128 v5, v[24:27] offset:3072
  s_waitcnt lgkmcnt(0)
  s_barrier
  ds_read_b128 v[84:87], v5 offset:12288
  ds_read_b128 v[88:91], v5 offset:13312
  ds_read_b128 v[92:95], v5 offset:14336
  ds_read_b128 v[96:99], v5 offset:15360
  ds_read_b128 v[100:103], v5 offset:16384
  ds_read_b128 v[104:107], v5 offset:17408
  ds_read_b128 v[108:111], v5 offset:18432
  ds_read_b128 v[112:115], v5 offset:19456
  ds_read_b128 v[116:119], v5 offset:20480
  ds_read_b128 v[120:123], v5 offset:21504
  ds_read_b128 v[124:127], v5 offset:22528
  ds_read_b128 v[128:131], v5 offset:23552
  s_waitcnt lgkmcnt(11)
  v_add_f32 v132, v28, v84
  v_add_f32 v133, v29, v85
  v_add_f32 v134, v30, v86
  v_add_f32 v135, v31, v87
  s_waitcnt lgkmcnt(10)
  v_add_f32 v136, v32, v88
  v_add_f32 v137, v33, v89
  v_add_f32 v138, v34, v90
  v_add_f32 v139, v35, v91
  s_waitcnt lgkmcnt(9)
  v_add_f32 v140, v36, v92
  v_add_f32 v141, v37, v93
  v_add_f32 v142, v38, v94
  v_add_f32 v143, v39, v95
  s_waitcnt lgkmcnt(8)
  v_add_f32 v144, v40, v96
  v_add_f32 v145, v41, v97
  v_add_f32 v146, v42, v98
  v_add_f32 v147, v43, v99
  s_waitcnt lgkmcnt(3)
  v_add_f32 v100, v100, v116
  v_add_f32 v101, v101, v117
  v_add_f32 v102, v102, v118
  v_add_f32 v103, v103, v119
  s_waitcnt lgkmcnt(2)
  v_add_f32 v104, v104, v120
  v_add_f32 v105, v105, v121
  v_add_f32 v106, v106, v122
  v_add_f32 v107, v107, v123
  s_waitcnt lgkmcnt(1)
  v_add_f32 v108, v108, v124
  v_add_f32 v109, v109, v125
  v_add_f32 v110, v110, v126
  v_add_f32 v111, v111, v127
  s_waitcnt lgkmcnt(0)
  v_add_f32 v112, v112, v128
  v_add_f32 v113, v113, v129
  v_add_f32 v114, v114, v130
  v_add_f32 v115, v115, v131
  v_add_f32 v132, v132, v100
  v_add_f32 v133, v133, v101
  v_add_f32 v134, v134, v102
  v_add_f32 v135, v135, v103
  v_add_f32 v136, v136, v104
  v_add_f32 v137, v137, v105
  v_add_f32 v138, v138, v106
  v_add_f32 v139, v139, v107
  v_add_f32 v140, v140, v108
  v_add_f32 v141, v141, v109
  v_add_f32 v142, v142, v110
  v_add_f32 v143, v143, v111
  v_add_f32 v144, v144, v112
  v_add_f32 v145, v145, v113
  v_add_f32 v146, v146, v114
  v_add_f32 v147, v147, v115
  s_branch rd39
rq37:
  s_cmp_lg_u32 s3, 2
  s_cbranch_scc1 rq38
  s_nop 5
  ds_write_b128 v5, v[60:63] offset:45056
  ds_write_b128 v5, v[64:67] offset:46080
  ds_write_b128 v5, v[68:71] offset:47104
  ds_write_b128 v5, v[72:75] offset:48128
  ds_write_b128 v5, v[12:15] offset:4096
  ds_write_b128 v5, v[16:19] offset:5120
  ds_write_b128 v5, v[20:23] offset:6144
  ds_write_b128 v5, v[24:27] offset:7168
  ds_write_b128 v5, v[28:31] offset:12288
  ds_write_b128 v5, v[32:35] offset:13312
  ds_write_b128 v5, v[36:39] offset:14336
  ds_write_b128 v5, v[40:43] offset:15360
  s_waitcnt lgkmcnt(0)
  s_barrier
  ds_read_b128 v[84:87], v5 offset:24576
  ds_read_b128 v[88:91], v5 offset:25600
  ds_read_b128 v[92:95], v5 offset:26624
  ds_read_b128 v[96:99], v5 offset:27648
  ds_read_b128 v[100:103], v5 offset:28672
  ds_read_b128 v[104:107], v5 offset:29696
  ds_read_b128 v[108:111], v5 offset:30720
  ds_read_b128 v[112:115], v5 offset:31744
  ds_read_b128 v[116:119], v5 offset:32768
  ds_read_b128 v[120:123], v5 offset:33792
  ds_read_b128 v[124:127], v5 offset:34816
  ds_read_b128 v[128:131], v5 offset:35840
  s_waitcnt lgkmcnt(11)
  v_add_f32 v132, v44, v84
  v_add_f32 v133, v45, v85
  v_add_f32 v134, v46, v86
  v_add_f32 v135, v47, v87
  s_waitcnt lgkmcnt(10)
  v_add_f32 v136, v48, v88
  v_add_f32 v137, v49, v89
  v_add_f32 v138, v50, v90
  v_add_f32 v139, v51, v91
  s_waitcnt lgkmcnt(9)
  v_add_f32 v140, v52, v92
  v_add_f32 v141, v53, v93
  v_add_f32 v142, v54, v94
  v_add_f32 v143, v55, v95
  s_waitcnt lgkmcnt(8)
  v_add_f32 v144, v56, v96
  v_add_f32 v145, v57, v97
  v_add_f32 v146, v58, v98
  v_add_f32 v147, v59, v99
  s_waitcnt lgkmcnt(3)
  v_add_f32 v100, v100, v116
  v_add_f32 v101, v101, v117
  v_add_f32 v102, v102, v118
  v_add_f32 v103, v103, v119
  s_waitcnt lgkmcnt(2)
  v_add_f32 v104, v104, v120
  v_add_f32 v105, v105, v121
  v_add_f32 v106, v106, v122
  v_add_f32 v107, v107, v123
  s_waitcnt lgkmcnt(1)
  v_add_f32 v108, v108, v124
  v_add_f32 v109, v109, v125
  v_add_f32 v110, v110, v126
  v_add_f32 v111, v111, v127
  s_waitcnt lgkmcnt(0)
  v_add_f32 v112, v112, v128
  v_add_f32 v113, v113, v129
  v_add_f32 v114, v114, v130
  v_add_f32 v115, v115, v131
  v_add_f32 v132, v132, v100
  v_add_f32 v133, v133, v101
  v_add_f32 v134, v134, v102
  v_add_f32 v135, v135, v103
  v_add_f32 v136, v136, v104
  v_add_f32 v137, v137, v105
  v_add_f32 v138, v138, v106
  v_add_f32 v139, v139, v107
  v_add_f32 v140, v140, v108
  v_add_f32 v141, v141, v109
  v_add_f32 v142, v142, v110
  v_add_f32 v143, v143, v111
  v_add_f32 v144, v144, v112
  v_add_f32 v145, v145, v113
  v_add_f32 v146, v146, v114
  v_add_f32 v147, v147, v115
  s_branch rd39
rq38:
  s_nop 1
  ds_write_b128 v5, v[12:15] offset:8192
  ds_write_b128 v5, v[16:19] offset:9216
  ds_write_b128 v5, v[20:23] offset:10240
  ds_write_b128 v5, v[24:27] offset:11264
  ds_write_b128 v5, v[28:31] offset:16384
  ds_write_b128 v5, v[32:35] offset:17408
  ds_write_b128 v5, v[36:39] offset:18432
  ds_write_b128 v5, v[40:43] offset:19456
  ds_write_b128 v5, v[44:47] offset:24576
  ds_write_b128 v5, v[48:51] offset:25600
  ds_write_b128 v5, v[52:55] offset:26624
  ds_write_b128 v5, v[56:59] offset:27648
  s_waitcnt lgkmcnt(0)
  s_barrier
  ds_read_b128 v[84:87], v5 offset:36864
  ds_read_b128 v[88:91], v5 offset:37888
  ds_read_b128 v[92:95], v5 offset:38912
  ds_read_b128 v[96:99], v5 offset:39936
  ds_read_b128 v[100:103], v5 offset:40960
  ds_read_b128 v[104:107], v5 offset:41984
  ds_read_b128 v[108:111], v5 offset:43008
  ds_read_b128 v[112:115], v5 offset:44032
  ds_read_b128 v[116:119], v5 offset:45056
  ds_read_b128 v[120:123], v5 offset:46080
  ds_read_b128 v[124:127], v5 offset:47104
  ds_read_b128 v[128:131], v5 offset:48128
  s_waitcnt lgkmcnt(11)
  v_add_f32 v132, v60, v84
  v_add_f32 v133, v61, v85
  v_add_f32 v134, v62, v86
  v_add_f32 v135, v63, v87
  s_waitcnt lgkmcnt(10)
  v_add_f32 v136, v64, v88
  v_add_f32 v137, v65, v89
  v_add_f32 v138, v66, v90
  v_add_f32 v139, v67, v91
  s_waitcnt lgkmcnt(9)
  v_add_f32 v140, v68, v92
  v_add_f32 v141, v69, v93
  v_add_f32 v142, v70, v94
  v_add_f32 v143, v71, v95
  s_waitcnt lgkmcnt(8)
  v_add_f32 v144, v72, v96
  v_add_f32 v145, v73, v97
  v_add_f32 v146, v74, v98
  v_add_f32 v147, v75, v99
  s_waitcnt lgkmcnt(3)
  v_add_f32 v100, v100, v116
  v_add_f32 v101, v101, v117
  v_add_f32 v102, v102, v118
  v_add_f32 v103, v103, v119
  s_waitcnt lgkmcnt(2)
  v_add_f32 v104, v104, v120
  v_add_f32 v105, v105, v121
  v_add_f32 v106, v106, v122
  v_add_f32 v107, v107, v123
  s_waitcnt lgkmcnt(1)
  v_add_f32 v108, v108, v124
  v_add_f32 v109, v109, v125
  v_add_f32 v110, v110, v126
  v_add_f32 v111, v111, v127
  s_waitcnt lgkmcnt(0)
  v_add_f32 v112, v112, v128
  v_add_f32 v113, v113, v129
  v_add_f32 v114, v114, v130
  v_add_f32 v115, v115, v131
  v_add_f32 v132, v132, v100
  v_add_f32 v133, v133, v101
  v_add_f32 v134, v134, v102
  v_add_f32 v135, v135, v103
  v_add_f32 v136, v136, v104
  v_add_f32 v137, v137, v105
  v_add_f32 v138, v138, v106
  v_add_f32 v139, v139, v107
  v_add_f32 v140, v140, v108
  v_add_f32 v141, v141, v109
  v_add_f32 v142, v142, v110
  v_add_f32 v143, v143, v111
  v_add_f32 v144, v144, v112
  v_add_f32 v145, v145, v113
  v_add_f32 v146, v146, v114
  v_add_f32 v147, v147, v115
rd39:
  s_waitcnt vmcnt(1)
  v_lshlrev_b32 v148, 16, v76
  v_and_b32 v149, 0xffff0000, v76
  v_lshlrev_b32 v150, 16, v77
  v_and_b32 v151, 0xffff0000, v77
  v_lshlrev_b32 v152, 16, v78
  v_and_b32 v153, 0xffff0000, v78
  v_lshlrev_b32 v154, 16, v79
  v_and_b32 v155, 0xffff0000, v79
  s_waitcnt vmcnt(0)
  v_lshlrev_b32 v156, 16, v80
  v_and_b32 v157, 0xffff0000, v80
  v_lshlrev_b32 v158, 16, v81
  v_and_b32 v159, 0xffff0000, v81
  v_lshlrev_b32 v160, 16, v82
  v_and_b32 v161, 0xffff0000, v82
  v_lshlrev_b32 v162, 16, v83
  v_and_b32 v163, 0xffff0000, v83
  v_add_f32 v132, v132, v148
  v_add_f32 v133, v133, v149
  v_add_f32 v134, v134, v150
  v_add_f32 v135, v135, v151
  v_add_f32 v136, v136, v152
  v_add_f32 v137, v137, v153
  v_add_f32 v138, v138, v154
  v_add_f32 v139, v139, v155
  v_add_f32 v140, v140, v156
  v_add_f32 v141, v141, v157
  v_add_f32 v142, v142, v158
  v_add_f32 v143, v143, v159
  v_add_f32 v144, v144, v160
  v_add_f32 v145, v145, v161
  v_add_f32 v146, v146, v162
  v_add_f32 v147, v147, v163
  v_cvt_pk_bf16_f32 v212, v132, v133
  v_cvt_pk_bf16_f32 v213, v134, v135
  v_cvt_pk_bf16_f32 v214, v136, v137
  v_cvt_pk_bf16_f32 v215, v138, v139
  v_cvt_pk_bf16_f32 v216, v140, v141
  v_cvt_pk_bf16_f32 v217, v142, v143
  v_cvt_pk_bf16_f32 v218, v144, v145
  v_cvt_pk_bf16_f32 v219, v146, v147
  v_permlane32_swap_b32 v212, v214
  v_permlane32_swap_b32 v213, v215
  v_permlane32_swap_b32 v216, v218
  v_permlane32_swap_b32 v217, v219
  v_lshlrev_b32 v8, 10, v6
  v_lshl_or_b32 v8, v7, 4, v8
  s_lshl_b32 s34, s33, 15
  s_lshl_b32 s35, s32, 6
  s_add_u32 s34, s34, s35
  buffer_store_dwordx4 v[212:215], v8, s[36:39], s34 offen
  buffer_store_dwordx4 v[216:219], v8, s[36:39], s34 offen offset:32
  s_endpgm
ge25:
  s_endpgm
.section .rodata,"a"
.p2align 6
.amdhsa_kernel q5_kernel
  .amdhsa_next_free_vgpr 504
  .amdhsa_next_free_sgpr 102
  .amdhsa_accum_offset 248
  .amdhsa_group_segment_fixed_size 0
  .amdhsa_kernarg_size 80
  .amdhsa_user_sgpr_count 2
  .amdhsa_user_sgpr_kernarg_segment_ptr 1
  .amdhsa_system_sgpr_workgroup_id_x 1
.end_amdhsa_kernel
.text
text_end:
.section .rodata,"a"
.set T0,15744
.set T1,15744
.set T2,15744
.set T3,15744
.set T4,15744
.set T5,15744
.set T6,15743
.set T7,15743
.set T8,15743
.set T9,15742
.set T10,15742
.set T11,15742
.set T12,15741
.set T13,15741
.set T14,15740
.set T15,15740
.set T16,15739
.set T17,15738
.set T18,15738
.set T19,15737
.set T20,15736
.set T21,15736
.set T22,15735
.set T23,15734
.set T24,15733
.set T25,15732
.set T26,15731
.set T27,15730
.set T28,15729
.set T29,15728
.set T30,15727
.set T31,15726
.set T32,15725
.set T33,15723
.set T34,15722
.set T35,15721
.set T36,15719
.set T37,15718
.set T38,15717
.set T39,15715
.set T40,15714
.set T41,15712
.set T42,15711
.set T43,15709
.set T44,15708
.set T45,15706
.set T46,15704
.set T47,15703
.set T48,15701
.set T49,15699
.set T50,15697
.set T51,15695
.set T52,15694
.set T53,15692
.set T54,15690
.set T55,15688
.set T56,15686
.set T57,15684
.set T58,15682
.set T59,15680
.set T60,15678
.set T61,15676
.set T62,15673
.set T63,15671
.set T64,15669
.set T65,15667
.set T66,15665
.set T67,15662
.set T68,15660
.set T69,15658
.set T70,15655
.set T71,15653
.set T72,15650
.set T73,15648
.set T74,15645
.set T75,15643
.set T76,15640
.set T77,15638
.set T78,15635
.set T79,15633
.set T80,15630
.set T81,15628
.set T82,15625
.set T83,15622
.set T84,15620
.set T85,15617
.set T86,15612
.set T87,15607
.set T88,15601
.set T89,15596
.set T90,15590
.set T91,15585
.set T92,15579
.set T93,15573
.set T94,15567
.set T95,15562
.set T96,15556
.set T97,15550
.set T98,15544
.set T99,15538
.set T100,15532
.set T101,15527
.set T102,15521
.set T103,15515
.set T104,15509
.set T105,15503
.set T106,15497
.set T107,15490
.set T108,15481
.set T109,15469
.set T110,15456
.set T111,15444
.set T112,15432
.set T113,15419
.set T114,15407
.set T115,15395
.set T116,15382
.set T117,15370
.set T118,15355
.set T119,15330
.set T120,15305
.set T121,15280
.set T122,15255
.set T123,15227
.set T124,15177
.set T125,15127
.set T126,15049
.set T127,14921
.set T128,0
.set T129,47689
.set T130,47817
.set T131,47895
.set T132,47945
.set T133,47995
.set T134,48023
.set T135,48048
.set T136,48073
.set T137,48098
.set T138,48123
.set T139,48138
.set T140,48150
.set T141,48163
.set T142,48175
.set T143,48187
.set T144,48200
.set T145,48212
.set T146,48224
.set T147,48237
.set T148,48249
.set T149,48258
.set T150,48265
.set T151,48271
.set T152,48277
.set T153,48283
.set T154,48289
.set T155,48295
.set T156,48300
.set T157,48306
.set T158,48312
.set T159,48318
.set T160,48324
.set T161,48330
.set T162,48335
.set T163,48341
.set T164,48347
.set T165,48353
.set T166,48358
.set T167,48364
.set T168,48369
.set T169,48375
.set T170,48380
.set T171,48385
.set T172,48388
.set T173,48390
.set T174,48393
.set T175,48396
.set T176,48398
.set T177,48401
.set T178,48403
.set T179,48406
.set T180,48408
.set T181,48411
.set T182,48413
.set T183,48416
.set T184,48418
.set T185,48421
.set T186,48423
.set T187,48426
.set T188,48428
.set T189,48430
.set T190,48433
.set T191,48435
.set T192,48437
.set T193,48439
.set T194,48441
.set T195,48444
.set T196,48446
.set T197,48448
.set T198,48450
.set T199,48452
.set T200,48454
.set T201,48456
.set T202,48458
.set T203,48460
.set T204,48462
.set T205,48463
.set T206,48465
.set T207,48467
.set T208,48469
.set T209,48471
.set T210,48472
.set T211,48474
.set T212,48476
.set T213,48477
.set T214,48479
.set T215,48480
.set T216,48482
.set T217,48483
.set T218,48485
.set T219,48486
.set T220,48487
.set T221,48489
.set T222,48490
.set T223,48491
.set T224,48493
.set T225,48494
.set T226,48495
.set T227,48496
.set T228,48497
.set T229,48498
.set T230,48499
.set T231,48500
.set T232,48501
.set T233,48502
.set T234,48503
.set T235,48504
.set T236,48504
.set T237,48505
.set T238,48506
.set T239,48506
.set T240,48507
.set T241,48508
.set T242,48508
.set T243,48509
.set T244,48509
.set T245,48510
.set T246,48510
.set T247,48510
.set T248,48511
.set T249,48511
.set T250,48511
.set T251,48512
.set T252,48512
.set T253,48512
.set T254,48512
.set T255,48512
.set T256,48512
.set T257,48512
.set T258,48512
.set T259,48512
.set T260,48512
.set T261,48512
.set T262,48511
.set T263,48511
.set T264,48511
.set T265,48510
.set T266,48510
.set T267,48510
.set T268,48509
.set T269,48509
.set T270,48508
.set T271,48508
.set T272,48507
.set T273,48506
.set T274,48506
.set T275,48505
.set T276,48504
.set T277,48504
.set T278,48503
.set T279,48502
.set T280,48501
.set T281,48500
.set T282,48499
.set T283,48498
.set T284,48497
.set T285,48496
.set T286,48495
.set T287,48494
.set T288,48493
.set T289,48491
.set T290,48490
.set T291,48489
.set T292,48487
.set T293,48486
.set T294,48485
.set T295,48483
.set T296,48482
.set T297,48480
.set T298,48479
.set T299,48477
.set T300,48476
.set T301,48474
.set T302,48472
.set T303,48471
.set T304,48469
.set T305,48467
.set T306,48465
.set T307,48463
.set T308,48462
.set T309,48460
.set T310,48458
.set T311,48456
.set T312,48454
.set T313,48452
.set T314,48450
.set T315,48448
.set T316,48446
.set T317,48444
.set T318,48441
.set T319,48439
.set T320,48437
.set T321,48435
.set T322,48433
.set T323,48430
.set T324,48428
.set T325,48426
.set T326,48423
.set T327,48421
.set T328,48418
.set T329,48416
.set T330,48413
.set T331,48411
.set T332,48408
.set T333,48406
.set T334,48403
.set T335,48401
.set T336,48398
.set T337,48396
.set T338,48393
.set T339,48390
.set T340,48388
.set T341,48385
.set T342,48380
.set T343,48375
.set T344,48369
.set T345,48364
.set T346,48358
.set T347,48353
.set T348,48347
.set T349,48341
.set T350,48335
.set T351,48330
.set T352,48324
.set T353,48318
.set T354,48312
.set T355,48306
.set T356,48300
.set T357,48295
.set T358,48289
.set T359,48283
.set T360,48277
.set T361,48271
.set T362,48265
.set T363,48258
.set T364,48249
.set T365,48237
.set T366,48224
.set T367,48212
.set T368,48200
.set T369,48187
.set T370,48175
.set T371,48163
.set T372,48150
.set T373,48138
.set T374,48123
.set T375,48098
.set T376,48073
.set T377,48048
.set T378,48023
.set T379,47995
.set T380,47945
.set T381,47895
.set T382,47817
.set T383,47689
.set T384,0
.set T385,14921
.set T386,15049
.set T387,15127
.set T388,15177
.set T389,15227
.set T390,15255
.set T391,15280
.set T392,15305
.set T393,15330
.set T394,15355
.set T395,15370
.set T396,15382
.set T397,15395
.set T398,15407
.set T399,15419
.set T400,15432
.set T401,15444
.set T402,15456
.set T403,15469
.set T404,15481
.set T405,15490
.set T406,15497
.set T407,15503
.set T408,15509
.set T409,15515
.set T410,15521
.set T411,15527
.set T412,15532
.set T413,15538
.set T414,15544
.set T415,15550
.set T416,15556
.set T417,15562
.set T418,15567
.set T419,15573
.set T420,15579
.set T421,15585
.set T422,15590
.set T423,15596
.set T424,15601
.set T425,15607
.set T426,15612
.set T427,15617
.set T428,15620
.set T429,15622
.set T430,15625
.set T431,15628
.set T432,15630
.set T433,15633
.set T434,15635
.set T435,15638
.set T436,15640
.set T437,15643
.set T438,15645
.set T439,15648
.set T440,15650
.set T441,15653
.set T442,15655
.set T443,15658
.set T444,15660
.set T445,15662
.set T446,15665
.set T447,15667
.set T448,15669
.set T449,15671
.set T450,15673
.set T451,15676
.set T452,15678
.set T453,15680
.set T454,15682
.set T455,15684
.set T456,15686
.set T457,15688
.set T458,15690
.set T459,15692
.set T460,15694
.set T461,15695
.set T462,15697
.set T463,15699
.set T464,15701
.set T465,15703
.set T466,15704
.set T467,15706
.set T468,15708
.set T469,15709
.set T470,15711
.set T471,15712
.set T472,15714
.set T473,15715
.set T474,15717
.set T475,15718
.set T476,15719
.set T477,15721
.set T478,15722
.set T479,15723
.set T480,15725
.set T481,15726
.set T482,15727
.set T483,15728
.set T484,15729
.set T485,15730
.set T486,15731
.set T487,15732
.set T488,15733
.set T489,15734
.set T490,15735
.set T491,15736
.set T492,15736
.set T493,15737
.set T494,15738
.set T495,15738
.set T496,15739
.set T497,15740
.set T498,15740
.set T499,15741
.set T500,15741
.set T501,15742
.set T502,15742
.set T503,15742
.set T504,15743
.set T505,15743
.set T506,15743
.set T507,15744
.set T508,15744
.set T509,15744
.set T510,15744
.set T511,15744
.set T512,15669
.set T513,48437
.altmacro
.macro E8 a,b,c,d,e,f,g,h
.short T\a,T\b,T\c,T\d,T\e,T\f,T\g,T\h
.endm
.macro ROW m,p,d
E8 %((\m*(\d)+\p)&511),%((\m*(\d+1)+\p)&511),%((\m*(\d+2)+\p)&511),%((\m*(\d+3)+\p)&511),%((\m*(\d+4)+\p)&511),%((\m*(\d+5)+\p)&511),%((\m*(\d+6)+\p)&511),%((\m*(\d+7)+\p)&511)
.endm
.macro Q4 d,c
.short T\d
.endm
.macro RTQ d,c
.if \c == 0
Q4 %(512+((\d)&1))
Q4 512
.else
Q4 %((\c*\d)&511)
Q4 %((\c*\d+128)&511)
.endif
Q4 %(((\c+1)*\d)&511)
Q4 %(((\c+1)*\d+128)&511)
.endm
.p2align 8
RF:
.set jb,0
.rept 16
.set ks,0
.rept 32
.set l,0
.rept 64
.set j,jb*32+(l&31)
.set d0,ks*16+(l>>5)*8
.if j > 1
ROW %(j>>1),%(128*(j&1)),%d0
.elseif j == 1
.short T512,T512,T512,T512,T512,T512,T512,T512
.else
.short T512,T513,T512,T513,T512,T513,T512,T513
.endif
.set l,l+1
.endr
.set ks,ks+1
.endr
.set jb,jb+1
.endr
.p2align 8
RT:
.set db,0
.rept 16
.set ks,0
.rept 32
.set l,0
.rept 64
.set d,db*32+(l&31)
.set c0,ks*8+(l>>5)*2
RTQ %d,%c0
RTQ %d,%(c0+4)
.set l,l+1
.endr
.set ks,ks+1
.endr
.set db,db+1
.endr
.noaltmacro
.p2align 8
CT:
.long 0x3f803f80,0x3f803f80,0x3f803f80,0x3f803f80,0x3f7f3f80,0x3f753f7b,0x3f623f6d,0x3f463f55,0x3f7b3f80,0x3f553f6d,0x3f0e3f35,0x3e483ec4,0x3f753f80,0x3f223f55,0x3dc93ec4,0xbef1be48
.long 0x3f6d3f80,0x3ec43f35,0xbec40000,0xbf6dbf35,0x3f623f80,0x3dc93f0e,0xbf46bec4,0xbf75bf7b,0x3f553f80,0xbe483ec4,0xbf7bbf35,0xbf0ebf6d,0x3f463f80,0xbef13e48,0xbf75bf6d,0x3dc9bf0e
.long 0x3f353f80,0xbf350000,0xbf35bf80,0x3f350000,0x3f223f80,0xbf62be48,0xbe95bf6d,0x3f7f3f0e,0x3f0e3f80,0xbf7bbec4,0x3e48bf35,0x3f553f6d,0x3ef13f80,0xbf7fbf0e,0x3f22bec4,0x3e953f7b
.long 0x3ec43f80,0xbf6dbf35,0x3f6d0000,0xbec43f35,0x3e953f80,0xbf46bf55,0x3f7f3ec4,0xbf623e48,0x3e483f80,0xbf0ebf6d,0x3f553f35,0xbf7bbec4,0x3dc93f80,0xbe95bf7b,0x3ef13f6d,0xbf22bf55
.long 0x3f803f80,0x3f803f80,0x3f803f80,0x3f803f80,0x3f223f35,0x3ef13f0e,0x3e953ec4,0x3dc93e48,0xbe480000,0xbf0ebec4,0xbf55bf35,0xbf7bbf6d,0xbf62bf35,0xbf7fbf7b,0xbf46bf6d,0xbe95bf0e
.long 0xbf6dbf80,0xbec4bf35,0x3ec40000,0x3f6d3f35,0xbe95bf35,0x3f223e48,0x3f7f3f6d,0x3ef13f55,0x3f0e0000,0x3f7b3f6d,0x3e483f35,0xbf55bec4,0x3f7f3f35,0x3e953f55,0xbf62bec4,0xbf22bf7b
.long 0x3f353f80,0xbf350000,0xbf35bf80,0x3f350000,0xbdc93f35,0xbf75bf55,0x3ef1bec4,0x3f463f7b,0xbf550000,0xbe48bf6d,0x3f7b3f35,0xbf0e3ec4,0xbf75bf35,0x3f46be48,0x3dc93f6d,0xbf62bf55
.long 0xbec4bf80,0x3f6d3f35,0xbf6d0000,0x3ec4bf35,0x3ef1bf35,0x3dc93f7b,0xbf22bf6d,0x3f753f0e,0x3f7b0000,0xbf553ec4,0x3f0ebf35,0xbe483f6d,0x3f463f35,0xbf62bf0e,0x3f753ec4,0xbf7fbe48
.long 0x3f803f80,0x3f803f80,0x3f803f80,0x3f803f80,0xbdc90000,0xbe95be48,0xbef1bec4,0xbf22bf0e,0xbf7bbf80,0xbf55bf6d,0xbf0ebf35,0xbe48bec4,0x3e950000,0x3f463f0e,0x3f7f3f6d,0x3f623f7b
.long 0x3f6d3f80,0x3ec43f35,0xbec40000,0xbf6dbf35,0xbef10000,0xbf7fbf55,0xbf22bf6d,0x3e95be48,0xbf55bf80,0x3e48bec4,0x3f7b3f35,0x3f0e3f6d,0x3f220000,0x3f623f7b,0xbe953ec4,0xbf7fbf55
.long 0x3f353f80,0xbf350000,0xbf35bf80,0x3f350000,0xbf460000,0xbef1bf7b,0x3f753ec4,0x3dc93f55,0xbf0ebf80,0x3f7b3ec4,0xbe483f35,0xbf55bf6d,0x3f620000,0xbdc93f55,0xbf46bf6d,0x3f753e48
.long 0x3ec43f80,0xbf6dbf35,0x3f6d0000,0xbec43f35,0xbf750000,0x3f22bf0e,0xbdc93f6d,0xbef1bf7b,0xbe48bf80,0x3f0e3f6d,0xbf55bf35,0x3f7b3ec4,0x3f7f0000,0xbf753e48,0x3f62bec4,0xbf463f0e
.long 0x3f803f80,0x3f803f80,0x3f803f80,0x3f803f80,0xbf46bf35,0xbf62bf55,0xbf75bf6d,0xbf7fbf7b,0x3e480000,0x3f0e3ec4,0x3f553f35,0x3f7b3f6d,0x3ef13f35,0xbdc93e48,0xbf22bec4,0xbf75bf55
.long 0xbf6dbf80,0xbec4bf35,0x3ec40000,0x3f6d3f35,0x3f753f35,0x3f463f7b,0xbdc93ec4,0xbf62bf0e,0xbf0e0000,0xbf7bbf6d,0xbe48bf35,0x3f553ec4,0xbdc9bf35,0x3f753f0e,0x3ef13f6d,0xbf46be48
.long 0x3f353f80,0xbf350000,0xbf35bf80,0x3f350000,0xbf7fbf35,0x3e95bf0e,0x3f623f6d,0xbf223e48,0x3f550000,0x3e483f6d,0xbf7bbf35,0x3f0ebec4,0xbe953f35,0xbf22bf7b,0x3f7f3ec4,0xbef13f0e
.long 0xbec4bf80,0x3f6d3f35,0xbf6d0000,0x3ec4bf35,0x3f623f35,0xbf7fbe48,0x3f46bec4,0xbe953f55,0xbf7b0000,0x3f55bec4,0xbf0e3f35,0x3e48bf6d,0x3f22bf35,0xbef13f55,0x3e95bf6d,0xbdc93f7b
.long 0x3f803f80,0x3f803f80,0x3f803f80,0x3f803f80,0xbf7fbf80,0xbf75bf7b,0xbf62bf6d,0xbf46bf55,0x3f7b3f80,0x3f553f6d,0x3f0e3f35,0x3e483ec4,0xbf75bf80,0xbf22bf55,0xbdc9bec4,0x3ef13e48
.long 0x3f6d3f80,0x3ec43f35,0xbec40000,0xbf6dbf35,0xbf62bf80,0xbdc9bf0e,0x3f463ec4,0x3f753f7b,0x3f553f80,0xbe483ec4,0xbf7bbf35,0xbf0ebf6d,0xbf46bf80,0x3ef1be48,0x3f753f6d,0xbdc93f0e
.long 0x3f353f80,0xbf350000,0xbf35bf80,0x3f350000,0xbf22bf80,0x3f623e48,0x3e953f6d,0xbf7fbf0e,0x3f0e3f80,0xbf7bbec4,0x3e48bf35,0x3f553f6d,0xbef1bf80,0x3f7f3f0e,0xbf223ec4,0xbe95bf7b
.long 0x3ec43f80,0xbf6dbf35,0x3f6d0000,0xbec43f35,0xbe95bf80,0x3f463f55,0xbf7fbec4,0x3f62be48,0x3e483f80,0xbf0ebf6d,0x3f553f35,0xbf7bbec4,0xbdc9bf80,0x3e953f7b,0xbef1bf6d,0x3f223f55
.long 0x3f803f80,0x3f803f80,0x3f803f80,0x3f803f80,0xbf22bf35,0xbef1bf0e,0xbe95bec4,0xbdc9be48,0xbe480000,0xbf0ebec4,0xbf55bf35,0xbf7bbf6d,0x3f623f35,0x3f7f3f7b,0x3f463f6d,0x3e953f0e
.long 0xbf6dbf80,0xbec4bf35,0x3ec40000,0x3f6d3f35,0x3e953f35,0xbf22be48,0xbf7fbf6d,0xbef1bf55,0x3f0e0000,0x3f7b3f6d,0x3e483f35,0xbf55bec4,0xbf7fbf35,0xbe95bf55,0x3f623ec4,0x3f223f7b
.long 0x3f353f80,0xbf350000,0xbf35bf80,0x3f350000,0x3dc9bf35,0x3f753f55,0xbef13ec4,0xbf46bf7b,0xbf550000,0xbe48bf6d,0x3f7b3f35,0xbf0e3ec4,0x3f753f35,0xbf463e48,0xbdc9bf6d,0x3f623f55
.long 0xbec4bf80,0x3f6d3f35,0xbf6d0000,0x3ec4bf35,0xbef13f35,0xbdc9bf7b,0x3f223f6d,0xbf75bf0e,0x3f7b0000,0xbf553ec4,0x3f0ebf35,0xbe483f6d,0xbf46bf35,0x3f623f0e,0xbf75bec4,0x3f7f3e48
.long 0x3f803f80,0x3f803f80,0x3f803f80,0x3f803f80,0x3dc90000,0x3e953e48,0x3ef13ec4,0x3f223f0e,0xbf7bbf80,0xbf55bf6d,0xbf0ebf35,0xbe48bec4,0xbe950000,0xbf46bf0e,0xbf7fbf6d,0xbf62bf7b
.long 0x3f6d3f80,0x3ec43f35,0xbec40000,0xbf6dbf35,0x3ef10000,0x3f7f3f55,0x3f223f6d,0xbe953e48,0xbf55bf80,0x3e48bec4,0x3f7b3f35,0x3f0e3f6d,0xbf220000,0xbf62bf7b,0x3e95bec4,0x3f7f3f55
.long 0x3f353f80,0xbf350000,0xbf35bf80,0x3f350000,0x3f460000,0x3ef13f7b,0xbf75bec4,0xbdc9bf55,0xbf0ebf80,0x3f7b3ec4,0xbe483f35,0xbf55bf6d,0xbf620000,0x3dc9bf55,0x3f463f6d,0xbf75be48
.long 0x3ec43f80,0xbf6dbf35,0x3f6d0000,0xbec43f35,0x3f750000,0xbf223f0e,0x3dc9bf6d,0x3ef13f7b,0xbe48bf80,0x3f0e3f6d,0xbf55bf35,0x3f7b3ec4,0xbf7f0000,0x3f75be48,0xbf623ec4,0x3f46bf0e
.long 0x3f803f80,0x3f803f80,0x3f803f80,0x3f803f80,0x3f463f35,0x3f623f55,0x3f753f6d,0x3f7f3f7b,0x3e480000,0x3f0e3ec4,0x3f553f35,0x3f7b3f6d,0xbef1bf35,0x3dc9be48,0x3f223ec4,0x3f753f55
.long 0xbf6dbf80,0xbec4bf35,0x3ec40000,0x3f6d3f35,0xbf75bf35,0xbf46bf7b,0x3dc9bec4,0x3f623f0e,0xbf0e0000,0xbf7bbf6d,0xbe48bf35,0x3f553ec4,0x3dc93f35,0xbf75bf0e,0xbef1bf6d,0x3f463e48
.long 0x3f353f80,0xbf350000,0xbf35bf80,0x3f350000,0x3f7f3f35,0xbe953f0e,0xbf62bf6d,0x3f22be48,0x3f550000,0x3e483f6d,0xbf7bbf35,0x3f0ebec4,0x3e95bf35,0x3f223f7b,0xbf7fbec4,0x3ef1bf0e
.long 0xbec4bf80,0x3f6d3f35,0xbf6d0000,0x3ec4bf35,0xbf62bf35,0x3f7f3e48,0xbf463ec4,0x3e95bf55,0xbf7b0000,0x3f55bec4,0xbf0e3f35,0x3e48bf6d,0xbf223f35,0x3ef1bf55,0xbe953f6d,0x3dc9bf7b
.long 0x3f80,0xbf80,0x3f80,0xbf80,0xbdc93f80,0x3e95bf7b,0xbef13f6d,0x3f22bf55,0xbe483f80,0x3f0ebf6d,0xbf553f35,0x3f7bbec4,0xbe953f80,0x3f46bf55,0xbf7f3ec4,0x3f623e48
.long 0xbec43f80,0x3f6dbf35,0xbf6d0000,0x3ec43f35,0xbef13f80,0x3f7fbf0e,0xbf22bec4,0xbe953f7b,0xbf0e3f80,0x3f7bbec4,0xbe48bf35,0xbf553f6d,0xbf223f80,0x3f62be48,0x3e95bf6d,0xbf7f3f0e
.long 0xbf353f80,0x3f350000,0x3f35bf80,0xbf350000,0xbf463f80,0x3ef13e48,0x3f75bf6d,0xbdc9bf0e,0xbf553f80,0x3e483ec4,0x3f7bbf35,0x3f0ebf6d,0xbf623f80,0xbdc93f0e,0x3f46bec4,0x3f75bf7b
.long 0xbf6d3f80,0xbec43f35,0x3ec40000,0x3f6dbf35,0xbf753f80,0xbf223f55,0xbdc93ec4,0x3ef1be48,0xbf7b3f80,0xbf553f6d,0xbf0e3f35,0xbe483ec4,0xbf7f3f80,0xbf753f7b,0xbf623f6d,0xbf463f55
.long 0x3f80,0xbf80,0x3f80,0xbf80,0xbf463f35,0x3f62bf0e,0xbf753ec4,0x3f7fbe48,0xbf7b0000,0x3f553ec4,0xbf0ebf35,0x3e483f6d,0xbef1bf35,0xbdc93f7b,0x3f22bf6d,0xbf753f0e
.long 0x3ec4bf80,0xbf6d3f35,0x3f6d0000,0xbec4bf35,0x3f75bf35,0xbf46be48,0xbdc93f6d,0x3f62bf55,0x3f550000,0x3e48bf6d,0xbf7b3f35,0x3f0e3ec4,0x3dc93f35,0x3f75bf55,0xbef1bec4,0xbf463f7b
.long 0xbf353f80,0x3f350000,0x3f35bf80,0xbf350000,0xbf7f3f35,0xbe953f55,0x3f62bec4,0x3f22bf7b,0xbf0e0000,0xbf7b3f6d,0xbe483f35,0x3f55bec4,0x3e95bf35,0xbf223e48,0xbf7f3f6d,0xbef13f55
.long 0x3f6dbf80,0x3ec4bf35,0xbec40000,0xbf6d3f35,0x3f62bf35,0x3f7fbf7b,0x3f46bf6d,0x3e95bf0e,0x3e480000,0x3f0ebec4,0x3f55bf35,0x3f7bbf6d,0xbf223f35,0xbef13f0e,0xbe953ec4,0xbdc93e48
.long 0x3f80,0xbf80,0x3f80,0xbf80,0xbf7f0000,0x3f753e48,0xbf62bec4,0x3f463f0e,0x3e48bf80,0xbf0e3f6d,0x3f55bf35,0xbf7b3ec4,0x3f750000,0xbf22bf0e,0x3dc93f6d,0x3ef1bf7b
.long 0xbec43f80,0x3f6dbf35,0xbf6d0000,0x3ec43f35,0xbf620000,0x3dc93f55,0x3f46bf6d,0xbf753e48,0x3f0ebf80,0xbf7b3ec4,0x3e483f35,0x3f55bf6d,0x3f460000,0x3ef1bf7b,0xbf753ec4,0xbdc93f55
.long 0xbf353f80,0x3f350000,0x3f35bf80,0xbf350000,0xbf220000,0xbf623f7b,0x3e953ec4,0x3f7fbf55,0x3f55bf80,0xbe48bec4,0xbf7b3f35,0xbf0e3f6d,0x3ef10000,0x3f7fbf55,0x3f22bf6d,0xbe95be48
.long 0xbf6d3f80,0xbec43f35,0x3ec40000,0x3f6dbf35,0xbe950000,0xbf463f0e,0xbf7f3f6d,0xbf623f7b,0x3f7bbf80,0x3f55bf6d,0x3f0ebf35,0x3e48bec4,0x3dc90000,0x3e95be48,0x3ef1bec4,0x3f22bf0e
.long 0x3f80,0xbf80,0x3f80,0xbf80,0xbf22bf35,0x3ef13f55,0xbe95bf6d,0x3dc93f7b,0x3f7b0000,0xbf55bec4,0x3f0e3f35,0xbe48bf6d,0xbf623f35,0x3f7fbe48,0xbf46bec4,0x3e953f55
.long 0x3ec4bf80,0xbf6d3f35,0x3f6d0000,0xbec4bf35,0x3e953f35,0x3f22bf7b,0xbf7f3ec4,0x3ef13f0e,0xbf550000,0xbe483f6d,0x3f7bbf35,0xbf0ebec4,0x3f7fbf35,0xbe95bf0e,0xbf623f6d,0x3f223e48
.long 0xbf353f80,0x3f350000,0x3f35bf80,0xbf350000,0x3dc9bf35,0xbf753f0e,0xbef13f6d,0x3f46be48,0x3f0e0000,0x3f7bbf6d,0x3e48bf35,0xbf553ec4,0xbf753f35,0xbf463f7b,0x3dc93ec4,0x3f62bf0e
.long 0x3f6dbf80,0x3ec4bf35,0xbec40000,0xbf6d3f35,0xbef13f35,0x3dc93e48,0x3f22bec4,0x3f75bf55,0xbe480000,0xbf0e3ec4,0xbf553f35,0xbf7b3f6d,0x3f46bf35,0x3f62bf55,0x3f75bf6d,0x3f7fbf7b
.long 0x3f80,0xbf80,0x3f80,0xbf80,0x3dc9bf80,0xbe953f7b,0x3ef1bf6d,0xbf223f55,0xbe483f80,0x3f0ebf6d,0xbf553f35,0x3f7bbec4,0x3e95bf80,0xbf463f55,0x3f7fbec4,0xbf62be48
.long 0xbec43f80,0x3f6dbf35,0xbf6d0000,0x3ec43f35,0x3ef1bf80,0xbf7f3f0e,0x3f223ec4,0x3e95bf7b,0xbf0e3f80,0x3f7bbec4,0xbe48bf35,0xbf553f6d,0x3f22bf80,0xbf623e48,0xbe953f6d,0x3f7fbf0e
.long 0xbf353f80,0x3f350000,0x3f35bf80,0xbf350000,0x3f46bf80,0xbef1be48,0xbf753f6d,0x3dc93f0e,0xbf553f80,0x3e483ec4,0x3f7bbf35,0x3f0ebf6d,0x3f62bf80,0x3dc9bf0e,0xbf463ec4,0xbf753f7b
.long 0xbf6d3f80,0xbec43f35,0x3ec40000,0x3f6dbf35,0x3f75bf80,0x3f22bf55,0x3dc9bec4,0xbef13e48,0xbf7b3f80,0xbf553f6d,0xbf0e3f35,0xbe483ec4,0x3f7fbf80,0x3f75bf7b,0x3f62bf6d,0x3f46bf55
.long 0x3f80,0xbf80,0x3f80,0xbf80,0x3f46bf35,0xbf623f0e,0x3f75bec4,0xbf7f3e48,0xbf7b0000,0x3f553ec4,0xbf0ebf35,0x3e483f6d,0x3ef13f35,0x3dc9bf7b,0xbf223f6d,0x3f75bf0e
.long 0x3ec4bf80,0xbf6d3f35,0x3f6d0000,0xbec4bf35,0xbf753f35,0x3f463e48,0x3dc9bf6d,0xbf623f55,0x3f550000,0x3e48bf6d,0xbf7b3f35,0x3f0e3ec4,0xbdc9bf35,0xbf753f55,0x3ef13ec4,0x3f46bf7b
.long 0xbf353f80,0x3f350000,0x3f35bf80,0xbf350000,0x3f7fbf35,0x3e95bf55,0xbf623ec4,0xbf223f7b,0xbf0e0000,0xbf7b3f6d,0xbe483f35,0x3f55bec4,0xbe953f35,0x3f22be48,0x3f7fbf6d,0x3ef1bf55
.long 0x3f6dbf80,0x3ec4bf35,0xbec40000,0xbf6d3f35,0xbf623f35,0xbf7f3f7b,0xbf463f6d,0xbe953f0e,0x3e480000,0x3f0ebec4,0x3f55bf35,0x3f7bbf6d,0x3f22bf35,0x3ef1bf0e,0x3e95bec4,0x3dc9be48
.long 0x3f80,0xbf80,0x3f80,0xbf80,0x3f7f0000,0xbf75be48,0x3f623ec4,0xbf46bf0e,0x3e48bf80,0xbf0e3f6d,0x3f55bf35,0xbf7b3ec4,0xbf750000,0x3f223f0e,0xbdc9bf6d,0xbef13f7b
.long 0xbec43f80,0x3f6dbf35,0xbf6d0000,0x3ec43f35,0x3f620000,0xbdc9bf55,0xbf463f6d,0x3f75be48,0x3f0ebf80,0xbf7b3ec4,0x3e483f35,0x3f55bf6d,0xbf460000,0xbef13f7b,0x3f75bec4,0x3dc9bf55
.long 0xbf353f80,0x3f350000,0x3f35bf80,0xbf350000,0x3f220000,0x3f62bf7b,0xbe95bec4,0xbf7f3f55,0x3f55bf80,0xbe48bec4,0xbf7b3f35,0xbf0e3f6d,0xbef10000,0xbf7f3f55,0xbf223f6d,0x3e953e48
.long 0xbf6d3f80,0xbec43f35,0x3ec40000,0x3f6dbf35,0x3e950000,0x3f46bf0e,0x3f7fbf6d,0x3f62bf7b,0x3f7bbf80,0x3f55bf6d,0x3f0ebf35,0x3e48bec4,0xbdc90000,0xbe953e48,0xbef13ec4,0xbf223f0e
.long 0x3f80,0xbf80,0x3f80,0xbf80,0x3f223f35,0xbef1bf55,0x3e953f6d,0xbdc9bf7b,0x3f7b0000,0xbf55bec4,0x3f0e3f35,0xbe48bf6d,0x3f62bf35,0xbf7f3e48,0x3f463ec4,0xbe95bf55
.long 0x3ec4bf80,0xbf6d3f35,0x3f6d0000,0xbec4bf35,0xbe95bf35,0xbf223f7b,0x3f7fbec4,0xbef1bf0e,0xbf550000,0xbe483f6d,0x3f7bbf35,0xbf0ebec4,0xbf7f3f35,0x3e953f0e,0x3f62bf6d,0xbf22be48
.long 0xbf353f80,0x3f350000,0x3f35bf80,0xbf350000,0xbdc93f35,0x3f75bf0e,0x3ef1bf6d,0xbf463e48,0x3f0e0000,0x3f7bbf6d,0x3e48bf35,0xbf553ec4,0x3f75bf35,0x3f46bf7b,0xbdc9bec4,0xbf623f0e
.long 0x3f6dbf80,0x3ec4bf35,0xbec40000,0xbf6d3f35,0x3ef1bf35,0xbdc9be48,0xbf223ec4,0xbf753f55,0xbe480000,0xbf0e3ec4,0xbf553f35,0xbf7b3f6d,0xbf463f35,0xbf623f55,0xbf753f6d,0xbf7f3f7b
.long 0xbf803f80,0xbf803f80,0xbf803f80,0xbf803f80,0xbf7f3f80,0xbf753f7b,0xbf623f6d,0xbf463f55,0xbf7b3f80,0xbf553f6d,0xbf0e3f35,0xbe483ec4,0xbf753f80,0xbf223f55,0xbdc93ec4,0x3ef1be48
.long 0xbf6d3f80,0xbec43f35,0x3ec40000,0x3f6dbf35,0xbf623f80,0xbdc93f0e,0x3f46bec4,0x3f75bf7b,0xbf553f80,0x3e483ec4,0x3f7bbf35,0x3f0ebf6d,0xbf463f80,0x3ef13e48,0x3f75bf6d,0xbdc9bf0e
.long 0xbf353f80,0x3f350000,0x3f35bf80,0xbf350000,0xbf223f80,0x3f62be48,0x3e95bf6d,0xbf7f3f0e,0xbf0e3f80,0x3f7bbec4,0xbe48bf35,0xbf553f6d,0xbef13f80,0x3f7fbf0e,0xbf22bec4,0xbe953f7b
.long 0xbec43f80,0x3f6dbf35,0xbf6d0000,0x3ec43f35,0xbe953f80,0x3f46bf55,0xbf7f3ec4,0x3f623e48,0xbe483f80,0x3f0ebf6d,0xbf553f35,0x3f7bbec4,0xbdc93f80,0x3e95bf7b,0xbef13f6d,0x3f22bf55
.long 0xbf803f80,0xbf803f80,0xbf803f80,0xbf803f80,0xbf223f35,0xbef13f0e,0xbe953ec4,0xbdc93e48,0x3e480000,0x3f0ebec4,0x3f55bf35,0x3f7bbf6d,0x3f62bf35,0x3f7fbf7b,0x3f46bf6d,0x3e95bf0e
.long 0x3f6dbf80,0x3ec4bf35,0xbec40000,0xbf6d3f35,0x3e95bf35,0xbf223e48,0xbf7f3f6d,0xbef13f55,0xbf0e0000,0xbf7b3f6d,0xbe483f35,0x3f55bec4,0xbf7f3f35,0xbe953f55,0x3f62bec4,0x3f22bf7b
.long 0xbf353f80,0x3f350000,0x3f35bf80,0xbf350000,0x3dc93f35,0x3f75bf55,0xbef1bec4,0xbf463f7b,0x3f550000,0x3e48bf6d,0xbf7b3f35,0x3f0e3ec4,0x3f75bf35,0xbf46be48,0xbdc93f6d,0x3f62bf55
.long 0x3ec4bf80,0xbf6d3f35,0x3f6d0000,0xbec4bf35,0xbef1bf35,0xbdc93f7b,0x3f22bf6d,0xbf753f0e,0xbf7b0000,0x3f553ec4,0xbf0ebf35,0x3e483f6d,0xbf463f35,0x3f62bf0e,0xbf753ec4,0x3f7fbe48
.long 0xbf803f80,0xbf803f80,0xbf803f80,0xbf803f80,0x3dc90000,0x3e95be48,0x3ef1bec4,0x3f22bf0e,0x3f7bbf80,0x3f55bf6d,0x3f0ebf35,0x3e48bec4,0xbe950000,0xbf463f0e,0xbf7f3f6d,0xbf623f7b
.long 0xbf6d3f80,0xbec43f35,0x3ec40000,0x3f6dbf35,0x3ef10000,0x3f7fbf55,0x3f22bf6d,0xbe95be48,0x3f55bf80,0xbe48bec4,0xbf7b3f35,0xbf0e3f6d,0xbf220000,0xbf623f7b,0x3e953ec4,0x3f7fbf55
.long 0xbf353f80,0x3f350000,0x3f35bf80,0xbf350000,0x3f460000,0x3ef1bf7b,0xbf753ec4,0xbdc93f55,0x3f0ebf80,0xbf7b3ec4,0x3e483f35,0x3f55bf6d,0xbf620000,0x3dc93f55,0x3f46bf6d,0xbf753e48
.long 0xbec43f80,0x3f6dbf35,0xbf6d0000,0x3ec43f35,0x3f750000,0xbf22bf0e,0x3dc93f6d,0x3ef1bf7b,0x3e48bf80,0xbf0e3f6d,0x3f55bf35,0xbf7b3ec4,0xbf7f0000,0x3f753e48,0xbf62bec4,0x3f463f0e
.long 0xbf803f80,0xbf803f80,0xbf803f80,0xbf803f80,0x3f46bf35,0x3f62bf55,0x3f75bf6d,0x3f7fbf7b,0xbe480000,0xbf0e3ec4,0xbf553f35,0xbf7b3f6d,0xbef13f35,0x3dc93e48,0x3f22bec4,0x3f75bf55
.long 0x3f6dbf80,0x3ec4bf35,0xbec40000,0xbf6d3f35,0xbf753f35,0xbf463f7b,0x3dc93ec4,0x3f62bf0e,0x3f0e0000,0x3f7bbf6d,0x3e48bf35,0xbf553ec4,0x3dc9bf35,0xbf753f0e,0xbef13f6d,0x3f46be48
.long 0xbf353f80,0x3f350000,0x3f35bf80,0xbf350000,0x3f7fbf35,0xbe95bf0e,0xbf623f6d,0x3f223e48,0xbf550000,0xbe483f6d,0x3f7bbf35,0xbf0ebec4,0x3e953f35,0x3f22bf7b,0xbf7f3ec4,0x3ef13f0e
.long 0x3ec4bf80,0xbf6d3f35,0x3f6d0000,0xbec4bf35,0xbf623f35,0x3f7fbe48,0xbf46bec4,0x3e953f55,0x3f7b0000,0xbf55bec4,0x3f0e3f35,0xbe48bf6d,0xbf22bf35,0x3ef13f55,0xbe95bf6d,0x3dc93f7b
.long 0xbf803f80,0xbf803f80,0xbf803f80,0xbf803f80,0x3f7fbf80,0x3f75bf7b,0x3f62bf6d,0x3f46bf55,0xbf7b3f80,0xbf553f6d,0xbf0e3f35,0xbe483ec4,0x3f75bf80,0x3f22bf55,0x3dc9bec4,0xbef13e48
.long 0xbf6d3f80,0xbec43f35,0x3ec40000,0x3f6dbf35,0x3f62bf80,0x3dc9bf0e,0xbf463ec4,0xbf753f7b,0xbf553f80,0x3e483ec4,0x3f7bbf35,0x3f0ebf6d,0x3f46bf80,0xbef1be48,0xbf753f6d,0x3dc93f0e
.long 0xbf353f80,0x3f350000,0x3f35bf80,0xbf350000,0x3f22bf80,0xbf623e48,0xbe953f6d,0x3f7fbf0e,0xbf0e3f80,0x3f7bbec4,0xbe48bf35,0xbf553f6d,0x3ef1bf80,0xbf7f3f0e,0x3f223ec4,0x3e95bf7b
.long 0xbec43f80,0x3f6dbf35,0xbf6d0000,0x3ec43f35,0x3e95bf80,0xbf463f55,0x3f7fbec4,0xbf62be48,0xbe483f80,0x3f0ebf6d,0xbf553f35,0x3f7bbec4,0x3dc9bf80,0xbe953f7b,0x3ef1bf6d,0xbf223f55
.long 0xbf803f80,0xbf803f80,0xbf803f80,0xbf803f80,0x3f22bf35,0x3ef1bf0e,0x3e95bec4,0x3dc9be48,0x3e480000,0x3f0ebec4,0x3f55bf35,0x3f7bbf6d,0xbf623f35,0xbf7f3f7b,0xbf463f6d,0xbe953f0e
.long 0x3f6dbf80,0x3ec4bf35,0xbec40000,0xbf6d3f35,0xbe953f35,0x3f22be48,0x3f7fbf6d,0x3ef1bf55,0xbf0e0000,0xbf7b3f6d,0xbe483f35,0x3f55bec4,0x3f7fbf35,0x3e95bf55,0xbf623ec4,0xbf223f7b
.long 0xbf353f80,0x3f350000,0x3f35bf80,0xbf350000,0xbdc9bf35,0xbf753f55,0x3ef13ec4,0x3f46bf7b,0x3f550000,0x3e48bf6d,0xbf7b3f35,0x3f0e3ec4,0xbf753f35,0x3f463e48,0x3dc9bf6d,0xbf623f55
.long 0x3ec4bf80,0xbf6d3f35,0x3f6d0000,0xbec4bf35,0x3ef13f35,0x3dc9bf7b,0xbf223f6d,0x3f75bf0e,0xbf7b0000,0x3f553ec4,0xbf0ebf35,0x3e483f6d,0x3f46bf35,0xbf623f0e,0x3f75bec4,0xbf7f3e48
.long 0xbf803f80,0xbf803f80,0xbf803f80,0xbf803f80,0xbdc90000,0xbe953e48,0xbef13ec4,0xbf223f0e,0x3f7bbf80,0x3f55bf6d,0x3f0ebf35,0x3e48bec4,0x3e950000,0x3f46bf0e,0x3f7fbf6d,0x3f62bf7b
.long 0xbf6d3f80,0xbec43f35,0x3ec40000,0x3f6dbf35,0xbef10000,0xbf7f3f55,0xbf223f6d,0x3e953e48,0x3f55bf80,0xbe48bec4,0xbf7b3f35,0xbf0e3f6d,0x3f220000,0x3f62bf7b,0xbe95bec4,0xbf7f3f55
.long 0xbf353f80,0x3f350000,0x3f35bf80,0xbf350000,0xbf460000,0xbef13f7b,0x3f75bec4,0x3dc9bf55,0x3f0ebf80,0xbf7b3ec4,0x3e483f35,0x3f55bf6d,0x3f620000,0xbdc9bf55,0xbf463f6d,0x3f75be48
.long 0xbec43f80,0x3f6dbf35,0xbf6d0000,0x3ec43f35,0xbf750000,0x3f223f0e,0xbdc9bf6d,0xbef13f7b,0x3e48bf80,0xbf0e3f6d,0x3f55bf35,0xbf7b3ec4,0x3f7f0000,0xbf75be48,0x3f623ec4,0xbf46bf0e
.long 0xbf803f80,0xbf803f80,0xbf803f80,0xbf803f80,0xbf463f35,0xbf623f55,0xbf753f6d,0xbf7f3f7b,0xbe480000,0xbf0e3ec4,0xbf553f35,0xbf7b3f6d,0x3ef1bf35,0xbdc9be48,0xbf223ec4,0xbf753f55
.long 0x3f6dbf80,0x3ec4bf35,0xbec40000,0xbf6d3f35,0x3f75bf35,0x3f46bf7b,0xbdc9bec4,0xbf623f0e,0x3f0e0000,0x3f7bbf6d,0x3e48bf35,0xbf553ec4,0xbdc93f35,0x3f75bf0e,0x3ef1bf6d,0xbf463e48
.long 0xbf353f80,0x3f350000,0x3f35bf80,0xbf350000,0xbf7f3f35,0x3e953f0e,0x3f62bf6d,0xbf22be48,0xbf550000,0xbe483f6d,0x3f7bbf35,0xbf0ebec4,0xbe95bf35,0xbf223f7b,0x3f7fbec4,0xbef1bf0e
.long 0x3ec4bf80,0xbf6d3f35,0x3f6d0000,0xbec4bf35,0x3f62bf35,0xbf7f3e48,0x3f463ec4,0xbe95bf55,0x3f7b0000,0xbf55bec4,0x3f0e3f35,0xbe48bf6d,0x3f223f35,0xbef1bf55,0x3e953f6d,0xbdc9bf7b
.long 0x3f80,0xbf80,0x3f80,0xbf80,0x3dc93f80,0xbe95bf7b,0x3ef13f6d,0xbf22bf55,0x3e483f80,0xbf0ebf6d,0x3f553f35,0xbf7bbec4,0x3e953f80,0xbf46bf55,0x3f7f3ec4,0xbf623e48
.long 0x3ec43f80,0xbf6dbf35,0x3f6d0000,0xbec43f35,0x3ef13f80,0xbf7fbf0e,0x3f22bec4,0x3e953f7b,0x3f0e3f80,0xbf7bbec4,0x3e48bf35,0x3f553f6d,0x3f223f80,0xbf62be48,0xbe95bf6d,0x3f7f3f0e
.long 0x3f353f80,0xbf350000,0xbf35bf80,0x3f350000,0x3f463f80,0xbef13e48,0xbf75bf6d,0x3dc9bf0e,0x3f553f80,0xbe483ec4,0xbf7bbf35,0xbf0ebf6d,0x3f623f80,0x3dc93f0e,0xbf46bec4,0xbf75bf7b
.long 0x3f6d3f80,0x3ec43f35,0xbec40000,0xbf6dbf35,0x3f753f80,0x3f223f55,0x3dc93ec4,0xbef1be48,0x3f7b3f80,0x3f553f6d,0x3f0e3f35,0x3e483ec4,0x3f7f3f80,0x3f753f7b,0x3f623f6d,0x3f463f55
.long 0x3f80,0xbf80,0x3f80,0xbf80,0x3f463f35,0xbf62bf0e,0x3f753ec4,0xbf7fbe48,0x3f7b0000,0xbf553ec4,0x3f0ebf35,0xbe483f6d,0x3ef1bf35,0x3dc93f7b,0xbf22bf6d,0x3f753f0e
.long 0xbec4bf80,0x3f6d3f35,0xbf6d0000,0x3ec4bf35,0xbf75bf35,0x3f46be48,0x3dc93f6d,0xbf62bf55,0xbf550000,0xbe48bf6d,0x3f7b3f35,0xbf0e3ec4,0xbdc93f35,0xbf75bf55,0x3ef1bec4,0x3f463f7b
.long 0x3f353f80,0xbf350000,0xbf35bf80,0x3f350000,0x3f7f3f35,0x3e953f55,0xbf62bec4,0xbf22bf7b,0x3f0e0000,0x3f7b3f6d,0x3e483f35,0xbf55bec4,0xbe95bf35,0x3f223e48,0x3f7f3f6d,0x3ef13f55
.long 0xbf6dbf80,0xbec4bf35,0x3ec40000,0x3f6d3f35,0xbf62bf35,0xbf7fbf7b,0xbf46bf6d,0xbe95bf0e,0xbe480000,0xbf0ebec4,0xbf55bf35,0xbf7bbf6d,0x3f223f35,0x3ef13f0e,0x3e953ec4,0x3dc93e48
.long 0x3f80,0xbf80,0x3f80,0xbf80,0x3f7f0000,0xbf753e48,0x3f62bec4,0xbf463f0e,0xbe48bf80,0x3f0e3f6d,0xbf55bf35,0x3f7b3ec4,0xbf750000,0x3f22bf0e,0xbdc93f6d,0xbef1bf7b
.long 0x3ec43f80,0xbf6dbf35,0x3f6d0000,0xbec43f35,0x3f620000,0xbdc93f55,0xbf46bf6d,0x3f753e48,0xbf0ebf80,0x3f7b3ec4,0xbe483f35,0xbf55bf6d,0xbf460000,0xbef1bf7b,0x3f753ec4,0x3dc93f55
.long 0x3f353f80,0xbf350000,0xbf35bf80,0x3f350000,0x3f220000,0x3f623f7b,0xbe953ec4,0xbf7fbf55,0xbf55bf80,0x3e48bec4,0x3f7b3f35,0x3f0e3f6d,0xbef10000,0xbf7fbf55,0xbf22bf6d,0x3e95be48
.long 0x3f6d3f80,0x3ec43f35,0xbec40000,0xbf6dbf35,0x3e950000,0x3f463f0e,0x3f7f3f6d,0x3f623f7b,0xbf7bbf80,0xbf55bf6d,0xbf0ebf35,0xbe48bec4,0xbdc90000,0xbe95be48,0xbef1bec4,0xbf22bf0e
.long 0x3f80,0xbf80,0x3f80,0xbf80,0x3f22bf35,0xbef13f55,0x3e95bf6d,0xbdc93f7b,0xbf7b0000,0x3f55bec4,0xbf0e3f35,0x3e48bf6d,0x3f623f35,0xbf7fbe48,0x3f46bec4,0xbe953f55
.long 0xbec4bf80,0x3f6d3f35,0xbf6d0000,0x3ec4bf35,0xbe953f35,0xbf22bf7b,0x3f7f3ec4,0xbef13f0e,0x3f550000,0x3e483f6d,0xbf7bbf35,0x3f0ebec4,0xbf7fbf35,0x3e95bf0e,0x3f623f6d,0xbf223e48
.long 0x3f353f80,0xbf350000,0xbf35bf80,0x3f350000,0xbdc9bf35,0x3f753f0e,0x3ef13f6d,0xbf46be48,0xbf0e0000,0xbf7bbf6d,0xbe48bf35,0x3f553ec4,0x3f753f35,0x3f463f7b,0xbdc93ec4,0xbf62bf0e
.long 0xbf6dbf80,0xbec4bf35,0x3ec40000,0x3f6d3f35,0x3ef13f35,0xbdc93e48,0xbf22bec4,0xbf75bf55,0x3e480000,0x3f0e3ec4,0x3f553f35,0x3f7b3f6d,0xbf46bf35,0xbf62bf55,0xbf75bf6d,0xbf7fbf7b
.long 0x3f80,0xbf80,0x3f80,0xbf80,0xbdc9bf80,0x3e953f7b,0xbef1bf6d,0x3f223f55,0x3e483f80,0xbf0ebf6d,0x3f553f35,0xbf7bbec4,0xbe95bf80,0x3f463f55,0xbf7fbec4,0x3f62be48
.long 0x3ec43f80,0xbf6dbf35,0x3f6d0000,0xbec43f35,0xbef1bf80,0x3f7f3f0e,0xbf223ec4,0xbe95bf7b,0x3f0e3f80,0xbf7bbec4,0x3e48bf35,0x3f553f6d,0xbf22bf80,0x3f623e48,0x3e953f6d,0xbf7fbf0e
.long 0x3f353f80,0xbf350000,0xbf35bf80,0x3f350000,0xbf46bf80,0x3ef1be48,0x3f753f6d,0xbdc93f0e,0x3f553f80,0xbe483ec4,0xbf7bbf35,0xbf0ebf6d,0xbf62bf80,0xbdc9bf0e,0x3f463ec4,0x3f753f7b
.long 0x3f6d3f80,0x3ec43f35,0xbec40000,0xbf6dbf35,0xbf75bf80,0xbf22bf55,0xbdc9bec4,0x3ef13e48,0x3f7b3f80,0x3f553f6d,0x3f0e3f35,0x3e483ec4,0xbf7fbf80,0xbf75bf7b,0xbf62bf6d,0xbf46bf55
.long 0x3f80,0xbf80,0x3f80,0xbf80,0xbf46bf35,0x3f623f0e,0xbf75bec4,0x3f7f3e48,0x3f7b0000,0xbf553ec4,0x3f0ebf35,0xbe483f6d,0xbef13f35,0xbdc9bf7b,0x3f223f6d,0xbf75bf0e
.long 0xbec4bf80,0x3f6d3f35,0xbf6d0000,0x3ec4bf35,0x3f753f35,0xbf463e48,0xbdc9bf6d,0x3f623f55,0xbf550000,0xbe48bf6d,0x3f7b3f35,0xbf0e3ec4,0x3dc9bf35,0x3f753f55,0xbef13ec4,0xbf46bf7b
.long 0x3f353f80,0xbf350000,0xbf35bf80,0x3f350000,0xbf7fbf35,0xbe95bf55,0x3f623ec4,0x3f223f7b,0x3f0e0000,0x3f7b3f6d,0x3e483f35,0xbf55bec4,0x3e953f35,0xbf22be48,0xbf7fbf6d,0xbef1bf55
.long 0xbf6dbf80,0xbec4bf35,0x3ec40000,0x3f6d3f35,0x3f623f35,0x3f7f3f7b,0x3f463f6d,0x3e953f0e,0xbe480000,0xbf0ebec4,0xbf55bf35,0xbf7bbf6d,0xbf22bf35,0xbef1bf0e,0xbe95bec4,0xbdc9be48
.long 0x3f80,0xbf80,0x3f80,0xbf80,0xbf7f0000,0x3f75be48,0xbf623ec4,0x3f46bf0e,0xbe48bf80,0x3f0e3f6d,0xbf55bf35,0x3f7b3ec4,0x3f750000,0xbf223f0e,0x3dc9bf6d,0x3ef13f7b
.long 0x3ec43f80,0xbf6dbf35,0x3f6d0000,0xbec43f35,0xbf620000,0x3dc9bf55,0x3f463f6d,0xbf75be48,0xbf0ebf80,0x3f7b3ec4,0xbe483f35,0xbf55bf6d,0x3f460000,0x3ef13f7b,0xbf75bec4,0xbdc9bf55
.long 0x3f353f80,0xbf350000,0xbf35bf80,0x3f350000,0xbf220000,0xbf62bf7b,0x3e95bec4,0x3f7f3f55,0xbf55bf80,0x3e48bec4,0x3f7b3f35,0x3f0e3f6d,0x3ef10000,0x3f7f3f55,0x3f223f6d,0xbe953e48
.long 0x3f6d3f80,0x3ec43f35,0xbec40000,0xbf6dbf35,0xbe950000,0xbf46bf0e,0xbf7fbf6d,0xbf62bf7b,0xbf7bbf80,0xbf55bf6d,0xbf0ebf35,0xbe48bec4,0x3dc90000,0x3e953e48,0x3ef13ec4,0x3f223f0e
.long 0x3f80,0xbf80,0x3f80,0xbf80,0xbf223f35,0x3ef1bf55,0xbe953f6d,0x3dc9bf7b,0xbf7b0000,0x3f55bec4,0xbf0e3f35,0x3e48bf6d,0xbf62bf35,0x3f7f3e48,0xbf463ec4,0x3e95bf55
.long 0xbec4bf80,0x3f6d3f35,0xbf6d0000,0x3ec4bf35,0x3e95bf35,0x3f223f7b,0xbf7fbec4,0x3ef1bf0e,0x3f550000,0x3e483f6d,0xbf7bbf35,0x3f0ebec4,0x3f7f3f35,0xbe953f0e,0xbf62bf6d,0x3f22be48
.long 0x3f353f80,0xbf350000,0xbf35bf80,0x3f350000,0x3dc93f35,0xbf75bf0e,0xbef1bf6d,0x3f463e48,0xbf0e0000,0xbf7bbf6d,0xbe48bf35,0x3f553ec4,0xbf75bf35,0xbf46bf7b,0x3dc9bec4,0x3f623f0e
.long 0xbf6dbf80,0xbec4bf35,0x3ec40000,0x3f6d3f35,0xbef1bf35,0x3dc9be48,0x3f223ec4,0x3f753f55,0x3e480000,0x3f0e3ec4,0x3f553f35,0x3f7b3f6d,0x3f463f35,0x3f623f55,0x3f753f6d,0x3f7f3f7b
.long 0x0,0x0,0x0,0x0,0x3dc90000,0x3e953e48,0x3ef13ec4,0x3f223f0e,0x3e480000,0x3f0e3ec4,0x3f553f35,0x3f7b3f6d,0x3e950000,0x3f463f0e,0x3f7f3f6d,0x3f623f7b
.long 0x3ec40000,0x3f6d3f35,0x3f6d3f80,0x3ec43f35,0x3ef10000,0x3f7f3f55,0x3f223f6d,0xbe953e48,0x3f0e0000,0x3f7b3f6d,0x3e483f35,0xbf55bec4,0x3f220000,0x3f623f7b,0xbe953ec4,0xbf7fbf55
.long 0x3f350000,0x3f353f80,0xbf350000,0xbf35bf80,0x3f460000,0x3ef13f7b,0xbf75bec4,0xbdc9bf55,0x3f550000,0x3e483f6d,0xbf7bbf35,0x3f0ebec4,0x3f620000,0xbdc93f55,0xbf46bf6d,0x3f753e48
.long 0x3f6d0000,0xbec43f35,0xbec4bf80,0x3f6d3f35,0x3f750000,0xbf223f0e,0x3dc9bf6d,0x3ef13f7b,0x3f7b0000,0xbf553ec4,0x3f0ebf35,0xbe483f6d,0x3f7f0000,0xbf753e48,0x3f62bec4,0xbf463f0e
.long 0x0,0x0,0x0,0x0,0x3f463f35,0x3f623f55,0x3f753f6d,0x3f7f3f7b,0x3f7b3f80,0x3f553f6d,0x3f0e3f35,0x3e483ec4,0x3ef13f35,0xbdc93e48,0xbf22bec4,0xbf75bf55
.long 0xbec40000,0xbf6dbf35,0xbf6dbf80,0xbec4bf35,0xbf75bf35,0xbf46bf7b,0x3dc9bec4,0x3f623f0e,0xbf55bf80,0x3e48bec4,0x3f7b3f35,0x3f0e3f6d,0xbdc9bf35,0x3f753f0e,0x3ef13f6d,0xbf46be48
.long 0x3f350000,0x3f353f80,0xbf350000,0xbf35bf80,0x3f7f3f35,0xbe953f0e,0xbf62bf6d,0x3f22be48,0x3f0e3f80,0xbf7bbec4,0x3e48bf35,0x3f553f6d,0xbe953f35,0xbf22bf7b,0x3f7f3ec4,0xbef13f0e
.long 0xbf6d0000,0x3ec4bf35,0x3ec43f80,0xbf6dbf35,0xbf62bf35,0x3f7f3e48,0xbf463ec4,0x3e95bf55,0xbe48bf80,0x3f0e3f6d,0xbf55bf35,0x3f7b3ec4,0x3f22bf35,0xbef13f55,0x3e95bf6d,0xbdc93f7b
.long 0x0,0x0,0x0,0x0,0x3f7f3f80,0x3f753f7b,0x3f623f6d,0x3f463f55,0xbe480000,0xbf0ebec4,0xbf55bf35,0xbf7bbf6d,0xbf75bf80,0xbf22bf55,0xbdc9bec4,0x3ef13e48
.long 0x3ec40000,0x3f6d3f35,0x3f6d3f80,0x3ec43f35,0x3f623f80,0x3dc93f0e,0xbf46bec4,0xbf75bf7b,0xbf0e0000,0xbf7bbf6d,0xbe48bf35,0x3f553ec4,0xbf46bf80,0x3ef1be48,0x3f753f6d,0xbdc93f0e
.long 0x3f350000,0x3f353f80,0xbf350000,0xbf35bf80,0x3f223f80,0xbf62be48,0xbe95bf6d,0x3f7f3f0e,0xbf550000,0xbe48bf6d,0x3f7b3f35,0xbf0e3ec4,0xbef1bf80,0x3f7f3f0e,0xbf223ec4,0xbe95bf7b
.long 0x3f6d0000,0xbec43f35,0xbec4bf80,0x3f6d3f35,0x3e953f80,0xbf46bf55,0x3f7f3ec4,0xbf623e48,0xbf7b0000,0x3f55bec4,0xbf0e3f35,0x3e48bf6d,0xbdc9bf80,0x3e953f7b,0xbef1bf6d,0x3f223f55
.long 0x0,0x0,0x0,0x0,0x3f223f35,0x3ef13f0e,0x3e953ec4,0x3dc93e48,0xbf7bbf80,0xbf55bf6d,0xbf0ebf35,0xbe48bec4,0x3f623f35,0x3f7f3f7b,0x3f463f6d,0x3e953f0e
.long 0xbec40000,0xbf6dbf35,0xbf6dbf80,0xbec4bf35,0xbe95bf35,0x3f223e48,0x3f7f3f6d,0x3ef13f55,0x3f553f80,0xbe483ec4,0xbf7bbf35,0xbf0ebf6d,0xbf7fbf35,0xbe95bf55,0x3f623ec4,0x3f223f7b
.long 0x3f350000,0x3f353f80,0xbf350000,0xbf35bf80,0xbdc93f35,0xbf75bf55,0x3ef1bec4,0x3f463f7b,0xbf0ebf80,0x3f7b3ec4,0xbe483f35,0xbf55bf6d,0x3f753f35,0xbf463e48,0xbdc9bf6d,0x3f623f55
.long 0xbf6d0000,0x3ec4bf35,0x3ec43f80,0xbf6dbf35,0x3ef1bf35,0x3dc93f7b,0xbf22bf6d,0x3f753f0e,0x3e483f80,0xbf0ebf6d,0x3f553f35,0xbf7bbec4,0xbf46bf35,0x3f623f0e,0xbf75bec4,0x3f7f3e48
.long 0x0,0x0,0x0,0x0,0xbdc90000,0xbe95be48,0xbef1bec4,0xbf22bf0e,0x3e480000,0x3f0e3ec4,0x3f553f35,0x3f7b3f6d,0xbe950000,0xbf46bf0e,0xbf7fbf6d,0xbf62bf7b
.long 0x3ec40000,0x3f6d3f35,0x3f6d3f80,0x3ec43f35,0xbef10000,0xbf7fbf55,0xbf22bf6d,0x3e95be48,0x3f0e0000,0x3f7b3f6d,0x3e483f35,0xbf55bec4,0xbf220000,0xbf62bf7b,0x3e95bec4,0x3f7f3f55
.long 0x3f350000,0x3f353f80,0xbf350000,0xbf35bf80,0xbf460000,0xbef1bf7b,0x3f753ec4,0x3dc93f55,0x3f550000,0x3e483f6d,0xbf7bbf35,0x3f0ebec4,0xbf620000,0x3dc9bf55,0x3f463f6d,0xbf75be48
.long 0x3f6d0000,0xbec43f35,0xbec4bf80,0x3f6d3f35,0xbf750000,0x3f22bf0e,0xbdc93f6d,0xbef1bf7b,0x3f7b0000,0xbf553ec4,0x3f0ebf35,0xbe483f6d,0xbf7f0000,0x3f75be48,0xbf623ec4,0x3f46bf0e
.long 0x0,0x0,0x0,0x0,0xbf46bf35,0xbf62bf55,0xbf75bf6d,0xbf7fbf7b,0x3f7b3f80,0x3f553f6d,0x3f0e3f35,0x3e483ec4,0xbef1bf35,0x3dc9be48,0x3f223ec4,0x3f753f55
.long 0xbec40000,0xbf6dbf35,0xbf6dbf80,0xbec4bf35,0x3f753f35,0x3f463f7b,0xbdc93ec4,0xbf62bf0e,0xbf55bf80,0x3e48bec4,0x3f7b3f35,0x3f0e3f6d,0x3dc93f35,0xbf75bf0e,0xbef1bf6d,0x3f463e48
.long 0x3f350000,0x3f353f80,0xbf350000,0xbf35bf80,0xbf7fbf35,0x3e95bf0e,0x3f623f6d,0xbf223e48,0x3f0e3f80,0xbf7bbec4,0x3e48bf35,0x3f553f6d,0x3e95bf35,0x3f223f7b,0xbf7fbec4,0x3ef1bf0e
.long 0xbf6d0000,0x3ec4bf35,0x3ec43f80,0xbf6dbf35,0x3f623f35,0xbf7fbe48,0x3f46bec4,0xbe953f55,0xbe48bf80,0x3f0e3f6d,0xbf55bf35,0x3f7b3ec4,0xbf223f35,0x3ef1bf55,0xbe953f6d,0x3dc9bf7b
.long 0x0,0x0,0x0,0x0,0xbf7fbf80,0xbf75bf7b,0xbf62bf6d,0xbf46bf55,0xbe480000,0xbf0ebec4,0xbf55bf35,0xbf7bbf6d,0x3f753f80,0x3f223f55,0x3dc93ec4,0xbef1be48
.long 0x3ec40000,0x3f6d3f35,0x3f6d3f80,0x3ec43f35,0xbf62bf80,0xbdc9bf0e,0x3f463ec4,0x3f753f7b,0xbf0e0000,0xbf7bbf6d,0xbe48bf35,0x3f553ec4,0x3f463f80,0xbef13e48,0xbf75bf6d,0x3dc9bf0e
.long 0x3f350000,0x3f353f80,0xbf350000,0xbf35bf80,0xbf22bf80,0x3f623e48,0x3e953f6d,0xbf7fbf0e,0xbf550000,0xbe48bf6d,0x3f7b3f35,0xbf0e3ec4,0x3ef13f80,0xbf7fbf0e,0x3f22bec4,0x3e953f7b
.long 0x3f6d0000,0xbec43f35,0xbec4bf80,0x3f6d3f35,0xbe95bf80,0x3f463f55,0xbf7fbec4,0x3f62be48,0xbf7b0000,0x3f55bec4,0xbf0e3f35,0x3e48bf6d,0x3dc93f80,0xbe95bf7b,0x3ef13f6d,0xbf22bf55
.long 0x0,0x0,0x0,0x0,0xbf22bf35,0xbef1bf0e,0xbe95bec4,0xbdc9be48,0xbf7bbf80,0xbf55bf6d,0xbf0ebf35,0xbe48bec4,0xbf62bf35,0xbf7fbf7b,0xbf46bf6d,0xbe95bf0e
.long 0xbec40000,0xbf6dbf35,0xbf6dbf80,0xbec4bf35,0x3e953f35,0xbf22be48,0xbf7fbf6d,0xbef1bf55,0x3f553f80,0xbe483ec4,0xbf7bbf35,0xbf0ebf6d,0x3f7f3f35,0x3e953f55,0xbf62bec4,0xbf22bf7b
.long 0x3f350000,0x3f353f80,0xbf350000,0xbf35bf80,0x3dc9bf35,0x3f753f55,0xbef13ec4,0xbf46bf7b,0xbf0ebf80,0x3f7b3ec4,0xbe483f35,0xbf55bf6d,0xbf75bf35,0x3f46be48,0x3dc93f6d,0xbf62bf55
.long 0xbf6d0000,0x3ec4bf35,0x3ec43f80,0xbf6dbf35,0xbef13f35,0xbdc9bf7b,0x3f223f6d,0xbf75bf0e,0x3e483f80,0xbf0ebf6d,0x3f553f35,0xbf7bbec4,0x3f463f35,0xbf62bf0e,0x3f753ec4,0xbf7fbe48
.long 0x3f800000,0xbf800000,0x3f800000,0xbf800000,0x3f7f0000,0xbf75be48,0x3f623ec4,0xbf46bf0e,0x3f7b0000,0xbf55bec4,0x3f0e3f35,0xbe48bf6d,0x3f750000,0xbf22bf0e,0x3dc93f6d,0x3ef1bf7b
.long 0x3f6d0000,0xbec4bf35,0xbec43f80,0x3f6dbf35,0x3f620000,0xbdc9bf55,0xbf463f6d,0x3f75be48,0x3f550000,0x3e48bf6d,0xbf7b3f35,0x3f0e3ec4,0x3f460000,0x3ef1bf7b,0xbf753ec4,0xbdc93f55
.long 0x3f350000,0x3f35bf80,0xbf350000,0xbf353f80,0x3f220000,0x3f62bf7b,0xbe95bec4,0xbf7f3f55,0x3f0e0000,0x3f7bbf6d,0x3e48bf35,0xbf553ec4,0x3ef10000,0x3f7fbf55,0x3f22bf6d,0xbe95be48
.long 0x3ec40000,0x3f6dbf35,0x3f6dbf80,0x3ec4bf35,0x3e950000,0x3f46bf0e,0x3f7fbf6d,0x3f62bf7b,0x3e480000,0x3f0ebec4,0x3f55bf35,0x3f7bbf6d,0x3dc90000,0x3e95be48,0x3ef1bec4,0x3f22bf0e
.long 0x3f800000,0xbf800000,0x3f800000,0xbf800000,0x3f223f35,0xbef1bf55,0x3e953f6d,0xbdc9bf7b,0xbe483f80,0x3f0ebf6d,0xbf553f35,0x3f7bbec4,0xbf623f35,0x3f7fbe48,0xbf46bec4,0x3e953f55
.long 0xbf6d0000,0x3ec43f35,0x3ec4bf80,0xbf6d3f35,0xbe95bf35,0xbf223f7b,0x3f7fbec4,0xbef1bf0e,0x3f0ebf80,0xbf7b3ec4,0x3e483f35,0x3f55bf6d,0x3f7fbf35,0xbe95bf0e,0xbf623f6d,0x3f223e48
.long 0x3f350000,0x3f35bf80,0xbf350000,0xbf353f80,0xbdc93f35,0x3f75bf0e,0x3ef1bf6d,0xbf463e48,0xbf553f80,0x3e483ec4,0x3f7bbf35,0x3f0ebf6d,0xbf753f35,0xbf463f7b,0x3dc93ec4,0x3f62bf0e
.long 0xbec40000,0xbf6d3f35,0xbf6d3f80,0xbec43f35,0x3ef1bf35,0xbdc9be48,0xbf223ec4,0xbf753f55,0x3f7bbf80,0x3f55bf6d,0x3f0ebf35,0x3e48bec4,0x3f46bf35,0x3f62bf55,0x3f75bf6d,0x3f7fbf7b
.long 0x3f800000,0xbf800000,0x3f800000,0xbf800000,0xbdc93f80,0x3e95bf7b,0xbef13f6d,0x3f22bf55,0xbf7b0000,0x3f553ec4,0xbf0ebf35,0x3e483f6d,0x3e95bf80,0xbf463f55,0x3f7fbec4,0xbf62be48
.long 0x3f6d0000,0xbec4bf35,0xbec43f80,0x3f6dbf35,0xbef13f80,0x3f7fbf0e,0xbf22bec4,0xbe953f7b,0xbf550000,0xbe483f6d,0x3f7bbf35,0xbf0ebec4,0x3f22bf80,0xbf623e48,0xbe953f6d,0x3f7fbf0e
.long 0x3f350000,0x3f35bf80,0xbf350000,0xbf353f80,0xbf463f80,0x3ef13e48,0x3f75bf6d,0xbdc9bf0e,0xbf0e0000,0xbf7b3f6d,0xbe483f35,0x3f55bec4,0x3f62bf80,0x3dc9bf0e,0xbf463ec4,0xbf753f7b
.long 0x3ec40000,0x3f6dbf35,0x3f6dbf80,0x3ec4bf35,0xbf753f80,0xbf223f55,0xbdc93ec4,0x3ef1be48,0xbe480000,0xbf0e3ec4,0xbf553f35,0xbf7b3f6d,0x3f7fbf80,0x3f75bf7b,0x3f62bf6d,0x3f46bf55
.long 0x3f800000,0xbf800000,0x3f800000,0xbf800000,0xbf463f35,0x3f62bf0e,0xbf753ec4,0x3f7fbe48,0x3e48bf80,0xbf0e3f6d,0x3f55bf35,0xbf7b3ec4,0x3ef13f35,0x3dc9bf7b,0xbf223f6d,0x3f75bf0e
.long 0xbf6d0000,0x3ec43f35,0x3ec4bf80,0xbf6d3f35,0x3f75bf35,0xbf46be48,0xbdc93f6d,0x3f62bf55,0xbf0e3f80,0x3f7bbec4,0xbe48bf35,0xbf553f6d,0xbdc9bf35,0xbf753f55,0x3ef13ec4,0x3f46bf7b
.long 0x3f350000,0x3f35bf80,0xbf350000,0xbf353f80,0xbf7f3f35,0xbe953f55,0x3f62bec4,0x3f22bf7b,0x3f55bf80,0xbe48bec4,0xbf7b3f35,0xbf0e3f6d,0xbe953f35,0x3f22be48,0x3f7fbf6d,0x3ef1bf55
.long 0xbec40000,0xbf6d3f35,0xbf6d3f80,0xbec43f35,0x3f62bf35,0x3f7fbf7b,0x3f46bf6d,0x3e95bf0e,0xbf7b3f80,0xbf553f6d,0xbf0e3f35,0xbe483ec4,0x3f22bf35,0x3ef1bf0e,0x3e95bec4,0x3dc9be48
.long 0x3f800000,0xbf800000,0x3f800000,0xbf800000,0xbf7f0000,0x3f753e48,0xbf62bec4,0x3f463f0e,0x3f7b0000,0xbf55bec4,0x3f0e3f35,0xbe48bf6d,0xbf750000,0x3f223f0e,0xbdc9bf6d,0xbef13f7b
.long 0x3f6d0000,0xbec4bf35,0xbec43f80,0x3f6dbf35,0xbf620000,0x3dc93f55,0x3f46bf6d,0xbf753e48,0x3f550000,0x3e48bf6d,0xbf7b3f35,0x3f0e3ec4,0xbf460000,0xbef13f7b,0x3f75bec4,0x3dc9bf55
.long 0x3f350000,0x3f35bf80,0xbf350000,0xbf353f80,0xbf220000,0xbf623f7b,0x3e953ec4,0x3f7fbf55,0x3f0e0000,0x3f7bbf6d,0x3e48bf35,0xbf553ec4,0xbef10000,0xbf7f3f55,0xbf223f6d,0x3e953e48
.long 0x3ec40000,0x3f6dbf35,0x3f6dbf80,0x3ec4bf35,0xbe950000,0xbf463f0e,0xbf7f3f6d,0xbf623f7b,0x3e480000,0x3f0ebec4,0x3f55bf35,0x3f7bbf6d,0xbdc90000,0xbe953e48,0xbef13ec4,0xbf223f0e
.long 0x3f800000,0xbf800000,0x3f800000,0xbf800000,0xbf22bf35,0x3ef13f55,0xbe95bf6d,0x3dc93f7b,0xbe483f80,0x3f0ebf6d,0xbf553f35,0x3f7bbec4,0x3f62bf35,0xbf7f3e48,0x3f463ec4,0xbe95bf55
.long 0xbf6d0000,0x3ec43f35,0x3ec4bf80,0xbf6d3f35,0x3e953f35,0x3f22bf7b,0xbf7f3ec4,0x3ef13f0e,0x3f0ebf80,0xbf7b3ec4,0x3e483f35,0x3f55bf6d,0xbf7f3f35,0x3e953f0e,0x3f62bf6d,0xbf22be48
.long 0x3f350000,0x3f35bf80,0xbf350000,0xbf353f80,0x3dc9bf35,0xbf753f0e,0xbef13f6d,0x3f46be48,0xbf553f80,0x3e483ec4,0x3f7bbf35,0x3f0ebf6d,0x3f75bf35,0x3f46bf7b,0xbdc9bec4,0xbf623f0e
.long 0xbec40000,0xbf6d3f35,0xbf6d3f80,0xbec43f35,0xbef13f35,0x3dc93e48,0x3f22bec4,0x3f75bf55,0x3f7bbf80,0x3f55bf6d,0x3f0ebf35,0x3e48bec4,0xbf463f35,0xbf623f55,0xbf753f6d,0xbf7f3f7b
.long 0x3f800000,0xbf800000,0x3f800000,0xbf800000,0x3dc9bf80,0xbe953f7b,0x3ef1bf6d,0xbf223f55,0xbf7b0000,0x3f553ec4,0xbf0ebf35,0x3e483f6d,0xbe953f80,0x3f46bf55,0xbf7f3ec4,0x3f623e48
.long 0x3f6d0000,0xbec4bf35,0xbec43f80,0x3f6dbf35,0x3ef1bf80,0xbf7f3f0e,0x3f223ec4,0x3e95bf7b,0xbf550000,0xbe483f6d,0x3f7bbf35,0xbf0ebec4,0xbf223f80,0x3f62be48,0x3e95bf6d,0xbf7f3f0e
.long 0x3f350000,0x3f35bf80,0xbf350000,0xbf353f80,0x3f46bf80,0xbef1be48,0xbf753f6d,0x3dc93f0e,0xbf0e0000,0xbf7b3f6d,0xbe483f35,0x3f55bec4,0xbf623f80,0xbdc93f0e,0x3f46bec4,0x3f75bf7b
.long 0x3ec40000,0x3f6dbf35,0x3f6dbf80,0x3ec4bf35,0x3f75bf80,0x3f22bf55,0x3dc9bec4,0xbef13e48,0xbe480000,0xbf0e3ec4,0xbf553f35,0xbf7b3f6d,0xbf7f3f80,0xbf753f7b,0xbf623f6d,0xbf463f55
.long 0x3f800000,0xbf800000,0x3f800000,0xbf800000,0x3f46bf35,0xbf623f0e,0x3f75bec4,0xbf7f3e48,0x3e48bf80,0xbf0e3f6d,0x3f55bf35,0xbf7b3ec4,0xbef1bf35,0xbdc93f7b,0x3f22bf6d,0xbf753f0e
.long 0xbf6d0000,0x3ec43f35,0x3ec4bf80,0xbf6d3f35,0xbf753f35,0x3f463e48,0x3dc9bf6d,0xbf623f55,0xbf0e3f80,0x3f7bbec4,0xbe48bf35,0xbf553f6d,0x3dc93f35,0x3f75bf55,0xbef1bec4,0xbf463f7b
.long 0x3f350000,0x3f35bf80,0xbf350000,0xbf353f80,0x3f7fbf35,0x3e95bf55,0xbf623ec4,0xbf223f7b,0x3f55bf80,0xbe48bec4,0xbf7b3f35,0xbf0e3f6d,0x3e95bf35,0xbf223e48,0xbf7f3f6d,0xbef13f55
.long 0xbec40000,0xbf6d3f35,0xbf6d3f80,0xbec43f35,0xbf623f35,0xbf7f3f7b,0xbf463f6d,0xbe953f0e,0xbf7b3f80,0xbf553f6d,0xbf0e3f35,0xbe483ec4,0xbf223f35,0xbef13f0e,0xbe953ec4,0xbdc93e48
.long 0x0,0x0,0x0,0x0,0xbdc90000,0xbe953e48,0xbef13ec4,0xbf223f0e,0xbe480000,0xbf0e3ec4,0xbf553f35,0xbf7b3f6d,0xbe950000,0xbf463f0e,0xbf7f3f6d,0xbf623f7b
.long 0xbec40000,0xbf6d3f35,0xbf6d3f80,0xbec43f35,0xbef10000,0xbf7f3f55,0xbf223f6d,0x3e953e48,0xbf0e0000,0xbf7b3f6d,0xbe483f35,0x3f55bec4,0xbf220000,0xbf623f7b,0x3e953ec4,0x3f7fbf55
.long 0xbf350000,0xbf353f80,0x3f350000,0x3f35bf80,0xbf460000,0xbef13f7b,0x3f75bec4,0x3dc9bf55,0xbf550000,0xbe483f6d,0x3f7bbf35,0xbf0ebec4,0xbf620000,0x3dc93f55,0x3f46bf6d,0xbf753e48
.long 0xbf6d0000,0x3ec43f35,0x3ec4bf80,0xbf6d3f35,0xbf750000,0x3f223f0e,0xbdc9bf6d,0xbef13f7b,0xbf7b0000,0x3f553ec4,0xbf0ebf35,0x3e483f6d,0xbf7f0000,0x3f753e48,0xbf62bec4,0x3f463f0e
.long 0x0,0x0,0x0,0x0,0xbf463f35,0xbf623f55,0xbf753f6d,0xbf7f3f7b,0xbf7b3f80,0xbf553f6d,0xbf0e3f35,0xbe483ec4,0xbef13f35,0x3dc93e48,0x3f22bec4,0x3f75bf55
.long 0x3ec40000,0x3f6dbf35,0x3f6dbf80,0x3ec4bf35,0x3f75bf35,0x3f46bf7b,0xbdc9bec4,0xbf623f0e,0x3f55bf80,0xbe48bec4,0xbf7b3f35,0xbf0e3f6d,0x3dc9bf35,0xbf753f0e,0xbef13f6d,0x3f46be48
.long 0xbf350000,0xbf353f80,0x3f350000,0x3f35bf80,0xbf7f3f35,0x3e953f0e,0x3f62bf6d,0xbf22be48,0xbf0e3f80,0x3f7bbec4,0xbe48bf35,0xbf553f6d,0x3e953f35,0x3f22bf7b,0xbf7f3ec4,0x3ef13f0e
.long 0x3f6d0000,0xbec4bf35,0xbec43f80,0x3f6dbf35,0x3f62bf35,0xbf7f3e48,0x3f463ec4,0xbe95bf55,0x3e48bf80,0xbf0e3f6d,0x3f55bf35,0xbf7b3ec4,0xbf22bf35,0x3ef13f55,0xbe95bf6d,0x3dc93f7b
.long 0x0,0x0,0x0,0x0,0xbf7f3f80,0xbf753f7b,0xbf623f6d,0xbf463f55,0x3e480000,0x3f0ebec4,0x3f55bf35,0x3f7bbf6d,0x3f75bf80,0x3f22bf55,0x3dc9bec4,0xbef13e48
.long 0xbec40000,0xbf6d3f35,0xbf6d3f80,0xbec43f35,0xbf623f80,0xbdc93f0e,0x3f46bec4,0x3f75bf7b,0x3f0e0000,0x3f7bbf6d,0x3e48bf35,0xbf553ec4,0x3f46bf80,0xbef1be48,0xbf753f6d,0x3dc93f0e
.long 0xbf350000,0xbf353f80,0x3f350000,0x3f35bf80,0xbf223f80,0x3f62be48,0x3e95bf6d,0xbf7f3f0e,0x3f550000,0x3e48bf6d,0xbf7b3f35,0x3f0e3ec4,0x3ef1bf80,0xbf7f3f0e,0x3f223ec4,0x3e95bf7b
.long 0xbf6d0000,0x3ec43f35,0x3ec4bf80,0xbf6d3f35,0xbe953f80,0x3f46bf55,0xbf7f3ec4,0x3f623e48,0x3f7b0000,0xbf55bec4,0x3f0e3f35,0xbe48bf6d,0x3dc9bf80,0xbe953f7b,0x3ef1bf6d,0xbf223f55
.long 0x0,0x0,0x0,0x0,0xbf223f35,0xbef13f0e,0xbe953ec4,0xbdc93e48,0x3f7bbf80,0x3f55bf6d,0x3f0ebf35,0x3e48bec4,0xbf623f35,0xbf7f3f7b,0xbf463f6d,0xbe953f0e
.long 0x3ec40000,0x3f6dbf35,0x3f6dbf80,0x3ec4bf35,0x3e95bf35,0xbf223e48,0xbf7f3f6d,0xbef13f55,0xbf553f80,0x3e483ec4,0x3f7bbf35,0x3f0ebf6d,0x3f7fbf35,0x3e95bf55,0xbf623ec4,0xbf223f7b
.long 0xbf350000,0xbf353f80,0x3f350000,0x3f35bf80,0x3dc93f35,0x3f75bf55,0xbef1bec4,0xbf463f7b,0x3f0ebf80,0xbf7b3ec4,0x3e483f35,0x3f55bf6d,0xbf753f35,0x3f463e48,0x3dc9bf6d,0xbf623f55
.long 0x3f6d0000,0xbec4bf35,0xbec43f80,0x3f6dbf35,0xbef1bf35,0xbdc93f7b,0x3f22bf6d,0xbf753f0e,0xbe483f80,0x3f0ebf6d,0xbf553f35,0x3f7bbec4,0x3f46bf35,0xbf623f0e,0x3f75bec4,0xbf7f3e48
.long 0x0,0x0,0x0,0x0,0x3dc90000,0x3e95be48,0x3ef1bec4,0x3f22bf0e,0xbe480000,0xbf0e3ec4,0xbf553f35,0xbf7b3f6d,0x3e950000,0x3f46bf0e,0x3f7fbf6d,0x3f62bf7b
.long 0xbec40000,0xbf6d3f35,0xbf6d3f80,0xbec43f35,0x3ef10000,0x3f7fbf55,0x3f22bf6d,0xbe95be48,0xbf0e0000,0xbf7b3f6d,0xbe483f35,0x3f55bec4,0x3f220000,0x3f62bf7b,0xbe95bec4,0xbf7f3f55
.long 0xbf350000,0xbf353f80,0x3f350000,0x3f35bf80,0x3f460000,0x3ef1bf7b,0xbf753ec4,0xbdc93f55,0xbf550000,0xbe483f6d,0x3f7bbf35,0xbf0ebec4,0x3f620000,0xbdc9bf55,0xbf463f6d,0x3f75be48
.long 0xbf6d0000,0x3ec43f35,0x3ec4bf80,0xbf6d3f35,0x3f750000,0xbf22bf0e,0x3dc93f6d,0x3ef1bf7b,0xbf7b0000,0x3f553ec4,0xbf0ebf35,0x3e483f6d,0x3f7f0000,0xbf75be48,0x3f623ec4,0xbf46bf0e
.long 0x0,0x0,0x0,0x0,0x3f46bf35,0x3f62bf55,0x3f75bf6d,0x3f7fbf7b,0xbf7b3f80,0xbf553f6d,0xbf0e3f35,0xbe483ec4,0x3ef1bf35,0xbdc9be48,0xbf223ec4,0xbf753f55
.long 0x3ec40000,0x3f6dbf35,0x3f6dbf80,0x3ec4bf35,0xbf753f35,0xbf463f7b,0x3dc93ec4,0x3f62bf0e,0x3f55bf80,0xbe48bec4,0xbf7b3f35,0xbf0e3f6d,0xbdc93f35,0x3f75bf0e,0x3ef1bf6d,0xbf463e48
.long 0xbf350000,0xbf353f80,0x3f350000,0x3f35bf80,0x3f7fbf35,0xbe95bf0e,0xbf623f6d,0x3f223e48,0xbf0e3f80,0x3f7bbec4,0xbe48bf35,0xbf553f6d,0xbe95bf35,0xbf223f7b,0x3f7fbec4,0xbef1bf0e
.long 0x3f6d0000,0xbec4bf35,0xbec43f80,0x3f6dbf35,0xbf623f35,0x3f7fbe48,0xbf46bec4,0x3e953f55,0x3e48bf80,0xbf0e3f6d,0x3f55bf35,0xbf7b3ec4,0x3f223f35,0xbef1bf55,0x3e953f6d,0xbdc9bf7b
.long 0x0,0x0,0x0,0x0,0x3f7fbf80,0x3f75bf7b,0x3f62bf6d,0x3f46bf55,0x3e480000,0x3f0ebec4,0x3f55bf35,0x3f7bbf6d,0xbf753f80,0xbf223f55,0xbdc93ec4,0x3ef1be48
.long 0xbec40000,0xbf6d3f35,0xbf6d3f80,0xbec43f35,0x3f62bf80,0x3dc9bf0e,0xbf463ec4,0xbf753f7b,0x3f0e0000,0x3f7bbf6d,0x3e48bf35,0xbf553ec4,0xbf463f80,0x3ef13e48,0x3f75bf6d,0xbdc9bf0e
.long 0xbf350000,0xbf353f80,0x3f350000,0x3f35bf80,0x3f22bf80,0xbf623e48,0xbe953f6d,0x3f7fbf0e,0x3f550000,0x3e48bf6d,0xbf7b3f35,0x3f0e3ec4,0xbef13f80,0x3f7fbf0e,0xbf22bec4,0xbe953f7b
.long 0xbf6d0000,0x3ec43f35,0x3ec4bf80,0xbf6d3f35,0x3e95bf80,0xbf463f55,0x3f7fbec4,0xbf62be48,0x3f7b0000,0xbf55bec4,0x3f0e3f35,0xbe48bf6d,0xbdc93f80,0x3e95bf7b,0xbef13f6d,0x3f22bf55
.long 0x0,0x0,0x0,0x0,0x3f22bf35,0x3ef1bf0e,0x3e95bec4,0x3dc9be48,0x3f7bbf80,0x3f55bf6d,0x3f0ebf35,0x3e48bec4,0x3f62bf35,0x3f7fbf7b,0x3f46bf6d,0x3e95bf0e
.long 0x3ec40000,0x3f6dbf35,0x3f6dbf80,0x3ec4bf35,0xbe953f35,0x3f22be48,0x3f7fbf6d,0x3ef1bf55,0xbf553f80,0x3e483ec4,0x3f7bbf35,0x3f0ebf6d,0xbf7f3f35,0xbe953f55,0x3f62bec4,0x3f22bf7b
.long 0xbf350000,0xbf353f80,0x3f350000,0x3f35bf80,0xbdc9bf35,0xbf753f55,0x3ef13ec4,0x3f46bf7b,0x3f0ebf80,0xbf7b3ec4,0x3e483f35,0x3f55bf6d,0x3f75bf35,0xbf46be48,0xbdc93f6d,0x3f62bf55
.long 0x3f6d0000,0xbec4bf35,0xbec43f80,0x3f6dbf35,0x3ef13f35,0x3dc9bf7b,0xbf223f6d,0x3f75bf0e,0xbe483f80,0x3f0ebf6d,0xbf553f35,0x3f7bbec4,0xbf463f35,0x3f62bf0e,0xbf753ec4,0x3f7fbe48
.long 0xbf800000,0x3f800000,0xbf800000,0x3f800000,0xbf7f0000,0x3f75be48,0xbf623ec4,0x3f46bf0e,0xbf7b0000,0x3f55bec4,0xbf0e3f35,0x3e48bf6d,0xbf750000,0x3f22bf0e,0xbdc93f6d,0xbef1bf7b
.long 0xbf6d0000,0x3ec4bf35,0x3ec43f80,0xbf6dbf35,0xbf620000,0x3dc9bf55,0x3f463f6d,0xbf75be48,0xbf550000,0xbe48bf6d,0x3f7b3f35,0xbf0e3ec4,0xbf460000,0xbef1bf7b,0x3f753ec4,0x3dc93f55
.long 0xbf350000,0xbf35bf80,0x3f350000,0x3f353f80,0xbf220000,0xbf62bf7b,0x3e95bec4,0x3f7f3f55,0xbf0e0000,0xbf7bbf6d,0xbe48bf35,0x3f553ec4,0xbef10000,0xbf7fbf55,0xbf22bf6d,0x3e95be48
.long 0xbec40000,0xbf6dbf35,0xbf6dbf80,0xbec4bf35,0xbe950000,0xbf46bf0e,0xbf7fbf6d,0xbf62bf7b,0xbe480000,0xbf0ebec4,0xbf55bf35,0xbf7bbf6d,0xbdc90000,0xbe95be48,0xbef1bec4,0xbf22bf0e
.long 0xbf800000,0x3f800000,0xbf800000,0x3f800000,0xbf223f35,0x3ef1bf55,0xbe953f6d,0x3dc9bf7b,0x3e483f80,0xbf0ebf6d,0x3f553f35,0xbf7bbec4,0x3f623f35,0xbf7fbe48,0x3f46bec4,0xbe953f55
.long 0x3f6d0000,0xbec43f35,0xbec4bf80,0x3f6d3f35,0x3e95bf35,0x3f223f7b,0xbf7fbec4,0x3ef1bf0e,0xbf0ebf80,0x3f7b3ec4,0xbe483f35,0xbf55bf6d,0xbf7fbf35,0x3e95bf0e,0x3f623f6d,0xbf223e48
.long 0xbf350000,0xbf35bf80,0x3f350000,0x3f353f80,0x3dc93f35,0xbf75bf0e,0xbef1bf6d,0x3f463e48,0x3f553f80,0xbe483ec4,0xbf7bbf35,0xbf0ebf6d,0x3f753f35,0x3f463f7b,0xbdc93ec4,0xbf62bf0e
.long 0x3ec40000,0x3f6d3f35,0x3f6d3f80,0x3ec43f35,0xbef1bf35,0x3dc9be48,0x3f223ec4,0x3f753f55,0xbf7bbf80,0xbf55bf6d,0xbf0ebf35,0xbe48bec4,0xbf46bf35,0xbf62bf55,0xbf75bf6d,0xbf7fbf7b
.long 0xbf800000,0x3f800000,0xbf800000,0x3f800000,0x3dc93f80,0xbe95bf7b,0x3ef13f6d,0xbf22bf55,0x3f7b0000,0xbf553ec4,0x3f0ebf35,0xbe483f6d,0xbe95bf80,0x3f463f55,0xbf7fbec4,0x3f62be48
.long 0xbf6d0000,0x3ec4bf35,0x3ec43f80,0xbf6dbf35,0x3ef13f80,0xbf7fbf0e,0x3f22bec4,0x3e953f7b,0x3f550000,0x3e483f6d,0xbf7bbf35,0x3f0ebec4,0xbf22bf80,0x3f623e48,0x3e953f6d,0xbf7fbf0e
.long 0xbf350000,0xbf35bf80,0x3f350000,0x3f353f80,0x3f463f80,0xbef13e48,0xbf75bf6d,0x3dc9bf0e,0x3f0e0000,0x3f7b3f6d,0x3e483f35,0xbf55bec4,0xbf62bf80,0xbdc9bf0e,0x3f463ec4,0x3f753f7b
.long 0xbec40000,0xbf6dbf35,0xbf6dbf80,0xbec4bf35,0x3f753f80,0x3f223f55,0x3dc93ec4,0xbef1be48,0x3e480000,0x3f0e3ec4,0x3f553f35,0x3f7b3f6d,0xbf7fbf80,0xbf75bf7b,0xbf62bf6d,0xbf46bf55
.long 0xbf800000,0x3f800000,0xbf800000,0x3f800000,0x3f463f35,0xbf62bf0e,0x3f753ec4,0xbf7fbe48,0xbe48bf80,0x3f0e3f6d,0xbf55bf35,0x3f7b3ec4,0xbef13f35,0xbdc9bf7b,0x3f223f6d,0xbf75bf0e
.long 0x3f6d0000,0xbec43f35,0xbec4bf80,0x3f6d3f35,0xbf75bf35,0x3f46be48,0x3dc93f6d,0xbf62bf55,0x3f0e3f80,0xbf7bbec4,0x3e48bf35,0x3f553f6d,0x3dc9bf35,0x3f753f55,0xbef13ec4,0xbf46bf7b
.long 0xbf350000,0xbf35bf80,0x3f350000,0x3f353f80,0x3f7f3f35,0x3e953f55,0xbf62bec4,0xbf22bf7b,0xbf55bf80,0x3e48bec4,0x3f7b3f35,0x3f0e3f6d,0x3e953f35,0xbf22be48,0xbf7fbf6d,0xbef1bf55
.long 0x3ec40000,0x3f6d3f35,0x3f6d3f80,0x3ec43f35,0xbf62bf35,0xbf7fbf7b,0xbf46bf6d,0xbe95bf0e,0x3f7b3f80,0x3f553f6d,0x3f0e3f35,0x3e483ec4,0xbf22bf35,0xbef1bf0e,0xbe95bec4,0xbdc9be48
.long 0xbf800000,0x3f800000,0xbf800000,0x3f800000,0x3f7f0000,0xbf753e48,0x3f62bec4,0xbf463f0e,0xbf7b0000,0x3f55bec4,0xbf0e3f35,0x3e48bf6d,0x3f750000,0xbf223f0e,0x3dc9bf6d,0x3ef13f7b
.long 0xbf6d0000,0x3ec4bf35,0x3ec43f80,0xbf6dbf35,0x3f620000,0xbdc93f55,0xbf46bf6d,0x3f753e48,0xbf550000,0xbe48bf6d,0x3f7b3f35,0xbf0e3ec4,0x3f460000,0x3ef13f7b,0xbf75bec4,0xbdc9bf55
.long 0xbf350000,0xbf35bf80,0x3f350000,0x3f353f80,0x3f220000,0x3f623f7b,0xbe953ec4,0xbf7fbf55,0xbf0e0000,0xbf7bbf6d,0xbe48bf35,0x3f553ec4,0x3ef10000,0x3f7f3f55,0x3f223f6d,0xbe953e48
.long 0xbec40000,0xbf6dbf35,0xbf6dbf80,0xbec4bf35,0x3e950000,0x3f463f0e,0x3f7f3f6d,0x3f623f7b,0xbe480000,0xbf0ebec4,0xbf55bf35,0xbf7bbf6d,0x3dc90000,0x3e953e48,0x3ef13ec4,0x3f223f0e
.long 0xbf800000,0x3f800000,0xbf800000,0x3f800000,0x3f22bf35,0xbef13f55,0x3e95bf6d,0xbdc93f7b,0x3e483f80,0xbf0ebf6d,0x3f553f35,0xbf7bbec4,0xbf62bf35,0x3f7f3e48,0xbf463ec4,0x3e95bf55
.long 0x3f6d0000,0xbec43f35,0xbec4bf80,0x3f6d3f35,0xbe953f35,0xbf22bf7b,0x3f7f3ec4,0xbef13f0e,0xbf0ebf80,0x3f7b3ec4,0xbe483f35,0xbf55bf6d,0x3f7f3f35,0xbe953f0e,0xbf62bf6d,0x3f22be48
.long 0xbf350000,0xbf35bf80,0x3f350000,0x3f353f80,0xbdc9bf35,0x3f753f0e,0x3ef13f6d,0xbf46be48,0x3f553f80,0xbe483ec4,0xbf7bbf35,0xbf0ebf6d,0xbf75bf35,0xbf46bf7b,0x3dc9bec4,0x3f623f0e
.long 0x3ec40000,0x3f6d3f35,0x3f6d3f80,0x3ec43f35,0x3ef13f35,0xbdc93e48,0xbf22bec4,0xbf75bf55,0xbf7bbf80,0xbf55bf6d,0xbf0ebf35,0xbe48bec4,0x3f463f35,0x3f623f55,0x3f753f6d,0x3f7f3f7b
.long 0xbf800000,0x3f800000,0xbf800000,0x3f800000,0xbdc9bf80,0x3e953f7b,0xbef1bf6d,0x3f223f55,0x3f7b0000,0xbf553ec4,0x3f0ebf35,0xbe483f6d,0x3e953f80,0xbf46bf55,0x3f7f3ec4,0xbf623e48
.long 0xbf6d0000,0x3ec4bf35,0x3ec43f80,0xbf6dbf35,0xbef1bf80,0x3f7f3f0e,0xbf223ec4,0xbe95bf7b,0x3f550000,0x3e483f6d,0xbf7bbf35,0x3f0ebec4,0x3f223f80,0xbf62be48,0xbe95bf6d,0x3f7f3f0e
.long 0xbf350000,0xbf35bf80,0x3f350000,0x3f353f80,0xbf46bf80,0x3ef1be48,0x3f753f6d,0xbdc93f0e,0x3f0e0000,0x3f7b3f6d,0x3e483f35,0xbf55bec4,0x3f623f80,0x3dc93f0e,0xbf46bec4,0xbf75bf7b
.long 0xbec40000,0xbf6dbf35,0xbf6dbf80,0xbec4bf35,0xbf75bf80,0xbf22bf55,0xbdc9bec4,0x3ef13e48,0x3e480000,0x3f0e3ec4,0x3f553f35,0x3f7b3f6d,0x3f7f3f80,0x3f753f7b,0x3f623f6d,0x3f463f55
.long 0xbf800000,0x3f800000,0xbf800000,0x3f800000,0xbf46bf35,0x3f623f0e,0xbf75bec4,0x3f7f3e48,0xbe48bf80,0x3f0e3f6d,0xbf55bf35,0x3f7b3ec4,0x3ef1bf35,0x3dc93f7b,0xbf22bf6d,0x3f753f0e
.long 0x3f6d0000,0xbec43f35,0xbec4bf80,0x3f6d3f35,0x3f753f35,0xbf463e48,0xbdc9bf6d,0x3f623f55,0x3f0e3f80,0xbf7bbec4,0x3e48bf35,0x3f553f6d,0xbdc93f35,0xbf75bf55,0x3ef1bec4,0x3f463f7b
.long 0xbf350000,0xbf35bf80,0x3f350000,0x3f353f80,0xbf7fbf35,0xbe95bf55,0x3f623ec4,0x3f223f7b,0xbf55bf80,0x3e48bec4,0x3f7b3f35,0x3f0e3f6d,0xbe95bf35,0x3f223e48,0x3f7f3f6d,0x3ef13f55
.long 0x3ec40000,0x3f6d3f35,0x3f6d3f80,0x3ec43f35,0x3f623f35,0x3f7f3f7b,0x3f463f6d,0x3e953f0e,0x3f7b3f80,0x3f553f6d,0x3f0e3f35,0x3e483ec4,0x3f223f35,0x3ef13f0e,0x3e953ec4,0x3dc93e48
.long 0x3f803f80,0x3f803f80,0x3f803f80,0x3f803f80,0x3f7b3f80,0x3f553f6d,0xbf7bbf80,0xbf55bf6d,0x3f6d3f80,0x3ec43f35,0x3f6d3f80,0x3ec43f35,0x3f553f80,0xbe483ec4,0xbf55bf80,0x3e48bec4
.long 0x3f353f80,0xbf350000,0x3f353f80,0xbf350000,0x3f0e3f80,0xbf7bbec4,0xbf0ebf80,0x3f7b3ec4,0x3ec43f80,0xbf6dbf35,0x3ec43f80,0xbf6dbf35,0x3e483f80,0xbf0ebf6d,0xbe48bf80,0x3f0e3f6d
.long 0x3f80,0xbf80,0x3f80,0xbf80,0xbe483f80,0x3f0ebf6d,0x3e48bf80,0xbf0e3f6d,0xbec43f80,0x3f6dbf35,0xbec43f80,0x3f6dbf35,0xbf0e3f80,0x3f7bbec4,0x3f0ebf80,0xbf7b3ec4
.long 0xbf353f80,0x3f350000,0xbf353f80,0x3f350000,0xbf553f80,0x3e483ec4,0x3f55bf80,0xbe48bec4,0xbf6d3f80,0xbec43f35,0xbf6d3f80,0xbec43f35,0xbf7b3f80,0xbf553f6d,0x3f7bbf80,0x3f55bf6d
.long 0x3f803f80,0x3f803f80,0x3f803f80,0x3f803f80,0x3f0e3f35,0x3e483ec4,0xbf0ebf35,0xbe48bec4,0xbec40000,0xbf6dbf35,0xbec40000,0xbf6dbf35,0xbf7bbf35,0xbf0ebf6d,0x3f7b3f35,0x3f0e3f6d
.long 0xbf35bf80,0x3f350000,0xbf35bf80,0x3f350000,0x3e48bf35,0x3f553f6d,0xbe483f35,0xbf55bf6d,0x3f6d0000,0xbec43f35,0x3f6d0000,0xbec43f35,0x3f553f35,0xbf7bbec4,0xbf55bf35,0x3f7b3ec4
.long 0x3f80,0xbf80,0x3f80,0xbf80,0xbf553f35,0x3f7bbec4,0x3f55bf35,0xbf7b3ec4,0xbf6d0000,0x3ec43f35,0xbf6d0000,0x3ec43f35,0xbe48bf35,0xbf553f6d,0x3e483f35,0x3f55bf6d
.long 0x3f35bf80,0xbf350000,0x3f35bf80,0xbf350000,0x3f7bbf35,0x3f0ebf6d,0xbf7b3f35,0xbf0e3f6d,0x3ec40000,0x3f6dbf35,0x3ec40000,0x3f6dbf35,0xbf0e3f35,0xbe483ec4,0x3f0ebf35,0x3e48bec4
.long 0x3f803f80,0x3f803f80,0x3f803f80,0x3f803f80,0xbe480000,0xbf0ebec4,0x3e480000,0x3f0e3ec4,0xbf6dbf80,0xbec4bf35,0xbf6dbf80,0xbec4bf35,0x3f0e0000,0x3f7b3f6d,0xbf0e0000,0xbf7bbf6d
.long 0x3f353f80,0xbf350000,0x3f353f80,0xbf350000,0xbf550000,0xbe48bf6d,0x3f550000,0x3e483f6d,0xbec4bf80,0x3f6d3f35,0xbec4bf80,0x3f6d3f35,0x3f7b0000,0xbf553ec4,0xbf7b0000,0x3f55bec4
.long 0x3f80,0xbf80,0x3f80,0xbf80,0xbf7b0000,0x3f553ec4,0x3f7b0000,0xbf55bec4,0x3ec4bf80,0xbf6d3f35,0x3ec4bf80,0xbf6d3f35,0x3f550000,0x3e48bf6d,0xbf550000,0xbe483f6d
.long 0xbf353f80,0x3f350000,0xbf353f80,0x3f350000,0xbf0e0000,0xbf7b3f6d,0x3f0e0000,0x3f7bbf6d,0x3f6dbf80,0x3ec4bf35,0x3f6dbf80,0x3ec4bf35,0x3e480000,0x3f0ebec4,0xbe480000,0xbf0e3ec4
.long 0x3f803f80,0x3f803f80,0x3f803f80,0x3f803f80,0xbf55bf35,0xbf7bbf6d,0x3f553f35,0x3f7b3f6d,0x3ec40000,0x3f6d3f35,0x3ec40000,0x3f6d3f35,0x3e483f35,0xbf55bec4,0xbe48bf35,0x3f553ec4
.long 0xbf35bf80,0x3f350000,0xbf35bf80,0x3f350000,0x3f7b3f35,0xbf0e3ec4,0xbf7bbf35,0x3f0ebec4,0xbf6d0000,0x3ec4bf35,0xbf6d0000,0x3ec4bf35,0x3f0ebf35,0xbe483f6d,0xbf0e3f35,0x3e48bf6d
.long 0x3f80,0xbf80,0x3f80,0xbf80,0xbf0ebf35,0x3e483f6d,0x3f0e3f35,0xbe48bf6d,0x3f6d0000,0xbec4bf35,0x3f6d0000,0xbec4bf35,0xbf7b3f35,0x3f0e3ec4,0x3f7bbf35,0xbf0ebec4
.long 0x3f35bf80,0xbf350000,0x3f35bf80,0xbf350000,0xbe483f35,0x3f55bec4,0x3e48bf35,0xbf553ec4,0xbec40000,0xbf6d3f35,0xbec40000,0xbf6d3f35,0x3f55bf35,0x3f7bbf6d,0xbf553f35,0xbf7b3f6d
.long 0xbf803f80,0xbf803f80,0xbf803f80,0xbf803f80,0xbf7b3f80,0xbf553f6d,0x3f7bbf80,0x3f55bf6d,0xbf6d3f80,0xbec43f35,0xbf6d3f80,0xbec43f35,0xbf553f80,0x3e483ec4,0x3f55bf80,0xbe48bec4
.long 0xbf353f80,0x3f350000,0xbf353f80,0x3f350000,0xbf0e3f80,0x3f7bbec4,0x3f0ebf80,0xbf7b3ec4,0xbec43f80,0x3f6dbf35,0xbec43f80,0x3f6dbf35,0xbe483f80,0x3f0ebf6d,0x3e48bf80,0xbf0e3f6d
.long 0x3f80,0xbf80,0x3f80,0xbf80,0x3e483f80,0xbf0ebf6d,0xbe48bf80,0x3f0e3f6d,0x3ec43f80,0xbf6dbf35,0x3ec43f80,0xbf6dbf35,0x3f0e3f80,0xbf7bbec4,0xbf0ebf80,0x3f7b3ec4
.long 0x3f353f80,0xbf350000,0x3f353f80,0xbf350000,0x3f553f80,0xbe483ec4,0xbf55bf80,0x3e48bec4,0x3f6d3f80,0x3ec43f35,0x3f6d3f80,0x3ec43f35,0x3f7b3f80,0x3f553f6d,0xbf7bbf80,0xbf55bf6d
.long 0xbf803f80,0xbf803f80,0xbf803f80,0xbf803f80,0xbf0e3f35,0xbe483ec4,0x3f0ebf35,0x3e48bec4,0x3ec40000,0x3f6dbf35,0x3ec40000,0x3f6dbf35,0x3f7bbf35,0x3f0ebf6d,0xbf7b3f35,0xbf0e3f6d
.long 0x3f35bf80,0xbf350000,0x3f35bf80,0xbf350000,0xbe48bf35,0xbf553f6d,0x3e483f35,0x3f55bf6d,0xbf6d0000,0x3ec43f35,0xbf6d0000,0x3ec43f35,0xbf553f35,0x3f7bbec4,0x3f55bf35,0xbf7b3ec4
.long 0x3f80,0xbf80,0x3f80,0xbf80,0x3f553f35,0xbf7bbec4,0xbf55bf35,0x3f7b3ec4,0x3f6d0000,0xbec43f35,0x3f6d0000,0xbec43f35,0x3e48bf35,0x3f553f6d,0xbe483f35,0xbf55bf6d
.long 0xbf35bf80,0x3f350000,0xbf35bf80,0x3f350000,0xbf7bbf35,0xbf0ebf6d,0x3f7b3f35,0x3f0e3f6d,0xbec40000,0xbf6dbf35,0xbec40000,0xbf6dbf35,0x3f0e3f35,0x3e483ec4,0xbf0ebf35,0xbe48bec4
.long 0xbf803f80,0xbf803f80,0xbf803f80,0xbf803f80,0x3e480000,0x3f0ebec4,0xbe480000,0xbf0e3ec4,0x3f6dbf80,0x3ec4bf35,0x3f6dbf80,0x3ec4bf35,0xbf0e0000,0xbf7b3f6d,0x3f0e0000,0x3f7bbf6d
.long 0xbf353f80,0x3f350000,0xbf353f80,0x3f350000,0x3f550000,0x3e48bf6d,0xbf550000,0xbe483f6d,0x3ec4bf80,0xbf6d3f35,0x3ec4bf80,0xbf6d3f35,0xbf7b0000,0x3f553ec4,0x3f7b0000,0xbf55bec4
.long 0x3f80,0xbf80,0x3f80,0xbf80,0x3f7b0000,0xbf553ec4,0xbf7b0000,0x3f55bec4,0xbec4bf80,0x3f6d3f35,0xbec4bf80,0x3f6d3f35,0xbf550000,0xbe48bf6d,0x3f550000,0x3e483f6d
.long 0x3f353f80,0xbf350000,0x3f353f80,0xbf350000,0x3f0e0000,0x3f7b3f6d,0xbf0e0000,0xbf7bbf6d,0xbf6dbf80,0xbec4bf35,0xbf6dbf80,0xbec4bf35,0xbe480000,0xbf0ebec4,0x3e480000,0x3f0e3ec4
.long 0xbf803f80,0xbf803f80,0xbf803f80,0xbf803f80,0x3f55bf35,0x3f7bbf6d,0xbf553f35,0xbf7b3f6d,0xbec40000,0xbf6d3f35,0xbec40000,0xbf6d3f35,0xbe483f35,0x3f55bec4,0x3e48bf35,0xbf553ec4
.long 0x3f35bf80,0xbf350000,0x3f35bf80,0xbf350000,0xbf7b3f35,0x3f0e3ec4,0x3f7bbf35,0xbf0ebec4,0x3f6d0000,0xbec4bf35,0x3f6d0000,0xbec4bf35,0xbf0ebf35,0x3e483f6d,0x3f0e3f35,0xbe48bf6d
.long 0x3f80,0xbf80,0x3f80,0xbf80,0x3f0ebf35,0xbe483f6d,0xbf0e3f35,0x3e48bf6d,0xbf6d0000,0x3ec4bf35,0xbf6d0000,0x3ec4bf35,0x3f7b3f35,0xbf0e3ec4,0xbf7bbf35,0x3f0ebec4
.long 0xbf35bf80,0x3f350000,0xbf35bf80,0x3f350000,0x3e483f35,0xbf55bec4,0xbe48bf35,0x3f553ec4,0x3ec40000,0x3f6d3f35,0x3ec40000,0x3f6d3f35,0xbf55bf35,0xbf7bbf6d,0x3f553f35,0x3f7b3f6d
.long 0x0,0x0,0x0,0x0,0x3e480000,0x3f0e3ec4,0xbe480000,0xbf0ebec4,0x3ec40000,0x3f6d3f35,0x3ec40000,0x3f6d3f35,0x3f0e0000,0x3f7b3f6d,0xbf0e0000,0xbf7bbf6d
.long 0x3f350000,0x3f353f80,0x3f350000,0x3f353f80,0x3f550000,0x3e483f6d,0xbf550000,0xbe48bf6d,0x3f6d0000,0xbec43f35,0x3f6d0000,0xbec43f35,0x3f7b0000,0xbf553ec4,0xbf7b0000,0x3f55bec4
.long 0x3f800000,0xbf800000,0x3f800000,0xbf800000,0x3f7b0000,0xbf55bec4,0xbf7b0000,0x3f553ec4,0x3f6d0000,0xbec4bf35,0x3f6d0000,0xbec4bf35,0x3f550000,0x3e48bf6d,0xbf550000,0xbe483f6d
.long 0x3f350000,0x3f35bf80,0x3f350000,0x3f35bf80,0x3f0e0000,0x3f7bbf6d,0xbf0e0000,0xbf7b3f6d,0x3ec40000,0x3f6dbf35,0x3ec40000,0x3f6dbf35,0x3e480000,0x3f0ebec4,0xbe480000,0xbf0e3ec4
.long 0x0,0x0,0x0,0x0,0x3f553f35,0x3f7b3f6d,0xbf55bf35,0xbf7bbf6d,0x3f6d3f80,0x3ec43f35,0x3f6d3f80,0x3ec43f35,0x3e483f35,0xbf55bec4,0xbe48bf35,0x3f553ec4
.long 0xbf350000,0xbf35bf80,0xbf350000,0xbf35bf80,0xbf7bbf35,0x3f0ebec4,0x3f7b3f35,0xbf0e3ec4,0xbec4bf80,0x3f6d3f35,0xbec4bf80,0x3f6d3f35,0x3f0ebf35,0xbe483f6d,0xbf0e3f35,0x3e48bf6d
.long 0x3f800000,0xbf800000,0x3f800000,0xbf800000,0x3f0e3f35,0xbe48bf6d,0xbf0ebf35,0x3e483f6d,0xbec43f80,0x3f6dbf35,0xbec43f80,0x3f6dbf35,0xbf7b3f35,0x3f0e3ec4,0x3f7bbf35,0xbf0ebec4
.long 0xbf350000,0xbf353f80,0xbf350000,0xbf353f80,0x3e48bf35,0xbf553ec4,0xbe483f35,0x3f55bec4,0x3f6dbf80,0x3ec4bf35,0x3f6dbf80,0x3ec4bf35,0x3f55bf35,0x3f7bbf6d,0xbf553f35,0xbf7b3f6d
.long 0x0,0x0,0x0,0x0,0x3f7b3f80,0x3f553f6d,0xbf7bbf80,0xbf55bf6d,0xbec40000,0xbf6dbf35,0xbec40000,0xbf6dbf35,0xbf55bf80,0x3e48bec4,0x3f553f80,0xbe483ec4
.long 0x3f350000,0x3f353f80,0x3f350000,0x3f353f80,0x3f0e3f80,0xbf7bbec4,0xbf0ebf80,0x3f7b3ec4,0xbf6d0000,0x3ec4bf35,0xbf6d0000,0x3ec4bf35,0xbe48bf80,0x3f0e3f6d,0x3e483f80,0xbf0ebf6d
.long 0x3f800000,0xbf800000,0x3f800000,0xbf800000,0xbe483f80,0x3f0ebf6d,0x3e48bf80,0xbf0e3f6d,0xbf6d0000,0x3ec43f35,0xbf6d0000,0x3ec43f35,0x3f0ebf80,0xbf7b3ec4,0xbf0e3f80,0x3f7bbec4
.long 0x3f350000,0x3f35bf80,0x3f350000,0x3f35bf80,0xbf553f80,0x3e483ec4,0x3f55bf80,0xbe48bec4,0xbec40000,0xbf6d3f35,0xbec40000,0xbf6d3f35,0x3f7bbf80,0x3f55bf6d,0xbf7b3f80,0xbf553f6d
.long 0x0,0x0,0x0,0x0,0x3f0e3f35,0x3e483ec4,0xbf0ebf35,0xbe48bec4,0xbf6dbf80,0xbec4bf35,0xbf6dbf80,0xbec4bf35,0x3f7b3f35,0x3f0e3f6d,0xbf7bbf35,0xbf0ebf6d
.long 0xbf350000,0xbf35bf80,0xbf350000,0xbf35bf80,0x3e48bf35,0x3f553f6d,0xbe483f35,0xbf55bf6d,0x3ec43f80,0xbf6dbf35,0x3ec43f80,0xbf6dbf35,0xbf55bf35,0x3f7b3ec4,0x3f553f35,0xbf7bbec4
.long 0x3f800000,0xbf800000,0x3f800000,0xbf800000,0xbf553f35,0x3f7bbec4,0x3f55bf35,0xbf7b3ec4,0x3ec4bf80,0xbf6d3f35,0x3ec4bf80,0xbf6d3f35,0x3e483f35,0x3f55bf6d,0xbe48bf35,0xbf553f6d
.long 0xbf350000,0xbf353f80,0xbf350000,0xbf353f80,0x3f7bbf35,0x3f0ebf6d,0xbf7b3f35,0xbf0e3f6d,0xbf6d3f80,0xbec43f35,0xbf6d3f80,0xbec43f35,0x3f0ebf35,0x3e48bec4,0xbf0e3f35,0xbe483ec4
.long 0x0,0x0,0x0,0x0,0xbe480000,0xbf0e3ec4,0x3e480000,0x3f0ebec4,0xbec40000,0xbf6d3f35,0xbec40000,0xbf6d3f35,0xbf0e0000,0xbf7b3f6d,0x3f0e0000,0x3f7bbf6d
.long 0xbf350000,0xbf353f80,0xbf350000,0xbf353f80,0xbf550000,0xbe483f6d,0x3f550000,0x3e48bf6d,0xbf6d0000,0x3ec43f35,0xbf6d0000,0x3ec43f35,0xbf7b0000,0x3f553ec4,0x3f7b0000,0xbf55bec4
.long 0xbf800000,0x3f800000,0xbf800000,0x3f800000,0xbf7b0000,0x3f55bec4,0x3f7b0000,0xbf553ec4,0xbf6d0000,0x3ec4bf35,0xbf6d0000,0x3ec4bf35,0xbf550000,0xbe48bf6d,0x3f550000,0x3e483f6d
.long 0xbf350000,0xbf35bf80,0xbf350000,0xbf35bf80,0xbf0e0000,0xbf7bbf6d,0x3f0e0000,0x3f7b3f6d,0xbec40000,0xbf6dbf35,0xbec40000,0xbf6dbf35,0xbe480000,0xbf0ebec4,0x3e480000,0x3f0e3ec4
.long 0x0,0x0,0x0,0x0,0xbf553f35,0xbf7b3f6d,0x3f55bf35,0x3f7bbf6d,0xbf6d3f80,0xbec43f35,0xbf6d3f80,0xbec43f35,0xbe483f35,0x3f55bec4,0x3e48bf35,0xbf553ec4
.long 0x3f350000,0x3f35bf80,0x3f350000,0x3f35bf80,0x3f7bbf35,0xbf0ebec4,0xbf7b3f35,0x3f0e3ec4,0x3ec4bf80,0xbf6d3f35,0x3ec4bf80,0xbf6d3f35,0xbf0ebf35,0x3e483f6d,0x3f0e3f35,0xbe48bf6d
.long 0xbf800000,0x3f800000,0xbf800000,0x3f800000,0xbf0e3f35,0x3e48bf6d,0x3f0ebf35,0xbe483f6d,0x3ec43f80,0xbf6dbf35,0x3ec43f80,0xbf6dbf35,0x3f7b3f35,0xbf0e3ec4,0xbf7bbf35,0x3f0ebec4
.long 0x3f350000,0x3f353f80,0x3f350000,0x3f353f80,0xbe48bf35,0x3f553ec4,0x3e483f35,0xbf55bec4,0xbf6dbf80,0xbec4bf35,0xbf6dbf80,0xbec4bf35,0xbf55bf35,0xbf7bbf6d,0x3f553f35,0x3f7b3f6d
.long 0x0,0x0,0x0,0x0,0xbf7b3f80,0xbf553f6d,0x3f7bbf80,0x3f55bf6d,0x3ec40000,0x3f6dbf35,0x3ec40000,0x3f6dbf35,0x3f55bf80,0xbe48bec4,0xbf553f80,0x3e483ec4
.long 0xbf350000,0xbf353f80,0xbf350000,0xbf353f80,0xbf0e3f80,0x3f7bbec4,0x3f0ebf80,0xbf7b3ec4,0x3f6d0000,0xbec4bf35,0x3f6d0000,0xbec4bf35,0x3e48bf80,0xbf0e3f6d,0xbe483f80,0x3f0ebf6d
.long 0xbf800000,0x3f800000,0xbf800000,0x3f800000,0x3e483f80,0xbf0ebf6d,0xbe48bf80,0x3f0e3f6d,0x3f6d0000,0xbec43f35,0x3f6d0000,0xbec43f35,0xbf0ebf80,0x3f7b3ec4,0x3f0e3f80,0xbf7bbec4
.long 0xbf350000,0xbf35bf80,0xbf350000,0xbf35bf80,0x3f553f80,0xbe483ec4,0xbf55bf80,0x3e48bec4,0x3ec40000,0x3f6d3f35,0x3ec40000,0x3f6d3f35,0xbf7bbf80,0xbf55bf6d,0x3f7b3f80,0x3f553f6d
.long 0x0,0x0,0x0,0x0,0xbf0e3f35,0xbe483ec4,0x3f0ebf35,0x3e48bec4,0x3f6dbf80,0x3ec4bf35,0x3f6dbf80,0x3ec4bf35,0xbf7b3f35,0xbf0e3f6d,0x3f7bbf35,0x3f0ebf6d
.long 0x3f350000,0x3f35bf80,0x3f350000,0x3f35bf80,0xbe48bf35,0xbf553f6d,0x3e483f35,0x3f55bf6d,0xbec43f80,0x3f6dbf35,0xbec43f80,0x3f6dbf35,0x3f55bf35,0xbf7b3ec4,0xbf553f35,0x3f7bbec4
.long 0xbf800000,0x3f800000,0xbf800000,0x3f800000,0x3f553f35,0xbf7bbec4,0xbf55bf35,0x3f7b3ec4,0xbec4bf80,0x3f6d3f35,0xbec4bf80,0x3f6d3f35,0xbe483f35,0xbf55bf6d,0x3e48bf35,0x3f553f6d
.long 0x3f350000,0x3f353f80,0x3f350000,0x3f353f80,0xbf7bbf35,0xbf0ebf6d,0x3f7b3f35,0x3f0e3f6d,0x3f6d3f80,0x3ec43f35,0x3f6d3f80,0x3ec43f35,0xbf0ebf35,0xbe48bec4,0x3f0e3f35,0x3e483ec4
.long 0x3f800000,0x3f800000,0x3f800000,0x3f800000,0x3f800000,0x3f7fffb1,0x3f7ffec4,0x3f7ffd39,0x3f800000,0x3f7ffec4,0x3f7ffb11,0x3f7ff4e6,0x3f800000,0x3f7ffd39,0x3f7ff4e6,0x3f7fe705
.long 0x3f800000,0x3f7ffb11,0x3f7fec43,0x3f7fd397,0x3f800000,0x3f7ff84a,0x3f7fe129,0x3f7fba9e,0x3f800000,0x3f7ff4e6,0x3f7fd397,0x3f7f9c18,0x3f800000,0x3f7ff0e3,0x3f7fc38f,0x3f7f7808
.long 0x3f800000,0x3f7fec43,0x3f7fb10f,0x3f7f4e6d,0x3f800000,0x3f7fe705,0x3f7f9c18,0x3f7f1f49,0x3f800000,0x3f7fe129,0x3f7f84ab,0x3f7eea9d,0x3f800000,0x3f7fdaaf,0x3f7f6ac7,0x3f7eb069
.long 0x3f800000,0x3f7fd397,0x3f7f4e6d,0x3f7e70b0,0x3f800000,0x3f7fcbe2,0x3f7f2f9d,0x3f7e2b72,0x3f800000,0x3f7fc38f,0x3f7f0e58,0x3f7de0b1,0x3f800000,0x3f7fba9e,0x3f7eea9d,0x3f7d906e
.long 0x3f800000,0x3f800000,0x3f800000,0x3f800000,0x3f7ffb11,0x3f7ff84a,0x3f7ff4e6,0x3f7ff0e3,0x3f7fec43,0x3f7fe129,0x3f7fd397,0x3f7fc38f,0x3f7fd397,0x3f7fba9e,0x3f7f9c18,0x3f7f7808
.long 0x3f7fb10f,0x3f7f84ab,0x3f7f4e6d,0x3f7f0e58,0x3f7f84ab,0x3f7f3f54,0x3f7eea9d,0x3f7e868b,0x3f7f4e6d,0x3f7eea9d,0x3f7e70b0,0x3f7de0b1,0x3f7f0e58,0x3f7e868b,0x3f7de0b1,0x3f7d1cdd
.long 0x3f7ec46d,0x3f7e1324,0x3f7d3aac,0x3f7c3b28,0x3f7e70b0,0x3f7d906e,0x3f7c7eb0,0x3f7b3bab,0x3f7e1324,0x3f7cfe73,0x3f7baccd,0x3f7a1e84,0x3f7dabcc,0x3f7c5d3a,0x3f7ac516,0x3f78e3d6
.long 0x3f7d3aac,0x3f7baccd,0x3f79c79d,0x3f778bc5,0x3f7cbfc9,0x3f7aed37,0x3f78b47b,0x3f76167a,0x3f7c3b28,0x3f7a1e84,0x3f778bc5,0x3f748422,0x3f7baccd,0x3f7940c0,0x3f764d97,0x3f72d4eb
.long 0x3f800000,0x3f800000,0x3f800000,0x3f800000,0x3f7fec43,0x3f7fe705,0x3f7fe129,0x3f7fdaaf,0x3f7fb10f,0x3f7f9c18,0x3f7f84ab,0x3f7f6ac7,0x3f7f4e6d,0x3f7f1f49,0x3f7eea9d,0x3f7eb069
.long 0x3f7ec46d,0x3f7e70b0,0x3f7e1324,0x3f7dabcc,0x3f7e1324,0x3f7d906e,0x3f7cfe73,0x3f7c5d3a,0x3f7d3aac,0x3f7c7eb0,0x3f7baccd,0x3f7ac516,0x3f7c3b28,0x3f7b3bab,0x3f7a1e84,0x3f78e3d6
.long 0x3f7b14be,0x3f79c79d,0x3f7853f8,0x3f76ba07,0x3f79c79d,0x3f7822d1,0x3f764d97,0x3f74484b,0x3f7853f8,0x3f764d97,0x3f740bdd,0x3f718f57,0x3f76ba07,0x3f74484b,0x3f718f57,0x3f6e8ff8
.long 0x3f74fa0b,0x3f721352,0x3f6ed89e,0x3f6b4b0c,0x3f731447,0x3f6faf1b,0x3f6be858,0x3f67c187,0x3f710908,0x3f6d1c1d,0x3f68bf3c,0x3f63f473,0x3f6ed89e,0x3f6a5ad9,0x3f655e0b,0x3f5fe4e9
.long 0x3f800000,0x3f800000,0x3f800000,0x3f800000,0x3f7fd397,0x3f7fcbe2,0x3f7fc38f,0x3f7fba9e,0x3f7f4e6d,0x3f7f2f9d,0x3f7f0e58,0x3f7eea9d,0x3f7e70b0,0x3f7e2b72,0x3f7de0b1,0x3f7d906e
.long 0x3f7d3aac,0x3f7cbfc9,0x3f7c3b28,0x3f7baccd,0x3f7baccd,0x3f7aed37,0x3f7a1e84,0x3f7940c0,0x3f79c79d,0x3f78b47b,0x3f778bc5,0x3f764d97,0x3f778bc5,0x3f76167a,0x3f748422,0x3f72d4eb
.long 0x3f74fa0b,0x3f731447,0x3f710908,0x3f6ed89e,0x3f721352,0x3f6faf1b,0x3f6d1c1d,0x3f6a5ad9,0x3f6ed89e,0x3f6be858,0x3f68bf3c,0x3f655e0b,0x3f6b4b0c,0x3f67c187,0x3f63f473,0x3f5fe4e9
.long 0x3f676bd8,0x3f633c5a,0x3f5ebe05,0x3f59f26a,0x3f633c5a,0x3f5e5aa6,0x3f591e6a,0x3f5389c7,0x3f5ebe05,0x3f591e6a,0x3f531849,0x3f4cae79,0x3f59f26a,0x3f5389c7,0x3f4cae79,0x3f456439
.long 0x0,0x0,0x0,0x0,0x0,0x3b490fc6,0x3bc90f88,0x3c16cb58,0x0,0x3bc90f88,0x3c490e90,0x3c96c9b6,0x0,0x3c16cb58,0x3c96c9b6,0x3ce22a7a
.long 0x0,0x3c490e90,0x3cc90ab0,0x3d16c32c,0x0,0x3c7b514b,0x3cfb49ba,0x3d3c6dd5,0x0,0x3c96c9b6,0x3d16c32c,0x3d621469,0x0,0x3cafea69,0x3d2fe007,0x3d83db0a
.long 0x0,0x3cc90ab0,0x3d48fb30,0x3d96a905,0x0,0x3ce22a7a,0x3d621469,0x3da973ba,0x0,0x3cfb49ba,0x3d7b2b74,0x3dbc3ac3,0x0,0x3d0a342f,0x3d8a200a,0x3dcefdb7
.long 0x0,0x3d16c32c,0x3d96a905,0x3de1bc2e,0x0,0x3d2351cb,0x3da3308c,0x3df475c0,0x0,0x3d2fe007,0x3dafb680,0x3e039502,0x0,0x3d3c6dd5,0x3dbc3ac3,0x3e0cec4a
.long 0x0,0x0,0x0,0x0,0x3c490e90,0x3c7b514b,0x3c96c9b6,0x3cafea69,0x3cc90ab0,0x3cfb49ba,0x3d16c32c,0x3d2fe007,0x3d16c32c,0x3d3c6dd5,0x3d621469,0x3d83db0a
.long 0x3d48fb30,0x3d7b2b74,0x3d96a905,0x3dafb680,0x3d7b2b74,0x3d9cecf9,0x3dbc3ac3,0x3ddb7d37,0x3d96a905,0x3dbc3ac3,0x3de1bc2e,0x3e039502,0x3dafb680,0x3ddb7d37,0x3e039502,0x3e195be0
.long 0x3dc8bd36,0x3dfab273,0x3e164083,0x3e2f10a2,0x3de1bc2e,0x3e0cec4a,0x3e28defc,0x3e44b0b9,0x3dfab273,0x3e1c76de,0x3e3b6ecf,0x3e5a3997,0x3e09cf86,0x3e2bf804,0x3e4dee60,0x3e6fa8b2
.long 0x3e164083,0x3e3b6ecf,0x3e605c13,0x3e827dc0,0x3e22abb6,0x3e4ada4f,0x3e72b651,0x3e8d17c0,0x3e2f10a2,0x3e5a3997,0x3e827dc0,0x3e97a117,0x3e3b6ecf,0x3e698bba,0x3e8b9507,0x3ea21887
.long 0x0,0x0,0x0,0x0,0x3cc90ab0,0x3ce22a7a,0x3cfb49ba,0x3d0a342f,0x3d48fb30,0x3d621469,0x3d7b2b74,0x3d8a200a,0x3d96a905,0x3da973ba,0x3dbc3ac3,0x3dcefdb7
.long 0x3dc8bd36,0x3de1bc2e,0x3dfab273,0x3e09cf86,0x3dfab273,0x3e0cec4a,0x3e1c76de,0x3e2bf804,0x3e164083,0x3e28defc,0x3e3b6ecf,0x3e4dee60,0x3e2f10a2,0x3e44b0b9,0x3e5a3997,0x3e6fa8b2
.long 0x3e47c5c2,0x3e605c13,0x3e78cfcc,0x3e888e93,0x3e605c13,0x3e7bdba4,0x3e8b9507,0x3e9920fe,0x3e78cfcc,0x3e8b9507,0x3e9aa086,0x3ea986c4,0x3e888e93,0x3e9920fe,0x3ea986c4,0x3eb9bb1e
.long 0x3e94a031,0x3ea68f12,0x3eb8442a,0x3ec9b953,0x3ea09ae5,0x3eb3dca5,0x3ec6d529,0x3ed97cb9,0x3eac7cd4,0x3ec1071e,0x3ed53641,0x3ee900b7,0x3eb8442a,0x3ece0bea,0x3ee363fa,0x3ef840c8
.long 0x0,0x0,0x0,0x0,0x3d16c32c,0x3d2351cb,0x3d2fe007,0x3d3c6dd5,0x3d96a905,0x3da3308c,0x3dafb680,0x3dbc3ac3,0x3de1bc2e,0x3df475c0,0x3e039502,0x3e0cec4a
.long 0x3e164083,0x3e22abb6,0x3e2f10a2,0x3e3b6ecf,0x3e3b6ecf,0x3e4ada4f,0x3e5a3997,0x3e698bba,0x3e605c13,0x3e72b651,0x3e827dc0,0x3e8b9507,0x3e827dc0,0x3e8d17c0,0x3e97a117,0x3ea21887
.long 0x3e94a031,0x3ea09ae5,0x3eac7cd4,0x3eb8442a,0x3ea68f12,0x3eb3dca5,0x3ec1071e,0x3ece0bea,0x3eb8442a,0x3ec6d529,0x3ed53641,0x3ee363fa,0x3ec9b953,0x3ed97cb9,0x3ee900b7,0x3ef840c8
.long 0x3edae880,0x3eebcbbb,0x3efc5d27,0x3f064b82,0x3eebcbbb,0x3efdbabb,0x3f07a136,0x3f102dd5,0x3efc5d27,0x3f07a136,0x3f10d3cd,0x3f19c200,0x3f064b82,0x3f102dd5,0x3f19c200,0x3f2302d3
.long 0x3f800000,0x3f7fb10f,0x3f7ec46d,0x3f7d3aac,0x3f800000,0x3f7fa6e3,0x3f7e9bc9,0x3f7cdf6c,0x3f800000,0x3f7f9c18,0x3f7e70b0,0x3f7c7eb0,0x3f800000,0x3f7f90b1,0x3f7e4323,0x3f7c187a
.long 0x3f800000,0x3f7f84ab,0x3f7e1324,0x3f7baccd,0x3f800000,0x3f7f7808,0x3f7de0b1,0x3f7b3bab,0x3f800000,0x3f7f6ac7,0x3f7dabcc,0x3f7ac516,0x3f800000,0x3f7f5ce9,0x3f7d7474,0x3f7a4910
.long 0x3f800000,0x3f7f4e6d,0x3f7d3aac,0x3f79c79d,0x3f800000,0x3f7f3f54,0x3f7cfe73,0x3f7940c0,0x3f800000,0x3f7f2f9d,0x3f7cbfc9,0x3f78b47b,0x3f800000,0x3f7f1f49,0x3f7c7eb0,0x3f7822d1
.long 0x3f800000,0x3f7f0e58,0x3f7c3b28,0x3f778bc5,0x3f800000,0x3f7efcc9,0x3f7bf531,0x3f76ef5b,0x3f800000,0x3f7eea9d,0x3f7baccd,0x3f764d97,0x3f800000,0x3f7ed7d4,0x3f7b61fc,0x3f75a67b
.long 0x3f7b14be,0x3f7853f8,0x3f74fa0b,0x3f710908,0x3f7a7302,0x3f77583a,0x3f73913f,0x3f6f20b0,0x3f79c79d,0x3f764d97,0x3f721352,0x3f6d1c1d,0x3f791298,0x3f75341d,0x3f708066,0x3f6afb8c
.long 0x3f7853f8,0x3f740bdd,0x3f6ed89e,0x3f68bf3c,0x3f778bc5,0x3f72d4eb,0x3f6d1c1d,0x3f666771,0x3f76ba07,0x3f718f57,0x3f6b4b0c,0x3f63f473,0x3f75dec6,0x3f703b37,0x3f696591,0x3f61668a
.long 0x3f74fa0b,0x3f6ed89e,0x3f676bd8,0x3f5ebe05,0x3f740bdd,0x3f6d67a1,0x3f655e0b,0x3f5bfb34,0x3f731447,0x3f6be858,0x3f633c5a,0x3f591e6a,0x3f721352,0x3f6a5ad9,0x3f6106f2,0x3f5627fe
.long 0x3f710908,0x3f68bf3c,0x3f5ebe05,0x3f531849,0x3f6ff573,0x3f671599,0x3f5c61c7,0x3f4fefa8,0x3f6ed89e,0x3f655e0b,0x3f59f26a,0x3f4cae79,0x3f6db293,0x3f6398ac,0x3f577026,0x3f495521
.long 0x3f6c835e,0x3f676bd8,0x3f61c598,0x3f5b941a,0x3f6a09a7,0x3f644fac,0x3f5df6be,0x3f570348,0x3f676bd8,0x3f6106f2,0x3f59f26a,0x3f5233c6,0x3f64aa59,0x3f5d924d,0x3f55b993,0x3f4d26fd
.long 0x3f61c598,0x3f59f26a,0x3f514d3d,0x3f47de65,0x3f5ebe05,0x3f5627fe,0x3f4cae79,0x3f425b89,0x3f5b941a,0x3f5233c6,0x3f47de65,0x3f3ca003,0x3f584853,0x3f4e1689,0x3f42de29,0x3f36ad7f
.long 0x3f54db31,0x3f49d112,0x3f3daef9,0x3f3085bb,0x3f514d3d,0x3f456439,0x3f385216,0x3f2a2a80,0x3f4d9f02,0x3f40d0da,0x3f32c8c9,0x3f239da9,0x3f49d112,0x3f3c17d9,0x3f2d1469,0x3f1ce11f
.long 0x3f45e403,0x3f373a23,0x3f273656,0x3f15f6d9,0x3f41d870,0x3f3238aa,0x3f212ff9,0x3f0ee0db,0x3f3daef9,0x3f2d1469,0x3f1b02c6,0x3f07a136,0x3f396842,0x3f27ce61,0x3f14b039,0x3f003a06
.long 0x3f54db31,0x3f4d9f02,0x3f45e403,0x3f3daef9,0x3f4f7a1f,0x3f476085,0x3f3ebc1b,0x3f3592e7,0x3f49d112,0x3f40d0da,0x3f373a23,0x3f2d1469,0x3f43e200,0x3f39f2ac,0x3f2f61a5,0x3f24381a
.long 0x3f3daef9,0x3f32c8c9,0x3f273656,0x3f1b02c6,0x3f373a23,0x3f2b561b,0x3f1ebc12,0x3f11796b,0x3f3085bb,0x3f239da9,0x3f15f6d9,0x3f07a136,0x3f299415,0x3f1ba299,0x3f0cead0,0x3efafef7
.long 0x3f226799,0x3f13682a,0x3f039c3d,0x3ee63375,0x3f1b02c6,0x3f0af1b7,0x3ef41f07,0x3ed0eb2a,0x3f13682a,0x3f0242b1,0x3ee0924f,0x3ebb31a0,0x3f0b9a6b,0x3ef2bd43,0x3ecc9b8b,0x3ea5129f
.long 0x3f039c3d,0x3ee0924f,0x3eb8442a,0x3e8e9a22,0x3ef6e0cb,0x3ece0bea,0x3ea395c5,0x3e6fa8b2,0x3ee63375,0x3ebb31a0,0x3e8e9a22,0x3e419b37,0x3ed53641,0x3ea80b1f,0x3e72b651,0x3e1324ca
.long 0x0,0x3d48fb30,0x3dc8bd36,0x3e164083,0x0,0x3d55880e,0x3dd53db9,0x3e1f917b,0x0,0x3d621469,0x3de1bc2e,0x3e28defc,0x0,0x3d6ea038,0x3dee3876,0x3e3228d4
.long 0x0,0x3d7b2b74,0x3dfab273,0x3e3b6ecf,0x0,0x3d83db0a,0x3e039502,0x3e44b0b9,0x0,0x3d8a200a,0x3e09cf86,0x3e4dee60,0x0,0x3d9064b4,0x3e1008b7,0x3e57278f
.long 0x0,0x3d96a905,0x3e164083,0x3e605c13,0x0,0x3d9cecf9,0x3e1c76de,0x3e698bba,0x0,0x3da3308c,0x3e22abb6,0x3e72b651,0x0,0x3da973ba,0x3e28defc,0x3e7bdba4
.long 0x0,0x3dafb680,0x3e2f10a2,0x3e827dc0,0x0,0x3db5f8da,0x3e354098,0x3e870ada,0x0,0x3dbc3ac3,0x3e3b6ecf,0x3e8b9507,0x0,0x3dc27c39,0x3e419b37,0x3e901c2c
.long 0x3e47c5c2,0x3e78cfcc,0x3e94a031,0x3eac7cd4,0x3e541501,0x3e840270,0x3e9d9e78,0x3eb6ccc3,0x3e605c13,0x3e8b9507,0x3ea68f12,0x3ec1071e,0x3e6c9a7f,0x3e931f35,0x3eaf713a,0x3ecb2aae
.long 0x3e78cfcc,0x3e9aa086,0x3eb8442a,0x3ed53641,0x3e827dc0,0x3ea21887,0x3ec1071e,0x3edf28a9,0x3e888e93,0x3ea986c4,0x3ec9b953,0x3ee900b7,0x3e8e9a22,0x3eb0eacb,0x3ed25a09,0x3ef2bd43
.long 0x3e94a031,0x3eb8442a,0x3edae880,0x3efc5d27,0x3e9aa086,0x3ebf926f,0x3ee363fa,0x3f02ef9f,0x3ea09ae5,0x3ec6d529,0x3eebcbbb,0x3f07a136,0x3ea68f12,0x3ece0bea,0x3ef41f07,0x3f0c42c9
.long 0x3eac7cd4,0x3ed53641,0x3efc5d27,0x3f10d3cd,0x3eb263ef,0x3edc53c1,0x3f0242b1,0x3f1553b7,0x3eb8442a,0x3ee363fa,0x3f064b82,0x3f19c200,0x3ebe1d4a,0x3eea6681,0x3f0a48ad,0x3f1e1e22
.long 0x3ec3ef15,0x3edae880,0x3ef15aea,0x3f039c3d,0x3ecf7bca,0x3ee79a5d,0x3eff17b2,0x3f0af1b7,0x3edae880,0x3ef41f07,0x3f064b82,0x3f121eb0,0x3ee63375,0x3f003a06,0x3f0cead0,0x3f19210f
.long 0x3ef15aea,0x3f064b82,0x3f13682a,0x3f1ff6cb,0x3efc5d27,0x3f0c42c9,0x3f19c200,0x3f269de3,0x3f039c3d,0x3f121eb0,0x3f1ff6cb,0x3f2d1469,0x3f08f59b,0x3f17de12,0x3f26050a,0x3f33587a
.long 0x3f0e39da,0x3f1d7fd1,0x3f2beb4a,0x3f396842,0x3f13682a,0x3f2302d3,0x3f31a81d,0x3f3f41fc,0x3f187fc0,0x3f286605,0x3f373a23,0x3f44e3f5,0x3f1d7fd1,0x3f2da859,0x3f3ca003,0x3f4a4c87
.long 0x3f226799,0x3f32c8c9,0x3f41d870,0x3f4f7a1f,0x3f273656,0x3f37c655,0x3f46e22a,0x3f546b3b,0x3f2beb4a,0x3f3ca003,0x3f4bbbf8,0x3f591e6a,0x3f3085bb,0x3f4154e1,0x3f5064af,0x3f5d924d
.long 0x3f0e39da,0x3f187fc0,0x3f226799,0x3f2beb4a,0x3f15f6d9,0x3f209393,0x3f2ac082,0x3f34768f,0x3f1d7fd1,0x3f286605,0x3f32c8c9,0x3f3ca003,0x3f24d225,0x3f2ff3e6,0x3f3a7ca4,0x3f446337
.long 0x3f2beb4a,0x3f373a23,0x3f41d870,0x3f4bbbf8,0x3f32c8c9,0x3f3e35c5,0x3f48d8b3,0x3f52a649,0x3f396842,0x3f44e3f5,0x3f4f7a1f,0x3f591e6a,0x3f3fc767,0x3f4b41fa,0x3f55b993,0x3f5f20db
.long 0x3f45e403,0x3f514d3d,0x3f5b941a,0x3f64aa59,0x3f4bbbf8,0x3f570348,0x3f6106f2,0x3f69b7e4,0x3f514d3d,0x3f5c61c7,0x3f660f88,0x3f6e46be,0x3f5695e5,0x3f61668a,0x3f6aab7b,0x3f725470
.long 0x3f5b941a,0x3f660f88,0x3f6ed89e,0x3f75dec6,0x3f604621,0x3f6a5ad9,0x3f7294f8,0x3f78e3d6,0x3f64aa59,0x3f6e46be,0x3f75dec6,0x3f7b61fc,0x3f68bf3c,0x3f71d19f,0x3f78b47b,0x3f7d57de
.long 0x3f800000,0x3f800000,0x3f800000,0x3f800000,0x3f7fb10f,0x3f7fa6e3,0x3f7f9c18,0x3f7f90b1,0x3f7ec46d,0x3f7e9bc9,0x3f7e70b0,0x3f7e4323,0x3f7d3aac,0x3f7cdf6c,0x3f7c7eb0,0x3f7c187a
.long 0x3f7b14be,0x3f7a7302,0x3f79c79d,0x3f791298,0x3f7853f8,0x3f77583a,0x3f764d97,0x3f75341d,0x3f74fa0b,0x3f73913f,0x3f721352,0x3f708066,0x3f710908,0x3f6f20b0,0x3f6d1c1d,0x3f6afb8c
.long 0x3f6c835e,0x3f6a09a7,0x3f676bd8,0x3f64aa59,0x3f676bd8,0x3f644fac,0x3f6106f2,0x3f5d924d,0x3f61c598,0x3f5df6be,0x3f59f26a,0x3f55b993,0x3f5b941a,0x3f570348,0x3f5233c6,0x3f4d26fd
.long 0x3f54db31,0x3f4f7a1f,0x3f49d112,0x3f43e200,0x3f4d9f02,0x3f476085,0x3f40d0da,0x3f39f2ac,0x3f45e403,0x3f3ebc1b,0x3f373a23,0x3f2f61a5,0x3f3daef9,0x3f3592e7,0x3f2d1469,0x3f24381a
.long 0x3f800000,0x3f800000,0x3f800000,0x3f800000,0x3f7f84ab,0x3f7f7808,0x3f7f6ac7,0x3f7f5ce9,0x3f7e1324,0x3f7de0b1,0x3f7dabcc,0x3f7d7474,0x3f7baccd,0x3f7b3bab,0x3f7ac516,0x3f7a4910
.long 0x3f7853f8,0x3f778bc5,0x3f76ba07,0x3f75dec6,0x3f740bdd,0x3f72d4eb,0x3f718f57,0x3f703b37,0x3f6ed89e,0x3f6d1c1d,0x3f6b4b0c,0x3f696591,0x3f68bf3c,0x3f666771,0x3f63f473,0x3f61668a
.long 0x3f61c598,0x3f5ebe05,0x3f5b941a,0x3f584853,0x3f59f26a,0x3f5627fe,0x3f5233c6,0x3f4e1689,0x3f514d3d,0x3f4cae79,0x3f47de65,0x3f42de29,0x3f47de65,0x3f425b89,0x3f3ca003,0x3f36ad7f
.long 0x3f3daef9,0x3f373a23,0x3f3085bb,0x3f299415,0x3f32c8c9,0x3f2b561b,0x3f239da9,0x3f1ba299,0x3f273656,0x3f1ebc12,0x3f15f6d9,0x3f0cead0,0x3f1b02c6,0x3f11796b,0x3f07a136,0x3efafef7
.long 0x3f800000,0x3f800000,0x3f800000,0x3f800000,0x3f7f4e6d,0x3f7f3f54,0x3f7f2f9d,0x3f7f1f49,0x3f7d3aac,0x3f7cfe73,0x3f7cbfc9,0x3f7c7eb0,0x3f79c79d,0x3f7940c0,0x3f78b47b,0x3f7822d1
.long 0x3f74fa0b,0x3f740bdd,0x3f731447,0x3f721352,0x3f6ed89e,0x3f6d67a1,0x3f6be858,0x3f6a5ad9,0x3f676bd8,0x3f655e0b,0x3f633c5a,0x3f6106f2,0x3f5ebe05,0x3f5bfb34,0x3f591e6a,0x3f5627fe
.long 0x3f54db31,0x3f514d3d,0x3f4d9f02,0x3f49d112,0x3f49d112,0x3f456439,0x3f40d0da,0x3f3c17d9,0x3f3daef9,0x3f385216,0x3f32c8c9,0x3f2d1469,0x3f3085bb,0x3f2a2a80,0x3f239da9,0x3f1ce11f
.long 0x3f226799,0x3f1b02c6,0x3f13682a,0x3f0b9a6b,0x3f13682a,0x3f0af1b7,0x3f0242b1,0x3ef2bd43,0x3f039c3d,0x3ef41f07,0x3ee0924f,0x3ecc9b8b,0x3ee63375,0x3ed0eb2a,0x3ebb31a0,0x3ea5129f
.long 0x3f800000,0x3f800000,0x3f800000,0x3f800000,0x3f7f0e58,0x3f7efcc9,0x3f7eea9d,0x3f7ed7d4,0x3f7c3b28,0x3f7bf531,0x3f7baccd,0x3f7b61fc,0x3f778bc5,0x3f76ef5b,0x3f764d97,0x3f75a67b
.long 0x3f710908,0x3f6ff573,0x3f6ed89e,0x3f6db293,0x3f68bf3c,0x3f671599,0x3f655e0b,0x3f6398ac,0x3f5ebe05,0x3f5c61c7,0x3f59f26a,0x3f577026,0x3f531849,0x3f4fefa8,0x3f4cae79,0x3f495521
.long 0x3f45e403,0x3f41d870,0x3f3daef9,0x3f396842,0x3f373a23,0x3f3238aa,0x3f2d1469,0x3f27ce61,0x3f273656,0x3f212ff9,0x3f1b02c6,0x3f14b039,0x3f15f6d9,0x3f0ee0db,0x3f07a136,0x3f003a06
.long 0x3f039c3d,0x3ef6e0cb,0x3ee63375,0x3ed53641,0x3ee0924f,0x3ece0bea,0x3ebb31a0,0x3ea80b1f,0x3eb8442a,0x3ea395c5,0x3e8e9a22,0x3e72b651,0x3e8e9a22,0x3e6fa8b2,0x3e419b37,0x3e1324ca
.long 0x0,0x0,0x0,0x0,0x3d48fb30,0x3d55880e,0x3d621469,0x3d6ea038,0x3dc8bd36,0x3dd53db9,0x3de1bc2e,0x3dee3876,0x3e164083,0x3e1f917b,0x3e28defc,0x3e3228d4
.long 0x3e47c5c2,0x3e541501,0x3e605c13,0x3e6c9a7f,0x3e78cfcc,0x3e840270,0x3e8b9507,0x3e931f35,0x3e94a031,0x3e9d9e78,0x3ea68f12,0x3eaf713a,0x3eac7cd4,0x3eb6ccc3,0x3ec1071e,0x3ecb2aae
.long 0x3ec3ef15,0x3ecf7bca,0x3edae880,0x3ee63375,0x3edae880,0x3ee79a5d,0x3ef41f07,0x3f003a06,0x3ef15aea,0x3eff17b2,0x3f064b82,0x3f0cead0,0x3f039c3d,0x3f0af1b7,0x3f121eb0,0x3f19210f
.long 0x3f0e39da,0x3f15f6d9,0x3f1d7fd1,0x3f24d225,0x3f187fc0,0x3f209393,0x3f286605,0x3f2ff3e6,0x3f226799,0x3f2ac082,0x3f32c8c9,0x3f3a7ca4,0x3f2beb4a,0x3f34768f,0x3f3ca003,0x3f446337
.long 0x0,0x0,0x0,0x0,0x3d7b2b74,0x3d83db0a,0x3d8a200a,0x3d9064b4,0x3dfab273,0x3e039502,0x3e09cf86,0x3e1008b7,0x3e3b6ecf,0x3e44b0b9,0x3e4dee60,0x3e57278f
.long 0x3e78cfcc,0x3e827dc0,0x3e888e93,0x3e8e9a22,0x3e9aa086,0x3ea21887,0x3ea986c4,0x3eb0eacb,0x3eb8442a,0x3ec1071e,0x3ec9b953,0x3ed25a09,0x3ed53641,0x3edf28a9,0x3ee900b7,0x3ef2bd43
.long 0x3ef15aea,0x3efc5d27,0x3f039c3d,0x3f08f59b,0x3f064b82,0x3f0c42c9,0x3f121eb0,0x3f17de12,0x3f13682a,0x3f19c200,0x3f1ff6cb,0x3f26050a,0x3f1ff6cb,0x3f269de3,0x3f2d1469,0x3f33587a
.long 0x3f2beb4a,0x3f32c8c9,0x3f396842,0x3f3fc767,0x3f373a23,0x3f3e35c5,0x3f44e3f5,0x3f4b41fa,0x3f41d870,0x3f48d8b3,0x3f4f7a1f,0x3f55b993,0x3f4bbbf8,0x3f52a649,0x3f591e6a,0x3f5f20db
.long 0x0,0x0,0x0,0x0,0x3d96a905,0x3d9cecf9,0x3da3308c,0x3da973ba,0x3e164083,0x3e1c76de,0x3e22abb6,0x3e28defc,0x3e605c13,0x3e698bba,0x3e72b651,0x3e7bdba4
.long 0x3e94a031,0x3e9aa086,0x3ea09ae5,0x3ea68f12,0x3eb8442a,0x3ebf926f,0x3ec6d529,0x3ece0bea,0x3edae880,0x3ee363fa,0x3eebcbbb,0x3ef41f07,0x3efc5d27,0x3f02ef9f,0x3f07a136,0x3f0c42c9
.long 0x3f0e39da,0x3f13682a,0x3f187fc0,0x3f1d7fd1,0x3f1d7fd1,0x3f2302d3,0x3f286605,0x3f2da859,0x3f2beb4a,0x3f31a81d,0x3f373a23,0x3f3ca003,0x3f396842,0x3f3f41fc,0x3f44e3f5,0x3f4a4c87
.long 0x3f45e403,0x3f4bbbf8,0x3f514d3d,0x3f5695e5,0x3f514d3d,0x3f570348,0x3f5c61c7,0x3f61668a,0x3f5b941a,0x3f6106f2,0x3f660f88,0x3f6aab7b,0x3f64aa59,0x3f69b7e4,0x3f6e46be,0x3f725470
.long 0x0,0x0,0x0,0x0,0x3dafb680,0x3db5f8da,0x3dbc3ac3,0x3dc27c39,0x3e2f10a2,0x3e354098,0x3e3b6ecf,0x3e419b37,0x3e827dc0,0x3e870ada,0x3e8b9507,0x3e901c2c
.long 0x3eac7cd4,0x3eb263ef,0x3eb8442a,0x3ebe1d4a,0x3ed53641,0x3edc53c1,0x3ee363fa,0x3eea6681,0x3efc5d27,0x3f0242b1,0x3f064b82,0x3f0a48ad,0x3f10d3cd,0x3f1553b7,0x3f19c200,0x3f1e1e22
.long 0x3f226799,0x3f273656,0x3f2beb4a,0x3f3085bb,0x3f32c8c9,0x3f37c655,0x3f3ca003,0x3f4154e1,0x3f41d870,0x3f46e22a,0x3f4bbbf8,0x3f5064af,0x3f4f7a1f,0x3f546b3b,0x3f591e6a,0x3f5d924d
.long 0x3f5b941a,0x3f604621,0x3f64aa59,0x3f68bf3c,0x3f660f88,0x3f6a5ad9,0x3f6e46be,0x3f71d19f,0x3f6ed89e,0x3f7294f8,0x3f75dec6,0x3f78b47b,0x3f75dec6,0x3f78e3d6,0x3f7b61fc,0x3f7d57de
.long 0x3f3504f3,0x3f2beb4a,0x3f226799,0x3f187fc0,0x3f2beb4a,0x3f21cbfb,0x3f173c07,0x3f0c42c9,0x3f226799,0x3f173c07,0x3f0b9a6b,0x3eff17b2,0x3f187fc0,0x3f0c42c9,0x3eff17b2,0x3ee4cbfe
.long 0x3f0e39da,0x3f00e7e4,0x3ee63375,0x3ec9b953,0x3f039c3d,0x3eea6681,0x3ecc9b8b,0x3eadf73c,0x3ef15aea,0x3ed25a09,0x3eb263ef,0x3e919ddd,0x3edae880,0x3eb9bb1e,0x3e97a117,0x3e698bba
.long 0x3ec3ef15,0x3ea09ae5,0x3e78cfcc,0x3e2f10a2,0x3eac7cd4,0x3e870ada,0x3e419b37,0x3de7fa9a,0x3e94a031,0x3e5a3997,0x3e09cf86,0x3d621469,0x3e78cfcc,0x3e25c58c,0x3da3308c,0xbb490fc6
.long 0x3e47c5c2,0x3de1bc2e,0x3cc90ab0,0xbd7b2b74,0x3e164083,0x3d6ea038,0xbcfb49ba,0xbdf475c0,0x3dc8bd36,0x3bc90f88,0xbdafb680,0xbe354098,0x3d48fb30,0xbd3c6dd5,0xbe1008b7,0xbe6fa8b2
.long 0x3f0e39da,0x3f039c3d,0x3ef15aea,0x3edae880,0x3f00e7e4,0x3eea6681,0x3ed25a09,0x3eb9bb1e,0x3ee63375,0x3ecc9b8b,0x3eb263ef,0x3e97a117,0x3ec9b953,0x3eadf73c,0x3e919ddd,0x3e698bba
.long 0x3eac7cd4,0x3e8e9a22,0x3e605c13,0x3e22abb6,0x3e8e9a22,0x3e5d4b1a,0x3e1c76de,0x3db5f8da,0x3e605c13,0x3e1c76de,0x3dafb680,0x3c96c9b6,0x3e22abb6,0x3db5f8da,0x3c96c9b6,0xbd55880e
.long 0x3dc8bd36,0x3cc90ab0,0xbd48fb30,0xbdfab273,0x3d16c32c,0xbd2351cb,0xbdee3876,0xbe44b0b9,0xbcc90ab0,0xbdd53db9,0xbe3b6ecf,0xbe8586ce,0xbdafb680,0xbe2bf804,0xbe7ee6e1,0xbea80b1f
.long 0xbe164083,0xbe6c9a7f,0xbea09ae5,0xbec9b953,0xbe541501,0xbe9620d2,0xbec1071e,0xbeea6681,0xbe888e93,0xbeb554ec,0xbee0924f,0xbf04f484,0xbea68f12,0xbed3c867,0xbeff17b2,0xbf140c5f
.long 0x3ec3ef15,0x3eac7cd4,0x3e94a031,0x3e78cfcc,0x3ea09ae5,0x3e870ada,0x3e5a3997,0x3e25c58c,0x3e78cfcc,0x3e419b37,0x3e09cf86,0x3da3308c,0x3e2f10a2,0x3de7fa9a,0x3d621469,0xbb490fc6
.long 0x3dc8bd36,0x3d16c32c,0xbcc90ab0,0xbdafb680,0x3cc90ab0,0xbd2351cb,0xbdd53db9,0xbe2bf804,0xbd48fb30,0xbdee3876,0xbe3b6ecf,0xbe7ee6e1,0xbdfab273,0xbe44b0b9,0xbe8586ce,0xbea80b1f
.long 0xbe47c5c2,0xbe888e93,0xbeac7cd4,0xbecf7bca,0xbe888e93,0xbeadf73c,0xbed25a09,0xbef58035,0xbeac7cd4,0xbed25a09,0xbef6e0cb,0xbf0cead0,0xbecf7bca,0xbef58035,0xbf0cead0,0xbf1e1e22
.long 0xbef15aea,0xbf0b9a6b,0xbf1d7fd1,0xbf2e3bde,0xbf08f59b,0xbf1ba299,0xbf2d1469,0xbf3d27b8,0xbf187fc0,0xbf2ac082,0xbf3b8f3b,0xbf4ac77f,0xbf273656,0xbf38dd65,0xbf48d8b3,0xbf570348
.long 0x3e47c5c2,0x3e164083,0x3dc8bd36,0x3d48fb30,0x3de1bc2e,0x3d6ea038,0x3bc90f88,0xbd3c6dd5,0x3cc90ab0,0xbcfb49ba,0xbdafb680,0xbe1008b7,0xbd7b2b74,0xbdf475c0,0xbe354098,0xbe6fa8b2
.long 0xbe164083,0xbe541501,0xbe888e93,0xbea68f12,0xbe6c9a7f,0xbe9620d2,0xbeb554ec,0xbed3c867,0xbea09ae5,0xbec1071e,0xbee0924f,0xbeff17b2,0xbec9b953,0xbeea6681,0xbf04f484,0xbf140c5f
.long 0xbef15aea,0xbf08f59b,0xbf187fc0,0xbf273656,0xbf0b9a6b,0xbf1ba299,0xbf2ac082,0xbf38dd65,0xbf1d7fd1,0xbf2d1469,0xbf3b8f3b,0xbf48d8b3,0xbf2e3bde,0xbf3d27b8,0xbf4ac77f,0xbf570348
.long 0xbf3daef9,0xbf4bbbf8,0xbf584853,0xbf633c5a,0xbf4bbbf8,0xbf58b3a1,0xbf63f473,0xbf6d67a1,0xbf584853,0xbf63f473,0xbf6db293,0xbf756d97,0xbf633c5a,0xbf6d67a1,0xbf756d97,0xbf7b3bab
.long 0x3f3504f3,0x3f3daef9,0x3f45e403,0x3f4d9f02,0x3f3daef9,0x3f466354,0x3f4e8d90,0x3f5627fe,0x3f45e403,0x3f4e8d90,0x3f5695e5,0x3f5df6be,0x3f4d9f02,0x3f5627fe,0x3f5df6be,0x3f650479
.long 0x3f54db31,0x3f5d2d53,0x3f64aa59,0x3f6b4b0c,0x3f5b941a,0x3f6398ac,0x3f6aab7b,0x3f70c501,0x3f61c598,0x3f696591,0x3f6ff573,0x3f756d97,0x3f676bd8,0x3f6e8ff8,0x3f748422,0x3f7940c0
.long 0x3f6c835e,0x3f731447,0x3f7853f8,0x3f7c3b28,0x3f710908,0x3f76ef5b,0x3f7b61fc,0x3f7e5a38,0x3f74fa0b,0x3f7a1e84,0x3f7dabcc,0x3f7f9c18,0x3f7853f8,0x3f7c9f8a,0x3f7f2f9d,0x3f7fffb1
.long 0x3f7b14be,0x3f7e70b0,0x3f7fec43,0x3f7f84ab,0x3f7d3aac,0x3f7f90b1,0x3f7fe129,0x3f7e2b72,0x3f7ec46d,0x3f7ffec4,0x3f7f0e58,0x3f7bf531,0x3f7fb10f,0x3f7fba9e,0x3f7d7474,0x3f78e3d6
.long 0x3f54db31,0x3f5b941a,0x3f61c598,0x3f676bd8,0x3f5d2d53,0x3f6398ac,0x3f696591,0x3f6e8ff8,0x3f64aa59,0x3f6aab7b,0x3f6ff573,0x3f748422,0x3f6b4b0c,0x3f70c501,0x3f756d97,0x3f7940c0
.long 0x3f710908,0x3f75dec6,0x3f79c79d,0x3f7cbfc9,0x3f75dec6,0x3f79f35e,0x3f7cfe73,0x3f7efcc9,0x3f79c79d,0x3f7cfe73,0x3f7f0e58,0x3f7ff4e6,0x3f7cbfc9,0x3f7efcc9,0x3f7ff4e6,0x3f7fa6e3
.long 0x3f7ec46d,0x3f7fec43,0x3f7fb10f,0x3f7e1324,0x3f7fd397,0x3f7fcbe2,0x3f7e4323,0x3f7b3bab,0x3f7fec43,0x3f7e9bc9,0x3f7baccd,0x3f772417,0x3f7f0e58,0x3f7c5d3a,0x3f77f110,0x3f71d19f
.long 0x3f7d3aac,0x3f791298,0x3f731447,0x3f6b4b0c,0x3f7a7302,0x3f74bf62,0x3f6d1c1d,0x3f6398ac,0x3f76ba07,0x3f6f6830,0x3f660f88,0x3f5ac450,0x3f721352,0x3f6912ae,0x3f5df6be,0x3f50d937
.long 0x3f6c835e,0x3f710908,0x3f74fa0b,0x3f7853f8,0x3f731447,0x3f76ef5b,0x3f7a1e84,0x3f7c9f8a,0x3f7853f8,0x3f7b61fc,0x3f7dabcc,0x3f7f2f9d,0x3f7c3b28,0x3f7e5a38,0x3f7f9c18,0x3f7fffb1
.long 0x3f7ec46d,0x3f7fd397,0x3f7fec43,0x3f7f0e58,0x3f7fec43,0x3f7fcbe2,0x3f7e9bc9,0x3f7c5d3a,0x3f7fb10f,0x3f7e4323,0x3f7baccd,0x3f77f110,0x3f7e1324,0x3f7b3bab,0x3f772417,0x3f71d19f
.long 0x3f7b14be,0x3f76ba07,0x3f710908,0x3f6a09a7,0x3f76ba07,0x3f70c501,0x3f696591,0x3f60a6cf,0x3f710908,0x3f696591,0x3f604621,0x3f55b993,0x3f6a09a7,0x3f60a6cf,0x3f55b993,0x3f495521
.long 0x3f61c598,0x3f5695e5,0x3f49d112,0x3f3b8f3b,0x3f584853,0x3f4b41fa,0x3f3ca003,0x3f2c800f,0x3f4d9f02,0x3f3ebc1b,0x3f2e3bde,0x3f1c420c,0x3f41d870,0x3f311722,0x3f1ebc12,0x3f0af1b7
.long 0x3f7b14be,0x3f7d3aac,0x3f7ec46d,0x3f7fb10f,0x3f7e70b0,0x3f7f90b1,0x3f7ffec4,0x3f7fba9e,0x3f7fec43,0x3f7fe129,0x3f7f0e58,0x3f7d7474,0x3f7f84ab,0x3f7e2b72,0x3f7bf531,0x3f78e3d6
.long 0x3f7d3aac,0x3f7a7302,0x3f76ba07,0x3f721352,0x3f791298,0x3f74bf62,0x3f6f6830,0x3f6912ae,0x3f731447,0x3f6d1c1d,0x3f660f88,0x3f5df6be,0x3f6b4b0c,0x3f6398ac,0x3f5ac450,0x3f50d937
.long 0x3f61c598,0x3f584853,0x3f4d9f02,0x3f41d870,0x3f5695e5,0x3f4b41fa,0x3f3ebc1b,0x3f311722,0x3f49d112,0x3f3ca003,0x3f2e3bde,0x3f1ebc12,0x3f3b8f3b,0x3f2c800f,0x3f1c420c,0x3f0af1b7
.long 0x3f2beb4a,0x3f1b02c6,0x3f08f59b,0x3eebcbbb,0x3f1b02c6,0x3f084b92,0x3ee900b7,0x3ebf926f,0x3f08f59b,0x3ee900b7,0x3ebe1d4a,0x3e919ddd,0x3eebcbbb,0x3ebf926f,0x3e919ddd,0x3e44b0b9
.long 0x3f800000,0x3f7ec46d,0x3f7b14be,0x3f74fa0b,0x3f800000,0x3f7eb069,0x3f7ac516,0x3f74484b,0x3f800000,0x3f7e9bc9,0x3f7a7302,0x3f73913f,0x3f800000,0x3f7e868b,0x3f7a1e84,0x3f72d4eb
.long 0x3f800000,0x3f7e70b0,0x3f79c79d,0x3f721352,0x3f800000,0x3f7e5a38,0x3f796e4e,0x3f714c7a,0x3f800000,0x3f7e4323,0x3f791298,0x3f708066,0x3f800000,0x3f7e2b72,0x3f78b47b,0x3f6faf1b
.long 0x3f800000,0x3f7e1324,0x3f7853f8,0x3f6ed89e,0x3f800000,0x3f7dfa38,0x3f77f110,0x3f6dfcf2,0x3f800000,0x3f7de0b1,0x3f778bc5,0x3f6d1c1d,0x3f800000,0x3f7dc68c,0x3f772417,0x3f6c3624
.long 0x3f800000,0x3f7dabcc,0x3f76ba07,0x3f6b4b0c,0x3f800000,0x3f7d906e,0x3f764d97,0x3f6a5ad9,0x3f800000,0x3f7d7474,0x3f75dec6,0x3f696591,0x3f800000,0x3f7d57de,0x3f756d97,0x3f686b39
.long 0x3f6c835e,0x3f61c598,0x3f54db31,0x3f45e403,0x3f6b4b0c,0x3f5fe4e9,0x3f5233c6,0x3f425b89,0x3f6a09a7,0x3f5df6be,0x3f4f7a1f,0x3f3ebc1b,0x3f68bf3c,0x3f5bfb34,0x3f4cae79,0x3f3b0629
.long 0x3f676bd8,0x3f59f26a,0x3f49d112,0x3f373a23,0x3f660f88,0x3f57dc7f,0x3f46e22a,0x3f33587a,0x3f64aa59,0x3f55b993,0x3f43e200,0x3f2f61a5,0x3f633c5a,0x3f5389c7,0x3f40d0da,0x3f2b561b
.long 0x3f61c598,0x3f514d3d,0x3f3daef9,0x3f273656,0x3f604621,0x3f4f0417,0x3f3a7ca4,0x3f2302d3,0x3f5ebe05,0x3f4cae79,0x3f373a23,0x3f1ebc12,0x3f5d2d53,0x3f4a4c87,0x3f33e7bc,0x3f1a6293
.long 0x3f5b941a,0x3f47de65,0x3f3085bb,0x3f15f6d9,0x3f59f26a,0x3f456439,0x3f2d1469,0x3f11796b,0x3f584853,0x3f42de29,0x3f299415,0x3f0cead0,0x3f5695e5,0x3f404c5c,0x3f26050a,0x3f084b92
.long 0x3f3504f3,0x3f226799,0x3f0e39da,0x3ef15aea,0x3f3085bb,0x3f1ce11f,0x3f07a136,0x3ee1fb6a,0x3f2beb4a,0x3f173c07,0x3f00e7e4,0x3ed25a09,0x3f273656,0x3f11796b,0x3ef41f07,0x3ec27b55
.long 0x3f226799,0x3f0b9a6b,0x3ee63375,0x3eb263ef,0x3f1d7fd1,0x3f05a02c,0x3ed8106b,0x3ea21887,0x3f187fc0,0x3eff17b2,0x3ec9b953,0x3e919ddd,0x3f13682a,0x3ef2bd43,0x3ebb31a0,0x3e80f8c0
.long 0x3f0e39da,0x3ee63375,0x3eac7cd4,0x3e605c13,0x3f08f59b,0x3ed97cb9,0x3e9d9e78,0x3e3e853e,0x3f039c3d,0x3ecc9b8b,0x3e8e9a22,0x3e1c76de,0x3efc5d27,0x3ebf926f,0x3e7ee6e1,0x3df475c0
.long 0x3ef15aea,0x3eb263ef,0x3e605c13,0x3dafb680,0x3ee63375,0x3ea5129f,0x3e419b37,0x3d55880e,0x3edae880,0x3e97a117,0x3e22abb6,0x3c96c9b6,0x3ecf7bca,0x3e8a11f7,0x3e039502,0xbc7b514b
.long 0x3ec3ef15,0x3e94a031,0x3e47c5c2,0x3dc8bd36,0x3eb263ef,0x3e80f8c0,0x3e1c76de,0x3d55880e,0x3ea09ae5,0x3e5a3997,0x3de1bc2e,0x3bc90f88,0x3e8e9a22,0x3e3228d4,0x3d8a200a,0xbd2351cb
.long 0x3e78cfcc,0x3e09cf86,0x3cc90ab0,0xbdafb680,0x3e541501,0x3dc27c39,0xbc96c9b6,0xbe06b26e,0x3e2f10a2,0x3d621469,0xbd7b2b74,0xbe354098,0x3e09cf86,0x3c7b514b,0xbdd53db9,0xbe636c83
.long 0x3dc8bd36,0xbcc90ab0,0xbe164083,0xbe888e93,0x3d7b2b74,0xbd83db0a,0xbe419b37,0xbe9f1cdf,0x3cc90ab0,0xbdd53db9,0xbe6c9a7f,0xbeb554ec,0xbc490e90,0xbe1324ca,0xbe8b9507,0xbecb2aae
.long 0xbd48fb30,0xbe3b6ecf,0xbea09ae5,0xbee0924f,0xbdafb680,0xbe636c83,0xbeb554ec,0xbef58035,0xbdfab273,0xbe8586ce,0xbec9b953,0xbf04f484,0xbe22abb6,0xbe9920fe,0xbeddbe79,0xbf0ee0db
.long 0x0,0x3dc8bd36,0x3e47c5c2,0x3e94a031,0x0,0x3dcefdb7,0x3e4dee60,0x3e9920fe,0x0,0x3dd53db9,0x3e541501,0x3e9d9e78,0x0,0x3ddb7d37,0x3e5a3997,0x3ea21887
.long 0x0,0x3de1bc2e,0x3e605c13,0x3ea68f12,0x0,0x3de7fa9a,0x3e667c66,0x3eab0201,0x0,0x3dee3876,0x3e6c9a7f,0x3eaf713a,0x0,0x3df475c0,0x3e72b651,0x3eb3dca5
.long 0x0,0x3dfab273,0x3e78cfcc,0x3eb8442a,0x0,0x3e007745,0x3e7ee6e1,0x3ebca7af,0x0,0x3e039502,0x3e827dc0,0x3ec1071e,0x0,0x3e06b26e,0x3e8586ce,0x3ec5625c
.long 0x0,0x3e09cf86,0x3e888e93,0x3ec9b953,0x0,0x3e0cec4a,0x3e8b9507,0x3ece0bea,0x0,0x3e1008b7,0x3e8e9a22,0x3ed25a09,0x0,0x3e1324ca,0x3e919ddd,0x3ed6a399
.long 0x3ec3ef15,0x3ef15aea,0x3f0e39da,0x3f226799,0x3ec9b953,0x3ef840c8,0x3f121eb0,0x3f269de3,0x3ecf7bca,0x3eff17b2,0x3f15f6d9,0x3f2ac082,0x3ed53641,0x3f02ef9f,0x3f19c200,0x3f2ecef7
.long 0x3edae880,0x3f064b82,0x3f1d7fd1,0x3f32c8c9,0x3ee0924f,0x3f099f4e,0x3f212ff9,0x3f36ad7f,0x3ee63375,0x3f0cead0,0x3f24d225,0x3f3a7ca4,0x3eebcbbb,0x3f102dd5,0x3f286605,0x3f3e35c5
.long 0x3ef15aea,0x3f13682a,0x3f2beb4a,0x3f41d870,0x3ef6e0cb,0x3f16999f,0x3f2f61a5,0x3f456439,0x3efc5d27,0x3f19c200,0x3f32c8c9,0x3f48d8b3,0x3f00e7e4,0x3f1ce11f,0x3f36206c,0x3f4c3578
.long 0x3f039c3d,0x3f1ff6cb,0x3f396842,0x3f4f7a1f,0x3f064b82,0x3f2302d3,0x3f3ca003,0x3f52a649,0x3f08f59b,0x3f26050a,0x3f3fc767,0x3f55b993,0x3f0b9a6b,0x3f28fd41,0x3f42de29,0x3f58b3a1
.long 0x3f3504f3,0x3f45e403,0x3f54db31,0x3f61c598,0x3f396842,0x3f4a4c87,0x3f591e6a,0x3f65b710,0x3f3daef9,0x3f4e8d90,0x3f5d2d53,0x3f696591,0x3f41d870,0x3f52a649,0x3f6106f2,0x3f6cd007
.long 0x3f45e403,0x3f5695e5,0x3f64aa59,0x3f6ff573,0x3f49d112,0x3f5a5ba0,0x3f6816a8,0x3f72d4eb,0x3f4d9f02,0x3f5df6be,0x3f6b4b0c,0x3f756d97,0x3f514d3d,0x3f61668a,0x3f6e46be,0x3f77beb7
.long 0x3f54db31,0x3f64aa59,0x3f710908,0x3f79c79d,0x3f584853,0x3f67c187,0x3f73913f,0x3f7b87b2,0x3f5b941a,0x3f6aab7b,0x3f75dec6,0x3f7cfe73,0x3f5ebe05,0x3f6d67a1,0x3f77f110,0x3f7e2b72
.long 0x3f61c598,0x3f6ff573,0x3f79c79d,0x3f7f0e58,0x3f64aa59,0x3f725470,0x3f7b61fc,0x3f7fa6e3,0x3f676bd8,0x3f748422,0x3f7cbfc9,0x3f7ff4e6,0x3f6a09a7,0x3f76841b,0x3f7de0b1,0x3f7ff84a
.long 0x3f6c835e,0x3f74fa0b,0x3f7b14be,0x3f7ec46d,0x3f6ff573,0x3f77beb7,0x3f7cfe73,0x3f7fa6e3,0x3f731447,0x3f7a1e84,0x3f7e70b0,0x3f7ffec4,0x3f75dec6,0x3f7c187a,0x3f7f6ac7,0x3f7fcbe2
.long 0x3f7853f8,0x3f7dabcc,0x3f7fec43,0x3f7f0e58,0x3f7a7302,0x3f7ed7d4,0x3f7ff4e6,0x3f7dc68c,0x3f7c3b28,0x3f7f9c18,0x3f7f84ab,0x3f7bf531,0x3f7dabcc,0x3f7ff84a,0x3f7e9bc9,0x3f799b43
.long 0x3f7ec46d,0x3f7fec43,0x3f7d3aac,0x3f76ba07,0x3f7f84ab,0x3f7f7808,0x3f7b61fc,0x3f73530e,0x3f7fec43,0x3f7e9bc9,0x3f791298,0x3f6f6830,0x3f7ffb11,0x3f7d57de,0x3f764d97,0x3f6afb8c
.long 0x3f7fb10f,0x3f7baccd,0x3f731447,0x3f660f88,0x3f7f0e58,0x3f799b43,0x3f6f6830,0x3f60a6cf,0x3f7e1324,0x3f772417,0x3f6b4b0c,0x3f5ac450,0x3f7cbfc9,0x3f74484b,0x3f66becc,0x3f546b3b
.long 0x3f800000,0x3f7d3aac,0x3f74fa0b,0x3f676bd8,0x3f800000,0x3f7d1cdd,0x3f748422,0x3f666771,0x3f800000,0x3f7cfe73,0x3f740bdd,0x3f655e0b,0x3f800000,0x3f7cdf6c,0x3f73913f,0x3f644fac
.long 0x3f800000,0x3f7cbfc9,0x3f731447,0x3f633c5a,0x3f800000,0x3f7c9f8a,0x3f7294f8,0x3f62241a,0x3f800000,0x3f7c7eb0,0x3f721352,0x3f6106f2,0x3f800000,0x3f7c5d3a,0x3f718f57,0x3f5fe4e9
.long 0x3f800000,0x3f7c3b28,0x3f710908,0x3f5ebe05,0x3f800000,0x3f7c187a,0x3f708066,0x3f5d924d,0x3f800000,0x3f7bf531,0x3f6ff573,0x3f5c61c7,0x3f800000,0x3f7bd14d,0x3f6f6830,0x3f5b2c79
.long 0x3f800000,0x3f7baccd,0x3f6ed89e,0x3f59f26a,0x3f800000,0x3f7b87b2,0x3f6e46be,0x3f58b3a1,0x3f800000,0x3f7b61fc,0x3f6db293,0x3f577026,0x3f800000,0x3f7b3bab,0x3f6d1c1d,0x3f5627fe
.long 0x3f54db31,0x3f3daef9,0x3f226799,0x3f039c3d,0x3f531849,0x3f3b0629,0x3f1ebc12,0x3efdbabb,0x3f514d3d,0x3f385216,0x3f1b02c6,0x3ef41f07,0x3f4f7a1f,0x3f3592e7,0x3f173c07,0x3eea6681
.long 0x3f4d9f02,0x3f32c8c9,0x3f13682a,0x3ee0924f,0x3f4bbbf8,0x3f2ff3e6,0x3f0f8784,0x3ed6a399,0x3f49d112,0x3f2d1469,0x3f0b9a6b,0x3ecc9b8b,0x3f47de65,0x3f2a2a80,0x3f07a136,0x3ec27b55
.long 0x3f45e403,0x3f273656,0x3f039c3d,0x3eb8442a,0x3f43e200,0x3f24381a,0x3eff17b2,0x3eadf73c,0x3f41d870,0x3f212ff9,0x3ef6e0cb,0x3ea395c5,0x3f3fc767,0x3f1e1e22,0x3eee9479,0x3e9920fe
.long 0x3f3daef9,0x3f1b02c6,0x3ee63375,0x3e8e9a22,0x3f3b8f3b,0x3f17de12,0x3eddbe79,0x3e840270,0x3f396842,0x3f14b039,0x3ed53641,0x3e72b651,0x3f373a23,0x3f11796b,0x3ecc9b8b,0x3e5d4b1a
.long 0x3ec3ef15,0x3e78cfcc,0x3dc8bd36,0xbd48fb30,0x3eb8442a,0x3e5d4b1a,0x3d8a200a,0xbda973ba,0x3eac7cd4,0x3e419b37,0x3d16c32c,0xbdee3876,0x3ea09ae5,0x3e25c58c,0x3bc90f88,0xbe195be0
.long 0x3e94a031,0x3e09cf86,0xbcc90ab0,0xbe3b6ecf,0x3e888e93,0x3ddb7d37,0xbd621469,0xbe5d4b1a,0x3e78cfcc,0x3da3308c,0xbdafb680,0xbe7ee6e1,0x3e605c13,0x3d55880e,0xbdee3876,0xbe901c2c
.long 0x3e47c5c2,0x3cc90ab0,0xbe164083,0xbea09ae5,0x3e2f10a2,0xbb490fc6,0xbe354098,0xbeb0eacb,0x3e164083,0xbcfb49ba,0xbe541501,0xbec1071e,0x3dfab273,0xbd6ea038,0xbe72b651,0xbed0eb2a
.long 0x3dc8bd36,0xbdafb680,0xbe888e93,0xbee0924f,0x3d96a905,0xbde7fa9a,0xbe97a117,0xbeeff7fb,0x3d48fb30,0xbe1008b7,0xbea68f12,0xbeff17b2,0x3cc90ab0,0xbe2bf804,0xbeb554ec,0xbf06f686
.long 0xbe47c5c2,0xbeac7cd4,0xbef15aea,0xbf187fc0,0xbe6c9a7f,0xbebf926f,0xbf0242b1,0xbf21cbfb,0xbe888e93,0xbed25a09,0xbf0b9a6b,0xbf2ac082,0xbe9aa086,0xbee4cbfe,0xbf14b039,0xbf33587a
.long 0xbeac7cd4,0xbef6e0cb,0xbf1d7fd1,0xbf3b8f3b,0xbebe1d4a,0xbf044889,0xbf26050a,0xbf436051,0xbecf7bca,0xbf0cead0,0xbf2e3bde,0xbf4ac77f,0xbee0924f,0xbf1553b7,0xbf36206c,0xbf51c0c2
.long 0xbef15aea,0xbf1d7fd1,0xbf3daef9,0xbf584853,0xbf00e7e4,0xbf256bcb,0xbf44e3f5,0xbf5e5aa6,0xbf08f59b,0xbf2d1469,0xbf4bbbf8,0xbf63f473,0xbf10d3cd,0xbf34768f,0xbf5233c6,0xbf6912ae
.long 0xbf187fc0,0xbf3b8f3b,0xbf584853,0xbf6db293,0xbf1ff6cb,0xbf425b89,0xbf5df6be,0xbf71d19f,0xbf273656,0xbf48d8b3,0xbf633c5a,0xbf756d97,0xbf2e3bde,0xbf4f0417,0xbf6816a8,0xbf788486
.long 0x0,0x3e164083,0x3e94a031,0x3edae880,0x0,0x3e195be0,0x3e97a117,0x3edf28a9,0x0,0x3e1c76de,0x3e9aa086,0x3ee363fa,0x0,0x3e1f917b,0x3e9d9e78,0x3ee79a5d
.long 0x0,0x3e22abb6,0x3ea09ae5,0x3eebcbbb,0x0,0x3e25c58c,0x3ea395c5,0x3eeff7fb,0x0,0x3e28defc,0x3ea68f12,0x3ef41f07,0x0,0x3e2bf804,0x3ea986c4,0x3ef840c8
.long 0x0,0x3e2f10a2,0x3eac7cd4,0x3efc5d27,0x0,0x3e3228d4,0x3eaf713a,0x3f003a06,0x0,0x3e354098,0x3eb263ef,0x3f0242b1,0x0,0x3e3857ec,0x3eb554ec,0x3f044889
.long 0x0,0x3e3b6ecf,0x3eb8442a,0x3f064b82,0x0,0x3e3e853e,0x3ebb31a0,0x3f084b92,0x0,0x3e419b37,0x3ebe1d4a,0x3f0a48ad,0x0,0x3e44b0b9,0x3ec1071e,0x3f0c42c9
.long 0x3f0e39da,0x3f2beb4a,0x3f45e403,0x3f5b941a,0x3f10d3cd,0x3f2ecef7,0x3f48d8b3,0x3f5e5aa6,0x3f13682a,0x3f31a81d,0x3f4bbbf8,0x3f6106f2,0x3f15f6d9,0x3f34768f,0x3f4e8d90,0x3f6398ac
.long 0x3f187fc0,0x3f373a23,0x3f514d3d,0x3f660f88,0x3f1b02c6,0x3f39f2ac,0x3f53fac3,0x3f686b39,0x3f1d7fd1,0x3f3ca003,0x3f5695e5,0x3f6aab7b,0x3f1ff6cb,0x3f3f41fc,0x3f591e6a,0x3f6cd007
.long 0x3f226799,0x3f41d870,0x3f5b941a,0x3f6ed89e,0x3f24d225,0x3f446337,0x3f5df6be,0x3f70c501,0x3f273656,0x3f46e22a,0x3f604621,0x3f7294f8,0x3f299415,0x3f495521,0x3f628210,0x3f74484b
.long 0x3f2beb4a,0x3f4bbbf8,0x3f64aa59,0x3f75dec6,0x3f2e3bde,0x3f4e1689,0x3f66becc,0x3f77583a,0x3f3085bb,0x3f5064af,0x3f68bf3c,0x3f78b47b,0x3f32c8c9,0x3f52a649,0x3f6aab7b,0x3f79f35e
.long 0x3f6c835e,0x3f7853f8,0x3f7ec46d,0x3f7fb10f,0x3f6ed89e,0x3f79f35e,0x3f7f6ac7,0x3f7f1f49,0x3f710908,0x3f7b61fc,0x3f7fd397,0x3f7e4323,0x3f731447,0x3f7c9f8a,0x3f7ffec4,0x3f7d1cdd
.long 0x3f74fa0b,0x3f7dabcc,0x3f7fec43,0x3f7baccd,0x3f76ba07,0x3f7e868b,0x3f7f9c18,0x3f79f35e,0x3f7853f8,0x3f7f2f9d,0x3f7f0e58,0x3f77f110,0x3f79c79d,0x3f7fa6e3,0x3f7e4323,0x3f75a67b
.long 0x3f7b14be,0x3f7fec43,0x3f7d3aac,0x3f731447,0x3f7c3b28,0x3f7fffb1,0x3f7bf531,0x3f703b37,0x3f7d3aac,0x3f7fe129,0x3f7a7302,0x3f6d1c1d,0x3f7e1324,0x3f7f90b1,0x3f78b47b,0x3f69b7e4
.long 0x3f7ec46d,0x3f7f0e58,0x3f76ba07,0x3f660f88,0x3f7f4e6d,0x3f7e5a38,0x3f748422,0x3f62241a,0x3f7fb10f,0x3f7d7474,0x3f721352,0x3f5df6be,0x3f7fec43,0x3f7c5d3a,0x3f6f6830,0x3f5988ad
.long 0x3f7b14be,0x3f710908,0x3f61c598,0x3f4d9f02,0x3f791298,0x3f6d67a1,0x3f5c61c7,0x3f466354,0x3f76ba07,0x3f696591,0x3f5695e5,0x3f3ebc1b,0x3f740bdd,0x3f650479,0x3f5064af,0x3f36ad7f
.long 0x3f710908,0x3f604621,0x3f49d112,0x3f2e3bde,0x3f6db293,0x3f5b2c79,0x3f42de29,0x3f256bcb,0x3f6a09a7,0x3f55b993,0x3f3b8f3b,0x3f1c420c,0x3f660f88,0x3f4fefa8,0x3f33e7bc,0x3f12c39a
.long 0x3f61c598,0x3f49d112,0x3f2beb4a,0x3f08f59b,0x3f5d2d53,0x3f436051,0x3f239da9,0x3efdbabb,0x3f584853,0x3f3ca003,0x3f1b02c6,0x3ee900b7,0x3f531849,0x3f3592e7,0x3f121eb0,0x3ed3c867
.long 0x3f4d9f02,0x3f2e3bde,0x3f08f59b,0x3ebe1d4a,0x3f47de65,0x3f269de3,0x3eff17b2,0x3ea80b1f,0x3f41d870,0x3f1ebc12,0x3eebcbbb,0x3e919ddd,0x3f3b8f3b,0x3f16999f,0x3ed8106b,0x3e75c35a
.long 0x0,0xbdc8bd36,0xbe47c5c2,0xbe94a031,0xbd48fb30,0xbe195be0,0xbe7ee6e1,0xbeb0eacb,0xbdc8bd36,0xbe4dee60,0xbe9aa086,0xbecc9b8b,0xbe164083,0xbe80f8c0,0xbeb554ec,0xbee79a5d
.long 0xbe47c5c2,0xbe9aa086,0xbecf7bca,0xbf00e7e4,0xbe78cfcc,0xbeb3dca5,0xbee900b7,0xbf0d9281,0xbe94a031,0xbecc9b8b,0xbf00e7e4,0xbf19c200,0xbeac7cd4,0xbee4cbfe,0xbf0cead0,0xbf256bcb
.long 0xbec3ef15,0xbefc5d27,0xbf187fc0,0xbf3085bb,0xbedae880,0xbf099f4e,0xbf239da9,0xbf3b0629,0xbef15aea,0xbf14b039,0xbf2e3bde,0xbf44e3f5,0xbf039c3d,0xbf1f599f,0xbf385216,0xbf4e1689
.long 0xbf0e39da,0xbf299415,0xbf41d870,0xbf5695e5,0xbf187fc0,0xbf33587a,0xbf4ac77f,0xbf5e5aa6,0xbf226799,0xbf3ca003,0xbf531849,0xbf655e0b,0xbf2beb4a,0xbf456439,0xbf5ac450,0xbf6b99fb
.long 0xbec3ef15,0xbef15aea,0xbf0e39da,0xbf226799,0xbee0924f,0xbf06f686,0xbf1c420c,0xbf2ff3e6,0xbefc5d27,0xbf14b039,0xbf299415,0xbf3ca003,0xbf0b9a6b,0xbf21cbfb,0xbf36206c,0xbf485bca
.long 0xbf187fc0,0xbf2e3bde,0xbf41d870,0xbf531849,0xbf24d225,0xbf39f2ac,0xbf4cae79,0xbf5cc7d1,0xbf3085bb,0xbf44e3f5,0xbf5695e5,0xbf655e0b,0xbf3b8f3b,0xbf4f0417,0xbf5f8327,0xbf6cd007
.long 0xbf45e403,0xbf584853,0xbf676bd8,0xbf731447,0xbf4f7a1f,0xbf60a6cf,0xbf6e46be,0xbf7822d1,0xbf584853,0xbf6816a8,0xbf740bdd,0xbf7bf531,0xbf604621,0xbf6e8ff8,0xbf78b47b,0xbf7e868b
.long 0xbf676bd8,0xbf740bdd,0xbf7c3b28,0xbf7fd397,0xbf6db293,0xbf788486,0xbf7e9bc9,0xbf7fdaaf,0xbf731447,0xbf7bf531,0xbf7fd397,0xbf7e9bc9,0xbf778bc5,0xbf7e5a38,0xbf7fe129,0xbf7c187a
.long 0xbf3504f3,0xbf45e403,0xbf54db31,0xbf61c598,0xbf41d870,0xbf51c0c2,0xbf5f8327,0xbf6afb8c,0xbf4d9f02,0xbf5c61c7,0xbf68bf3c,0xbf7294f8,0xbf584853,0xbf65b710,0xbf708066,0xbf788486
.long 0xbf61c598,0xbf6db293,0xbf76ba07,0xbf7cbfc9,0xbf6a09a7,0xbf74484b,0xbf7b61fc,0xbf7f3f54,0xbf710908,0xbf796e4e,0xbf7e70b0,0xbf7ffec4,0xbf76ba07,0xbf7d1cdd,0xbf7fe129,0xbf7efcc9
.long 0xbf7b14be,0xbf7f4e6d,0xbf7fb10f,0xbf7c3b28,0xbf7e1324,0xbf7fffb1,0xbf7de0b1,0xbf77beb7,0xbf7fb10f,0xbf7f2f9d,0xbf7a7302,0xbf718f57,0xbf7fec43,0xbf7cdf6c,0xbf756d97,0xbf69b7e4
.long 0xbf7ec46d,0xbf791298,0xbf6ed89e,0xbf604621,0xbf7c3b28,0xbf73ced9,0xbf66becc,0xbf554aa4,0xbf7853f8,0xbf6d1c1d,0xbf5d2d53,0xbf48d8b3,0xbf731447,0xbf650479,0xbf5233c6,0xbf3b0629
.long 0xbf6c835e,0xbf74fa0b,0xbf7b14be,0xbf7ec46d,0xbf740bdd,0xbf7a9c59,0xbf7e9bc9,0xbf7fffb1,0xbf79c79d,0xbf7e4323,0xbf7ffb11,0xbf7eea9d,0xbf7dabcc,0xbf7fe705,0xbf7f2f9d,0xbf7b87b2
.long 0xbf7fb10f,0xbf7f84ab,0xbf7c3b28,0xbf75dec6,0xbf7fd397,0xbf7d1cdd,0xbf772417,0xbf6dfcf2,0xbf7e1324,0xbf78b47b,0xbf6ff573,0xbf63f473,0xbf7a7302,0xbf725470,0xbf66becc,0xbf57dc7f
.long 0xbf74fa0b,0xbf6a09a7,0xbf5b941a,0xbf49d112,0xbf6db293,0xbf5fe4e9,0xbf4e8d90,0xbf39f2ac,0xbf64aa59,0xbf53fac3,0xbf3fc767,0xbf286605,0xbf59f26a,0xbf466354,0xbf2f61a5,0xbf1553b7
.long 0xbf4d9f02,0xbf373a23,0xbf1d7fd1,0xbf00e7e4,0xbf3fc767,0xbf269de3,0xbf0a48ad,0xbed6a399,0xbf3085bb,0xbf14b039,0xbeebcbbb,0xbea986c4,0xbf1ff6cb,0xbf019573,0xbec1071e,0xbe75c35a
.long 0x3f800000,0x3f7ec46d,0x3f7b14be,0x3f74fa0b,0x3f7fb10f,0x3f7d1cdd,0x3f77f110,0x3f703b37,0x3f7ec46d,0x3f7ac516,0x3f740bdd,0x3f6aab7b,0x3f7d3aac,0x3f77beb7,0x3f6f6830,0x3f644fac
.long 0x3f7b14be,0x3f740bdd,0x3f6a09a7,0x3f5d2d53,0x3f7853f8,0x3f6faf1b,0x3f63f473,0x3f554aa4,0x3f74fa0b,0x3f6aab7b,0x3f5d2d53,0x3f4cae79,0x3f710908,0x3f650479,0x3f55b993,0x3f436051
.long 0x3f6c835e,0x3f5ebe05,0x3f4d9f02,0x3f396842,0x3f676bd8,0x3f57dc7f,0x3f44e3f5,0x3f2ecef7,0x3f61c598,0x3f5064af,0x3f3b8f3b,0x3f239da9,0x3f5b941a,0x3f485bca,0x3f31a81d,0x3f17de12
.long 0x3f54db31,0x3f3fc767,0x3f273656,0x3f0b9a6b,0x3f4d9f02,0x3f36ad7f,0x3f1c420c,0x3efdbabb,0x3f45e403,0x3f2d1469,0x3f10d3cd,0x3ee363fa,0x3f3daef9,0x3f2302d3,0x3f04f484,0x3ec8477c
.long 0x3f6c835e,0x3f61c598,0x3f54db31,0x3f45e403,0x3f660f88,0x3f5988ad,0x3f4ac77f,0x3f39f2ac,0x3f5ebe05,0x3f5064af,0x3f3fc767,0x3f2d1469,0x3f5695e5,0x3f466354,0x3f33e7bc,0x3f1f599f
.long 0x3f4d9f02,0x3f3b8f3b,0x3f273656,0x3f10d3cd,0x3f43e200,0x3f2ff3e6,0x3f19c200,0x3f019573,0x3f396842,0x3f239da9,0x3f0b9a6b,0x3ee363fa,0x3f2e3bde,0x3f16999f,0x3ef9a02d,0x3ec27b55
.long 0x3f226799,0x3f08f59b,0x3edae880,0x3ea09ae5,0x3f15f6d9,0x3ef58035,0x3ebb31a0,0x3e7bdba4,0x3f08f59b,0x3ed8106b,0x3e9aa086,0x3e354098,0x3ef6e0cb,0x3eb9bb1e,0x3e72b651,0x3ddb7d37
.long 0x3edae880,0x3e9aa086,0x3e2f10a2,0x3d16c32c,0x3ebe1d4a,0x3e75c35a,0x3dd53db9,0xbd0a342f,0x3ea09ae5,0x3e354098,0x3d16c32c,0xbdd53db9,0x3e827dc0,0x3de7fa9a,0xbcfb49ba,0xbe3228d4
.long 0x3f3504f3,0x3f226799,0x3f0e39da,0x3ef15aea,0x3f273656,0x3f12c39a,0x3ef9a02d,0x3ecb2aae,0x3f187fc0,0x3f0242b1,0x3ed53641,0x3ea395c5,0x3f08f59b,0x3ee1fb6a,0x3eaf713a,0x3e75c35a
.long 0x3ef15aea,0x3ebe1d4a,0x3e888e93,0x3e22abb6,0x3ecf7bca,0x3e9920fe,0x3e419b37,0x3d9cecf9,0x3eac7cd4,0x3e667c66,0x3de1bc2e,0xbbc90f88,0x3e888e93,0x3e195be0,0x3cfb49ba,0xbdb5f8da
.long 0x3e47c5c2,0x3d96a905,0xbd48fb30,0xbe2f10a2,0x3dfab273,0xbb490fc6,0xbe039502,0xbe80f8c0,0x3d48fb30,0xbda3308c,0xbe541501,0xbea986c4,0xbcc90ab0,0xbe1f917b,0xbe919ddd,0xbed0eb2a
.long 0xbdc8bd36,0xbe6c9a7f,0xbeb8442a,0xbef6e0cb,0xbe2f10a2,0xbe9c1faf,0xbeddbe79,0xbf0d9281,0xbe78cfcc,0xbec1071e,0xbf00e7e4,0xbf1ebc12,0xbea09ae5,0xbee4cbfe,0xbf121eb0,0xbf2ecef7
.long 0x3ec3ef15,0x3e94a031,0x3e47c5c2,0x3dc8bd36,0x3e9aa086,0x3e5101f1,0x3dd53db9,0x3b490fc6,0x3e605c13,0x3dee3876,0x3c490e90,0xbdbc3ac3,0x3e09cf86,0x3ce22a7a,0xbda3308c,0xbe3e853e
.long 0x3d48fb30,0xbd7b2b74,0xbe2f10a2,0xbe8e9a22,0xbd16c32c,0xbe195be0,0xbe8586ce,0xbebca7af,0xbdfab273,0xbe72b651,0xbeb263ef,0xbee900b7,0xbe541501,0xbea5129f,0xbeddbe79,0xbf099f4e
.long 0xbe94a031,0xbecf7bca,0xbf039c3d,0xbf1d7fd1,0xbebe1d4a,0xbef840c8,0xbf173c07,0xbf2ff3e6,0xbee63375,0xbf0f8784,0xbf299415,0xbf40d0da,0xbf064b82,0xbf21cbfb,0xbf3a7ca4,0xbf4fefa8
.long 0xbf187fc0,0xbf32c8c9,0xbf49d112,0xbf5d2d53,0xbf299415,0xbf425b89,0xbf577026,0xbf686b39,0xbf396842,0xbf5064af,0xbf633c5a,0xbf718f57,0xbf47de65,0xbf5cc7d1,0xbf6d1c1d,0xbf788486
.long 0xbf3504f3,0xbf4d9f02,0xbf61c598,0xbf710908,0xbf3daef9,0xbf554aa4,0xbf6816a8,0xbf75a67b,0xbf45e403,0xbf5c61c7,0xbf6db293,0xbf796e4e,0xbf4d9f02,0xbf62df7b,0xbf7294f8,0xbf7c5d3a
.long 0xbf54db31,0xbf68bf3c,0xbf76ba07,0xbf7e70b0,0xbf5b941a,0xbf6dfcf2,0xbf7a1e84,0xbf7fa6e3,0xbf61c598,0xbf7294f8,0xbf7cbfc9,0xbf7ffec4,0xbf676bd8,0xbf76841b,0xbf7e9bc9,0xbf7f7808
.long 0xbf6c835e,0xbf79c79d,0xbf7fb10f,0xbf7e1324,0xbf710908,0xbf7c5d3a,0xbf7ffec4,0xbf7bd14d,0xbf74fa0b,0xbf7e4323,0xbf7f84ab,0xbf78b47b,0xbf7853f8,0xbf7f7808,0xbf7e4323,0xbf74bf62
.long 0xbf7b14be,0xbf7ffb11,0xbf7c3b28,0xbf6ff573,0xbf7d3aac,0xbf7fcbe2,0xbf796e4e,0xbf6a5ad9,0xbf7ec46d,0xbf7eea9d,0xbf75dec6,0xbf63f473,0xbf7fb10f,0xbf7d57de,0xbf718f57,0xbf5cc7d1
.long 0xbf7b14be,0xbf7fb10f,0xbf7ec46d,0xbf7853f8,0xbf7dabcc,0xbf7ff84a,0xbf7c7eb0,0xbf73530e,0xbf7f4e6d,0xbf7f2f9d,0xbf791298,0xbf6d1c1d,0xbf7ffb11,0xbf7d57de,0xbf748422,0xbf65b710
.long 0xbf7fb10f,0xbf7a7302,0xbf6ed89e,0xbf5d2d53,0xbf7e70b0,0xbf76841b,0xbf6816a8,0xbf5389c7,0xbf7c3b28,0xbf718f57,0xbf604621,0xbf48d8b3,0xbf791298,0xbf6b99fb,0xbf577026,0xbf3d27b8
.long 0xbf74fa0b,0xbf64aa59,0xbf4d9f02,0xbf3085bb,0xbf6ff573,0xbf5cc7d1,0xbf42de29,0xbf2302d3,0xbf6a09a7,0xbf53fac3,0xbf373a23,0xbf14b039,0xbf633c5a,0xbf4a4c87,0xbf2ac082,0xbf05a02c
.long 0xbf5b941a,0xbf3fc767,0xbf1d7fd1,0xbeebcbbb,0xbf531849,0xbf34768f,0xbf0f8784,0xbecb2aae,0xbf49d112,0xbf286605,0xbf00e7e4,0xbea986c4,0xbf3fc767,0xbf1ba299,0xbee363fa,0xbe870ada
.long 0xbf6c835e,0xbf5b941a,0xbf45e403,0xbf2beb4a,0xbf64aa59,0xbf50d937,0xbf385216,0xbf1ba299,0xbf5b941a,0xbf44e3f5,0xbf299415,0xbf0a48ad,0xbf514d3d,0xbf37c655,0xbf19c200,0xbeeff7fb
.long 0xbf45e403,0xbf299415,0xbf08f59b,0xbec9b953,0xbf396842,0xbf1a6293,0xbeee9479,0xbea21887,0xbf2beb4a,0xbf0a48ad,0xbec9b953,0xbe72b651,0xbf1d7fd1,0xbef2bd43,0xbea395c5,0xbe1f917b
.long 0xbf0e39da,0xbecf7bca,0xbe78cfcc,0xbd96a905,0xbefc5d27,0xbeab0201,0xbe28defc,0x3c16cb58,0xbedae880,0xbe8586ce,0xbdafb680,0x3dbc3ac3,0xbeb8442a,0xbe3e853e,0xbbc90f88,0x3e3228d4
.long 0xbe94a031,0xbde1bc2e,0x3d96a905,0x3e827dc0,0xbe605c13,0xbd0a342f,0x3e1c76de,0x3eab0201,0xbe164083,0x3d2fe007,0x3e6c9a7f,0x3ed25a09,0xbd96a905,0x3df475c0,0x3e9d9e78,0x3ef840c8
.long 0xbf0e39da,0xbedae880,0xbe94a031,0xbe164083,0xbef6e0cb,0xbeb0eacb,0xbe4dee60,0xbd55880e,0xbecf7bca,0xbe8586ce,0xbde1bc2e,0x3d2fe007,0xbea68f12,0xbe3228d4,0xbc96c9b6,0x3e0cec4a
.long 0xbe78cfcc,0xbdafb680,0x3d96a905,0x3e6c9a7f,0xbe22abb6,0x3b490fc6,0x3e28defc,0x3ea5129f,0xbd96a905,0x3dbc3ac3,0x3e827dc0,0x3ed25a09,0x3c490e90,0x3e3857ec,0x3eaf713a,0x3efdbabb
.long 0x3dc8bd36,0x3e888e93,0x3edae880,0x3f13682a,0x3e3b6ecf,0x3eb3dca5,0x3f0242b1,0x3f269de3,0x3e888e93,0x3eddbe79,0x3f15f6d9,0x3f385216,0x3eb263ef,0x3f02ef9f,0x3f286605,0x3f485bca
.long 0x3edae880,0x3f15f6d9,0x3f396842,0x3f5695e5,0x3f00e7e4,0x3f27ce61,0x3f48d8b3,0x3f62df7b,0x3f13682a,0x3f385216,0x3f5695e5,0x3f6d1c1d,0x3f24d225,0x3f476085,0x3f628210,0x3f75341d
.long 0x3f3504f3,0x3f187fc0,0x3ef15aea,0x3eac7cd4,0x3f2beb4a,0x3f0d9281,0x3ed8106b,0x3e901c2c,0x3f226799,0x3f0242b1,0x3ebe1d4a,0x3e667c66,0x3f187fc0,0x3eed3063,0x3ea395c5,0x3e2bf804
.long 0x3f0e39da,0x3ed53641,0x3e888e93,0x3de1bc2e,0x3f039c3d,0x3ebca7af,0x3e5a3997,0x3d55880e,0x3ef15aea,0x3ea395c5,0x3e22abb6,0xbbc90f88,0x3edae880,0x3e8a11f7,0x3dd53db9,0xbd83db0a
.long 0x3ec3ef15,0x3e605c13,0x3d48fb30,0xbdfab273,0x3eac7cd4,0x3e2bf804,0xbbc90f88,0xbe3857ec,0x3e94a031,0x3dee3876,0xbd7b2b74,0xbe72b651,0x3e78cfcc,0x3d83db0a,0xbdee3876,0xbe9620d2
.long 0x3e47c5c2,0x3c490e90,0xbe2f10a2,0xbeb263ef,0x3e164083,0xbd2351cb,0xbe667c66,0xbece0bea,0x3dc8bd36,0xbdbc3ac3,0xbe8e9a22,0xbee900b7,0x3d48fb30,0xbe1324ca,0xbea986c4,0xbf019573
.long 0x3e47c5c2,0x3d48fb30,0xbdc8bd36,0xbe78cfcc,0x3e09cf86,0xbc7b514b,0xbe28defc,0xbe9f1cdf,0x3d96a905,0xbda3308c,0xbe6c9a7f,0xbec1071e,0x3c490e90,0xbe1324ca,0xbe97a117,0xbee1fb6a
.long 0xbd48fb30,0xbe541501,0xbeb8442a,0xbf00e7e4,0xbde1bc2e,0xbe8a11f7,0xbed8106b,0xbf102dd5,0xbe2f10a2,0xbea986c4,0xbef6e0cb,0xbf1ebc12,0xbe6c9a7f,0xbec8477c,0xbf0a48ad,0xbf2c800f
.long 0xbe94a031,0xbee63375,0xbf187fc0,0xbf396842,0xbeb263ef,0xbf019573,0xbf26050a,0xbf456439,0xbecf7bca,0xbf0f8784,0xbf32c8c9,0xbf5064af,0xbeebcbbb,0xbf1ce11f,0xbf3ebc1b,0xbf5a5ba0
.long 0xbf039c3d,0xbf299415,0xbf49d112,0xbf633c5a,0xbf10d3cd,0xbf3592e7,0xbf53fac3,0xbf6afb8c,0xbf1d7fd1,0xbf40d0da,0xbf5d2d53,0xbf718f57,0xbf299415,0xbf4b41fa,0xbf655e0b,0xbf76ef5b
.long 0xbec3ef15,0xbf039c3d,0xbf226799,0xbf3daef9,0xbee63375,0xbf140c5f,0xbf31a81d,0xbf4b41fa,0xbf039c3d,0xbf239da9,0xbf3fc767,0xbf577026,0xbf13682a,0xbf3238aa,0xbf4cae79,0xbf62241a
.long 0xbf226799,0xbf3fc767,0xbf584853,0xbf6b4b0c,0xbf3085bb,0xbf4c3578,0xbf628210,0xbf72d4eb,0xbf3daef9,0xbf577026,0xbf6b4b0c,0xbf78b47b,0xbf49d112,0xbf61668a,0xbf7294f8,0xbf7cdf6c
.long 0xbf54db31,0xbf6a09a7,0xbf7853f8,0xbf7f4e6d,0xbf5ebe05,0xbf714c7a,0xbf7c7eb0,0xbf7ffd39,0xbf676bd8,0xbf772417,0xbf7f0e58,0xbf7eea9d,0xbf6ed89e,0xbf7b87b2,0xbf7ffec4,0xbf7c187a
.long 0xbf74fa0b,0xbf7e70b0,0xbf7f4e6d,0xbf778bc5,0xbf79c79d,0xbf7fdaaf,0xbf7cfe73,0xbf714c7a,0xbf7d3aac,0xbf7fc38f,0xbf791298,0xbf696591,0xbf7f4e6d,0xbf7e2b72,0xbf73913f,0xbf5fe4e9
.long 0xbf54db31,0xbf676bd8,0xbf74fa0b,0xbf7d3aac,0xbf604621,0xbf703b37,0xbf7ac516,0xbf7fa6e3,0xbf6a09a7,0xbf772417,0xbf7e70b0,0xbf7fc38f,0xbf721352,0xbf7c187a,0xbf7ff4e6,0xbf7d906e
.long 0xbf7853f8,0xbf7f0e58,0xbf7f4e6d,0xbf791298,0xbf7cbfc9,0xbf7fffb1,0xbf7c7eb0,0xbf725470,0xbf7f4e6d,0xbf7eea9d,0xbf778bc5,0xbf696591,0xbf7ffb11,0xbf7bd14d,0xbf708066,0xbf5e5aa6
.long 0xbf7ec46d,0xbf76ba07,0xbf676bd8,0xbf514d3d,0xbf7baccd,0xbf6faf1b,0xbf5c61c7,0xbf425b89,0xbf76ba07,0xbf66becc,0xbf4f7a1f,0xbf31a81d,0xbf6ff573,0xbf5bfb34,0xbf40d0da,0xbf1f599f
.long 0xbf676bd8,0xbf4f7a1f,0xbf3085bb,0xbf0b9a6b,0xbf5d2d53,0xbf4154e1,0xbf1ebc12,0xbeed3063,0xbf514d3d,0xbf31a81d,0xbf0b9a6b,0xbec1071e,0xbf43e200,0xbf209393,0xbeee9479,0xbe931f35
.long 0x3f800000,0x3f800000,0x3f800000,0x3f800000,0x3f800000,0x3f7fffb1,0x3f7ffec4,0x3f7ffd39,0x3f800000,0x3f7ffec4,0x3f7ffb11,0x3f7ff4e6,0x3f800000,0x3f7ffd39,0x3f7ff4e6,0x3f7fe705
.long 0x3f800000,0x3f7ffb11,0x3f7fec43,0x3f7fd397,0x3f800000,0x3f7ff84a,0x3f7fe129,0x3f7fba9e,0x3f800000,0x3f7ff4e6,0x3f7fd397,0x3f7f9c18,0x3f800000,0x3f7ff0e3,0x3f7fc38f,0x3f7f7808
.long 0x3f800000,0x3f7fec43,0x3f7fb10f,0x3f7f4e6d,0x3f800000,0x3f7fe705,0x3f7f9c18,0x3f7f1f49,0x3f800000,0x3f7fe129,0x3f7f84ab,0x3f7eea9d,0x3f800000,0x3f7fdaaf,0x3f7f6ac7,0x3f7eb069
.long 0x3f800000,0x3f7fd397,0x3f7f4e6d,0x3f7e70b0,0x3f800000,0x3f7fcbe2,0x3f7f2f9d,0x3f7e2b72,0x3f800000,0x3f7fc38f,0x3f7f0e58,0x3f7de0b1,0x3f800000,0x3f7fba9e,0x3f7eea9d,0x3f7d906e
.long 0x3f800000,0x3f800000,0x3f800000,0x3f800000,0x3f7ffb11,0x3f7ff84a,0x3f7ff4e6,0x3f7ff0e3,0x3f7fec43,0x3f7fe129,0x3f7fd397,0x3f7fc38f,0x3f7fd397,0x3f7fba9e,0x3f7f9c18,0x3f7f7808
.long 0x3f7fb10f,0x3f7f84ab,0x3f7f4e6d,0x3f7f0e58,0x3f7f84ab,0x3f7f3f54,0x3f7eea9d,0x3f7e868b,0x3f7f4e6d,0x3f7eea9d,0x3f7e70b0,0x3f7de0b1,0x3f7f0e58,0x3f7e868b,0x3f7de0b1,0x3f7d1cdd
.long 0x3f7ec46d,0x3f7e1324,0x3f7d3aac,0x3f7c3b28,0x3f7e70b0,0x3f7d906e,0x3f7c7eb0,0x3f7b3bab,0x3f7e1324,0x3f7cfe73,0x3f7baccd,0x3f7a1e84,0x3f7dabcc,0x3f7c5d3a,0x3f7ac516,0x3f78e3d6
.long 0x3f7d3aac,0x3f7baccd,0x3f79c79d,0x3f778bc5,0x3f7cbfc9,0x3f7aed37,0x3f78b47b,0x3f76167a,0x3f7c3b28,0x3f7a1e84,0x3f778bc5,0x3f748422,0x3f7baccd,0x3f7940c0,0x3f764d97,0x3f72d4eb
.long 0x3f800000,0x3f800000,0x3f800000,0x3f800000,0x3f7fec43,0x3f7fe705,0x3f7fe129,0x3f7fdaaf,0x3f7fb10f,0x3f7f9c18,0x3f7f84ab,0x3f7f6ac7,0x3f7f4e6d,0x3f7f1f49,0x3f7eea9d,0x3f7eb069
.long 0x3f7ec46d,0x3f7e70b0,0x3f7e1324,0x3f7dabcc,0x3f7e1324,0x3f7d906e,0x3f7cfe73,0x3f7c5d3a,0x3f7d3aac,0x3f7c7eb0,0x3f7baccd,0x3f7ac516,0x3f7c3b28,0x3f7b3bab,0x3f7a1e84,0x3f78e3d6
.long 0x3f7b14be,0x3f79c79d,0x3f7853f8,0x3f76ba07,0x3f79c79d,0x3f7822d1,0x3f764d97,0x3f74484b,0x3f7853f8,0x3f764d97,0x3f740bdd,0x3f718f57,0x3f76ba07,0x3f74484b,0x3f718f57,0x3f6e8ff8
.long 0x3f74fa0b,0x3f721352,0x3f6ed89e,0x3f6b4b0c,0x3f731447,0x3f6faf1b,0x3f6be858,0x3f67c187,0x3f710908,0x3f6d1c1d,0x3f68bf3c,0x3f63f473,0x3f6ed89e,0x3f6a5ad9,0x3f655e0b,0x3f5fe4e9
.long 0x3f800000,0x3f800000,0x3f800000,0x3f800000,0x3f7fd397,0x3f7fcbe2,0x3f7fc38f,0x3f7fba9e,0x3f7f4e6d,0x3f7f2f9d,0x3f7f0e58,0x3f7eea9d,0x3f7e70b0,0x3f7e2b72,0x3f7de0b1,0x3f7d906e
.long 0x3f7d3aac,0x3f7cbfc9,0x3f7c3b28,0x3f7baccd,0x3f7baccd,0x3f7aed37,0x3f7a1e84,0x3f7940c0,0x3f79c79d,0x3f78b47b,0x3f778bc5,0x3f764d97,0x3f778bc5,0x3f76167a,0x3f748422,0x3f72d4eb
.long 0x3f74fa0b,0x3f731447,0x3f710908,0x3f6ed89e,0x3f721352,0x3f6faf1b,0x3f6d1c1d,0x3f6a5ad9,0x3f6ed89e,0x3f6be858,0x3f68bf3c,0x3f655e0b,0x3f6b4b0c,0x3f67c187,0x3f63f473,0x3f5fe4e9
.long 0x3f676bd8,0x3f633c5a,0x3f5ebe05,0x3f59f26a,0x3f633c5a,0x3f5e5aa6,0x3f591e6a,0x3f5389c7,0x3f5ebe05,0x3f591e6a,0x3f531849,0x3f4cae79,0x3f59f26a,0x3f5389c7,0x3f4cae79,0x3f456439
.long 0x0,0x0,0x0,0x0,0x0,0x3b490fc6,0x3bc90f88,0x3c16cb58,0x0,0x3bc90f88,0x3c490e90,0x3c96c9b6,0x0,0x3c16cb58,0x3c96c9b6,0x3ce22a7a
.long 0x0,0x3c490e90,0x3cc90ab0,0x3d16c32c,0x0,0x3c7b514b,0x3cfb49ba,0x3d3c6dd5,0x0,0x3c96c9b6,0x3d16c32c,0x3d621469,0x0,0x3cafea69,0x3d2fe007,0x3d83db0a
.long 0x0,0x3cc90ab0,0x3d48fb30,0x3d96a905,0x0,0x3ce22a7a,0x3d621469,0x3da973ba,0x0,0x3cfb49ba,0x3d7b2b74,0x3dbc3ac3,0x0,0x3d0a342f,0x3d8a200a,0x3dcefdb7
.long 0x0,0x3d16c32c,0x3d96a905,0x3de1bc2e,0x0,0x3d2351cb,0x3da3308c,0x3df475c0,0x0,0x3d2fe007,0x3dafb680,0x3e039502,0x0,0x3d3c6dd5,0x3dbc3ac3,0x3e0cec4a
.long 0x0,0x0,0x0,0x0,0x3c490e90,0x3c7b514b,0x3c96c9b6,0x3cafea69,0x3cc90ab0,0x3cfb49ba,0x3d16c32c,0x3d2fe007,0x3d16c32c,0x3d3c6dd5,0x3d621469,0x3d83db0a
.long 0x3d48fb30,0x3d7b2b74,0x3d96a905,0x3dafb680,0x3d7b2b74,0x3d9cecf9,0x3dbc3ac3,0x3ddb7d37,0x3d96a905,0x3dbc3ac3,0x3de1bc2e,0x3e039502,0x3dafb680,0x3ddb7d37,0x3e039502,0x3e195be0
.long 0x3dc8bd36,0x3dfab273,0x3e164083,0x3e2f10a2,0x3de1bc2e,0x3e0cec4a,0x3e28defc,0x3e44b0b9,0x3dfab273,0x3e1c76de,0x3e3b6ecf,0x3e5a3997,0x3e09cf86,0x3e2bf804,0x3e4dee60,0x3e6fa8b2
.long 0x3e164083,0x3e3b6ecf,0x3e605c13,0x3e827dc0,0x3e22abb6,0x3e4ada4f,0x3e72b651,0x3e8d17c0,0x3e2f10a2,0x3e5a3997,0x3e827dc0,0x3e97a117,0x3e3b6ecf,0x3e698bba,0x3e8b9507,0x3ea21887
.long 0x0,0x0,0x0,0x0,0x3cc90ab0,0x3ce22a7a,0x3cfb49ba,0x3d0a342f,0x3d48fb30,0x3d621469,0x3d7b2b74,0x3d8a200a,0x3d96a905,0x3da973ba,0x3dbc3ac3,0x3dcefdb7
.long 0x3dc8bd36,0x3de1bc2e,0x3dfab273,0x3e09cf86,0x3dfab273,0x3e0cec4a,0x3e1c76de,0x3e2bf804,0x3e164083,0x3e28defc,0x3e3b6ecf,0x3e4dee60,0x3e2f10a2,0x3e44b0b9,0x3e5a3997,0x3e6fa8b2
.long 0x3e47c5c2,0x3e605c13,0x3e78cfcc,0x3e888e93,0x3e605c13,0x3e7bdba4,0x3e8b9507,0x3e9920fe,0x3e78cfcc,0x3e8b9507,0x3e9aa086,0x3ea986c4,0x3e888e93,0x3e9920fe,0x3ea986c4,0x3eb9bb1e
.long 0x3e94a031,0x3ea68f12,0x3eb8442a,0x3ec9b953,0x3ea09ae5,0x3eb3dca5,0x3ec6d529,0x3ed97cb9,0x3eac7cd4,0x3ec1071e,0x3ed53641,0x3ee900b7,0x3eb8442a,0x3ece0bea,0x3ee363fa,0x3ef840c8
.long 0x0,0x0,0x0,0x0,0x3d16c32c,0x3d2351cb,0x3d2fe007,0x3d3c6dd5,0x3d96a905,0x3da3308c,0x3dafb680,0x3dbc3ac3,0x3de1bc2e,0x3df475c0,0x3e039502,0x3e0cec4a
.long 0x3e164083,0x3e22abb6,0x3e2f10a2,0x3e3b6ecf,0x3e3b6ecf,0x3e4ada4f,0x3e5a3997,0x3e698bba,0x3e605c13,0x3e72b651,0x3e827dc0,0x3e8b9507,0x3e827dc0,0x3e8d17c0,0x3e97a117,0x3ea21887
.long 0x3e94a031,0x3ea09ae5,0x3eac7cd4,0x3eb8442a,0x3ea68f12,0x3eb3dca5,0x3ec1071e,0x3ece0bea,0x3eb8442a,0x3ec6d529,0x3ed53641,0x3ee363fa,0x3ec9b953,0x3ed97cb9,0x3ee900b7,0x3ef840c8
.long 0x3edae880,0x3eebcbbb,0x3efc5d27,0x3f064b82,0x3eebcbbb,0x3efdbabb,0x3f07a136,0x3f102dd5,0x3efc5d27,0x3f07a136,0x3f10d3cd,0x3f19c200,0x3f064b82,0x3f102dd5,0x3f19c200,0x3f2302d3
.long 0x3f800000,0x3f7fb10f,0x3f7ec46d,0x3f7d3aac,0x3f800000,0x3f7fa6e3,0x3f7e9bc9,0x3f7cdf6c,0x3f800000,0x3f7f9c18,0x3f7e70b0,0x3f7c7eb0,0x3f800000,0x3f7f90b1,0x3f7e4323,0x3f7c187a
.long 0x3f800000,0x3f7f84ab,0x3f7e1324,0x3f7baccd,0x3f800000,0x3f7f7808,0x3f7de0b1,0x3f7b3bab,0x3f800000,0x3f7f6ac7,0x3f7dabcc,0x3f7ac516,0x3f800000,0x3f7f5ce9,0x3f7d7474,0x3f7a4910
.long 0x3f800000,0x3f7f4e6d,0x3f7d3aac,0x3f79c79d,0x3f800000,0x3f7f3f54,0x3f7cfe73,0x3f7940c0,0x3f800000,0x3f7f2f9d,0x3f7cbfc9,0x3f78b47b,0x3f800000,0x3f7f1f49,0x3f7c7eb0,0x3f7822d1
.long 0x3f800000,0x3f7f0e58,0x3f7c3b28,0x3f778bc5,0x3f800000,0x3f7efcc9,0x3f7bf531,0x3f76ef5b,0x3f800000,0x3f7eea9d,0x3f7baccd,0x3f764d97,0x3f800000,0x3f7ed7d4,0x3f7b61fc,0x3f75a67b
.long 0x3f7b14be,0x3f7853f8,0x3f74fa0b,0x3f710908,0x3f7a7302,0x3f77583a,0x3f73913f,0x3f6f20b0,0x3f79c79d,0x3f764d97,0x3f721352,0x3f6d1c1d,0x3f791298,0x3f75341d,0x3f708066,0x3f6afb8c
.long 0x3f7853f8,0x3f740bdd,0x3f6ed89e,0x3f68bf3c,0x3f778bc5,0x3f72d4eb,0x3f6d1c1d,0x3f666771,0x3f76ba07,0x3f718f57,0x3f6b4b0c,0x3f63f473,0x3f75dec6,0x3f703b37,0x3f696591,0x3f61668a
.long 0x3f74fa0b,0x3f6ed89e,0x3f676bd8,0x3f5ebe05,0x3f740bdd,0x3f6d67a1,0x3f655e0b,0x3f5bfb34,0x3f731447,0x3f6be858,0x3f633c5a,0x3f591e6a,0x3f721352,0x3f6a5ad9,0x3f6106f2,0x3f5627fe
.long 0x3f710908,0x3f68bf3c,0x3f5ebe05,0x3f531849,0x3f6ff573,0x3f671599,0x3f5c61c7,0x3f4fefa8,0x3f6ed89e,0x3f655e0b,0x3f59f26a,0x3f4cae79,0x3f6db293,0x3f6398ac,0x3f577026,0x3f495521
.long 0x3f6c835e,0x3f676bd8,0x3f61c598,0x3f5b941a,0x3f6a09a7,0x3f644fac,0x3f5df6be,0x3f570348,0x3f676bd8,0x3f6106f2,0x3f59f26a,0x3f5233c6,0x3f64aa59,0x3f5d924d,0x3f55b993,0x3f4d26fd
.long 0x3f61c598,0x3f59f26a,0x3f514d3d,0x3f47de65,0x3f5ebe05,0x3f5627fe,0x3f4cae79,0x3f425b89,0x3f5b941a,0x3f5233c6,0x3f47de65,0x3f3ca003,0x3f584853,0x3f4e1689,0x3f42de29,0x3f36ad7f
.long 0x3f54db31,0x3f49d112,0x3f3daef9,0x3f3085bb,0x3f514d3d,0x3f456439,0x3f385216,0x3f2a2a80,0x3f4d9f02,0x3f40d0da,0x3f32c8c9,0x3f239da9,0x3f49d112,0x3f3c17d9,0x3f2d1469,0x3f1ce11f
.long 0x3f45e403,0x3f373a23,0x3f273656,0x3f15f6d9,0x3f41d870,0x3f3238aa,0x3f212ff9,0x3f0ee0db,0x3f3daef9,0x3f2d1469,0x3f1b02c6,0x3f07a136,0x3f396842,0x3f27ce61,0x3f14b039,0x3f003a06
.long 0x3f54db31,0x3f4d9f02,0x3f45e403,0x3f3daef9,0x3f4f7a1f,0x3f476085,0x3f3ebc1b,0x3f3592e7,0x3f49d112,0x3f40d0da,0x3f373a23,0x3f2d1469,0x3f43e200,0x3f39f2ac,0x3f2f61a5,0x3f24381a
.long 0x3f3daef9,0x3f32c8c9,0x3f273656,0x3f1b02c6,0x3f373a23,0x3f2b561b,0x3f1ebc12,0x3f11796b,0x3f3085bb,0x3f239da9,0x3f15f6d9,0x3f07a136,0x3f299415,0x3f1ba299,0x3f0cead0,0x3efafef7
.long 0x3f226799,0x3f13682a,0x3f039c3d,0x3ee63375,0x3f1b02c6,0x3f0af1b7,0x3ef41f07,0x3ed0eb2a,0x3f13682a,0x3f0242b1,0x3ee0924f,0x3ebb31a0,0x3f0b9a6b,0x3ef2bd43,0x3ecc9b8b,0x3ea5129f
.long 0x3f039c3d,0x3ee0924f,0x3eb8442a,0x3e8e9a22,0x3ef6e0cb,0x3ece0bea,0x3ea395c5,0x3e6fa8b2,0x3ee63375,0x3ebb31a0,0x3e8e9a22,0x3e419b37,0x3ed53641,0x3ea80b1f,0x3e72b651,0x3e1324ca
.long 0x0,0x3d48fb30,0x3dc8bd36,0x3e164083,0x0,0x3d55880e,0x3dd53db9,0x3e1f917b,0x0,0x3d621469,0x3de1bc2e,0x3e28defc,0x0,0x3d6ea038,0x3dee3876,0x3e3228d4
.long 0x0,0x3d7b2b74,0x3dfab273,0x3e3b6ecf,0x0,0x3d83db0a,0x3e039502,0x3e44b0b9,0x0,0x3d8a200a,0x3e09cf86,0x3e4dee60,0x0,0x3d9064b4,0x3e1008b7,0x3e57278f
.long 0x0,0x3d96a905,0x3e164083,0x3e605c13,0x0,0x3d9cecf9,0x3e1c76de,0x3e698bba,0x0,0x3da3308c,0x3e22abb6,0x3e72b651,0x0,0x3da973ba,0x3e28defc,0x3e7bdba4
.long 0x0,0x3dafb680,0x3e2f10a2,0x3e827dc0,0x0,0x3db5f8da,0x3e354098,0x3e870ada,0x0,0x3dbc3ac3,0x3e3b6ecf,0x3e8b9507,0x0,0x3dc27c39,0x3e419b37,0x3e901c2c
.long 0x3e47c5c2,0x3e78cfcc,0x3e94a031,0x3eac7cd4,0x3e541501,0x3e840270,0x3e9d9e78,0x3eb6ccc3,0x3e605c13,0x3e8b9507,0x3ea68f12,0x3ec1071e,0x3e6c9a7f,0x3e931f35,0x3eaf713a,0x3ecb2aae
.long 0x3e78cfcc,0x3e9aa086,0x3eb8442a,0x3ed53641,0x3e827dc0,0x3ea21887,0x3ec1071e,0x3edf28a9,0x3e888e93,0x3ea986c4,0x3ec9b953,0x3ee900b7,0x3e8e9a22,0x3eb0eacb,0x3ed25a09,0x3ef2bd43
.long 0x3e94a031,0x3eb8442a,0x3edae880,0x3efc5d27,0x3e9aa086,0x3ebf926f,0x3ee363fa,0x3f02ef9f,0x3ea09ae5,0x3ec6d529,0x3eebcbbb,0x3f07a136,0x3ea68f12,0x3ece0bea,0x3ef41f07,0x3f0c42c9
.long 0x3eac7cd4,0x3ed53641,0x3efc5d27,0x3f10d3cd,0x3eb263ef,0x3edc53c1,0x3f0242b1,0x3f1553b7,0x3eb8442a,0x3ee363fa,0x3f064b82,0x3f19c200,0x3ebe1d4a,0x3eea6681,0x3f0a48ad,0x3f1e1e22
.long 0x3ec3ef15,0x3edae880,0x3ef15aea,0x3f039c3d,0x3ecf7bca,0x3ee79a5d,0x3eff17b2,0x3f0af1b7,0x3edae880,0x3ef41f07,0x3f064b82,0x3f121eb0,0x3ee63375,0x3f003a06,0x3f0cead0,0x3f19210f
.long 0x3ef15aea,0x3f064b82,0x3f13682a,0x3f1ff6cb,0x3efc5d27,0x3f0c42c9,0x3f19c200,0x3f269de3,0x3f039c3d,0x3f121eb0,0x3f1ff6cb,0x3f2d1469,0x3f08f59b,0x3f17de12,0x3f26050a,0x3f33587a
.long 0x3f0e39da,0x3f1d7fd1,0x3f2beb4a,0x3f396842,0x3f13682a,0x3f2302d3,0x3f31a81d,0x3f3f41fc,0x3f187fc0,0x3f286605,0x3f373a23,0x3f44e3f5,0x3f1d7fd1,0x3f2da859,0x3f3ca003,0x3f4a4c87
.long 0x3f226799,0x3f32c8c9,0x3f41d870,0x3f4f7a1f,0x3f273656,0x3f37c655,0x3f46e22a,0x3f546b3b,0x3f2beb4a,0x3f3ca003,0x3f4bbbf8,0x3f591e6a,0x3f3085bb,0x3f4154e1,0x3f5064af,0x3f5d924d
.long 0x3f0e39da,0x3f187fc0,0x3f226799,0x3f2beb4a,0x3f15f6d9,0x3f209393,0x3f2ac082,0x3f34768f,0x3f1d7fd1,0x3f286605,0x3f32c8c9,0x3f3ca003,0x3f24d225,0x3f2ff3e6,0x3f3a7ca4,0x3f446337
.long 0x3f2beb4a,0x3f373a23,0x3f41d870,0x3f4bbbf8,0x3f32c8c9,0x3f3e35c5,0x3f48d8b3,0x3f52a649,0x3f396842,0x3f44e3f5,0x3f4f7a1f,0x3f591e6a,0x3f3fc767,0x3f4b41fa,0x3f55b993,0x3f5f20db
.long 0x3f45e403,0x3f514d3d,0x3f5b941a,0x3f64aa59,0x3f4bbbf8,0x3f570348,0x3f6106f2,0x3f69b7e4,0x3f514d3d,0x3f5c61c7,0x3f660f88,0x3f6e46be,0x3f5695e5,0x3f61668a,0x3f6aab7b,0x3f725470
.long 0x3f5b941a,0x3f660f88,0x3f6ed89e,0x3f75dec6,0x3f604621,0x3f6a5ad9,0x3f7294f8,0x3f78e3d6,0x3f64aa59,0x3f6e46be,0x3f75dec6,0x3f7b61fc,0x3f68bf3c,0x3f71d19f,0x3f78b47b,0x3f7d57de
.long 0x3f800000,0x3f800000,0x3f800000,0x3f800000,0x3f7fb10f,0x3f7fa6e3,0x3f7f9c18,0x3f7f90b1,0x3f7ec46d,0x3f7e9bc9,0x3f7e70b0,0x3f7e4323,0x3f7d3aac,0x3f7cdf6c,0x3f7c7eb0,0x3f7c187a
.long 0x3f7b14be,0x3f7a7302,0x3f79c79d,0x3f791298,0x3f7853f8,0x3f77583a,0x3f764d97,0x3f75341d,0x3f74fa0b,0x3f73913f,0x3f721352,0x3f708066,0x3f710908,0x3f6f20b0,0x3f6d1c1d,0x3f6afb8c
.long 0x3f6c835e,0x3f6a09a7,0x3f676bd8,0x3f64aa59,0x3f676bd8,0x3f644fac,0x3f6106f2,0x3f5d924d,0x3f61c598,0x3f5df6be,0x3f59f26a,0x3f55b993,0x3f5b941a,0x3f570348,0x3f5233c6,0x3f4d26fd
.long 0x3f54db31,0x3f4f7a1f,0x3f49d112,0x3f43e200,0x3f4d9f02,0x3f476085,0x3f40d0da,0x3f39f2ac,0x3f45e403,0x3f3ebc1b,0x3f373a23,0x3f2f61a5,0x3f3daef9,0x3f3592e7,0x3f2d1469,0x3f24381a
.long 0x3f800000,0x3f800000,0x3f800000,0x3f800000,0x3f7f84ab,0x3f7f7808,0x3f7f6ac7,0x3f7f5ce9,0x3f7e1324,0x3f7de0b1,0x3f7dabcc,0x3f7d7474,0x3f7baccd,0x3f7b3bab,0x3f7ac516,0x3f7a4910
.long 0x3f7853f8,0x3f778bc5,0x3f76ba07,0x3f75dec6,0x3f740bdd,0x3f72d4eb,0x3f718f57,0x3f703b37,0x3f6ed89e,0x3f6d1c1d,0x3f6b4b0c,0x3f696591,0x3f68bf3c,0x3f666771,0x3f63f473,0x3f61668a
.long 0x3f61c598,0x3f5ebe05,0x3f5b941a,0x3f584853,0x3f59f26a,0x3f5627fe,0x3f5233c6,0x3f4e1689,0x3f514d3d,0x3f4cae79,0x3f47de65,0x3f42de29,0x3f47de65,0x3f425b89,0x3f3ca003,0x3f36ad7f
.long 0x3f3daef9,0x3f373a23,0x3f3085bb,0x3f299415,0x3f32c8c9,0x3f2b561b,0x3f239da9,0x3f1ba299,0x3f273656,0x3f1ebc12,0x3f15f6d9,0x3f0cead0,0x3f1b02c6,0x3f11796b,0x3f07a136,0x3efafef7
.long 0x3f800000,0x3f800000,0x3f800000,0x3f800000,0x3f7f4e6d,0x3f7f3f54,0x3f7f2f9d,0x3f7f1f49,0x3f7d3aac,0x3f7cfe73,0x3f7cbfc9,0x3f7c7eb0,0x3f79c79d,0x3f7940c0,0x3f78b47b,0x3f7822d1
.long 0x3f74fa0b,0x3f740bdd,0x3f731447,0x3f721352,0x3f6ed89e,0x3f6d67a1,0x3f6be858,0x3f6a5ad9,0x3f676bd8,0x3f655e0b,0x3f633c5a,0x3f6106f2,0x3f5ebe05,0x3f5bfb34,0x3f591e6a,0x3f5627fe
.long 0x3f54db31,0x3f514d3d,0x3f4d9f02,0x3f49d112,0x3f49d112,0x3f456439,0x3f40d0da,0x3f3c17d9,0x3f3daef9,0x3f385216,0x3f32c8c9,0x3f2d1469,0x3f3085bb,0x3f2a2a80,0x3f239da9,0x3f1ce11f
.long 0x3f226799,0x3f1b02c6,0x3f13682a,0x3f0b9a6b,0x3f13682a,0x3f0af1b7,0x3f0242b1,0x3ef2bd43,0x3f039c3d,0x3ef41f07,0x3ee0924f,0x3ecc9b8b,0x3ee63375,0x3ed0eb2a,0x3ebb31a0,0x3ea5129f
.long 0x3f800000,0x3f800000,0x3f800000,0x3f800000,0x3f7f0e58,0x3f7efcc9,0x3f7eea9d,0x3f7ed7d4,0x3f7c3b28,0x3f7bf531,0x3f7baccd,0x3f7b61fc,0x3f778bc5,0x3f76ef5b,0x3f764d97,0x3f75a67b
.long 0x3f710908,0x3f6ff573,0x3f6ed89e,0x3f6db293,0x3f68bf3c,0x3f671599,0x3f655e0b,0x3f6398ac,0x3f5ebe05,0x3f5c61c7,0x3f59f26a,0x3f577026,0x3f531849,0x3f4fefa8,0x3f4cae79,0x3f495521
.long 0x3f45e403,0x3f41d870,0x3f3daef9,0x3f396842,0x3f373a23,0x3f3238aa,0x3f2d1469,0x3f27ce61,0x3f273656,0x3f212ff9,0x3f1b02c6,0x3f14b039,0x3f15f6d9,0x3f0ee0db,0x3f07a136,0x3f003a06
.long 0x3f039c3d,0x3ef6e0cb,0x3ee63375,0x3ed53641,0x3ee0924f,0x3ece0bea,0x3ebb31a0,0x3ea80b1f,0x3eb8442a,0x3ea395c5,0x3e8e9a22,0x3e72b651,0x3e8e9a22,0x3e6fa8b2,0x3e419b37,0x3e1324ca
.long 0x0,0x0,0x0,0x0,0x3d48fb30,0x3d55880e,0x3d621469,0x3d6ea038,0x3dc8bd36,0x3dd53db9,0x3de1bc2e,0x3dee3876,0x3e164083,0x3e1f917b,0x3e28defc,0x3e3228d4
.long 0x3e47c5c2,0x3e541501,0x3e605c13,0x3e6c9a7f,0x3e78cfcc,0x3e840270,0x3e8b9507,0x3e931f35,0x3e94a031,0x3e9d9e78,0x3ea68f12,0x3eaf713a,0x3eac7cd4,0x3eb6ccc3,0x3ec1071e,0x3ecb2aae
.long 0x3ec3ef15,0x3ecf7bca,0x3edae880,0x3ee63375,0x3edae880,0x3ee79a5d,0x3ef41f07,0x3f003a06,0x3ef15aea,0x3eff17b2,0x3f064b82,0x3f0cead0,0x3f039c3d,0x3f0af1b7,0x3f121eb0,0x3f19210f
.long 0x3f0e39da,0x3f15f6d9,0x3f1d7fd1,0x3f24d225,0x3f187fc0,0x3f209393,0x3f286605,0x3f2ff3e6,0x3f226799,0x3f2ac082,0x3f32c8c9,0x3f3a7ca4,0x3f2beb4a,0x3f34768f,0x3f3ca003,0x3f446337
.long 0x0,0x0,0x0,0x0,0x3d7b2b74,0x3d83db0a,0x3d8a200a,0x3d9064b4,0x3dfab273,0x3e039502,0x3e09cf86,0x3e1008b7,0x3e3b6ecf,0x3e44b0b9,0x3e4dee60,0x3e57278f
.long 0x3e78cfcc,0x3e827dc0,0x3e888e93,0x3e8e9a22,0x3e9aa086,0x3ea21887,0x3ea986c4,0x3eb0eacb,0x3eb8442a,0x3ec1071e,0x3ec9b953,0x3ed25a09,0x3ed53641,0x3edf28a9,0x3ee900b7,0x3ef2bd43
.long 0x3ef15aea,0x3efc5d27,0x3f039c3d,0x3f08f59b,0x3f064b82,0x3f0c42c9,0x3f121eb0,0x3f17de12,0x3f13682a,0x3f19c200,0x3f1ff6cb,0x3f26050a,0x3f1ff6cb,0x3f269de3,0x3f2d1469,0x3f33587a
.long 0x3f2beb4a,0x3f32c8c9,0x3f396842,0x3f3fc767,0x3f373a23,0x3f3e35c5,0x3f44e3f5,0x3f4b41fa,0x3f41d870,0x3f48d8b3,0x3f4f7a1f,0x3f55b993,0x3f4bbbf8,0x3f52a649,0x3f591e6a,0x3f5f20db
.long 0x0,0x0,0x0,0x0,0x3d96a905,0x3d9cecf9,0x3da3308c,0x3da973ba,0x3e164083,0x3e1c76de,0x3e22abb6,0x3e28defc,0x3e605c13,0x3e698bba,0x3e72b651,0x3e7bdba4
.long 0x3e94a031,0x3e9aa086,0x3ea09ae5,0x3ea68f12,0x3eb8442a,0x3ebf926f,0x3ec6d529,0x3ece0bea,0x3edae880,0x3ee363fa,0x3eebcbbb,0x3ef41f07,0x3efc5d27,0x3f02ef9f,0x3f07a136,0x3f0c42c9
.long 0x3f0e39da,0x3f13682a,0x3f187fc0,0x3f1d7fd1,0x3f1d7fd1,0x3f2302d3,0x3f286605,0x3f2da859,0x3f2beb4a,0x3f31a81d,0x3f373a23,0x3f3ca003,0x3f396842,0x3f3f41fc,0x3f44e3f5,0x3f4a4c87
.long 0x3f45e403,0x3f4bbbf8,0x3f514d3d,0x3f5695e5,0x3f514d3d,0x3f570348,0x3f5c61c7,0x3f61668a,0x3f5b941a,0x3f6106f2,0x3f660f88,0x3f6aab7b,0x3f64aa59,0x3f69b7e4,0x3f6e46be,0x3f725470
.long 0x0,0x0,0x0,0x0,0x3dafb680,0x3db5f8da,0x3dbc3ac3,0x3dc27c39,0x3e2f10a2,0x3e354098,0x3e3b6ecf,0x3e419b37,0x3e827dc0,0x3e870ada,0x3e8b9507,0x3e901c2c
.long 0x3eac7cd4,0x3eb263ef,0x3eb8442a,0x3ebe1d4a,0x3ed53641,0x3edc53c1,0x3ee363fa,0x3eea6681,0x3efc5d27,0x3f0242b1,0x3f064b82,0x3f0a48ad,0x3f10d3cd,0x3f1553b7,0x3f19c200,0x3f1e1e22
.long 0x3f226799,0x3f273656,0x3f2beb4a,0x3f3085bb,0x3f32c8c9,0x3f37c655,0x3f3ca003,0x3f4154e1,0x3f41d870,0x3f46e22a,0x3f4bbbf8,0x3f5064af,0x3f4f7a1f,0x3f546b3b,0x3f591e6a,0x3f5d924d
.long 0x3f5b941a,0x3f604621,0x3f64aa59,0x3f68bf3c,0x3f660f88,0x3f6a5ad9,0x3f6e46be,0x3f71d19f,0x3f6ed89e,0x3f7294f8,0x3f75dec6,0x3f78b47b,0x3f75dec6,0x3f78e3d6,0x3f7b61fc,0x3f7d57de
.long 0x3f3504f3,0x3f2beb4a,0x3f226799,0x3f187fc0,0x3f2beb4a,0x3f21cbfb,0x3f173c07,0x3f0c42c9,0x3f226799,0x3f173c07,0x3f0b9a6b,0x3eff17b2,0x3f187fc0,0x3f0c42c9,0x3eff17b2,0x3ee4cbfe
.long 0x3f0e39da,0x3f00e7e4,0x3ee63375,0x3ec9b953,0x3f039c3d,0x3eea6681,0x3ecc9b8b,0x3eadf73c,0x3ef15aea,0x3ed25a09,0x3eb263ef,0x3e919ddd,0x3edae880,0x3eb9bb1e,0x3e97a117,0x3e698bba
.long 0x3ec3ef15,0x3ea09ae5,0x3e78cfcc,0x3e2f10a2,0x3eac7cd4,0x3e870ada,0x3e419b37,0x3de7fa9a,0x3e94a031,0x3e5a3997,0x3e09cf86,0x3d621469,0x3e78cfcc,0x3e25c58c,0x3da3308c,0xbb490fc6
.long 0x3e47c5c2,0x3de1bc2e,0x3cc90ab0,0xbd7b2b74,0x3e164083,0x3d6ea038,0xbcfb49ba,0xbdf475c0,0x3dc8bd36,0x3bc90f88,0xbdafb680,0xbe354098,0x3d48fb30,0xbd3c6dd5,0xbe1008b7,0xbe6fa8b2
.long 0x3f0e39da,0x3f039c3d,0x3ef15aea,0x3edae880,0x3f00e7e4,0x3eea6681,0x3ed25a09,0x3eb9bb1e,0x3ee63375,0x3ecc9b8b,0x3eb263ef,0x3e97a117,0x3ec9b953,0x3eadf73c,0x3e919ddd,0x3e698bba
.long 0x3eac7cd4,0x3e8e9a22,0x3e605c13,0x3e22abb6,0x3e8e9a22,0x3e5d4b1a,0x3e1c76de,0x3db5f8da,0x3e605c13,0x3e1c76de,0x3dafb680,0x3c96c9b6,0x3e22abb6,0x3db5f8da,0x3c96c9b6,0xbd55880e
.long 0x3dc8bd36,0x3cc90ab0,0xbd48fb30,0xbdfab273,0x3d16c32c,0xbd2351cb,0xbdee3876,0xbe44b0b9,0xbcc90ab0,0xbdd53db9,0xbe3b6ecf,0xbe8586ce,0xbdafb680,0xbe2bf804,0xbe7ee6e1,0xbea80b1f
.long 0xbe164083,0xbe6c9a7f,0xbea09ae5,0xbec9b953,0xbe541501,0xbe9620d2,0xbec1071e,0xbeea6681,0xbe888e93,0xbeb554ec,0xbee0924f,0xbf04f484,0xbea68f12,0xbed3c867,0xbeff17b2,0xbf140c5f
.long 0x3ec3ef15,0x3eac7cd4,0x3e94a031,0x3e78cfcc,0x3ea09ae5,0x3e870ada,0x3e5a3997,0x3e25c58c,0x3e78cfcc,0x3e419b37,0x3e09cf86,0x3da3308c,0x3e2f10a2,0x3de7fa9a,0x3d621469,0xbb490fc6
.long 0x3dc8bd36,0x3d16c32c,0xbcc90ab0,0xbdafb680,0x3cc90ab0,0xbd2351cb,0xbdd53db9,0xbe2bf804,0xbd48fb30,0xbdee3876,0xbe3b6ecf,0xbe7ee6e1,0xbdfab273,0xbe44b0b9,0xbe8586ce,0xbea80b1f
.long 0xbe47c5c2,0xbe888e93,0xbeac7cd4,0xbecf7bca,0xbe888e93,0xbeadf73c,0xbed25a09,0xbef58035,0xbeac7cd4,0xbed25a09,0xbef6e0cb,0xbf0cead0,0xbecf7bca,0xbef58035,0xbf0cead0,0xbf1e1e22
.long 0xbef15aea,0xbf0b9a6b,0xbf1d7fd1,0xbf2e3bde,0xbf08f59b,0xbf1ba299,0xbf2d1469,0xbf3d27b8,0xbf187fc0,0xbf2ac082,0xbf3b8f3b,0xbf4ac77f,0xbf273656,0xbf38dd65,0xbf48d8b3,0xbf570348
.long 0x3e47c5c2,0x3e164083,0x3dc8bd36,0x3d48fb30,0x3de1bc2e,0x3d6ea038,0x3bc90f88,0xbd3c6dd5,0x3cc90ab0,0xbcfb49ba,0xbdafb680,0xbe1008b7,0xbd7b2b74,0xbdf475c0,0xbe354098,0xbe6fa8b2
.long 0xbe164083,0xbe541501,0xbe888e93,0xbea68f12,0xbe6c9a7f,0xbe9620d2,0xbeb554ec,0xbed3c867,0xbea09ae5,0xbec1071e,0xbee0924f,0xbeff17b2,0xbec9b953,0xbeea6681,0xbf04f484,0xbf140c5f
.long 0xbef15aea,0xbf08f59b,0xbf187fc0,0xbf273656,0xbf0b9a6b,0xbf1ba299,0xbf2ac082,0xbf38dd65,0xbf1d7fd1,0xbf2d1469,0xbf3b8f3b,0xbf48d8b3,0xbf2e3bde,0xbf3d27b8,0xbf4ac77f,0xbf570348
.long 0xbf3daef9,0xbf4bbbf8,0xbf584853,0xbf633c5a,0xbf4bbbf8,0xbf58b3a1,0xbf63f473,0xbf6d67a1,0xbf584853,0xbf63f473,0xbf6db293,0xbf756d97,0xbf633c5a,0xbf6d67a1,0xbf756d97,0xbf7b3bab
.long 0x3f3504f3,0x3f3daef9,0x3f45e403,0x3f4d9f02,0x3f3daef9,0x3f466354,0x3f4e8d90,0x3f5627fe,0x3f45e403,0x3f4e8d90,0x3f5695e5,0x3f5df6be,0x3f4d9f02,0x3f5627fe,0x3f5df6be,0x3f650479
.long 0x3f54db31,0x3f5d2d53,0x3f64aa59,0x3f6b4b0c,0x3f5b941a,0x3f6398ac,0x3f6aab7b,0x3f70c501,0x3f61c598,0x3f696591,0x3f6ff573,0x3f756d97,0x3f676bd8,0x3f6e8ff8,0x3f748422,0x3f7940c0
.long 0x3f6c835e,0x3f731447,0x3f7853f8,0x3f7c3b28,0x3f710908,0x3f76ef5b,0x3f7b61fc,0x3f7e5a38,0x3f74fa0b,0x3f7a1e84,0x3f7dabcc,0x3f7f9c18,0x3f7853f8,0x3f7c9f8a,0x3f7f2f9d,0x3f7fffb1
.long 0x3f7b14be,0x3f7e70b0,0x3f7fec43,0x3f7f84ab,0x3f7d3aac,0x3f7f90b1,0x3f7fe129,0x3f7e2b72,0x3f7ec46d,0x3f7ffec4,0x3f7f0e58,0x3f7bf531,0x3f7fb10f,0x3f7fba9e,0x3f7d7474,0x3f78e3d6
.long 0x3f54db31,0x3f5b941a,0x3f61c598,0x3f676bd8,0x3f5d2d53,0x3f6398ac,0x3f696591,0x3f6e8ff8,0x3f64aa59,0x3f6aab7b,0x3f6ff573,0x3f748422,0x3f6b4b0c,0x3f70c501,0x3f756d97,0x3f7940c0
.long 0x3f710908,0x3f75dec6,0x3f79c79d,0x3f7cbfc9,0x3f75dec6,0x3f79f35e,0x3f7cfe73,0x3f7efcc9,0x3f79c79d,0x3f7cfe73,0x3f7f0e58,0x3f7ff4e6,0x3f7cbfc9,0x3f7efcc9,0x3f7ff4e6,0x3f7fa6e3
.long 0x3f7ec46d,0x3f7fec43,0x3f7fb10f,0x3f7e1324,0x3f7fd397,0x3f7fcbe2,0x3f7e4323,0x3f7b3bab,0x3f7fec43,0x3f7e9bc9,0x3f7baccd,0x3f772417,0x3f7f0e58,0x3f7c5d3a,0x3f77f110,0x3f71d19f
.long 0x3f7d3aac,0x3f791298,0x3f731447,0x3f6b4b0c,0x3f7a7302,0x3f74bf62,0x3f6d1c1d,0x3f6398ac,0x3f76ba07,0x3f6f6830,0x3f660f88,0x3f5ac450,0x3f721352,0x3f6912ae,0x3f5df6be,0x3f50d937
.long 0x3f6c835e,0x3f710908,0x3f74fa0b,0x3f7853f8,0x3f731447,0x3f76ef5b,0x3f7a1e84,0x3f7c9f8a,0x3f7853f8,0x3f7b61fc,0x3f7dabcc,0x3f7f2f9d,0x3f7c3b28,0x3f7e5a38,0x3f7f9c18,0x3f7fffb1
.long 0x3f7ec46d,0x3f7fd397,0x3f7fec43,0x3f7f0e58,0x3f7fec43,0x3f7fcbe2,0x3f7e9bc9,0x3f7c5d3a,0x3f7fb10f,0x3f7e4323,0x3f7baccd,0x3f77f110,0x3f7e1324,0x3f7b3bab,0x3f772417,0x3f71d19f
.long 0x3f7b14be,0x3f76ba07,0x3f710908,0x3f6a09a7,0x3f76ba07,0x3f70c501,0x3f696591,0x3f60a6cf,0x3f710908,0x3f696591,0x3f604621,0x3f55b993,0x3f6a09a7,0x3f60a6cf,0x3f55b993,0x3f495521
.long 0x3f61c598,0x3f5695e5,0x3f49d112,0x3f3b8f3b,0x3f584853,0x3f4b41fa,0x3f3ca003,0x3f2c800f,0x3f4d9f02,0x3f3ebc1b,0x3f2e3bde,0x3f1c420c,0x3f41d870,0x3f311722,0x3f1ebc12,0x3f0af1b7
.long 0x3f7b14be,0x3f7d3aac,0x3f7ec46d,0x3f7fb10f,0x3f7e70b0,0x3f7f90b1,0x3f7ffec4,0x3f7fba9e,0x3f7fec43,0x3f7fe129,0x3f7f0e58,0x3f7d7474,0x3f7f84ab,0x3f7e2b72,0x3f7bf531,0x3f78e3d6
.long 0x3f7d3aac,0x3f7a7302,0x3f76ba07,0x3f721352,0x3f791298,0x3f74bf62,0x3f6f6830,0x3f6912ae,0x3f731447,0x3f6d1c1d,0x3f660f88,0x3f5df6be,0x3f6b4b0c,0x3f6398ac,0x3f5ac450,0x3f50d937
.long 0x3f61c598,0x3f584853,0x3f4d9f02,0x3f41d870,0x3f5695e5,0x3f4b41fa,0x3f3ebc1b,0x3f311722,0x3f49d112,0x3f3ca003,0x3f2e3bde,0x3f1ebc12,0x3f3b8f3b,0x3f2c800f,0x3f1c420c,0x3f0af1b7
.long 0x3f2beb4a,0x3f1b02c6,0x3f08f59b,0x3eebcbbb,0x3f1b02c6,0x3f084b92,0x3ee900b7,0x3ebf926f,0x3f08f59b,0x3ee900b7,0x3ebe1d4a,0x3e919ddd,0x3eebcbbb,0x3ebf926f,0x3e919ddd,0x3e44b0b9
.long 0x3f800000,0x3f800000,0x3f800000,0x3f800000,0x3f7ec46d,0x3f7eb069,0x3f7e9bc9,0x3f7e868b,0x3f7b14be,0x3f7ac516,0x3f7a7302,0x3f7a1e84,0x3f74fa0b,0x3f74484b,0x3f73913f,0x3f72d4eb
.long 0x3f6c835e,0x3f6b4b0c,0x3f6a09a7,0x3f68bf3c,0x3f61c598,0x3f5fe4e9,0x3f5df6be,0x3f5bfb34,0x3f54db31,0x3f5233c6,0x3f4f7a1f,0x3f4cae79,0x3f45e403,0x3f425b89,0x3f3ebc1b,0x3f3b0629
.long 0x3f3504f3,0x3f3085bb,0x3f2beb4a,0x3f273656,0x3f226799,0x3f1ce11f,0x3f173c07,0x3f11796b,0x3f0e39da,0x3f07a136,0x3f00e7e4,0x3ef41f07,0x3ef15aea,0x3ee1fb6a,0x3ed25a09,0x3ec27b55
.long 0x3ec3ef15,0x3eb263ef,0x3ea09ae5,0x3e8e9a22,0x3e94a031,0x3e80f8c0,0x3e5a3997,0x3e3228d4,0x3e47c5c2,0x3e1c76de,0x3de1bc2e,0x3d8a200a,0x3dc8bd36,0x3d55880e,0x3bc90f88,0xbd2351cb
.long 0x3f800000,0x3f800000,0x3f800000,0x3f800000,0x3f7e70b0,0x3f7e5a38,0x3f7e4323,0x3f7e2b72,0x3f79c79d,0x3f796e4e,0x3f791298,0x3f78b47b,0x3f721352,0x3f714c7a,0x3f708066,0x3f6faf1b
.long 0x3f676bd8,0x3f660f88,0x3f64aa59,0x3f633c5a,0x3f59f26a,0x3f57dc7f,0x3f55b993,0x3f5389c7,0x3f49d112,0x3f46e22a,0x3f43e200,0x3f40d0da,0x3f373a23,0x3f33587a,0x3f2f61a5,0x3f2b561b
.long 0x3f226799,0x3f1d7fd1,0x3f187fc0,0x3f13682a,0x3f0b9a6b,0x3f05a02c,0x3eff17b2,0x3ef2bd43,0x3ee63375,0x3ed8106b,0x3ec9b953,0x3ebb31a0,0x3eb263ef,0x3ea21887,0x3e919ddd,0x3e80f8c0
.long 0x3e78cfcc,0x3e541501,0x3e2f10a2,0x3e09cf86,0x3e09cf86,0x3dc27c39,0x3d621469,0x3c7b514b,0x3cc90ab0,0xbc96c9b6,0xbd7b2b74,0xbdd53db9,0xbdafb680,0xbe06b26e,0xbe354098,0xbe636c83
.long 0x3f800000,0x3f800000,0x3f800000,0x3f800000,0x3f7e1324,0x3f7dfa38,0x3f7de0b1,0x3f7dc68c,0x3f7853f8,0x3f77f110,0x3f778bc5,0x3f772417,0x3f6ed89e,0x3f6dfcf2,0x3f6d1c1d,0x3f6c3624
.long 0x3f61c598,0x3f604621,0x3f5ebe05,0x3f5d2d53,0x3f514d3d,0x3f4f0417,0x3f4cae79,0x3f4a4c87,0x3f3daef9,0x3f3a7ca4,0x3f373a23,0x3f33e7bc,0x3f273656,0x3f2302d3,0x3f1ebc12,0x3f1a6293
.long 0x3f0e39da,0x3f08f59b,0x3f039c3d,0x3efc5d27,0x3ee63375,0x3ed97cb9,0x3ecc9b8b,0x3ebf926f,0x3eac7cd4,0x3e9d9e78,0x3e8e9a22,0x3e7ee6e1,0x3e605c13,0x3e3e853e,0x3e1c76de,0x3df475c0
.long 0x3dc8bd36,0x3d7b2b74,0x3cc90ab0,0xbc490e90,0xbcc90ab0,0xbd83db0a,0xbdd53db9,0xbe1324ca,0xbe164083,0xbe419b37,0xbe6c9a7f,0xbe8b9507,0xbe888e93,0xbe9f1cdf,0xbeb554ec,0xbecb2aae
.long 0x3f800000,0x3f800000,0x3f800000,0x3f800000,0x3f7dabcc,0x3f7d906e,0x3f7d7474,0x3f7d57de,0x3f76ba07,0x3f764d97,0x3f75dec6,0x3f756d97,0x3f6b4b0c,0x3f6a5ad9,0x3f696591,0x3f686b39
.long 0x3f5b941a,0x3f59f26a,0x3f584853,0x3f5695e5,0x3f47de65,0x3f456439,0x3f42de29,0x3f404c5c,0x3f3085bb,0x3f2d1469,0x3f299415,0x3f26050a,0x3f15f6d9,0x3f11796b,0x3f0cead0,0x3f084b92
.long 0x3ef15aea,0x3ee63375,0x3edae880,0x3ecf7bca,0x3eb263ef,0x3ea5129f,0x3e97a117,0x3e8a11f7,0x3e605c13,0x3e419b37,0x3e22abb6,0x3e039502,0x3dafb680,0x3d55880e,0x3c96c9b6,0xbc7b514b
.long 0xbd48fb30,0xbdafb680,0xbdfab273,0xbe22abb6,0xbe3b6ecf,0xbe636c83,0xbe8586ce,0xbe9920fe,0xbea09ae5,0xbeb554ec,0xbec9b953,0xbeddbe79,0xbee0924f,0xbef58035,0xbf04f484,0xbf0ee0db
.long 0x0,0x0,0x0,0x0,0x3dc8bd36,0x3dcefdb7,0x3dd53db9,0x3ddb7d37,0x3e47c5c2,0x3e4dee60,0x3e541501,0x3e5a3997,0x3e94a031,0x3e9920fe,0x3e9d9e78,0x3ea21887
.long 0x3ec3ef15,0x3ec9b953,0x3ecf7bca,0x3ed53641,0x3ef15aea,0x3ef840c8,0x3eff17b2,0x3f02ef9f,0x3f0e39da,0x3f121eb0,0x3f15f6d9,0x3f19c200,0x3f226799,0x3f269de3,0x3f2ac082,0x3f2ecef7
.long 0x3f3504f3,0x3f396842,0x3f3daef9,0x3f41d870,0x3f45e403,0x3f4a4c87,0x3f4e8d90,0x3f52a649,0x3f54db31,0x3f591e6a,0x3f5d2d53,0x3f6106f2,0x3f61c598,0x3f65b710,0x3f696591,0x3f6cd007
.long 0x3f6c835e,0x3f6ff573,0x3f731447,0x3f75dec6,0x3f74fa0b,0x3f77beb7,0x3f7a1e84,0x3f7c187a,0x3f7b14be,0x3f7cfe73,0x3f7e70b0,0x3f7f6ac7,0x3f7ec46d,0x3f7fa6e3,0x3f7ffec4,0x3f7fcbe2
.long 0x0,0x0,0x0,0x0,0x3de1bc2e,0x3de7fa9a,0x3dee3876,0x3df475c0,0x3e605c13,0x3e667c66,0x3e6c9a7f,0x3e72b651,0x3ea68f12,0x3eab0201,0x3eaf713a,0x3eb3dca5
.long 0x3edae880,0x3ee0924f,0x3ee63375,0x3eebcbbb,0x3f064b82,0x3f099f4e,0x3f0cead0,0x3f102dd5,0x3f1d7fd1,0x3f212ff9,0x3f24d225,0x3f286605,0x3f32c8c9,0x3f36ad7f,0x3f3a7ca4,0x3f3e35c5
.long 0x3f45e403,0x3f49d112,0x3f4d9f02,0x3f514d3d,0x3f5695e5,0x3f5a5ba0,0x3f5df6be,0x3f61668a,0x3f64aa59,0x3f6816a8,0x3f6b4b0c,0x3f6e46be,0x3f6ff573,0x3f72d4eb,0x3f756d97,0x3f77beb7
.long 0x3f7853f8,0x3f7a7302,0x3f7c3b28,0x3f7dabcc,0x3f7dabcc,0x3f7ed7d4,0x3f7f9c18,0x3f7ff84a,0x3f7fec43,0x3f7ff4e6,0x3f7f84ab,0x3f7e9bc9,0x3f7f0e58,0x3f7dc68c,0x3f7bf531,0x3f799b43
.long 0x0,0x0,0x0,0x0,0x3dfab273,0x3e007745,0x3e039502,0x3e06b26e,0x3e78cfcc,0x3e7ee6e1,0x3e827dc0,0x3e8586ce,0x3eb8442a,0x3ebca7af,0x3ec1071e,0x3ec5625c
.long 0x3ef15aea,0x3ef6e0cb,0x3efc5d27,0x3f00e7e4,0x3f13682a,0x3f16999f,0x3f19c200,0x3f1ce11f,0x3f2beb4a,0x3f2f61a5,0x3f32c8c9,0x3f36206c,0x3f41d870,0x3f456439,0x3f48d8b3,0x3f4c3578
.long 0x3f54db31,0x3f584853,0x3f5b941a,0x3f5ebe05,0x3f64aa59,0x3f67c187,0x3f6aab7b,0x3f6d67a1,0x3f710908,0x3f73913f,0x3f75dec6,0x3f77f110,0x3f79c79d,0x3f7b87b2,0x3f7cfe73,0x3f7e2b72
.long 0x3f7ec46d,0x3f7f84ab,0x3f7fec43,0x3f7ffb11,0x3f7fec43,0x3f7f7808,0x3f7e9bc9,0x3f7d57de,0x3f7d3aac,0x3f7b61fc,0x3f791298,0x3f764d97,0x3f76ba07,0x3f73530e,0x3f6f6830,0x3f6afb8c
.long 0x0,0x0,0x0,0x0,0x3e09cf86,0x3e0cec4a,0x3e1008b7,0x3e1324ca,0x3e888e93,0x3e8b9507,0x3e8e9a22,0x3e919ddd,0x3ec9b953,0x3ece0bea,0x3ed25a09,0x3ed6a399
.long 0x3f039c3d,0x3f064b82,0x3f08f59b,0x3f0b9a6b,0x3f1ff6cb,0x3f2302d3,0x3f26050a,0x3f28fd41,0x3f396842,0x3f3ca003,0x3f3fc767,0x3f42de29,0x3f4f7a1f,0x3f52a649,0x3f55b993,0x3f58b3a1
.long 0x3f61c598,0x3f64aa59,0x3f676bd8,0x3f6a09a7,0x3f6ff573,0x3f725470,0x3f748422,0x3f76841b,0x3f79c79d,0x3f7b61fc,0x3f7cbfc9,0x3f7de0b1,0x3f7f0e58,0x3f7fa6e3,0x3f7ff4e6,0x3f7ff84a
.long 0x3f7fb10f,0x3f7f0e58,0x3f7e1324,0x3f7cbfc9,0x3f7baccd,0x3f799b43,0x3f772417,0x3f74484b,0x3f731447,0x3f6f6830,0x3f6b4b0c,0x3f66becc,0x3f660f88,0x3f60a6cf,0x3f5ac450,0x3f546b3b
.long 0x0,0xbd48fb30,0xbdc8bd36,0xbe164083,0xbdc8bd36,0xbe195be0,0xbe4dee60,0xbe80f8c0,0xbe47c5c2,0xbe7ee6e1,0xbe9aa086,0xbeb554ec,0xbe94a031,0xbeb0eacb,0xbecc9b8b,0xbee79a5d
.long 0xbec3ef15,0xbee0924f,0xbefc5d27,0xbf0b9a6b,0xbef15aea,0xbf06f686,0xbf14b039,0xbf21cbfb,0xbf0e39da,0xbf1c420c,0xbf299415,0xbf36206c,0xbf226799,0xbf2ff3e6,0xbf3ca003,0xbf485bca
.long 0xbf3504f3,0xbf41d870,0xbf4d9f02,0xbf584853,0xbf45e403,0xbf51c0c2,0xbf5c61c7,0xbf65b710,0xbf54db31,0xbf5f8327,0xbf68bf3c,0xbf708066,0xbf61c598,0xbf6afb8c,0xbf7294f8,0xbf788486
.long 0xbf6c835e,0xbf740bdd,0xbf79c79d,0xbf7dabcc,0xbf74fa0b,0xbf7a9c59,0xbf7e4323,0xbf7fe705,0xbf7b14be,0xbf7e9bc9,0xbf7ffb11,0xbf7f2f9d,0xbf7ec46d,0xbf7fffb1,0xbf7eea9d,0xbf7b87b2
.long 0xbe47c5c2,0xbe78cfcc,0xbe94a031,0xbeac7cd4,0xbe9aa086,0xbeb3dca5,0xbecc9b8b,0xbee4cbfe,0xbecf7bca,0xbee900b7,0xbf00e7e4,0xbf0cead0,0xbf00e7e4,0xbf0d9281,0xbf19c200,0xbf256bcb
.long 0xbf187fc0,0xbf24d225,0xbf3085bb,0xbf3b8f3b,0xbf2e3bde,0xbf39f2ac,0xbf44e3f5,0xbf4f0417,0xbf41d870,0xbf4cae79,0xbf5695e5,0xbf5f8327,0xbf531849,0xbf5cc7d1,0xbf655e0b,0xbf6cd007
.long 0xbf61c598,0xbf6a09a7,0xbf710908,0xbf76ba07,0xbf6db293,0xbf74484b,0xbf796e4e,0xbf7d1cdd,0xbf76ba07,0xbf7b61fc,0xbf7e70b0,0xbf7fe129,0xbf7cbfc9,0xbf7f3f54,0xbf7ffec4,0xbf7efcc9
.long 0xbf7fb10f,0xbf7fd397,0xbf7e1324,0xbf7a7302,0xbf7f84ab,0xbf7d1cdd,0xbf78b47b,0xbf725470,0xbf7c3b28,0xbf772417,0xbf6ff573,0xbf66becc,0xbf75dec6,0xbf6dfcf2,0xbf63f473,0xbf57dc7f
.long 0xbec3ef15,0xbedae880,0xbef15aea,0xbf039c3d,0xbefc5d27,0xbf099f4e,0xbf14b039,0xbf1f599f,0xbf187fc0,0xbf239da9,0xbf2e3bde,0xbf385216,0xbf3085bb,0xbf3b0629,0xbf44e3f5,0xbf4e1689
.long 0xbf45e403,0xbf4f7a1f,0xbf584853,0xbf604621,0xbf584853,0xbf60a6cf,0xbf6816a8,0xbf6e8ff8,0xbf676bd8,0xbf6e46be,0xbf740bdd,0xbf78b47b,0xbf731447,0xbf7822d1,0xbf7bf531,0xbf7e868b
.long 0xbf7b14be,0xbf7e1324,0xbf7fb10f,0xbf7fec43,0xbf7f4e6d,0xbf7fffb1,0xbf7f2f9d,0xbf7cdf6c,0xbf7fb10f,0xbf7de0b1,0xbf7a7302,0xbf756d97,0xbf7c3b28,0xbf77beb7,0xbf718f57,0xbf69b7e4
.long 0xbf74fa0b,0xbf6db293,0xbf64aa59,0xbf59f26a,0xbf6a09a7,0xbf5fe4e9,0xbf53fac3,0xbf466354,0xbf5b941a,0xbf4e8d90,0xbf3fc767,0xbf2f61a5,0xbf49d112,0xbf39f2ac,0xbf286605,0xbf1553b7
.long 0xbf0e39da,0xbf187fc0,0xbf226799,0xbf2beb4a,0xbf299415,0xbf33587a,0xbf3ca003,0xbf456439,0xbf41d870,0xbf4ac77f,0xbf531849,0xbf5ac450,0xbf5695e5,0xbf5e5aa6,0xbf655e0b,0xbf6b99fb
.long 0xbf676bd8,0xbf6db293,0xbf731447,0xbf778bc5,0xbf740bdd,0xbf788486,0xbf7bf531,0xbf7e5a38,0xbf7c3b28,0xbf7e9bc9,0xbf7fd397,0xbf7fe129,0xbf7fd397,0xbf7fdaaf,0xbf7e9bc9,0xbf7c187a
.long 0xbf7ec46d,0xbf7c3b28,0xbf7853f8,0xbf731447,0xbf791298,0xbf73ced9,0xbf6d1c1d,0xbf650479,0xbf6ed89e,0xbf66becc,0xbf5d2d53,0xbf5233c6,0xbf604621,0xbf554aa4,0xbf48d8b3,0xbf3b0629
.long 0xbf4d9f02,0xbf3fc767,0xbf3085bb,0xbf1ff6cb,0xbf373a23,0xbf269de3,0xbf14b039,0xbf019573,0xbf1d7fd1,0xbf0a48ad,0xbeebcbbb,0xbec1071e,0xbf00e7e4,0xbed6a399,0xbea986c4,0xbe75c35a
.long 0x3f800000,0x3f7fb10f,0x3f7ec46d,0x3f7d3aac,0x3f7ec46d,0x3f7d1cdd,0x3f7ac516,0x3f77beb7,0x3f7b14be,0x3f77f110,0x3f740bdd,0x3f6f6830,0x3f74fa0b,0x3f703b37,0x3f6aab7b,0x3f644fac
.long 0x3f6c835e,0x3f660f88,0x3f5ebe05,0x3f5695e5,0x3f61c598,0x3f5988ad,0x3f5064af,0x3f466354,0x3f54db31,0x3f4ac77f,0x3f3fc767,0x3f33e7bc,0x3f45e403,0x3f39f2ac,0x3f2d1469,0x3f1f599f
.long 0x3f3504f3,0x3f273656,0x3f187fc0,0x3f08f59b,0x3f226799,0x3f12c39a,0x3f0242b1,0x3ee1fb6a,0x3f0e39da,0x3ef9a02d,0x3ed53641,0x3eaf713a,0x3ef15aea,0x3ecb2aae,0x3ea395c5,0x3e75c35a
.long 0x3ec3ef15,0x3e9aa086,0x3e605c13,0x3e09cf86,0x3e94a031,0x3e5101f1,0x3dee3876,0x3ce22a7a,0x3e47c5c2,0x3dd53db9,0x3c490e90,0xbda3308c,0x3dc8bd36,0x3b490fc6,0xbdbc3ac3,0xbe3e853e
.long 0x3f7b14be,0x3f7853f8,0x3f74fa0b,0x3f710908,0x3f740bdd,0x3f6faf1b,0x3f6aab7b,0x3f650479,0x3f6a09a7,0x3f63f473,0x3f5d2d53,0x3f55b993,0x3f5d2d53,0x3f554aa4,0x3f4cae79,0x3f436051
.long 0x3f4d9f02,0x3f43e200,0x3f396842,0x3f2e3bde,0x3f3b8f3b,0x3f2ff3e6,0x3f239da9,0x3f16999f,0x3f273656,0x3f19c200,0x3f0b9a6b,0x3ef9a02d,0x3f10d3cd,0x3f019573,0x3ee363fa,0x3ec27b55
.long 0x3ef15aea,0x3ecf7bca,0x3eac7cd4,0x3e888e93,0x3ebe1d4a,0x3e9920fe,0x3e667c66,0x3e195be0,0x3e888e93,0x3e419b37,0x3de1bc2e,0x3cfb49ba,0x3e22abb6,0x3d9cecf9,0xbbc90f88,0xbdb5f8da
.long 0x3d48fb30,0xbd16c32c,0xbdfab273,0xbe541501,0xbd7b2b74,0xbe195be0,0xbe72b651,0xbea5129f,0xbe2f10a2,0xbe8586ce,0xbeb263ef,0xbeddbe79,0xbe8e9a22,0xbebca7af,0xbee900b7,0xbf099f4e
.long 0x3f6c835e,0x3f676bd8,0x3f61c598,0x3f5b941a,0x3f5ebe05,0x3f57dc7f,0x3f5064af,0x3f485bca,0x3f4d9f02,0x3f44e3f5,0x3f3b8f3b,0x3f31a81d,0x3f396842,0x3f2ecef7,0x3f239da9,0x3f17de12
.long 0x3f226799,0x3f15f6d9,0x3f08f59b,0x3ef6e0cb,0x3f08f59b,0x3ef58035,0x3ed8106b,0x3eb9bb1e,0x3edae880,0x3ebb31a0,0x3e9aa086,0x3e72b651,0x3ea09ae5,0x3e7bdba4,0x3e354098,0x3ddb7d37
.long 0x3e47c5c2,0x3dfab273,0x3d48fb30,0xbcc90ab0,0x3d96a905,0xbb490fc6,0xbda3308c,0xbe1f917b,0xbd48fb30,0xbe039502,0xbe541501,0xbe919ddd,0xbe2f10a2,0xbe80f8c0,0xbea986c4,0xbed0eb2a
.long 0xbe94a031,0xbebe1d4a,0xbee63375,0xbf064b82,0xbecf7bca,0xbef840c8,0xbf0f8784,0xbf21cbfb,0xbf039c3d,0xbf173c07,0xbf299415,0xbf3a7ca4,0xbf1d7fd1,0xbf2ff3e6,0xbf40d0da,0xbf4fefa8
.long 0x3f54db31,0x3f4d9f02,0x3f45e403,0x3f3daef9,0x3f3fc767,0x3f36ad7f,0x3f2d1469,0x3f2302d3,0x3f273656,0x3f1c420c,0x3f10d3cd,0x3f04f484,0x3f0b9a6b,0x3efdbabb,0x3ee363fa,0x3ec8477c
.long 0x3edae880,0x3ebe1d4a,0x3ea09ae5,0x3e827dc0,0x3e9aa086,0x3e75c35a,0x3e354098,0x3de7fa9a,0x3e2f10a2,0x3dd53db9,0x3d16c32c,0xbcfb49ba,0x3d16c32c,0xbd0a342f,0xbdd53db9,0xbe3228d4
.long 0xbdc8bd36,0xbe2f10a2,0xbe78cfcc,0xbea09ae5,0xbe6c9a7f,0xbe9c1faf,0xbec1071e,0xbee4cbfe,0xbeb8442a,0xbeddbe79,0xbf00e7e4,0xbf121eb0,0xbef6e0cb,0xbf0d9281,0xbf1ebc12,0xbf2ecef7
.long 0xbf187fc0,0xbf299415,0xbf396842,0xbf47de65,0xbf32c8c9,0xbf425b89,0xbf5064af,0xbf5cc7d1,0xbf49d112,0xbf577026,0xbf633c5a,0xbf6d1c1d,0xbf5d2d53,0xbf686b39,0xbf718f57,0xbf788486
.long 0x3f800000,0x3f800000,0x3f800000,0x3f800000,0x3f7d3aac,0x3f7d1cdd,0x3f7cfe73,0x3f7cdf6c,0x3f74fa0b,0x3f748422,0x3f740bdd,0x3f73913f,0x3f676bd8,0x3f666771,0x3f655e0b,0x3f644fac
.long 0x3f54db31,0x3f531849,0x3f514d3d,0x3f4f7a1f,0x3f3daef9,0x3f3b0629,0x3f385216,0x3f3592e7,0x3f226799,0x3f1ebc12,0x3f1b02c6,0x3f173c07,0x3f039c3d,0x3efdbabb,0x3ef41f07,0x3eea6681
.long 0x3ec3ef15,0x3eb8442a,0x3eac7cd4,0x3ea09ae5,0x3e78cfcc,0x3e5d4b1a,0x3e419b37,0x3e25c58c,0x3dc8bd36,0x3d8a200a,0x3d16c32c,0x3bc90f88,0xbd48fb30,0xbda973ba,0xbdee3876,0xbe195be0
.long 0xbe47c5c2,0xbe6c9a7f,0xbe888e93,0xbe9aa086,0xbeac7cd4,0xbebf926f,0xbed25a09,0xbee4cbfe,0xbef15aea,0xbf0242b1,0xbf0b9a6b,0xbf14b039,0xbf187fc0,0xbf21cbfb,0xbf2ac082,0xbf33587a
.long 0x3f800000,0x3f800000,0x3f800000,0x3f800000,0x3f7cbfc9,0x3f7c9f8a,0x3f7c7eb0,0x3f7c5d3a,0x3f731447,0x3f7294f8,0x3f721352,0x3f718f57,0x3f633c5a,0x3f62241a,0x3f6106f2,0x3f5fe4e9
.long 0x3f4d9f02,0x3f4bbbf8,0x3f49d112,0x3f47de65,0x3f32c8c9,0x3f2ff3e6,0x3f2d1469,0x3f2a2a80,0x3f13682a,0x3f0f8784,0x3f0b9a6b,0x3f07a136,0x3ee0924f,0x3ed6a399,0x3ecc9b8b,0x3ec27b55
.long 0x3e94a031,0x3e888e93,0x3e78cfcc,0x3e605c13,0x3e09cf86,0x3ddb7d37,0x3da3308c,0x3d55880e,0xbcc90ab0,0xbd621469,0xbdafb680,0xbdee3876,0xbe3b6ecf,0xbe5d4b1a,0xbe7ee6e1,0xbe901c2c
.long 0xbeac7cd4,0xbebe1d4a,0xbecf7bca,0xbee0924f,0xbef6e0cb,0xbf044889,0xbf0cead0,0xbf1553b7,0xbf1d7fd1,0xbf26050a,0xbf2e3bde,0xbf36206c,0xbf3b8f3b,0xbf436051,0xbf4ac77f,0xbf51c0c2
.long 0x3f800000,0x3f800000,0x3f800000,0x3f800000,0x3f7c3b28,0x3f7c187a,0x3f7bf531,0x3f7bd14d,0x3f710908,0x3f708066,0x3f6ff573,0x3f6f6830,0x3f5ebe05,0x3f5d924d,0x3f5c61c7,0x3f5b2c79
.long 0x3f45e403,0x3f43e200,0x3f41d870,0x3f3fc767,0x3f273656,0x3f24381a,0x3f212ff9,0x3f1e1e22,0x3f039c3d,0x3eff17b2,0x3ef6e0cb,0x3eee9479,0x3eb8442a,0x3eadf73c,0x3ea395c5,0x3e9920fe
.long 0x3e47c5c2,0x3e2f10a2,0x3e164083,0x3dfab273,0x3cc90ab0,0xbb490fc6,0xbcfb49ba,0xbd6ea038,0xbe164083,0xbe354098,0xbe541501,0xbe72b651,0xbea09ae5,0xbeb0eacb,0xbec1071e,0xbed0eb2a
.long 0xbef15aea,0xbf00e7e4,0xbf08f59b,0xbf10d3cd,0xbf1d7fd1,0xbf256bcb,0xbf2d1469,0xbf34768f,0xbf3daef9,0xbf44e3f5,0xbf4bbbf8,0xbf5233c6,0xbf584853,0xbf5e5aa6,0xbf63f473,0xbf6912ae
.long 0x3f800000,0x3f800000,0x3f800000,0x3f800000,0x3f7baccd,0x3f7b87b2,0x3f7b61fc,0x3f7b3bab,0x3f6ed89e,0x3f6e46be,0x3f6db293,0x3f6d1c1d,0x3f59f26a,0x3f58b3a1,0x3f577026,0x3f5627fe
.long 0x3f3daef9,0x3f3b8f3b,0x3f396842,0x3f373a23,0x3f1b02c6,0x3f17de12,0x3f14b039,0x3f11796b,0x3ee63375,0x3eddbe79,0x3ed53641,0x3ecc9b8b,0x3e8e9a22,0x3e840270,0x3e72b651,0x3e5d4b1a
.long 0x3dc8bd36,0x3d96a905,0x3d48fb30,0x3cc90ab0,0xbdafb680,0xbde7fa9a,0xbe1008b7,0xbe2bf804,0xbe888e93,0xbe97a117,0xbea68f12,0xbeb554ec,0xbee0924f,0xbeeff7fb,0xbeff17b2,0xbf06f686
.long 0xbf187fc0,0xbf1ff6cb,0xbf273656,0xbf2e3bde,0xbf3b8f3b,0xbf425b89,0xbf48d8b3,0xbf4f0417,0xbf584853,0xbf5df6be,0xbf633c5a,0xbf6816a8,0xbf6db293,0xbf71d19f,0xbf756d97,0xbf788486
.long 0x0,0x0,0x0,0x0,0x3e164083,0x3e195be0,0x3e1c76de,0x3e1f917b,0x3e94a031,0x3e97a117,0x3e9aa086,0x3e9d9e78,0x3edae880,0x3edf28a9,0x3ee363fa,0x3ee79a5d
.long 0x3f0e39da,0x3f10d3cd,0x3f13682a,0x3f15f6d9,0x3f2beb4a,0x3f2ecef7,0x3f31a81d,0x3f34768f,0x3f45e403,0x3f48d8b3,0x3f4bbbf8,0x3f4e8d90,0x3f5b941a,0x3f5e5aa6,0x3f6106f2,0x3f6398ac
.long 0x3f6c835e,0x3f6ed89e,0x3f710908,0x3f731447,0x3f7853f8,0x3f79f35e,0x3f7b61fc,0x3f7c9f8a,0x3f7ec46d,0x3f7f6ac7,0x3f7fd397,0x3f7ffec4,0x3f7fb10f,0x3f7f1f49,0x3f7e4323,0x3f7d1cdd
.long 0x3f7b14be,0x3f791298,0x3f76ba07,0x3f740bdd,0x3f710908,0x3f6d67a1,0x3f696591,0x3f650479,0x3f61c598,0x3f5c61c7,0x3f5695e5,0x3f5064af,0x3f4d9f02,0x3f466354,0x3f3ebc1b,0x3f36ad7f
.long 0x0,0x0,0x0,0x0,0x3e22abb6,0x3e25c58c,0x3e28defc,0x3e2bf804,0x3ea09ae5,0x3ea395c5,0x3ea68f12,0x3ea986c4,0x3eebcbbb,0x3eeff7fb,0x3ef41f07,0x3ef840c8
.long 0x3f187fc0,0x3f1b02c6,0x3f1d7fd1,0x3f1ff6cb,0x3f373a23,0x3f39f2ac,0x3f3ca003,0x3f3f41fc,0x3f514d3d,0x3f53fac3,0x3f5695e5,0x3f591e6a,0x3f660f88,0x3f686b39,0x3f6aab7b,0x3f6cd007
.long 0x3f74fa0b,0x3f76ba07,0x3f7853f8,0x3f79c79d,0x3f7dabcc,0x3f7e868b,0x3f7f2f9d,0x3f7fa6e3,0x3f7fec43,0x3f7f9c18,0x3f7f0e58,0x3f7e4323,0x3f7baccd,0x3f79f35e,0x3f77f110,0x3f75a67b
.long 0x3f710908,0x3f6db293,0x3f6a09a7,0x3f660f88,0x3f604621,0x3f5b2c79,0x3f55b993,0x3f4fefa8,0x3f49d112,0x3f42de29,0x3f3b8f3b,0x3f33e7bc,0x3f2e3bde,0x3f256bcb,0x3f1c420c,0x3f12c39a
.long 0x0,0x0,0x0,0x0,0x3e2f10a2,0x3e3228d4,0x3e354098,0x3e3857ec,0x3eac7cd4,0x3eaf713a,0x3eb263ef,0x3eb554ec,0x3efc5d27,0x3f003a06,0x3f0242b1,0x3f044889
.long 0x3f226799,0x3f24d225,0x3f273656,0x3f299415,0x3f41d870,0x3f446337,0x3f46e22a,0x3f495521,0x3f5b941a,0x3f5df6be,0x3f604621,0x3f628210,0x3f6ed89e,0x3f70c501,0x3f7294f8,0x3f74484b
.long 0x3f7b14be,0x3f7c3b28,0x3f7d3aac,0x3f7e1324,0x3f7fec43,0x3f7fffb1,0x3f7fe129,0x3f7f90b1,0x3f7d3aac,0x3f7bf531,0x3f7a7302,0x3f78b47b,0x3f731447,0x3f703b37,0x3f6d1c1d,0x3f69b7e4
.long 0x3f61c598,0x3f5d2d53,0x3f584853,0x3f531849,0x3f49d112,0x3f436051,0x3f3ca003,0x3f3592e7,0x3f2beb4a,0x3f239da9,0x3f1b02c6,0x3f121eb0,0x3f08f59b,0x3efdbabb,0x3ee900b7,0x3ed3c867
.long 0x0,0x0,0x0,0x0,0x3e3b6ecf,0x3e3e853e,0x3e419b37,0x3e44b0b9,0x3eb8442a,0x3ebb31a0,0x3ebe1d4a,0x3ec1071e,0x3f064b82,0x3f084b92,0x3f0a48ad,0x3f0c42c9
.long 0x3f2beb4a,0x3f2e3bde,0x3f3085bb,0x3f32c8c9,0x3f4bbbf8,0x3f4e1689,0x3f5064af,0x3f52a649,0x3f64aa59,0x3f66becc,0x3f68bf3c,0x3f6aab7b,0x3f75dec6,0x3f77583a,0x3f78b47b,0x3f79f35e
.long 0x3f7ec46d,0x3f7f4e6d,0x3f7fb10f,0x3f7fec43,0x3f7f0e58,0x3f7e5a38,0x3f7d7474,0x3f7c5d3a,0x3f76ba07,0x3f748422,0x3f721352,0x3f6f6830,0x3f660f88,0x3f62241a,0x3f5df6be,0x3f5988ad
.long 0x3f4d9f02,0x3f47de65,0x3f41d870,0x3f3b8f3b,0x3f2e3bde,0x3f269de3,0x3f1ebc12,0x3f16999f,0x3f08f59b,0x3eff17b2,0x3eebcbbb,0x3ed8106b,0x3ebe1d4a,0x3ea80b1f,0x3e919ddd,0x3e75c35a
.long 0xbf3504f3,0xbf3daef9,0xbf45e403,0xbf4d9f02,0xbf4d9f02,0xbf554aa4,0xbf5c61c7,0xbf62df7b,0xbf61c598,0xbf6816a8,0xbf6db293,0xbf7294f8,0xbf710908,0xbf75a67b,0xbf796e4e,0xbf7c5d3a
.long 0xbf7b14be,0xbf7dabcc,0xbf7f4e6d,0xbf7ffb11,0xbf7fb10f,0xbf7ff84a,0xbf7f2f9d,0xbf7d57de,0xbf7ec46d,0xbf7c7eb0,0xbf791298,0xbf748422,0xbf7853f8,0xbf73530e,0xbf6d1c1d,0xbf65b710
.long 0xbf6c835e,0xbf64aa59,0xbf5b941a,0xbf514d3d,0xbf5b941a,0xbf50d937,0xbf44e3f5,0xbf37c655,0xbf45e403,0xbf385216,0xbf299415,0xbf19c200,0xbf2beb4a,0xbf1ba299,0xbf0a48ad,0xbeeff7fb
.long 0xbf0e39da,0xbef6e0cb,0xbecf7bca,0xbea68f12,0xbedae880,0xbeb0eacb,0xbe8586ce,0xbe3228d4,0xbe94a031,0xbe4dee60,0xbde1bc2e,0xbc96c9b6,0xbe164083,0xbd55880e,0x3d2fe007,0x3e0cec4a
.long 0xbf54db31,0xbf5b941a,0xbf61c598,0xbf676bd8,0xbf68bf3c,0xbf6dfcf2,0xbf7294f8,0xbf76841b,0xbf76ba07,0xbf7a1e84,0xbf7cbfc9,0xbf7e9bc9,0xbf7e70b0,0xbf7fa6e3,0xbf7ffec4,0xbf7f7808
.long 0xbf7fb10f,0xbf7e70b0,0xbf7c3b28,0xbf791298,0xbf7a7302,0xbf76841b,0xbf718f57,0xbf6b99fb,0xbf6ed89e,0xbf6816a8,0xbf604621,0xbf577026,0xbf5d2d53,0xbf5389c7,0xbf48d8b3,0xbf3d27b8
.long 0xbf45e403,0xbf396842,0xbf2beb4a,0xbf1d7fd1,0xbf299415,0xbf1a6293,0xbf0a48ad,0xbef2bd43,0xbf08f59b,0xbeee9479,0xbec9b953,0xbea395c5,0xbec9b953,0xbea21887,0xbe72b651,0xbe1f917b
.long 0xbe78cfcc,0xbe22abb6,0xbd96a905,0x3c490e90,0xbdafb680,0x3b490fc6,0x3dbc3ac3,0x3e3857ec,0x3d96a905,0x3e28defc,0x3e827dc0,0x3eaf713a,0x3e6c9a7f,0x3ea5129f,0x3ed25a09,0x3efdbabb
.long 0xbf6c835e,0xbf710908,0xbf74fa0b,0xbf7853f8,0xbf79c79d,0xbf7c5d3a,0xbf7e4323,0xbf7f7808,0xbf7fb10f,0xbf7ffec4,0xbf7f84ab,0xbf7e4323,0xbf7e1324,0xbf7bd14d,0xbf78b47b,0xbf74bf62
.long 0xbf74fa0b,0xbf6ff573,0xbf6a09a7,0xbf633c5a,0xbf64aa59,0xbf5cc7d1,0xbf53fac3,0xbf4a4c87,0xbf4d9f02,0xbf42de29,0xbf373a23,0xbf2ac082,0xbf3085bb,0xbf2302d3,0xbf14b039,0xbf05a02c
.long 0xbf0e39da,0xbefc5d27,0xbedae880,0xbeb8442a,0xbecf7bca,0xbeab0201,0xbe8586ce,0xbe3e853e,0xbe78cfcc,0xbe28defc,0xbdafb680,0xbbc90f88,0xbd96a905,0x3c16cb58,0x3dbc3ac3,0x3e3228d4
.long 0x3dc8bd36,0x3e3b6ecf,0x3e888e93,0x3eb263ef,0x3e888e93,0x3eb3dca5,0x3eddbe79,0x3f02ef9f,0x3edae880,0x3f0242b1,0x3f15f6d9,0x3f286605,0x3f13682a,0x3f269de3,0x3f385216,0x3f485bca
.long 0xbf7b14be,0xbf7d3aac,0xbf7ec46d,0xbf7fb10f,0xbf7ffb11,0xbf7fcbe2,0xbf7eea9d,0xbf7d57de,0xbf7c3b28,0xbf796e4e,0xbf75dec6,0xbf718f57,0xbf6ff573,0xbf6a5ad9,0xbf63f473,0xbf5cc7d1
.long 0xbf5b941a,0xbf531849,0xbf49d112,0xbf3fc767,0xbf3fc767,0xbf34768f,0xbf286605,0xbf1ba299,0xbf1d7fd1,0xbf0f8784,0xbf00e7e4,0xbee363fa,0xbeebcbbb,0xbecb2aae,0xbea986c4,0xbe870ada
.long 0xbe94a031,0xbe605c13,0xbe164083,0xbd96a905,0xbde1bc2e,0xbd0a342f,0x3d2fe007,0x3df475c0,0x3d96a905,0x3e1c76de,0x3e6c9a7f,0x3e9d9e78,0x3e827dc0,0x3eab0201,0x3ed25a09,0x3ef840c8
.long 0x3edae880,0x3f00e7e4,0x3f13682a,0x3f24d225,0x3f15f6d9,0x3f27ce61,0x3f385216,0x3f476085,0x3f396842,0x3f48d8b3,0x3f5695e5,0x3f628210,0x3f5695e5,0x3f62df7b,0x3f6d1c1d,0x3f75341d
.long 0x3f3504f3,0x3f2beb4a,0x3f226799,0x3f187fc0,0x3f187fc0,0x3f0d9281,0x3f0242b1,0x3eed3063,0x3ef15aea,0x3ed8106b,0x3ebe1d4a,0x3ea395c5,0x3eac7cd4,0x3e901c2c,0x3e667c66,0x3e2bf804
.long 0x3e47c5c2,0x3e09cf86,0x3d96a905,0x3c490e90,0x3d48fb30,0xbc7b514b,0xbda3308c,0xbe1324ca,0xbdc8bd36,0xbe28defc,0xbe6c9a7f,0xbe97a117,0xbe78cfcc,0xbe9f1cdf,0xbec1071e,0xbee1fb6a
.long 0xbec3ef15,0xbee63375,0xbf039c3d,0xbf13682a,0xbf039c3d,0xbf140c5f,0xbf239da9,0xbf3238aa,0xbf226799,0xbf31a81d,0xbf3fc767,0xbf4cae79,0xbf3daef9,0xbf4b41fa,0xbf577026,0xbf62241a
.long 0xbf54db31,0xbf604621,0xbf6a09a7,0xbf721352,0xbf676bd8,0xbf703b37,0xbf772417,0xbf7c187a,0xbf74fa0b,0xbf7ac516,0xbf7e70b0,0xbf7ff4e6,0xbf7d3aac,0xbf7fa6e3,0xbf7fc38f,0xbf7d906e
.long 0x3f0e39da,0x3f039c3d,0x3ef15aea,0x3edae880,0x3ed53641,0x3ebca7af,0x3ea395c5,0x3e8a11f7,0x3e888e93,0x3e5a3997,0x3e22abb6,0x3dd53db9,0x3de1bc2e,0x3d55880e,0xbbc90f88,0xbd83db0a
.long 0xbd48fb30,0xbde1bc2e,0xbe2f10a2,0xbe6c9a7f,0xbe541501,0xbe8a11f7,0xbea986c4,0xbec8477c,0xbeb8442a,0xbed8106b,0xbef6e0cb,0xbf0a48ad,0xbf00e7e4,0xbf102dd5,0xbf1ebc12,0xbf2c800f
.long 0xbf226799,0xbf3085bb,0xbf3daef9,0xbf49d112,0xbf3fc767,0xbf4c3578,0xbf577026,0xbf61668a,0xbf584853,0xbf628210,0xbf6b4b0c,0xbf7294f8,0xbf6b4b0c,0xbf72d4eb,0xbf78b47b,0xbf7cdf6c
.long 0xbf7853f8,0xbf7cbfc9,0xbf7f4e6d,0xbf7ffb11,0xbf7f0e58,0xbf7fffb1,0xbf7eea9d,0xbf7bd14d,0xbf7f4e6d,0xbf7c7eb0,0xbf778bc5,0xbf708066,0xbf791298,0xbf725470,0xbf696591,0xbf5e5aa6
.long 0x3ec3ef15,0x3eac7cd4,0x3e94a031,0x3e78cfcc,0x3e605c13,0x3e2bf804,0x3dee3876,0x3d83db0a,0x3d48fb30,0xbbc90f88,0xbd7b2b74,0xbdee3876,0xbdfab273,0xbe3857ec,0xbe72b651,0xbe9620d2
.long 0xbe94a031,0xbeb263ef,0xbecf7bca,0xbeebcbbb,0xbee63375,0xbf019573,0xbf0f8784,0xbf1ce11f,0xbf187fc0,0xbf26050a,0xbf32c8c9,0xbf3ebc1b,0xbf396842,0xbf456439,0xbf5064af,0xbf5a5ba0
.long 0xbf54db31,0xbf5ebe05,0xbf676bd8,0xbf6ed89e,0xbf6a09a7,0xbf714c7a,0xbf772417,0xbf7b87b2,0xbf7853f8,0xbf7c7eb0,0xbf7f0e58,0xbf7ffec4,0xbf7f4e6d,0xbf7ffd39,0xbf7eea9d,0xbf7c187a
.long 0xbf7ec46d,0xbf7baccd,0xbf76ba07,0xbf6ff573,0xbf76ba07,0xbf6faf1b,0xbf66becc,0xbf5bfb34,0xbf676bd8,0xbf5c61c7,0xbf4f7a1f,0xbf40d0da,0xbf514d3d,0xbf425b89,0xbf31a81d,0xbf1f599f
.long 0x3e47c5c2,0x3e164083,0x3dc8bd36,0x3d48fb30,0x3c490e90,0xbd2351cb,0xbdbc3ac3,0xbe1324ca,0xbe2f10a2,0xbe667c66,0xbe8e9a22,0xbea986c4,0xbeb263ef,0xbece0bea,0xbee900b7,0xbf019573
.long 0xbf039c3d,0xbf10d3cd,0xbf1d7fd1,0xbf299415,0xbf299415,0xbf3592e7,0xbf40d0da,0xbf4b41fa,0xbf49d112,0xbf53fac3,0xbf5d2d53,0xbf655e0b,0xbf633c5a,0xbf6afb8c,0xbf718f57,0xbf76ef5b
.long 0xbf74fa0b,0xbf79c79d,0xbf7d3aac,0xbf7f4e6d,0xbf7e70b0,0xbf7fdaaf,0xbf7fc38f,0xbf7e2b72,0xbf7f4e6d,0xbf7cfe73,0xbf791298,0xbf73913f,0xbf778bc5,0xbf714c7a,0xbf696591,0xbf5fe4e9
.long 0xbf676bd8,0xbf5d2d53,0xbf514d3d,0xbf43e200,0xbf4f7a1f,0xbf4154e1,0xbf31a81d,0xbf209393,0xbf3085bb,0xbf1ebc12,0xbf0b9a6b,0xbeee9479,0xbf0b9a6b,0xbeed3063,0xbec1071e,0xbe931f35
```
